```python
import torch

def _softmax(x, axis=-1):
    return torch.softmax(x, dim=axis)
def _gelu(x):
    return torch.nn.functional.gelu(x, approximate="tanh")
def _silu(x):
    return torch.nn.functional.silu(x)
def _sigmoid(x):
    return torch.sigmoid(x)
def _layernorm(x, axis=-1, eps=1e-5):
    m = x.mean(dim=axis, keepdim=True)
    v = x.var(dim=axis, keepdim=True, unbiased=False)
    return (x - m) / torch.sqrt(v + eps)
def _scatter_add(tgt, idx, src, axis=0):
    return tgt.clone().index_add_(axis, idx, src)
def _segment_sum(src, seg, n):
    out = torch.zeros((n,) + src.shape[1:], dtype=src.dtype)
    return out.index_add_(0, seg, src)
def _pad(x, pw):
    flat = tuple(v for pair in reversed(pw) for v in pair)
    return torch.nn.functional.pad(x, flat)

kernel_name = 'gated_mix__compressed_kv_cla__dense_activation_mish__prompt'

def setup_inputs():

    _w = (lambda a: (lambda t: t.to(torch.bfloat16) if t.is_floating_point() else t)(torch.as_tensor(a)))
    def _A_setup():
        B, H, Sq, Sk, D, M = 1, 32, 2048, 2048, 128, 640
        Dc = 4 * D
        return {
            "x": _w((lambda *s: torch.randn(*s, dtype=torch.bfloat16) * 0.05)(B, Sq, M)),
            "c_kv": _w((lambda *s: torch.randn(*s, dtype=torch.bfloat16) * 0.4)(B, Sk, Dc)),
            "w_q": _w((lambda *s: torch.randn(*s, dtype=torch.bfloat16) * 6.4)(M, H, D) * (M ** -0.5)),
            "w_uk": _w((lambda *s: torch.randn(*s, dtype=torch.bfloat16) * 6.4)(Dc, H, D) * (Dc ** -0.5)),
            "w_uv": _w((lambda *s: torch.randn(*s, dtype=torch.bfloat16) * 0.4)(Dc, H, D) * (Dc ** -0.5)),
            "w_o": _w((lambda *s: torch.randn(*s, dtype=torch.bfloat16) * 0.4)(H, D, M) * ((H * D) ** -0.5)),
        }
    _A_in = _A_setup()

    def _B_setup():
        B, S, D, F = 1, 2048, 640, 1728
        return {
            "x": _w((lambda *s: torch.randn(*s, dtype=torch.bfloat16) * 0.05)(B, S, D)),
            "w1": _w((lambda *s: torch.randn(*s, dtype=torch.bfloat16) * 12.8)(D, F) * (D ** -0.5)),
            "b1": _w((lambda *s: torch.randn(*s, dtype=torch.bfloat16) * 0.2)(F)),
            "w2": _w((lambda *s: torch.randn(*s, dtype=torch.bfloat16) * 0.05)(F, D) * (F ** -0.5)),
        }
    _B_in = _B_setup()

    return {
        "A_x": _A_in["x"],
        "A_c_kv": _A_in["c_kv"],
        "A_w_q": _A_in["w_q"],
        "A_w_uk": _A_in["w_uk"],
        "A_w_uv": _A_in["w_uv"],
        "A_w_o": _A_in["w_o"],
        "B_x": _B_in["x"],
        "B_w1": _B_in["w1"],
        "B_b1": _B_in["b1"],
        "B_w2": _B_in["w2"],
        "gate_w": _w((lambda *s: torch.randn(*s, dtype=torch.bfloat16) * 0.05)(640) * 16.0),
    }

def reference(A_x, A_c_kv, A_w_q, A_w_uk, A_w_uv, A_w_o, B_x, B_w1, B_b1, B_w2, gate_w):
    def _A_ref(x, c_kv, w_q, w_uk, w_uv, w_o):
        B, Sq, M = x.shape[0], x.shape[1], x.shape[2]
        Sk = c_kv.shape[1]
        H, D = w_q.shape[1], w_q.shape[2]
        q = torch.einsum("bqm,mhd->bhqd", x, w_q)
        k = torch.einsum("bkc,chd->bhkd", c_kv, w_uk)
        v = torch.einsum("bkc,chd->bhkd", c_kv, w_uv)
        scores = torch.einsum("bhqd,bhkd->bhqk", q, k) * (D ** -0.5)
        off = Sk - Sq
        qi = torch.arange(Sq)[:, None]
        kj = torch.arange(Sk)[None, :]
        cmask = kj <= (qi + off)
        scores = torch.where(cmask[None, None], scores, -1e9)
        p = _softmax(scores, axis=-1)
        ctx = torch.einsum("bhqk,bhkd->bhqd", p, v)
        return torch.einsum("bhqd,hdm->bqm", ctx, w_o)

    def _B_ref(x, w1, b1, w2):
        h = torch.einsum("bsd,df->bsf", x, w1) + b1
        sp = torch.log1p(torch.exp(-torch.abs(h))) + torch.where(h > 0, h, torch.zeros_like(h))
        act = h * torch.tanh(sp)
        return torch.einsum("bsf,fd->bsd", act, w2)

    x = A_x
    g = _sigmoid((x * gate_w).sum(-1, keepdims=True))
    a = _A_ref(x, A_c_kv, A_w_q, A_w_uk, A_w_uv, A_w_o)
    b = _B_ref(x, B_w1, B_b1, B_w2)
    return g * a + (1 - g) * b
```

```asm
; @launch grid=(256,1,1) block=(256,1,1) lds=163840
.amdgcn_target "amdgcn-amd-amdhsa--gfx950"
.text
.globl gated_mix__compressed_kv_cla__dense_activation_mish__prompt_kernel
.p2align 8
.type gated_mix__compressed_kv_cla__dense_activation_mish__prompt_kernel,@function
gated_mix__compressed_kv_cla__dense_activation_mish__prompt_kernel:
    s_cmp_ge_u32 s2, 256
    s_cbranch_scc0 L_go
    s_endpgm
L_go:
    s_load_dwordx16 s[64:79], s[0:1], 0
    s_load_dwordx8 s[80:87], s[0:1], 64
    s_load_dwordx4 s[88:91], s[0:1], 96
    v_lshrrev_b32 v14, 6, v0
    v_and_b32 v1, 63, v0
    v_readfirstlane_b32 s36, v14
    s_and_b32 s37, s2, 7
    s_lshl_b32 s37, s37, 2
    s_bfe_u32 s40, s2, 0x20003
    s_add_u32 s37, s37, s40
    s_lshr_b32 s38, s2, 5
    s_getpc_b64 s[32:33]
L_t1:
    s_lshr_b32 s40, s2, 3
    s_lshl_b32 s40, s40, 2
    s_add_u32 s40, s40, s36
    s_lshl_b32 s40, s40, 7
    v_and_b32 v252, 7, v1
    v_lshl_add_u32 v252, v252, 14, s40
    v_min_u32 v252, L_code_end-L_t1-4, v252
    v_mov_b32 v253, 0
    v_lshl_add_u64 v[252:253], v[252:253], 0, s[32:33]
    global_load_dword v252, v[252:253], off
    v_lshrrev_b32 v14, 3, v1
    v_mul_u32_u24 v14, 1024, v14
    v_lshrrev_b32 v15, 4, v1
    v_and_b32 v3, 7, v1
    v_xor_b32 v15, v15, v3
    v_lshl_add_u32 v2, v15, 4, v14
    v_xor_b32 v15, 4, v15
    v_lshl_add_u32 v3, v15, 4, v14
    v_add_u32 v3, 7168, v3
    v_bfe_u32 v14, v1, 2, 2
    v_lshlrev_b32 v14, 13, v14
    v_lshrrev_b32 v15, 4, v1
    v_lshl_add_u32 v14, v15, 6, v14
    s_and_b32 s41, s36, 1
    s_lshl_b32 s42, s41, 1
    v_and_b32 v31, 3, v1
    v_xor_b32 v31, s42, v31
    v_lshl_add_u32 v4, v31, 4, v14
    v_add_u32 v5, 31744, v4
    v_lshrrev_b32 v14, 5, v1
    v_and_b32 v14, 1, v14
    s_and_b32 s42, s37, 1
    v_xor_b32 v14, s42, v14
    v_lshl_add_u32 v250, v14, 8, v4
    v_lshl_add_u32 v251, v14, 8, v5
    s_lshr_b32 s40, s36, 1
    s_lshl_b32 s42, s40, 5
    s_lshl_b32 s43, s41, 3
    s_add_u32 s58, s42, s43
    s_lshl_b32 s57, s58, 13
    s_and_b32 s43, s37, 30
    s_lshl_b32 s43, s43, 8
    s_add_u32 s57, s57, s43
    s_lshl_b32 s60, s41, 14
    s_lshl_b32 s40, s40, 13
    s_add_u32 s60, s60, s40
    s_add_u32 s60, s60, 65536
    s_lshl_b32 s61, s36, 13
    s_add_u32 s56, s37, s38
    s_and_b32 s56, s56, 0
    s_lshl_b32 s40, s38, 2
    s_add_u32 s63, s40, s36
    s_lshl_b32 s44, s63, 15
    s_add_u32 s45, s44, 16384
    s_add_u32 s46, s44, 1048576
    s_add_u32 s47, s44, 1064960
    s_mov_b32 s6, 2097152
    s_mov_b32 s7, 0x00020000
    s_mov_b32 s10, 4194304
    s_mov_b32 s11, 0x00020000
    s_mov_b32 s14, 4196352
    s_mov_b32 s15, 0x00020000
    s_waitcnt lgkmcnt(0)
    s_mov_b64 s[4:5], s[66:67]
    s_mov_b64 s[8:9], s[70:71]
    s_sub_u32 s12, s72, 2048
    s_subb_u32 s13, s73, 0
    s_mul_i32 s40, s56, 524288
    s_add_u32 s40, s40, s57
    s_add_u32 m0, s60, 0
    s_nop 0
    buffer_load_dwordx4 v250, s[8:11], s40 offen nt lds
    buffer_load_dwordx4 v251, s[8:11], s40 offen offset:1024 nt lds
    s_xor_b32 s41, s40, 512
    buffer_load_dwordx4 v250, s[12:15], s41 offen offset:2048 nt lds
    buffer_load_dwordx4 v251, s[12:15], s41 offen offset:3072 nt lds
    s_add_u32 s40, s40, 131072
    s_add_u32 m0, s60, 4096
    s_nop 0
    buffer_load_dwordx4 v250, s[8:11], s40 offen nt lds
    buffer_load_dwordx4 v251, s[8:11], s40 offen offset:1024 nt lds
    s_xor_b32 s41, s40, 512
    buffer_load_dwordx4 v250, s[12:15], s41 offen offset:2048 nt lds
    buffer_load_dwordx4 v251, s[12:15], s41 offen offset:3072 nt lds
    s_lshl_b32 s42, s56, 7
    s_add_u32 m0, s61, 0
    s_add_u32 s40, s44, s42
    buffer_load_dwordx4 v2, s[4:7], s40 offen lds
    buffer_load_dwordx4 v3, s[4:7], s40 offen offset:1024 lds
    s_add_u32 m0, s61, 2048
    s_add_u32 s40, s45, s42
    buffer_load_dwordx4 v2, s[4:7], s40 offen lds
    buffer_load_dwordx4 v3, s[4:7], s40 offen offset:1024 lds
    s_add_u32 m0, s61, 4096
    s_add_u32 s40, s46, s42
    buffer_load_dwordx4 v2, s[4:7], s40 offen lds
    buffer_load_dwordx4 v3, s[4:7], s40 offen offset:1024 lds
    s_add_u32 m0, s61, 6144
    s_add_u32 s40, s47, s42
    buffer_load_dwordx4 v2, s[4:7], s40 offen lds
    buffer_load_dwordx4 v3, s[4:7], s40 offen offset:1024 lds
    s_add_u32 s56, s56, 1
    s_cmp_eq_u32 s56, 8
    s_cselect_b32 s56, 0, s56
    v_and_b32 v14, 15, v1
    v_lshlrev_b32 v15, 7, v14
    v_lshrrev_b32 v14, 1, v14
    v_lshrrev_b32 v27, 4, v1
    v_xor_b32 v14, v14, v27
    v_lshl_add_u32 v15, v14, 4, v15
    v_add_u32 v7, s61, v15
    v_xor_b32 v8, 64, v7
    v_bfe_u32 v14, v1, 2, 2
    v_lshlrev_b32 v14, 6, v14
    v_and_b32 v15, 3, v1
    v_lshl_add_u32 v14, v15, 3, v14
    v_bfe_u32 v15, v1, 4, 1
    v_lshl_add_u32 v14, v15, 5, v14
    v_lshl_add_u32 v28, v27, 10, v14
    v_lshl_add_u32 v14, v15, 14, v14
    v_lshrrev_b32 v15, 5, v1
    v_lshl_add_u32 v14, v15, 12, v14
    v_add_u32 v12, 65536, v14
    v_xor_b32 v13, 32, v12
    v_mov_b32 v9, v12
    v_mov_b32 v10, v13
    s_mul_i32 s40, s56, 524288
    s_add_u32 s40, s40, s57
    s_add_u32 m0, s60, 32768
    s_nop 0
    buffer_load_dwordx4 v250, s[8:11], s40 offen nt lds
    buffer_load_dwordx4 v251, s[8:11], s40 offen offset:1024 nt lds
    s_xor_b32 s41, s40, 512
    buffer_load_dwordx4 v250, s[12:15], s41 offen offset:2048 nt lds
    buffer_load_dwordx4 v251, s[12:15], s41 offen offset:3072 nt lds
    v_lshrrev_b32 v14, 4, v1
    v_min_u32 v14, 1, v14
    v_lshlrev_b32 v14, 30, v14
    v_lshl_add_u32 v14, v1, 7, v14
    s_lshl_b32 s0, s2, 2
    s_add_u32 s0, s0, s36
    s_lshl_b32 s0, s0, 11
    buffer_load_dword v254, v14, s[4:7], s0 offen
    s_mov_b64 exec, 0
    s_cmp_eq_u32 s36, 0
    s_cbranch_scc1 L_ws_518
    s_cmp_eq_u32 s36, 1
    s_cbranch_scc1 L_ws_1077
    s_cmp_eq_u32 s36, 2
    s_cbranch_scc1 L_ws_1631
    s_branch L_ws_2197
L_wr_a:
    s_mov_b64 exec, -1
    s_waitcnt vmcnt(5) lgkmcnt(0)
    s_barrier
    ds_read_b64_tr_b16 a[96:97], v9 offset:0
    ds_read_b64_tr_b16 a[98:99], v9 offset:1024
    ds_read_b64_tr_b16 a[100:101], v9 offset:8192
    ds_read_b64_tr_b16 a[102:103], v9 offset:9216
    ds_read_b128 a[32:35], v7 offset:0
    ds_read_b128 a[36:39], v8 offset:0
    ds_read_b128 a[40:43], v7 offset:2048
    ds_read_b128 a[44:47], v8 offset:2048
    ds_read_b128 a[48:51], v7 offset:4096
    ds_read_b128 a[52:55], v8 offset:4096
    ds_read_b128 a[56:59], v7 offset:6144
    ds_read_b128 a[60:63], v8 offset:6144
    s_waitcnt lgkmcnt(8)
    ds_read_b64_tr_b16 a[104:105], v10 offset:0
    ds_read_b64_tr_b16 a[106:107], v10 offset:1024
    ds_read_b64_tr_b16 a[108:109], v10 offset:8192
    ds_read_b64_tr_b16 a[110:111], v10 offset:9216
    s_waitcnt lgkmcnt(4)
    v_mfma_f32_16x16x32_bf16 v[32:35], a[96:99], a[32:35], 0
    s_add_u32 s40, s40, 131072
    ds_read_b64_tr_b16 a[112:113], v9 offset:256
    v_mfma_f32_16x16x32_bf16 v[32:35], a[100:103], a[36:39], v[32:35]
    s_add_u32 m0, s60, 36864
    ds_read_b64_tr_b16 a[114:115], v9 offset:1280
    v_mfma_f32_16x16x32_bf16 v[36:39], a[100:103], a[44:47], 0
    ds_read_b64_tr_b16 a[116:117], v9 offset:8448
    buffer_load_dwordx4 v250, s[8:11], s40 offen nt lds
    v_mfma_f32_16x16x32_bf16 v[36:39], a[96:99], a[40:43], v[36:39]
    s_mov_b32 s16, s64
    ds_read_b64_tr_b16 a[118:119], v9 offset:9472
    v_mfma_f32_16x16x32_bf16 v[40:43], a[96:99], a[48:51], 0
    s_mov_b32 s17, s65
    s_mov_b32 s18, 2621440
    s_mov_b32 s19, 0x00020000
    v_mfma_f32_16x16x32_bf16 v[40:43], a[100:103], a[52:55], v[40:43]
    buffer_load_dwordx4 v251, s[8:11], s40 offen offset:1024 nt lds
    v_mfma_f32_16x16x32_bf16 v[44:47], a[100:103], a[60:63], 0
    s_mov_b32 s20, s68
    s_mov_b32 s21, s69
    s_xor_b32 s41, s40, 512
    v_mfma_f32_16x16x32_bf16 v[44:47], a[96:99], a[56:59], v[44:47]
    s_waitcnt lgkmcnt(4)
    v_mfma_f32_16x16x32_bf16 v[48:51], a[104:107], a[32:35], 0
    ds_read_b64_tr_b16 a[120:121], v10 offset:256
    buffer_load_dwordx4 v250, s[12:15], s41 offen offset:2048 nt lds
    v_mfma_f32_16x16x32_bf16 v[48:51], a[108:111], a[36:39], v[48:51]
    ds_read_b64_tr_b16 a[122:123], v10 offset:1280
    v_mfma_f32_16x16x32_bf16 v[52:55], a[108:111], a[44:47], 0
    s_mov_b32 s22, 5242880
    ds_read_b64_tr_b16 a[124:125], v10 offset:8448
    v_mfma_f32_16x16x32_bf16 v[52:55], a[104:107], a[40:43], v[52:55]
    ds_read_b64_tr_b16 a[126:127], v10 offset:9472
    buffer_load_dwordx4 v251, s[12:15], s41 offen offset:3072 nt lds
    v_mfma_f32_16x16x32_bf16 v[56:59], a[104:107], a[48:51], 0
    s_lshl_b32 s42, s56, 7
    v_mfma_f32_16x16x32_bf16 v[56:59], a[108:111], a[52:55], v[56:59]
    s_mov_b32 s23, 0x00020000
    s_sub_u32 s24, s78, 2048
    s_subb_u32 s25, s79, 0
    v_mfma_f32_16x16x32_bf16 v[60:63], a[108:111], a[60:63], 0
    s_mov_b32 s26, 2213888
    s_mov_b32 s27, 0x00020000
    s_add_u32 m0, s61, 32768
    v_mfma_f32_16x16x32_bf16 v[60:63], a[104:107], a[56:59], v[60:63]
    s_mov_b32 s95, s37
    s_add_u32 s40, s44, s42
    s_waitcnt lgkmcnt(4)
    v_mfma_f32_16x16x32_bf16 v[64:67], a[112:115], a[32:35], 0
    ds_read_b64_tr_b16 a[96:97], v9 offset:512
    buffer_load_dwordx4 v2, s[4:7], s40 offen lds
    v_mfma_f32_16x16x32_bf16 v[64:67], a[116:119], a[36:39], v[64:67]
    s_lshl_b32 s94, s37, 1
    ds_read_b64_tr_b16 a[98:99], v9 offset:1536
    v_mfma_f32_16x16x32_bf16 v[68:71], a[116:119], a[44:47], 0
    s_add_u32 s0, s37, 26
    ds_read_b64_tr_b16 a[100:101], v9 offset:8704
    v_mfma_f32_16x16x32_bf16 v[68:71], a[112:115], a[40:43], v[68:71]
    ds_read_b64_tr_b16 a[102:103], v9 offset:9728
    v_mfma_f32_16x16x32_bf16 v[72:75], a[112:115], a[48:51], 0
    buffer_load_dwordx4 v3, s[4:7], s40 offen offset:1024 lds
    v_mfma_f32_16x16x32_bf16 v[72:75], a[116:119], a[52:55], v[72:75]
    s_cmp_ge_u32 s37, 20
    s_cselect_b32 s0, s0, s94
    s_add_u32 m0, s61, 34816
    v_mfma_f32_16x16x32_bf16 v[76:79], a[116:119], a[60:63], 0
    s_sub_u32 s94, s94, 8
    s_cmp_ge_u32 s37, 24
    s_cselect_b32 s94, s94, s0
    v_mfma_f32_16x16x32_bf16 v[76:79], a[112:115], a[56:59], v[76:79]
    s_add_u32 s40, s45, s42
    s_waitcnt lgkmcnt(4)
    v_mfma_f32_16x16x32_bf16 v[80:83], a[120:123], a[32:35], 0
    ds_read_b64_tr_b16 a[104:105], v10 offset:512
    v_mfma_f32_16x16x32_bf16 v[80:83], a[124:127], a[36:39], v[80:83]
    ds_read_b64_tr_b16 a[106:107], v10 offset:1536
    buffer_load_dwordx4 v2, s[4:7], s40 offen lds
    v_mfma_f32_16x16x32_bf16 v[84:87], a[124:127], a[44:47], 0
    ds_read_b64_tr_b16 a[108:109], v10 offset:8704
    v_mfma_f32_16x16x32_bf16 v[84:87], a[120:123], a[40:43], v[84:87]
    ds_read_b64_tr_b16 a[110:111], v10 offset:9728
    v_mfma_f32_16x16x32_bf16 v[88:91], a[120:123], a[48:51], 0
    s_add_u32 s0, s37, 22
    s_cmp_ge_u32 s37, 28
    s_cselect_b32 s94, s0, s94
    v_mfma_f32_16x16x32_bf16 v[88:91], a[124:127], a[52:55], v[88:91]
    buffer_load_dwordx4 v3, s[4:7], s40 offen offset:1024 lds
    v_mfma_f32_16x16x32_bf16 v[92:95], a[124:127], a[60:63], 0
    s_cmp_eq_u32 s37, 27
    s_cselect_b32 s94, 60, s94
    s_add_u32 m0, s61, 36864
    v_mfma_f32_16x16x32_bf16 v[92:95], a[120:123], a[56:59], v[92:95]
    v_cmp_gt_u32 vcc, 7, v1
    s_waitcnt lgkmcnt(4)
    v_mfma_f32_16x16x32_bf16 v[96:99], a[96:99], a[32:35], 0
    s_add_u32 s40, s46, s42
    ds_read_b64_tr_b16 a[112:113], v9 offset:768
    v_mfma_f32_16x16x32_bf16 v[96:99], a[100:103], a[36:39], v[96:99]
    ds_read_b64_tr_b16 a[114:115], v9 offset:1792
    buffer_load_dwordx4 v2, s[4:7], s40 offen lds
    v_mfma_f32_16x16x32_bf16 v[100:103], a[100:103], a[44:47], 0
    ds_read_b64_tr_b16 a[116:117], v9 offset:8960
    v_mfma_f32_16x16x32_bf16 v[100:103], a[96:99], a[40:43], v[100:103]
    ds_read_b64_tr_b16 a[118:119], v9 offset:9984
    v_mov_b32 v129, 0x40000000
    v_mfma_f32_16x16x32_bf16 v[104:107], a[96:99], a[48:51], 0
    buffer_load_dwordx4 v3, s[4:7], s40 offen offset:1024 lds
    v_mfma_f32_16x16x32_bf16 v[104:107], a[100:103], a[52:55], v[104:107]
    s_add_u32 m0, s61, 38912
    v_lshlrev_b32 v128, 7, v1
    v_cndmask_b32 v130, v129, v128, vcc
    v_mfma_f32_16x16x32_bf16 v[108:111], a[100:103], a[60:63], 0
    s_mul_i32 s0, s63, 7
    v_add_u32 v133, s0, v1
    v_mul_u32_u24 v128, 3456, v133
    v_mfma_f32_16x16x32_bf16 v[108:111], a[96:99], a[56:59], v[108:111]
    s_add_u32 s40, s47, s42
    s_waitcnt lgkmcnt(4)
    v_mfma_f32_16x16x32_bf16 v[112:115], a[104:107], a[32:35], 0
    ds_read_b64_tr_b16 a[120:121], v10 offset:768
    buffer_load_dwordx4 v2, s[4:7], s40 offen lds
    v_mfma_f32_16x16x32_bf16 v[112:115], a[108:111], a[36:39], v[112:115]
    ds_read_b64_tr_b16 a[122:123], v10 offset:1792
    v_cndmask_b32 v131, v129, v128, vcc
    v_mfma_f32_16x16x32_bf16 v[116:119], a[108:111], a[44:47], 0
    ds_read_b64_tr_b16 a[124:125], v10 offset:8960
    v_lshrrev_b32 v128, 1, v133
    v_mfma_f32_16x16x32_bf16 v[116:119], a[104:107], a[40:43], v[116:119]
    ds_read_b64_tr_b16 a[126:127], v10 offset:9984
    v_lshlrev_b32 v128, 13, v128
    v_mfma_f32_16x16x32_bf16 v[120:123], a[104:107], a[48:51], 0
    buffer_load_dwordx4 v3, s[4:7], s40 offen offset:1024 lds
    v_mfma_f32_16x16x32_bf16 v[120:123], a[108:111], a[52:55], v[120:123]
    v_and_b32 v132, 1, v133
    v_lshl_add_u32 v128, v132, 7, v128
    v_mfma_f32_16x16x32_bf16 v[124:127], a[108:111], a[60:63], 0
    s_add_u32 s56, s56, 1
    s_cmp_eq_u32 s56, 8
    s_cselect_b32 s56, 0, s56
    v_mfma_f32_16x16x32_bf16 v[124:127], a[104:107], a[56:59], v[124:127]
    s_mul_i32 s40, s56, 524288
    s_add_u32 s40, s40, s57
    s_waitcnt lgkmcnt(4)
    v_mfma_f32_16x16x32_bf16 a[0:3], a[112:115], a[32:35], 0
    ds_read_b64_tr_b16 a[96:97], v9 offset:2048
    v_mfma_f32_16x16x32_bf16 a[0:3], a[116:119], a[36:39], a[0:3]
    ds_read_b64_tr_b16 a[98:99], v9 offset:3072
    v_cndmask_b32 v132, v129, v128, vcc
    v_mfma_f32_16x16x32_bf16 a[4:7], a[116:119], a[44:47], 0
    s_add_u32 m0, s60, 65536
    ds_read_b64_tr_b16 a[100:101], v9 offset:10240
    v_mfma_f32_16x16x32_bf16 a[4:7], a[112:115], a[40:43], a[4:7]
    ds_read_b64_tr_b16 a[102:103], v9 offset:11264
    v_mfma_f32_16x16x32_bf16 a[8:11], a[112:115], a[48:51], 0
    buffer_load_dwordx4 v250, s[8:11], s40 offen nt lds
    v_mfma_f32_16x16x32_bf16 a[8:11], a[116:119], a[52:55], a[8:11]
    s_mov_b32 s28, s90
    s_mov_b32 s29, s91
    v_mfma_f32_16x16x32_bf16 a[12:15], a[116:119], a[60:63], 0
    buffer_load_dwordx4 v251, s[8:11], s40 offen offset:1024 nt lds
    v_mfma_f32_16x16x32_bf16 a[12:15], a[112:115], a[56:59], a[12:15]
    s_waitcnt lgkmcnt(4)
    v_mfma_f32_16x16x32_bf16 a[16:19], a[120:123], a[32:35], 0
    ds_read_b64_tr_b16 a[104:105], v10 offset:2048
    v_mfma_f32_16x16x32_bf16 a[16:19], a[124:127], a[36:39], a[16:19]
    ds_read_b64_tr_b16 a[106:107], v10 offset:3072
    v_mfma_f32_16x16x32_bf16 a[20:23], a[124:127], a[44:47], 0
    s_xor_b32 s41, s40, 512
    ds_read_b64_tr_b16 a[108:109], v10 offset:10240
    v_mfma_f32_16x16x32_bf16 a[20:23], a[120:123], a[40:43], a[20:23]
    s_mov_b32 s30, 268435456
    ds_read_b64_tr_b16 a[110:111], v10 offset:11264
    v_mfma_f32_16x16x32_bf16 a[24:27], a[120:123], a[48:51], 0
    buffer_load_dwordx4 v250, s[12:15], s41 offen offset:2048 nt lds
    v_mfma_f32_16x16x32_bf16 a[24:27], a[124:127], a[52:55], a[24:27]
    s_mov_b32 s31, 0x00020000
    s_mov_b32 s32, s84
    s_mov_b32 s33, s85
    v_mfma_f32_16x16x32_bf16 a[28:31], a[124:127], a[60:63], 0
    s_mov_b32 s34, 1280
    v_mfma_f32_16x16x32_bf16 a[28:31], a[120:123], a[56:59], a[28:31]
    s_mov_b32 s35, 0x00020000
    s_mov_b32 s68, s88
    s_waitcnt lgkmcnt(4)
    v_mfma_f32_16x16x32_bf16 a[128:131], a[32:35], a[96:99], 0
    s_mov_b32 s69, s89
    ds_read_b64_tr_b16 a[112:113], v9 offset:2304
    v_mfma_f32_16x16x32_bf16 a[128:131], a[36:39], a[100:103], a[128:131]
    s_mov_b32 s70, 32
    ds_read_b64_tr_b16 a[114:115], v9 offset:3328
    v_mfma_f32_16x16x32_bf16 a[132:135], a[44:47], a[100:103], 0
    ds_read_b64_tr_b16 a[116:117], v9 offset:10496
    v_mfma_f32_16x16x32_bf16 a[132:135], a[40:43], a[96:99], a[132:135]
    ds_read_b64_tr_b16 a[118:119], v9 offset:11520
    v_mfma_f32_16x16x32_bf16 a[136:139], a[48:51], a[96:99], 0
    buffer_load_dwordx4 v251, s[12:15], s41 offen offset:3072 nt lds
    v_mfma_f32_16x16x32_bf16 a[136:139], a[52:55], a[100:103], a[136:139]
    s_mov_b32 s71, 0x00020000
    v_mfma_f32_16x16x32_bf16 a[140:143], a[60:63], a[100:103], 0
    s_add_u32 s40, s40, 131072
    v_lshlrev_b32 v11, 4, v1
    v_mov_b32 v136, -1
    v_mfma_f32_16x16x32_bf16 a[140:143], a[56:59], a[96:99], a[140:143]
    v_mov_b32 v137, -1
    s_waitcnt lgkmcnt(4)
    v_mfma_f32_16x16x32_bf16 a[144:147], a[32:35], a[104:107], 0
    ds_read_b64_tr_b16 a[120:121], v10 offset:2304
    v_mfma_f32_16x16x32_bf16 a[144:147], a[36:39], a[108:111], a[144:147]
    ds_read_b64_tr_b16 a[122:123], v10 offset:3328
    v_mov_b32 v138, -1
    v_mfma_f32_16x16x32_bf16 a[148:151], a[44:47], a[108:111], 0
    s_add_u32 m0, s60, 69632
    ds_read_b64_tr_b16 a[124:125], v10 offset:10496
    v_mfma_f32_16x16x32_bf16 a[148:151], a[40:43], a[104:107], a[148:151]
    ds_read_b64_tr_b16 a[126:127], v10 offset:11520
    v_mov_b32 v139, -1
    v_mfma_f32_16x16x32_bf16 a[152:155], a[48:51], a[104:107], 0
    buffer_load_dwordx4 v250, s[8:11], s40 offen nt lds
    v_mfma_f32_16x16x32_bf16 a[152:155], a[52:55], a[108:111], a[152:155]
    s_lshl_b32 s0, s2, 2
    v_mfma_f32_16x16x32_bf16 a[156:159], a[60:63], a[108:111], 0
    buffer_load_dwordx4 v251, s[8:11], s40 offen offset:1024 nt lds
    v_mfma_f32_16x16x32_bf16 a[156:159], a[56:59], a[104:107], a[156:159]
    s_add_u32 s0, s0, s36
    s_lshl_b32 s0, s0, 10
    s_waitcnt lgkmcnt(4)
    v_mfma_f32_16x16x32_bf16 a[160:163], a[32:35], a[112:115], 0
    s_xor_b32 s41, s40, 512
    ds_read_b64_tr_b16 a[96:97], v9 offset:2560
    v_mfma_f32_16x16x32_bf16 a[160:163], a[36:39], a[116:119], a[160:163]
    s_add_u32 s0, s0, 83886080
    ds_read_b64_tr_b16 a[98:99], v9 offset:3584
    v_mfma_f32_16x16x32_bf16 a[164:167], a[44:47], a[116:119], 0
    ds_read_b64_tr_b16 a[100:101], v9 offset:10752
    v_mfma_f32_16x16x32_bf16 a[164:167], a[40:43], a[112:115], a[164:167]
    ds_read_b64_tr_b16 a[102:103], v9 offset:11776
    v_mfma_f32_16x16x32_bf16 a[168:171], a[48:51], a[112:115], 0
    buffer_load_dwordx4 v250, s[12:15], s41 offen offset:2048 nt lds
    v_mfma_f32_16x16x32_bf16 a[168:171], a[52:55], a[116:119], a[168:171]
    s_cmp_lt_u32 s2, 8
    s_cselect_b32 s0, s0, 0x40000000
    v_mfma_f32_16x16x32_bf16 a[172:175], a[60:63], a[116:119], 0
    buffer_store_dwordx4 v[136:139], v11, s[28:31], s0 offen sc1
    v_mfma_f32_16x16x32_bf16 a[172:175], a[56:59], a[112:115], a[172:175]
    s_waitcnt lgkmcnt(4)
    v_mfma_f32_16x16x32_bf16 a[176:179], a[32:35], a[120:123], 0
    ds_read_b64_tr_b16 a[104:105], v10 offset:2560
    v_mfma_f32_16x16x32_bf16 a[176:179], a[36:39], a[124:127], a[176:179]
    ds_read_b64_tr_b16 a[106:107], v10 offset:3584
    v_mfma_f32_16x16x32_bf16 a[180:183], a[44:47], a[124:127], 0
    s_lshl_b32 s0, s38, 7
    ds_read_b64_tr_b16 a[108:109], v10 offset:10752
    v_mfma_f32_16x16x32_bf16 a[180:183], a[40:43], a[120:123], a[180:183]
    s_sub_u32 s1, 1792, s0
    ds_read_b64_tr_b16 a[110:111], v10 offset:11776
    v_mfma_f32_16x16x32_bf16 a[184:187], a[48:51], a[120:123], 0
    buffer_load_dwordx4 v251, s[12:15], s41 offen offset:3072 nt lds
    v_mfma_f32_16x16x32_bf16 a[184:187], a[52:55], a[124:127], a[184:187]
    s_cmp_lt_u32 s37, 16
    s_cselect_b32 s0, s0, s1
    s_lshl_b32 s1, s37, 2
    v_mfma_f32_16x16x32_bf16 a[188:191], a[60:63], a[124:127], 0
    s_add_u32 s1, s1, s36
    s_lshl_b32 s1, s1, 1
    s_lshl_b32 s42, s56, 7
    v_mfma_f32_16x16x32_bf16 a[188:191], a[56:59], a[120:123], a[188:191]
    s_add_u32 s66, s0, s1
    s_add_u32 m0, s61, 0
    s_waitcnt lgkmcnt(4)
    v_mfma_f32_16x16x32_bf16 a[192:195], a[32:35], a[96:99], 0
    s_mul_i32 s84, s66, 1280
    ds_read_b64_tr_b16 a[112:113], v9 offset:2816
    v_mfma_f32_16x16x32_bf16 a[192:195], a[36:39], a[100:103], a[192:195]
    s_add_u32 s40, s44, s42
    ds_read_b64_tr_b16 a[114:115], v9 offset:3840
    v_mfma_f32_16x16x32_bf16 a[196:199], a[44:47], a[100:103], 0
    ds_read_b64_tr_b16 a[116:117], v9 offset:11008
    v_mfma_f32_16x16x32_bf16 a[196:199], a[40:43], a[96:99], a[196:199]
    ds_read_b64_tr_b16 a[118:119], v9 offset:12032
    v_and_b32 v165, 31, v1
    v_mfma_f32_16x16x32_bf16 a[200:203], a[48:51], a[96:99], 0
    buffer_load_dwordx4 v2, s[4:7], s40 offen lds
    v_mfma_f32_16x16x32_bf16 a[200:203], a[52:55], a[100:103], a[200:203]
    buffer_load_dwordx4 v3, s[4:7], s40 offen offset:1024 lds
    v_mfma_f32_16x16x32_bf16 a[204:207], a[60:63], a[100:103], 0
    v_lshlrev_b32 v165, 3, v165
    v_mfma_f32_16x16x32_bf16 a[204:207], a[56:59], a[96:99], a[204:207]
    s_add_u32 m0, s61, 2048
    s_waitcnt lgkmcnt(4)
    v_mfma_f32_16x16x32_bf16 a[208:211], a[32:35], a[104:107], 0
    s_add_u32 s40, s45, s42
    ds_read_b64_tr_b16 a[120:121], v10 offset:2816
    v_mfma_f32_16x16x32_bf16 a[208:211], a[36:39], a[108:111], a[208:211]
    ds_read_b64_tr_b16 a[122:123], v10 offset:3840
    buffer_load_dwordx4 v2, s[4:7], s40 offen lds
    v_mfma_f32_16x16x32_bf16 a[212:215], a[44:47], a[108:111], 0
    ds_read_b64_tr_b16 a[124:125], v10 offset:11008
    v_lshrrev_b32 v166, 5, v1
    v_mfma_f32_16x16x32_bf16 a[212:215], a[40:43], a[104:107], a[212:215]
    ds_read_b64_tr_b16 a[126:127], v10 offset:12032
    v_mul_u32_u24 v167, 1280, v166
    v_mfma_f32_16x16x32_bf16 a[216:219], a[48:51], a[104:107], 0
    buffer_load_dwordx4 v3, s[4:7], s40 offen offset:1024 lds
    v_mfma_f32_16x16x32_bf16 a[216:219], a[52:55], a[108:111], a[216:219]
    s_add_u32 m0, s61, 4096
    v_add_u32 v167, v167, v165
    v_mfma_f32_16x16x32_bf16 a[220:223], a[60:63], a[108:111], 0
    s_add_u32 s40, s46, s42
    v_add_u32 v9, 32768, v12
    v_add_u32 v10, 32768, v13
    v_mfma_f32_16x16x32_bf16 a[220:223], a[56:59], a[104:107], a[220:223]
    s_waitcnt vmcnt(13) lgkmcnt(0)
    s_barrier
    v_mfma_f32_16x16x32_bf16 a[224:227], a[32:35], a[112:115], 0
    ds_read_b64_tr_b16 a[96:97], v9 offset:0
    buffer_load_dwordx4 v2, s[4:7], s40 offen lds
    v_mfma_f32_16x16x32_bf16 a[224:227], a[36:39], a[116:119], a[224:227]
    ds_read_b64_tr_b16 a[98:99], v9 offset:1024
    v_mfma_f32_16x16x32_bf16 a[228:231], a[44:47], a[116:119], 0
    ds_read_b64_tr_b16 a[100:101], v9 offset:8192
    v_mfma_f32_16x16x32_bf16 a[228:231], a[40:43], a[112:115], a[228:231]
    ds_read_b64_tr_b16 a[102:103], v9 offset:9216
    v_mfma_f32_16x16x32_bf16 a[232:235], a[48:51], a[112:115], 0
    ds_read_b128 a[64:67], v7 offset:32768
    buffer_load_dwordx4 v3, s[4:7], s40 offen offset:1024 lds
    v_mfma_f32_16x16x32_bf16 a[232:235], a[52:55], a[116:119], a[232:235]
    s_add_u32 m0, s61, 6144
L_ws_518:
    s_cbranch_execz L_ws_2785
    ds_read_b128 a[68:71], v8 offset:32768
    v_mfma_f32_16x16x32_bf16 a[236:239], a[60:63], a[116:119], 0
    s_add_u32 s40, s47, s42
    ds_read_b128 a[72:75], v7 offset:34816
    v_mfma_f32_16x16x32_bf16 a[236:239], a[56:59], a[112:115], a[236:239]
    ds_read_b128 a[76:79], v8 offset:34816
    v_mfma_f32_16x16x32_bf16 a[240:243], a[32:35], a[120:123], 0
    ds_read_b128 a[80:83], v7 offset:36864
    buffer_load_dwordx4 v2, s[4:7], s40 offen lds
    v_mfma_f32_16x16x32_bf16 a[240:243], a[36:39], a[124:127], a[240:243]
    ds_read_b128 a[84:87], v8 offset:36864
    v_mfma_f32_16x16x32_bf16 a[244:247], a[44:47], a[124:127], 0
    ds_read_b128 a[88:91], v7 offset:38912
    v_mfma_f32_16x16x32_bf16 a[244:247], a[40:43], a[120:123], a[244:247]
    ds_read_b128 a[92:95], v8 offset:38912
    v_mfma_f32_16x16x32_bf16 a[248:251], a[48:51], a[120:123], 0
    ds_read_b64_tr_b16 a[104:105], v10 offset:0
    buffer_load_dwordx4 v3, s[4:7], s40 offen offset:1024 lds
    v_mfma_f32_16x16x32_bf16 a[248:251], a[52:55], a[124:127], a[248:251]
    s_add_u32 s56, s56, 1
    s_cmp_eq_u32 s56, 8
    s_cselect_b32 s56, 0, s56
    ds_read_b64_tr_b16 a[106:107], v10 offset:1024
    v_mfma_f32_16x16x32_bf16 a[252:255], a[60:63], a[124:127], 0
    ds_read_b64_tr_b16 a[108:109], v10 offset:8192
    v_mfma_f32_16x16x32_bf16 a[252:255], a[56:59], a[120:123], a[252:255]
    ds_read_b64_tr_b16 a[110:111], v10 offset:9216
    s_waitcnt lgkmcnt(4)
    v_mfma_f32_16x16x32_bf16 v[32:35], a[96:99], a[64:67], v[32:35]
    ds_read_b64_tr_b16 a[112:113], v9 offset:256
    v_cmp_eq_u32 vcc, 0, v0
    v_mfma_f32_16x16x32_bf16 v[32:35], a[100:103], a[68:71], v[32:35]
    ds_read_b64_tr_b16 a[114:115], v9 offset:1280
    v_mov_b32 v30, 0
    v_mfma_f32_16x16x32_bf16 v[36:39], a[100:103], a[76:79], v[36:39]
    ds_read_b64_tr_b16 a[116:117], v9 offset:8448
    v_cndmask_b32 v0, v129, v30, vcc
    v_mfma_f32_16x16x32_bf16 v[36:39], a[96:99], a[72:75], v[36:39]
    ds_read_b64_tr_b16 a[118:119], v9 offset:9472
    v_mfma_f32_16x16x32_bf16 v[40:43], a[96:99], a[80:83], v[40:43]
    s_mul_i32 s40, s56, 524288
    s_add_u32 s40, s40, s57
    s_and_b32 s76, s2, 3
    v_mfma_f32_16x16x32_bf16 v[40:43], a[100:103], a[84:87], v[40:43]
    s_add_u32 m0, s60, 0
    v_mfma_f32_16x16x32_bf16 v[44:47], a[100:103], a[92:95], v[44:47]
    buffer_load_dwordx4 v250, s[8:11], s40 offen nt lds
    v_mfma_f32_16x16x32_bf16 v[44:47], a[96:99], a[88:91], v[44:47]
    s_waitcnt lgkmcnt(4)
    v_mfma_f32_16x16x32_bf16 v[60:63], a[104:107], a[88:91], v[60:63]
    s_and_b32 s77, s2, 4
    ds_read_b64_tr_b16 a[120:121], v10 offset:256
    v_mfma_f32_16x16x32_bf16 v[60:63], a[108:111], a[92:95], v[60:63]
    ds_read_b64_tr_b16 a[122:123], v10 offset:1280
    v_mfma_f32_16x16x32_bf16 v[56:59], a[108:111], a[84:87], v[56:59]
    ds_read_b64_tr_b16 a[124:125], v10 offset:8448
    v_mfma_f32_16x16x32_bf16 v[56:59], a[104:107], a[80:83], v[56:59]
    ds_read_b64_tr_b16 a[126:127], v10 offset:9472
    v_mfma_f32_16x16x32_bf16 v[52:55], a[104:107], a[72:75], v[52:55]
    s_lshl_b32 s77, s77, 1
    v_mfma_f32_16x16x32_bf16 v[52:55], a[108:111], a[76:79], v[52:55]
    buffer_load_dwordx4 v251, s[8:11], s40 offen offset:1024 nt lds
    v_mfma_f32_16x16x32_bf16 v[48:51], a[108:111], a[68:71], v[48:51]
    v_mfma_f32_16x16x32_bf16 v[48:51], a[104:107], a[64:67], v[48:51]
    s_xor_b32 s41, s40, 512
    s_waitcnt lgkmcnt(4)
    v_mfma_f32_16x16x32_bf16 v[64:67], a[112:115], a[64:67], v[64:67]
    ds_read_b64_tr_b16 a[96:97], v9 offset:512
    v_mfma_f32_16x16x32_bf16 v[64:67], a[116:119], a[68:71], v[64:67]
    ds_read_b64_tr_b16 a[98:99], v9 offset:1536
    v_mfma_f32_16x16x32_bf16 v[68:71], a[116:119], a[76:79], v[68:71]
    ds_read_b64_tr_b16 a[100:101], v9 offset:8704
    v_mfma_f32_16x16x32_bf16 v[68:71], a[112:115], a[72:75], v[68:71]
    ds_read_b64_tr_b16 a[102:103], v9 offset:9728
    v_mfma_f32_16x16x32_bf16 v[72:75], a[112:115], a[80:83], v[72:75]
    buffer_load_dwordx4 v250, s[12:15], s41 offen offset:2048 nt lds
    v_mfma_f32_16x16x32_bf16 v[72:75], a[116:119], a[84:87], v[72:75]
    s_add_u32 s77, s77, s38
    v_mfma_f32_16x16x32_bf16 v[76:79], a[116:119], a[92:95], v[76:79]
    s_bfe_u32 s78, s2, 0x20003
    v_mfma_f32_16x16x32_bf16 v[76:79], a[112:115], a[88:91], v[76:79]
    s_waitcnt lgkmcnt(4)
    v_mfma_f32_16x16x32_bf16 v[92:95], a[120:123], a[88:91], v[92:95]
    ds_read_b64_tr_b16 a[104:105], v10 offset:512
    v_mfma_f32_16x16x32_bf16 v[92:95], a[124:127], a[92:95], v[92:95]
    ds_read_b64_tr_b16 a[106:107], v10 offset:1536
    v_mfma_f32_16x16x32_bf16 v[88:91], a[124:127], a[84:87], v[88:91]
    ds_read_b64_tr_b16 a[108:109], v10 offset:8704
    v_mfma_f32_16x16x32_bf16 v[88:91], a[120:123], a[80:83], v[88:91]
    ds_read_b64_tr_b16 a[110:111], v10 offset:9728
    v_mfma_f32_16x16x32_bf16 v[84:87], a[120:123], a[72:75], v[84:87]
    s_lshl_b32 s0, s77, 2
    v_mfma_f32_16x16x32_bf16 v[84:87], a[124:127], a[76:79], v[84:87]
    buffer_load_dwordx4 v251, s[12:15], s41 offen offset:3072 nt lds
    v_mfma_f32_16x16x32_bf16 v[80:83], a[124:127], a[68:71], v[80:83]
    s_add_u32 s0, s0, s78
    s_lshl_b32 s0, s0, 2
    v_mfma_f32_16x16x32_bf16 v[80:83], a[120:123], a[64:67], v[80:83]
    s_add_u32 s40, s40, 131072
    s_add_u32 s0, s0, s36
    s_waitcnt lgkmcnt(4)
    v_mfma_f32_16x16x32_bf16 v[96:99], a[96:99], a[64:67], v[96:99]
    s_add_u32 m0, s60, 4096
    ds_read_b64_tr_b16 a[112:113], v9 offset:768
    v_mfma_f32_16x16x32_bf16 v[96:99], a[100:103], a[68:71], v[96:99]
    s_lshl_b32 s0, s0, 2
    ds_read_b64_tr_b16 a[114:115], v9 offset:1792
    v_mfma_f32_16x16x32_bf16 v[100:103], a[100:103], a[76:79], v[100:103]
    ds_read_b64_tr_b16 a[116:117], v9 offset:8960
    v_mfma_f32_16x16x32_bf16 v[100:103], a[96:99], a[72:75], v[100:103]
    s_add_u32 s0, s0, s76
    ds_read_b64_tr_b16 a[118:119], v9 offset:9984
    v_mfma_f32_16x16x32_bf16 v[104:107], a[96:99], a[80:83], v[104:107]
    buffer_load_dwordx4 v250, s[8:11], s40 offen nt lds
    v_mfma_f32_16x16x32_bf16 v[104:107], a[100:103], a[84:87], v[104:107]
    v_mfma_f32_16x16x32_bf16 v[108:111], a[100:103], a[92:95], v[108:111]
    v_mfma_f32_16x16x32_bf16 v[108:111], a[96:99], a[88:91], v[108:111]
    s_waitcnt lgkmcnt(4)
    v_mfma_f32_16x16x32_bf16 v[124:127], a[104:107], a[88:91], v[124:127]
    ds_read_b64_tr_b16 a[120:121], v10 offset:768
    v_mfma_f32_16x16x32_bf16 v[124:127], a[108:111], a[92:95], v[124:127]
    s_mul_i32 s0, s0, 10240
    ds_read_b64_tr_b16 a[122:123], v10 offset:1792
    v_mfma_f32_16x16x32_bf16 v[120:123], a[108:111], a[84:87], v[120:123]
    ds_read_b64_tr_b16 a[124:125], v10 offset:8960
    v_mfma_f32_16x16x32_bf16 v[120:123], a[104:107], a[80:83], v[120:123]
    s_add_u32 s79, s0, 69206016
    ds_read_b64_tr_b16 a[126:127], v10 offset:9984
    v_mfma_f32_16x16x32_bf16 v[116:119], a[104:107], a[72:75], v[116:119]
    v_mfma_f32_16x16x32_bf16 v[116:119], a[108:111], a[76:79], v[116:119]
    v_mfma_f32_16x16x32_bf16 v[112:115], a[108:111], a[68:71], v[112:115]
    buffer_load_dwordx4 v251, s[8:11], s40 offen offset:1024 nt lds
    v_mfma_f32_16x16x32_bf16 v[112:115], a[104:107], a[64:67], v[112:115]
    s_cmp_eq_u32 s36, s76
    s_cselect_b32 s79, 0x40000000, s79
    s_waitcnt lgkmcnt(4)
    v_mfma_f32_16x16x32_bf16 a[0:3], a[112:115], a[64:67], a[0:3]
    s_lshr_b32 s1, s37, 2
    ds_read_b64_tr_b16 a[96:97], v9 offset:2048
    v_mfma_f32_16x16x32_bf16 a[0:3], a[116:119], a[68:71], a[0:3]
    s_xor_b32 s41, s40, 512
    ds_read_b64_tr_b16 a[98:99], v9 offset:3072
    v_mfma_f32_16x16x32_bf16 a[4:7], a[116:119], a[76:79], a[4:7]
    ds_read_b64_tr_b16 a[100:101], v9 offset:10240
    v_mfma_f32_16x16x32_bf16 a[4:7], a[112:115], a[72:75], a[4:7]
    s_lshl_b32 s0, s38, 3
    ds_read_b64_tr_b16 a[102:103], v9 offset:11264
    v_mfma_f32_16x16x32_bf16 a[8:11], a[112:115], a[80:83], a[8:11]
    buffer_load_dwordx4 v250, s[12:15], s41 offen offset:2048 nt lds
    v_mfma_f32_16x16x32_bf16 a[8:11], a[116:119], a[84:87], a[8:11]
    s_add_u32 s0, s0, s1
    s_lshl_b32 s0, s0, 5
    s_and_b32 s1, s37, 3
    v_mfma_f32_16x16x32_bf16 a[12:15], a[116:119], a[92:95], a[12:15]
    buffer_load_dwordx4 v251, s[12:15], s41 offen offset:3072 nt lds
    v_mfma_f32_16x16x32_bf16 a[12:15], a[112:115], a[88:91], a[12:15]
    s_waitcnt lgkmcnt(4)
    v_mfma_f32_16x16x32_bf16 a[28:31], a[120:123], a[88:91], a[28:31]
    ds_read_b64_tr_b16 a[104:105], v10 offset:2048
    v_mfma_f32_16x16x32_bf16 a[28:31], a[124:127], a[92:95], a[28:31]
    ds_read_b64_tr_b16 a[106:107], v10 offset:3072
    v_mfma_f32_16x16x32_bf16 a[24:27], a[124:127], a[84:87], a[24:27]
    s_lshl_b32 s42, s56, 7
    ds_read_b64_tr_b16 a[108:109], v10 offset:10240
    v_mfma_f32_16x16x32_bf16 a[24:27], a[120:123], a[80:83], a[24:27]
    s_add_u32 m0, s61, 32768
    ds_read_b64_tr_b16 a[110:111], v10 offset:11264
    v_mfma_f32_16x16x32_bf16 a[20:23], a[120:123], a[72:75], a[20:23]
    s_add_u32 s40, s44, s42
    v_mfma_f32_16x16x32_bf16 a[20:23], a[124:127], a[76:79], a[20:23]
    s_add_u32 s0, s0, s1
    v_mfma_f32_16x16x32_bf16 a[16:19], a[124:127], a[68:71], a[16:19]
    buffer_load_dwordx4 v2, s[4:7], s40 offen lds
    v_mfma_f32_16x16x32_bf16 a[16:19], a[120:123], a[64:67], a[16:19]
    s_waitcnt lgkmcnt(4)
    v_mfma_f32_16x16x32_bf16 a[128:131], a[64:67], a[96:99], a[128:131]
    ds_read_b64_tr_b16 a[112:113], v9 offset:2304
    v_mfma_f32_16x16x32_bf16 a[128:131], a[68:71], a[100:103], a[128:131]
    ds_read_b64_tr_b16 a[114:115], v9 offset:3328
    v_mfma_f32_16x16x32_bf16 a[132:135], a[76:79], a[100:103], a[132:135]
    s_lshl_b32 s0, s0, 2
    ds_read_b64_tr_b16 a[116:117], v9 offset:10496
    v_mfma_f32_16x16x32_bf16 a[132:135], a[72:75], a[96:99], a[132:135]
    s_add_u32 s67, s0, 83894272
    ds_read_b64_tr_b16 a[118:119], v9 offset:11520
    v_mfma_f32_16x16x32_bf16 a[136:139], a[80:83], a[96:99], a[136:139]
    buffer_load_dwordx4 v3, s[4:7], s40 offen offset:1024 lds
    v_mfma_f32_16x16x32_bf16 a[136:139], a[84:87], a[100:103], a[136:139]
    s_add_u32 m0, s61, 34816
    v_mfma_f32_16x16x32_bf16 a[140:143], a[92:95], a[100:103], a[140:143]
    s_lshl_b32 s0, s37, 5
    s_add_u32 s0, s0, s38
    v_mfma_f32_16x16x32_bf16 a[140:143], a[88:91], a[96:99], a[140:143]
    s_waitcnt lgkmcnt(4)
    v_mfma_f32_16x16x32_bf16 a[156:159], a[88:91], a[104:107], a[156:159]
    s_add_u32 s40, s45, s42
    ds_read_b64_tr_b16 a[120:121], v10 offset:2304
    v_mfma_f32_16x16x32_bf16 a[156:159], a[92:95], a[108:111], a[156:159]
    ds_read_b64_tr_b16 a[122:123], v10 offset:3328
    v_mfma_f32_16x16x32_bf16 a[152:155], a[84:87], a[108:111], a[152:155]
    ds_read_b64_tr_b16 a[124:125], v10 offset:10496
    v_mfma_f32_16x16x32_bf16 a[152:155], a[80:83], a[104:107], a[152:155]
    ds_read_b64_tr_b16 a[126:127], v10 offset:11520
    v_mfma_f32_16x16x32_bf16 a[148:151], a[72:75], a[104:107], a[148:151]
    buffer_load_dwordx4 v2, s[4:7], s40 offen lds
    v_mfma_f32_16x16x32_bf16 a[148:151], a[76:79], a[108:111], a[148:151]
    v_mfma_f32_16x16x32_bf16 a[144:147], a[68:71], a[108:111], a[144:147]
    v_mfma_f32_16x16x32_bf16 a[144:147], a[64:67], a[104:107], a[144:147]
    s_waitcnt lgkmcnt(4)
    v_mfma_f32_16x16x32_bf16 a[160:163], a[64:67], a[112:115], a[160:163]
    ds_read_b64_tr_b16 a[96:97], v9 offset:2560
    v_mfma_f32_16x16x32_bf16 a[160:163], a[68:71], a[116:119], a[160:163]
    ds_read_b64_tr_b16 a[98:99], v9 offset:3584
    v_mfma_f32_16x16x32_bf16 a[164:167], a[76:79], a[116:119], a[164:167]
    ds_read_b64_tr_b16 a[100:101], v9 offset:10752
    v_mfma_f32_16x16x32_bf16 a[164:167], a[72:75], a[112:115], a[164:167]
    ds_read_b64_tr_b16 a[102:103], v9 offset:11776
    v_mfma_f32_16x16x32_bf16 a[168:171], a[80:83], a[112:115], a[168:171]
    s_lshl_b32 s0, s0, 2
    v_mfma_f32_16x16x32_bf16 a[168:171], a[84:87], a[116:119], a[168:171]
    v_mfma_f32_16x16x32_bf16 a[172:175], a[92:95], a[116:119], a[172:175]
    buffer_load_dwordx4 v3, s[4:7], s40 offen offset:1024 lds
    v_mfma_f32_16x16x32_bf16 a[172:175], a[88:91], a[112:115], a[172:175]
    s_add_u32 s88, s0, 83902464
    s_lshl_b32 s0, s2, 2
    s_waitcnt lgkmcnt(4)
    v_mfma_f32_16x16x32_bf16 a[188:191], a[88:91], a[120:123], a[188:191]
    s_add_u32 m0, s61, 36864
    ds_read_b64_tr_b16 a[104:105], v10 offset:2560
    v_mfma_f32_16x16x32_bf16 a[188:191], a[92:95], a[124:127], a[188:191]
    s_add_u32 s40, s46, s42
    ds_read_b64_tr_b16 a[106:107], v10 offset:3584
    v_mfma_f32_16x16x32_bf16 a[184:187], a[84:87], a[124:127], a[184:187]
    ds_read_b64_tr_b16 a[108:109], v10 offset:10752
    v_mfma_f32_16x16x32_bf16 a[184:187], a[80:83], a[120:123], a[184:187]
    ds_read_b64_tr_b16 a[110:111], v10 offset:11776
    v_mfma_f32_16x16x32_bf16 a[180:183], a[72:75], a[120:123], a[180:183]
    buffer_load_dwordx4 v2, s[4:7], s40 offen lds
    v_mfma_f32_16x16x32_bf16 a[180:183], a[76:79], a[124:127], a[180:183]
    v_mfma_f32_16x16x32_bf16 a[176:179], a[68:71], a[124:127], a[176:179]
    buffer_load_dwordx4 v3, s[4:7], s40 offen offset:1024 lds
    v_mfma_f32_16x16x32_bf16 a[176:179], a[64:67], a[120:123], a[176:179]
    s_add_u32 m0, s61, 38912
    s_waitcnt lgkmcnt(4)
    v_mfma_f32_16x16x32_bf16 a[192:195], a[64:67], a[96:99], a[192:195]
    ds_read_b64_tr_b16 a[112:113], v9 offset:2816
    v_mfma_f32_16x16x32_bf16 a[192:195], a[68:71], a[100:103], a[192:195]
    s_add_u32 s40, s47, s42
    ds_read_b64_tr_b16 a[114:115], v9 offset:3840
    v_mfma_f32_16x16x32_bf16 a[196:199], a[76:79], a[100:103], a[196:199]
    ds_read_b64_tr_b16 a[116:117], v9 offset:11008
    v_mfma_f32_16x16x32_bf16 a[196:199], a[72:75], a[96:99], a[196:199]
    s_add_u32 s89, s0, 83906560
    ds_read_b64_tr_b16 a[118:119], v9 offset:12032
    v_mfma_f32_16x16x32_bf16 a[200:203], a[80:83], a[96:99], a[200:203]
    buffer_load_dwordx4 v2, s[4:7], s40 offen lds
    v_mfma_f32_16x16x32_bf16 a[200:203], a[84:87], a[100:103], a[200:203]
    v_mov_b32 v30, 1
    v_mfma_f32_16x16x32_bf16 a[204:207], a[92:95], a[100:103], a[204:207]
    s_lshl_b32 s3, s2, 2
    v_mfma_f32_16x16x32_bf16 a[204:207], a[88:91], a[96:99], a[204:207]
    v_lshlrev_b32 v140, 2, v1
    s_waitcnt lgkmcnt(4)
    v_mfma_f32_16x16x32_bf16 a[220:223], a[88:91], a[104:107], a[220:223]
    ds_read_b64_tr_b16 a[120:121], v10 offset:2816
    v_mfma_f32_16x16x32_bf16 a[220:223], a[92:95], a[108:111], a[220:223]
    ds_read_b64_tr_b16 a[122:123], v10 offset:3840
    v_mfma_f32_16x16x32_bf16 a[216:219], a[84:87], a[108:111], a[216:219]
    ds_read_b64_tr_b16 a[124:125], v10 offset:11008
    v_mfma_f32_16x16x32_bf16 a[216:219], a[80:83], a[104:107], a[216:219]
    ds_read_b64_tr_b16 a[126:127], v10 offset:12032
    v_and_b32 v140, 28, v140
    v_mfma_f32_16x16x32_bf16 a[212:215], a[72:75], a[104:107], a[212:215]
    buffer_load_dwordx4 v3, s[4:7], s40 offen offset:1024 lds
    v_mfma_f32_16x16x32_bf16 a[212:215], a[76:79], a[108:111], a[212:215]
    s_add_u32 s56, s56, 1
    s_cmp_eq_u32 s56, 8
    s_cselect_b32 s56, 0, s56
    v_mfma_f32_16x16x32_bf16 a[208:211], a[68:71], a[108:111], a[208:211]
    v_add_u32 v9, 65536, v12
    v_add_u32 v10, 65536, v13
    v_mfma_f32_16x16x32_bf16 a[208:211], a[64:67], a[104:107], a[208:211]
    s_waitcnt vmcnt(16) lgkmcnt(0)
    s_barrier
    v_mfma_f32_16x16x32_bf16 a[224:227], a[64:67], a[112:115], a[224:227]
    ds_read_b64_tr_b16 a[96:97], v9 offset:0
    v_mfma_f32_16x16x32_bf16 a[224:227], a[68:71], a[116:119], a[224:227]
    ds_read_b64_tr_b16 a[98:99], v9 offset:1024
    buffer_store_dword v30, v0, s[68:71], s3 offen sc1
    v_mfma_f32_16x16x32_bf16 a[228:231], a[76:79], a[116:119], a[228:231]
    s_xor_b32 s0, s37, 0
    ds_read_b64_tr_b16 a[100:101], v9 offset:8192
    v_mfma_f32_16x16x32_bf16 a[228:231], a[72:75], a[112:115], a[228:231]
    s_lshl_b32 s0, s0, 8
    ds_read_b64_tr_b16 a[102:103], v9 offset:9216
    v_mfma_f32_16x16x32_bf16 a[232:235], a[80:83], a[112:115], a[232:235]
    ds_read_b128 a[32:35], v7 offset:0
    v_mfma_f32_16x16x32_bf16 a[232:235], a[84:87], a[116:119], a[232:235]
    ds_read_b128 a[36:39], v8 offset:0
    v_mfma_f32_16x16x32_bf16 a[236:239], a[92:95], a[116:119], a[236:239]
    s_add_u32 s0, s0, 0
    ds_read_b128 a[40:43], v7 offset:2048
    v_mfma_f32_16x16x32_bf16 a[236:239], a[88:91], a[112:115], a[236:239]
    ds_read_b128 a[44:47], v8 offset:2048
    v_mfma_f32_16x16x32_bf16 a[252:255], a[88:91], a[120:123], a[252:255]
    ds_read_b128 a[48:51], v7 offset:4096
    buffer_load_dword v135, v132, s[20:23], s0 offen
    v_mfma_f32_16x16x32_bf16 a[252:255], a[92:95], a[124:127], a[252:255]
    ds_read_b128 a[52:55], v8 offset:4096
    v_mfma_f32_16x16x32_bf16 a[248:251], a[84:87], a[124:127], a[248:251]
    ds_read_b128 a[56:59], v7 offset:6144
    v_mfma_f32_16x16x32_bf16 a[248:251], a[80:83], a[120:123], a[248:251]
    ds_read_b128 a[60:63], v8 offset:6144
    v_mfma_f32_16x16x32_bf16 a[244:247], a[72:75], a[120:123], a[244:247]
    ds_read_b64_tr_b16 a[104:105], v10 offset:0
    v_mfma_f32_16x16x32_bf16 a[244:247], a[76:79], a[124:127], a[244:247]
    ds_read_b64_tr_b16 a[106:107], v10 offset:1024
    v_mfma_f32_16x16x32_bf16 a[240:243], a[68:71], a[124:127], a[240:243]
    ds_read_b64_tr_b16 a[108:109], v10 offset:8192
    buffer_load_dwordx2 v[144:145], v167, s[16:19], s84 offen offset:0
    v_mfma_f32_16x16x32_bf16 a[240:243], a[64:67], a[120:123], a[240:243]
    ds_read_b64_tr_b16 a[110:111], v10 offset:9216
    s_waitcnt lgkmcnt(4)
    v_mfma_f32_16x16x32_bf16 v[32:35], a[96:99], a[32:35], v[32:35]
    ds_read_b64_tr_b16 a[112:113], v9 offset:256
    v_mfma_f32_16x16x32_bf16 v[32:35], a[100:103], a[36:39], v[32:35]
    ds_read_b64_tr_b16 a[114:115], v9 offset:1280
    v_mfma_f32_16x16x32_bf16 v[36:39], a[100:103], a[44:47], v[36:39]
    ds_read_b64_tr_b16 a[116:117], v9 offset:8448
    v_mfma_f32_16x16x32_bf16 v[36:39], a[96:99], a[40:43], v[36:39]
    ds_read_b64_tr_b16 a[118:119], v9 offset:9472
    v_mfma_f32_16x16x32_bf16 v[40:43], a[96:99], a[48:51], v[40:43]
    s_mul_i32 s40, s56, 524288
    s_add_u32 s40, s40, s57
    v_mfma_f32_16x16x32_bf16 v[40:43], a[100:103], a[52:55], v[40:43]
    v_mfma_f32_16x16x32_bf16 v[44:47], a[100:103], a[60:63], v[44:47]
    buffer_load_dwordx2 v[154:155], v165, s[32:35], 0 offen offset:0
    v_mfma_f32_16x16x32_bf16 v[44:47], a[96:99], a[56:59], v[44:47]
    s_waitcnt lgkmcnt(4)
    v_mfma_f32_16x16x32_bf16 v[60:63], a[104:107], a[56:59], v[60:63]
    s_add_u32 m0, s60, 32768
    ds_read_b64_tr_b16 a[120:121], v10 offset:256
    v_mfma_f32_16x16x32_bf16 v[60:63], a[108:111], a[60:63], v[60:63]
    ds_read_b64_tr_b16 a[122:123], v10 offset:1280
    v_mfma_f32_16x16x32_bf16 v[56:59], a[108:111], a[52:55], v[56:59]
    ds_read_b64_tr_b16 a[124:125], v10 offset:8448
    v_mfma_f32_16x16x32_bf16 v[56:59], a[104:107], a[48:51], v[56:59]
    ds_read_b64_tr_b16 a[126:127], v10 offset:9472
    v_mfma_f32_16x16x32_bf16 v[52:55], a[104:107], a[40:43], v[52:55]
    buffer_load_dwordx2 v[156:157], v165, s[32:35], 0 offen offset:256
    v_mfma_f32_16x16x32_bf16 v[52:55], a[108:111], a[44:47], v[52:55]
    v_mfma_f32_16x16x32_bf16 v[48:51], a[108:111], a[36:39], v[48:51]
    buffer_load_dwordx4 v250, s[8:11], s40 offen nt lds
    v_mfma_f32_16x16x32_bf16 v[48:51], a[104:107], a[32:35], v[48:51]
    s_waitcnt lgkmcnt(4)
    v_mfma_f32_16x16x32_bf16 v[64:67], a[112:115], a[32:35], v[64:67]
    ds_read_b64_tr_b16 a[96:97], v9 offset:512
    v_mfma_f32_16x16x32_bf16 v[64:67], a[116:119], a[36:39], v[64:67]
    ds_read_b64_tr_b16 a[98:99], v9 offset:1536
    v_mfma_f32_16x16x32_bf16 v[68:71], a[116:119], a[44:47], v[68:71]
    ds_read_b64_tr_b16 a[100:101], v9 offset:8704
    v_mfma_f32_16x16x32_bf16 v[68:71], a[112:115], a[40:43], v[68:71]
    ds_read_b64_tr_b16 a[102:103], v9 offset:9728
    v_mfma_f32_16x16x32_bf16 v[72:75], a[112:115], a[48:51], v[72:75]
    v_mfma_f32_16x16x32_bf16 v[72:75], a[116:119], a[52:55], v[72:75]
    buffer_load_dwordx4 v251, s[8:11], s40 offen offset:1024 nt lds
    v_mfma_f32_16x16x32_bf16 v[76:79], a[116:119], a[60:63], v[76:79]
    v_mfma_f32_16x16x32_bf16 v[76:79], a[112:115], a[56:59], v[76:79]
    s_waitcnt lgkmcnt(4)
    v_mfma_f32_16x16x32_bf16 v[92:95], a[120:123], a[56:59], v[92:95]
    s_xor_b32 s41, s40, 512
    ds_read_b64_tr_b16 a[104:105], v10 offset:512
    v_mfma_f32_16x16x32_bf16 v[92:95], a[124:127], a[60:63], v[92:95]
    ds_read_b64_tr_b16 a[106:107], v10 offset:1536
    v_mfma_f32_16x16x32_bf16 v[88:91], a[124:127], a[52:55], v[88:91]
    ds_read_b64_tr_b16 a[108:109], v10 offset:8704
    v_mfma_f32_16x16x32_bf16 v[88:91], a[120:123], a[48:51], v[88:91]
    ds_read_b64_tr_b16 a[110:111], v10 offset:9728
    v_mfma_f32_16x16x32_bf16 v[84:87], a[120:123], a[40:43], v[84:87]
    buffer_load_dwordx4 v250, s[12:15], s41 offen offset:2048 nt lds
    v_mfma_f32_16x16x32_bf16 v[84:87], a[124:127], a[44:47], v[84:87]
    v_mfma_f32_16x16x32_bf16 v[80:83], a[124:127], a[36:39], v[80:83]
    buffer_load_dwordx4 v251, s[12:15], s41 offen offset:3072 nt lds
    v_mfma_f32_16x16x32_bf16 v[80:83], a[120:123], a[32:35], v[80:83]
    s_waitcnt lgkmcnt(4)
    v_mfma_f32_16x16x32_bf16 v[96:99], a[96:99], a[32:35], v[96:99]
    ds_read_b64_tr_b16 a[112:113], v9 offset:768
    v_mfma_f32_16x16x32_bf16 v[96:99], a[100:103], a[36:39], v[96:99]
    ds_read_b64_tr_b16 a[114:115], v9 offset:1792
    v_mfma_f32_16x16x32_bf16 v[100:103], a[100:103], a[44:47], v[100:103]
    ds_read_b64_tr_b16 a[116:117], v9 offset:8960
    v_mfma_f32_16x16x32_bf16 v[100:103], a[96:99], a[40:43], v[100:103]
    ds_read_b64_tr_b16 a[118:119], v9 offset:9984
    v_mfma_f32_16x16x32_bf16 v[104:107], a[96:99], a[48:51], v[104:107]
    v_mfma_f32_16x16x32_bf16 v[104:107], a[100:103], a[52:55], v[104:107]
    v_mfma_f32_16x16x32_bf16 v[108:111], a[100:103], a[60:63], v[108:111]
    buffer_load_dwordx2 v[158:159], v165, s[32:35], 0 offen offset:512
    v_mfma_f32_16x16x32_bf16 v[108:111], a[96:99], a[56:59], v[108:111]
    s_waitcnt lgkmcnt(4)
    v_mfma_f32_16x16x32_bf16 v[124:127], a[104:107], a[56:59], v[124:127]
    s_add_u32 s40, s40, 131072
    ds_read_b64_tr_b16 a[120:121], v10 offset:768
    v_mfma_f32_16x16x32_bf16 v[124:127], a[108:111], a[60:63], v[124:127]
    s_add_u32 m0, s60, 36864
    ds_read_b64_tr_b16 a[122:123], v10 offset:1792
    v_mfma_f32_16x16x32_bf16 v[120:123], a[108:111], a[52:55], v[120:123]
    ds_read_b64_tr_b16 a[124:125], v10 offset:8960
    v_mfma_f32_16x16x32_bf16 v[120:123], a[104:107], a[48:51], v[120:123]
    ds_read_b64_tr_b16 a[126:127], v10 offset:9984
    v_mfma_f32_16x16x32_bf16 v[116:119], a[104:107], a[40:43], v[116:119]
    buffer_load_dwordx4 v250, s[8:11], s40 offen nt lds
    v_mfma_f32_16x16x32_bf16 v[116:119], a[108:111], a[44:47], v[116:119]
    v_mfma_f32_16x16x32_bf16 v[112:115], a[108:111], a[36:39], v[112:115]
    buffer_load_dwordx4 v251, s[8:11], s40 offen offset:1024 nt lds
    v_mfma_f32_16x16x32_bf16 v[112:115], a[104:107], a[32:35], v[112:115]
    s_waitcnt lgkmcnt(4)
    v_mfma_f32_16x16x32_bf16 a[0:3], a[112:115], a[32:35], a[0:3]
    s_xor_b32 s41, s40, 512
    ds_read_b64_tr_b16 a[96:97], v9 offset:2048
    v_mfma_f32_16x16x32_bf16 a[0:3], a[116:119], a[36:39], a[0:3]
    ds_read_b64_tr_b16 a[98:99], v9 offset:3072
    v_mfma_f32_16x16x32_bf16 a[4:7], a[116:119], a[44:47], a[4:7]
    ds_read_b64_tr_b16 a[100:101], v9 offset:10240
    v_mfma_f32_16x16x32_bf16 a[4:7], a[112:115], a[40:43], a[4:7]
    ds_read_b64_tr_b16 a[102:103], v9 offset:11264
    v_mfma_f32_16x16x32_bf16 a[8:11], a[112:115], a[48:51], a[8:11]
    buffer_load_dwordx4 v250, s[12:15], s41 offen offset:2048 nt lds
    v_mfma_f32_16x16x32_bf16 a[8:11], a[116:119], a[52:55], a[8:11]
    v_mfma_f32_16x16x32_bf16 a[12:15], a[116:119], a[60:63], a[12:15]
    buffer_load_dwordx4 v251, s[12:15], s41 offen offset:3072 nt lds
    v_mfma_f32_16x16x32_bf16 a[12:15], a[112:115], a[56:59], a[12:15]
    s_lshl_b32 s42, s56, 7
    s_waitcnt lgkmcnt(4)
    v_mfma_f32_16x16x32_bf16 a[28:31], a[120:123], a[56:59], a[28:31]
    s_add_u32 m0, s61, 0
    ds_read_b64_tr_b16 a[104:105], v10 offset:2048
    v_mfma_f32_16x16x32_bf16 a[28:31], a[124:127], a[60:63], a[28:31]
    ds_read_b64_tr_b16 a[106:107], v10 offset:3072
    v_mfma_f32_16x16x32_bf16 a[24:27], a[124:127], a[52:55], a[24:27]
    s_add_u32 s40, s44, s42
    ds_read_b64_tr_b16 a[108:109], v10 offset:10240
    v_mfma_f32_16x16x32_bf16 a[24:27], a[120:123], a[48:51], a[24:27]
    ds_read_b64_tr_b16 a[110:111], v10 offset:11264
    v_mfma_f32_16x16x32_bf16 a[20:23], a[120:123], a[40:43], a[20:23]
    buffer_load_dwordx4 v2, s[4:7], s40 offen lds
    v_mfma_f32_16x16x32_bf16 a[20:23], a[124:127], a[44:47], a[20:23]
    v_mfma_f32_16x16x32_bf16 a[16:19], a[124:127], a[36:39], a[16:19]
    buffer_load_dwordx4 v3, s[4:7], s40 offen offset:1024 lds
    v_mfma_f32_16x16x32_bf16 a[16:19], a[120:123], a[32:35], a[16:19]
    s_waitcnt lgkmcnt(4)
    v_mfma_f32_16x16x32_bf16 a[128:131], a[32:35], a[96:99], a[128:131]
    ds_read_b64_tr_b16 a[112:113], v9 offset:2304
    v_mfma_f32_16x16x32_bf16 a[128:131], a[36:39], a[100:103], a[128:131]
    s_add_u32 m0, s61, 2048
    ds_read_b64_tr_b16 a[114:115], v9 offset:3328
    v_mfma_f32_16x16x32_bf16 a[132:135], a[44:47], a[100:103], a[132:135]
    ds_read_b64_tr_b16 a[116:117], v9 offset:10496
    v_mfma_f32_16x16x32_bf16 a[132:135], a[40:43], a[96:99], a[132:135]
    ds_read_b64_tr_b16 a[118:119], v9 offset:11520
    v_mfma_f32_16x16x32_bf16 a[136:139], a[48:51], a[96:99], a[136:139]
    v_mfma_f32_16x16x32_bf16 a[136:139], a[52:55], a[100:103], a[136:139]
    v_mfma_f32_16x16x32_bf16 a[140:143], a[60:63], a[100:103], a[140:143]
    buffer_load_dwordx2 v[160:161], v165, s[32:35], 0 offen offset:768
    v_mfma_f32_16x16x32_bf16 a[140:143], a[56:59], a[96:99], a[140:143]
    s_waitcnt lgkmcnt(4)
    v_mfma_f32_16x16x32_bf16 a[156:159], a[56:59], a[104:107], a[156:159]
    ds_read_b64_tr_b16 a[120:121], v10 offset:2304
    v_mfma_f32_16x16x32_bf16 a[156:159], a[60:63], a[108:111], a[156:159]
    ds_read_b64_tr_b16 a[122:123], v10 offset:3328
    v_mfma_f32_16x16x32_bf16 a[152:155], a[52:55], a[108:111], a[152:155]
    s_add_u32 s40, s45, s42
    ds_read_b64_tr_b16 a[124:125], v10 offset:10496
    v_mfma_f32_16x16x32_bf16 a[152:155], a[48:51], a[104:107], a[152:155]
    ds_read_b64_tr_b16 a[126:127], v10 offset:11520
    v_mfma_f32_16x16x32_bf16 a[148:151], a[40:43], a[104:107], a[148:151]
    buffer_load_dwordx4 v2, s[4:7], s40 offen lds
    v_mfma_f32_16x16x32_bf16 a[148:151], a[44:47], a[108:111], a[148:151]
    v_mfma_f32_16x16x32_bf16 a[144:147], a[36:39], a[108:111], a[144:147]
    buffer_load_dwordx4 v3, s[4:7], s40 offen offset:1024 lds
    v_mfma_f32_16x16x32_bf16 a[144:147], a[32:35], a[104:107], a[144:147]
    s_waitcnt lgkmcnt(4)
    v_mfma_f32_16x16x32_bf16 a[160:163], a[32:35], a[112:115], a[160:163]
    s_add_u32 m0, s61, 4096
    ds_read_b64_tr_b16 a[96:97], v9 offset:2560
    v_mfma_f32_16x16x32_bf16 a[160:163], a[36:39], a[116:119], a[160:163]
    ds_read_b64_tr_b16 a[98:99], v9 offset:3584
    v_mfma_f32_16x16x32_bf16 a[164:167], a[44:47], a[116:119], a[164:167]
    s_add_u32 s40, s46, s42
    ds_read_b64_tr_b16 a[100:101], v9 offset:10752
    v_mfma_f32_16x16x32_bf16 a[164:167], a[40:43], a[112:115], a[164:167]
    ds_read_b64_tr_b16 a[102:103], v9 offset:11776
    v_mfma_f32_16x16x32_bf16 a[168:171], a[48:51], a[112:115], a[168:171]
    v_mfma_f32_16x16x32_bf16 a[168:171], a[52:55], a[116:119], a[168:171]
    buffer_load_dwordx4 v2, s[4:7], s40 offen lds
    v_mfma_f32_16x16x32_bf16 a[172:175], a[60:63], a[116:119], a[172:175]
    v_mfma_f32_16x16x32_bf16 a[172:175], a[56:59], a[112:115], a[172:175]
    s_waitcnt lgkmcnt(4)
    v_mfma_f32_16x16x32_bf16 a[188:191], a[56:59], a[120:123], a[188:191]
    ds_read_b64_tr_b16 a[104:105], v10 offset:2560
    v_mfma_f32_16x16x32_bf16 a[188:191], a[60:63], a[124:127], a[188:191]
    ds_read_b64_tr_b16 a[106:107], v10 offset:3584
    v_mfma_f32_16x16x32_bf16 a[184:187], a[52:55], a[124:127], a[184:187]
    ds_read_b64_tr_b16 a[108:109], v10 offset:10752
    v_mfma_f32_16x16x32_bf16 a[184:187], a[48:51], a[120:123], a[184:187]
    ds_read_b64_tr_b16 a[110:111], v10 offset:11776
    v_mfma_f32_16x16x32_bf16 a[180:183], a[40:43], a[120:123], a[180:183]
    v_mfma_f32_16x16x32_bf16 a[180:183], a[44:47], a[124:127], a[180:183]
    buffer_load_dwordx4 v3, s[4:7], s40 offen offset:1024 lds
    v_mfma_f32_16x16x32_bf16 a[176:179], a[36:39], a[124:127], a[176:179]
    s_add_u32 m0, s61, 6144
    v_mfma_f32_16x16x32_bf16 a[176:179], a[32:35], a[120:123], a[176:179]
    s_waitcnt lgkmcnt(4)
    v_mfma_f32_16x16x32_bf16 a[192:195], a[32:35], a[96:99], a[192:195]
    ds_read_b64_tr_b16 a[112:113], v9 offset:2816
    v_mfma_f32_16x16x32_bf16 a[192:195], a[36:39], a[100:103], a[192:195]
    s_add_u32 s40, s47, s42
    ds_read_b64_tr_b16 a[114:115], v9 offset:3840
    v_mfma_f32_16x16x32_bf16 a[196:199], a[44:47], a[100:103], a[196:199]
    ds_read_b64_tr_b16 a[116:117], v9 offset:11008
    v_mfma_f32_16x16x32_bf16 a[196:199], a[40:43], a[96:99], a[196:199]
    ds_read_b64_tr_b16 a[118:119], v9 offset:12032
    v_mfma_f32_16x16x32_bf16 a[200:203], a[48:51], a[96:99], a[200:203]
    buffer_load_dwordx4 v2, s[4:7], s40 offen lds
    v_mfma_f32_16x16x32_bf16 a[200:203], a[52:55], a[100:103], a[200:203]
    v_mfma_f32_16x16x32_bf16 a[204:207], a[60:63], a[100:103], a[204:207]
    buffer_load_dwordx2 v[162:163], v165, s[32:35], 0 offen offset:1024
    v_mfma_f32_16x16x32_bf16 a[204:207], a[56:59], a[96:99], a[204:207]
    s_waitcnt lgkmcnt(4)
    v_mfma_f32_16x16x32_bf16 a[220:223], a[56:59], a[104:107], a[220:223]
    ds_read_b64_tr_b16 a[120:121], v10 offset:2816
    v_mfma_f32_16x16x32_bf16 a[220:223], a[60:63], a[108:111], a[220:223]
    ds_read_b64_tr_b16 a[122:123], v10 offset:3840
    v_mfma_f32_16x16x32_bf16 a[216:219], a[52:55], a[108:111], a[216:219]
    ds_read_b64_tr_b16 a[124:125], v10 offset:11008
    v_mfma_f32_16x16x32_bf16 a[216:219], a[48:51], a[104:107], a[216:219]
    ds_read_b64_tr_b16 a[126:127], v10 offset:12032
    v_mfma_f32_16x16x32_bf16 a[212:215], a[40:43], a[104:107], a[212:215]
    buffer_load_dwordx4 v3, s[4:7], s40 offen offset:1024 lds
    v_mfma_f32_16x16x32_bf16 a[212:215], a[44:47], a[108:111], a[212:215]
    s_add_u32 s56, s56, 1
    s_cmp_eq_u32 s56, 8
    s_cselect_b32 s56, 0, s56
    v_mfma_f32_16x16x32_bf16 a[208:211], a[36:39], a[108:111], a[208:211]
    v_add_u32 v9, 0, v12
    v_add_u32 v10, 0, v13
    v_mfma_f32_16x16x32_bf16 a[208:211], a[32:35], a[104:107], a[208:211]
    s_waitcnt vmcnt(24) lgkmcnt(0)
    s_barrier
    v_mfma_f32_16x16x32_bf16 a[224:227], a[32:35], a[112:115], a[224:227]
    s_xor_b32 s0, s37, 1
    ds_read_b64_tr_b16 a[96:97], v9 offset:0
    v_mfma_f32_16x16x32_bf16 a[224:227], a[36:39], a[116:119], a[224:227]
    ds_read_b64_tr_b16 a[98:99], v9 offset:1024
    v_mfma_f32_16x16x32_bf16 a[228:231], a[44:47], a[116:119], a[228:231]
    s_lshl_b32 s0, s0, 8
    ds_read_b64_tr_b16 a[100:101], v9 offset:8192
    v_mfma_f32_16x16x32_bf16 a[228:231], a[40:43], a[112:115], a[228:231]
    s_add_u32 s0, s0, 917504
L_ws_1077:
    s_cbranch_execz L_ws_3332
    ds_read_b64_tr_b16 a[102:103], v9 offset:9216
    v_mfma_f32_16x16x32_bf16 a[232:235], a[48:51], a[112:115], a[232:235]
    ds_read_b128 a[64:67], v7 offset:32768
    buffer_load_dword v135, v132, s[20:23], s0 offen
    v_mfma_f32_16x16x32_bf16 a[232:235], a[52:55], a[116:119], a[232:235]
    s_lshl_b32 s0, s95, 7
    ds_read_b128 a[68:71], v8 offset:32768
    v_mfma_f32_16x16x32_bf16 a[236:239], a[60:63], a[116:119], a[236:239]
    s_add_u32 s0, s0, 0
    ds_read_b128 a[72:75], v7 offset:34816
    v_mfma_f32_16x16x32_bf16 a[236:239], a[56:59], a[112:115], a[236:239]
    ds_read_b128 a[76:79], v8 offset:34816
    v_mfma_f32_16x16x32_bf16 a[252:255], a[56:59], a[120:123], a[252:255]
    ds_read_b128 a[80:83], v7 offset:36864
    v_mfma_f32_16x16x32_bf16 a[252:255], a[60:63], a[124:127], a[252:255]
    ds_read_b128 a[84:87], v8 offset:36864
    buffer_load_dword v135, v131, s[24:27], s0 offen offset:2048
    v_mfma_f32_16x16x32_bf16 a[248:251], a[52:55], a[124:127], a[248:251]
    ds_read_b128 a[88:91], v7 offset:38912
    v_mfma_f32_16x16x32_bf16 a[248:251], a[48:51], a[120:123], a[248:251]
    ds_read_b128 a[92:95], v8 offset:38912
    v_mfma_f32_16x16x32_bf16 a[244:247], a[40:43], a[120:123], a[244:247]
    ds_read_b64_tr_b16 a[104:105], v10 offset:0
    v_mfma_f32_16x16x32_bf16 a[244:247], a[44:47], a[124:127], a[244:247]
    ds_read_b64_tr_b16 a[106:107], v10 offset:1024
    v_mfma_f32_16x16x32_bf16 a[240:243], a[36:39], a[124:127], a[240:243]
    ds_read_b64_tr_b16 a[108:109], v10 offset:8192
    buffer_load_dwordx2 v[146:147], v167, s[16:19], s84 offen offset:256
    v_mfma_f32_16x16x32_bf16 a[240:243], a[32:35], a[120:123], a[240:243]
    ds_read_b64_tr_b16 a[110:111], v10 offset:9216
    s_waitcnt lgkmcnt(4)
    v_mfma_f32_16x16x32_bf16 v[32:35], a[96:99], a[64:67], v[32:35]
    ds_read_b64_tr_b16 a[112:113], v9 offset:256
    v_mfma_f32_16x16x32_bf16 v[32:35], a[100:103], a[68:71], v[32:35]
    ds_read_b64_tr_b16 a[114:115], v9 offset:1280
    v_mfma_f32_16x16x32_bf16 v[36:39], a[100:103], a[76:79], v[36:39]
    ds_read_b64_tr_b16 a[116:117], v9 offset:8448
    v_mfma_f32_16x16x32_bf16 v[36:39], a[96:99], a[72:75], v[36:39]
    ds_read_b64_tr_b16 a[118:119], v9 offset:9472
    v_mfma_f32_16x16x32_bf16 v[40:43], a[96:99], a[80:83], v[40:43]
    s_mul_i32 s40, s56, 524288
    s_add_u32 s40, s40, s57
    v_mfma_f32_16x16x32_bf16 v[40:43], a[100:103], a[84:87], v[40:43]
    s_add_u32 m0, s60, 65536
    v_mfma_f32_16x16x32_bf16 v[44:47], a[100:103], a[92:95], v[44:47]
    buffer_load_dwordx4 v250, s[8:11], s40 offen nt lds
    v_mfma_f32_16x16x32_bf16 v[44:47], a[96:99], a[88:91], v[44:47]
    v_add_u32 v28, s61, v28
    s_waitcnt lgkmcnt(4)
    v_mfma_f32_16x16x32_bf16 v[60:63], a[104:107], a[88:91], v[60:63]
    ds_read_b64_tr_b16 a[120:121], v10 offset:256
    v_mfma_f32_16x16x32_bf16 v[60:63], a[108:111], a[92:95], v[60:63]
    ds_read_b64_tr_b16 a[122:123], v10 offset:1280
    v_mfma_f32_16x16x32_bf16 v[56:59], a[108:111], a[84:87], v[56:59]
    ds_read_b64_tr_b16 a[124:125], v10 offset:8448
    v_bfe_u32 v128, v1, 2, 2
    v_mfma_f32_16x16x32_bf16 v[56:59], a[104:107], a[80:83], v[56:59]
    ds_read_b64_tr_b16 a[126:127], v10 offset:9472
    v_mul_u32_u24 v128, 1280, v128
    v_mfma_f32_16x16x32_bf16 v[52:55], a[104:107], a[72:75], v[52:55]
    v_lshl_add_u32 v128, v27, 6, v128
    v_mfma_f32_16x16x32_bf16 v[52:55], a[108:111], a[76:79], v[52:55]
    buffer_load_dwordx4 v251, s[8:11], s40 offen offset:1024 nt lds
    v_mfma_f32_16x16x32_bf16 v[48:51], a[108:111], a[68:71], v[48:51]
    v_mfma_f32_16x16x32_bf16 v[48:51], a[104:107], a[64:67], v[48:51]
    v_and_b32 v129, 3, v1
    s_waitcnt lgkmcnt(4)
    v_mfma_f32_16x16x32_bf16 v[64:67], a[112:115], a[64:67], v[64:67]
    s_xor_b32 s41, s40, 512
    ds_read_b64_tr_b16 a[96:97], v9 offset:512
    v_mfma_f32_16x16x32_bf16 v[64:67], a[116:119], a[68:71], v[64:67]
    ds_read_b64_tr_b16 a[98:99], v9 offset:1536
    v_mfma_f32_16x16x32_bf16 v[68:71], a[116:119], a[76:79], v[68:71]
    ds_read_b64_tr_b16 a[100:101], v9 offset:8704
    v_lshl_add_u32 v26, v129, 4, v128
    v_mfma_f32_16x16x32_bf16 v[68:71], a[112:115], a[72:75], v[68:71]
    s_lshl_b32 s0, s2, 2
    ds_read_b64_tr_b16 a[102:103], v9 offset:9728
    v_mfma_f32_16x16x32_bf16 v[72:75], a[112:115], a[80:83], v[72:75]
    buffer_load_dwordx4 v250, s[12:15], s41 offen offset:2048 nt lds
    v_mfma_f32_16x16x32_bf16 v[72:75], a[116:119], a[84:87], v[72:75]
    s_add_u32 s0, s0, s36
    v_mfma_f32_16x16x32_bf16 v[76:79], a[116:119], a[92:95], v[76:79]
    buffer_load_dwordx4 v251, s[12:15], s41 offen offset:3072 nt lds
    v_mfma_f32_16x16x32_bf16 v[76:79], a[112:115], a[88:91], v[76:79]
    s_add_u32 s40, s40, 131072
    s_waitcnt lgkmcnt(4)
    v_mfma_f32_16x16x32_bf16 v[92:95], a[120:123], a[88:91], v[92:95]
    ds_read_b64_tr_b16 a[104:105], v10 offset:512
    v_mfma_f32_16x16x32_bf16 v[92:95], a[124:127], a[92:95], v[92:95]
    ds_read_b64_tr_b16 a[106:107], v10 offset:1536
    v_mfma_f32_16x16x32_bf16 v[88:91], a[124:127], a[84:87], v[88:91]
    ds_read_b64_tr_b16 a[108:109], v10 offset:8704
    v_mfma_f32_16x16x32_bf16 v[88:91], a[120:123], a[80:83], v[88:91]
    s_sub_u32 s0, s0, 128
    ds_read_b64_tr_b16 a[110:111], v10 offset:9728
    v_mfma_f32_16x16x32_bf16 v[84:87], a[120:123], a[72:75], v[84:87]
    s_add_u32 m0, s60, 69632
    s_and_b32 s0, s0, 1023
    s_mul_i32 s1, s0, 13108
    v_mfma_f32_16x16x32_bf16 v[84:87], a[124:127], a[76:79], v[84:87]
    buffer_load_dwordx4 v250, s[8:11], s40 offen nt lds
    v_mfma_f32_16x16x32_bf16 v[80:83], a[124:127], a[68:71], v[80:83]
    v_mfma_f32_16x16x32_bf16 v[80:83], a[120:123], a[64:67], v[80:83]
    s_lshr_b32 s1, s1, 16
    s_waitcnt lgkmcnt(4)
    v_mfma_f32_16x16x32_bf16 v[96:99], a[96:99], a[64:67], v[96:99]
    ds_read_b64_tr_b16 a[112:113], v9 offset:768
    v_mfma_f32_16x16x32_bf16 v[96:99], a[100:103], a[68:71], v[96:99]
    ds_read_b64_tr_b16 a[114:115], v9 offset:1792
    v_mfma_f32_16x16x32_bf16 v[100:103], a[100:103], a[76:79], v[100:103]
    ds_read_b64_tr_b16 a[116:117], v9 offset:8960
    v_mfma_f32_16x16x32_bf16 v[100:103], a[96:99], a[72:75], v[100:103]
    ds_read_b64_tr_b16 a[118:119], v9 offset:9984
    v_mfma_f32_16x16x32_bf16 v[104:107], a[96:99], a[80:83], v[104:107]
    s_mul_i32 s39, s1, 5
    s_sub_u32 s39, s0, s39
    v_mfma_f32_16x16x32_bf16 v[104:107], a[100:103], a[84:87], v[104:107]
    s_cmp_lt_u32 s1, 128
    s_cselect_b32 s72, s74, s82
    s_cselect_b32 s73, s75, s83
    s_mov_b32 s74, 2211840
    s_cselect_b32 s74, 5242880, s74
    v_mfma_f32_16x16x32_bf16 v[108:111], a[100:103], a[92:95], v[108:111]
    buffer_load_dwordx4 v251, s[8:11], s40 offen offset:1024 nt lds
    v_mfma_f32_16x16x32_bf16 v[108:111], a[96:99], a[88:91], v[108:111]
    s_waitcnt lgkmcnt(4)
    v_mfma_f32_16x16x32_bf16 v[124:127], a[104:107], a[88:91], v[124:127]
    ds_read_b64_tr_b16 a[120:121], v10 offset:768
    v_mfma_f32_16x16x32_bf16 v[124:127], a[108:111], a[92:95], v[124:127]
    ds_read_b64_tr_b16 a[122:123], v10 offset:1792
    v_mfma_f32_16x16x32_bf16 v[120:123], a[108:111], a[84:87], v[120:123]
    s_mov_b32 s75, 0x00020000
    ds_read_b64_tr_b16 a[124:125], v10 offset:8960
    v_mfma_f32_16x16x32_bf16 v[120:123], a[104:107], a[80:83], v[120:123]
    ds_read_b64_tr_b16 a[126:127], v10 offset:9984
    v_mfma_f32_16x16x32_bf16 v[116:119], a[104:107], a[72:75], v[116:119]
    s_xor_b32 s41, s40, 512
    s_and_b32 s1, s1, 127
    v_mfma_f32_16x16x32_bf16 v[116:119], a[108:111], a[76:79], v[116:119]
    buffer_load_dwordx4 v250, s[12:15], s41 offen offset:2048 nt lds
    v_mfma_f32_16x16x32_bf16 v[112:115], a[108:111], a[68:71], v[112:115]
    v_mfma_f32_16x16x32_bf16 v[112:115], a[104:107], a[64:67], v[112:115]
    s_mul_i32 s64, s1, 40960
    s_lshl_b32 s39, s39, 8
    s_waitcnt lgkmcnt(4)
    v_mfma_f32_16x16x32_bf16 a[0:3], a[112:115], a[64:67], a[0:3]
    ds_read_b64_tr_b16 a[96:97], v9 offset:2048
    v_mfma_f32_16x16x32_bf16 a[0:3], a[116:119], a[68:71], a[0:3]
    s_add_u32 s64, s64, s39
    ds_read_b64_tr_b16 a[98:99], v9 offset:3072
    v_mfma_f32_16x16x32_bf16 a[4:7], a[116:119], a[76:79], a[4:7]
    ds_read_b64_tr_b16 a[100:101], v9 offset:10240
    v_mfma_f32_16x16x32_bf16 a[4:7], a[112:115], a[72:75], a[4:7]
    s_lshl_b32 s65, s0, 13
    ds_read_b64_tr_b16 a[102:103], v9 offset:11264
    v_mfma_f32_16x16x32_bf16 a[8:11], a[112:115], a[80:83], a[8:11]
    buffer_load_dwordx4 v251, s[12:15], s41 offen offset:3072 nt lds
    v_mfma_f32_16x16x32_bf16 a[8:11], a[116:119], a[84:87], a[8:11]
    s_lshl_b32 s42, s56, 7
    v_mfma_f32_16x16x32_bf16 a[12:15], a[116:119], a[92:95], a[12:15]
    v_mfma_f32_16x16x32_bf16 a[12:15], a[112:115], a[88:91], a[12:15]
    s_waitcnt lgkmcnt(4)
    v_mfma_f32_16x16x32_bf16 a[28:31], a[120:123], a[88:91], a[28:31]
    ds_read_b64_tr_b16 a[104:105], v10 offset:2048
    v_mfma_f32_16x16x32_bf16 a[28:31], a[124:127], a[92:95], a[28:31]
    ds_read_b64_tr_b16 a[106:107], v10 offset:3072
    v_mfma_f32_16x16x32_bf16 a[24:27], a[124:127], a[84:87], a[24:27]
    ds_read_b64_tr_b16 a[108:109], v10 offset:10240
    v_mfma_f32_16x16x32_bf16 a[24:27], a[120:123], a[80:83], a[24:27]
    s_add_u32 m0, s61, 32768
    ds_read_b64_tr_b16 a[110:111], v10 offset:11264
    v_mfma_f32_16x16x32_bf16 a[20:23], a[120:123], a[72:75], a[20:23]
    s_add_u32 s40, s44, s42
    s_lshl_b32 s0, s38, 3
    v_mfma_f32_16x16x32_bf16 a[20:23], a[124:127], a[76:79], a[20:23]
    buffer_load_dwordx4 v2, s[4:7], s40 offen lds
    v_mfma_f32_16x16x32_bf16 a[16:19], a[124:127], a[68:71], a[16:19]
    v_mfma_f32_16x16x32_bf16 a[16:19], a[120:123], a[64:67], a[16:19]
    s_add_u32 s52, s0, s36
    s_sub_u32 s53, s0, s36
    s_waitcnt lgkmcnt(4)
    v_mfma_f32_16x16x32_bf16 a[128:131], a[64:67], a[96:99], a[128:131]
    s_add_u32 s53, s53, 7
    ds_read_b64_tr_b16 a[112:113], v9 offset:2304
    v_mfma_f32_16x16x32_bf16 a[128:131], a[68:71], a[100:103], a[128:131]
    ds_read_b64_tr_b16 a[114:115], v9 offset:3328
    v_mfma_f32_16x16x32_bf16 a[132:135], a[76:79], a[100:103], a[132:135]
    s_sub_u32 s54, 127, s53
    ds_read_b64_tr_b16 a[116:117], v9 offset:10496
    v_mfma_f32_16x16x32_bf16 a[132:135], a[72:75], a[96:99], a[132:135]
    s_sub_u32 s55, 127, s52
    ds_read_b64_tr_b16 a[118:119], v9 offset:11520
    v_mfma_f32_16x16x32_bf16 a[136:139], a[80:83], a[96:99], a[136:139]
    s_mul_i32 s48, s52, 20480
    v_mfma_f32_16x16x32_bf16 a[136:139], a[84:87], a[100:103], a[136:139]
    buffer_load_dwordx4 v3, s[4:7], s40 offen offset:1024 lds
    v_mfma_f32_16x16x32_bf16 a[140:143], a[92:95], a[100:103], a[140:143]
    v_mfma_f32_16x16x32_bf16 a[140:143], a[88:91], a[96:99], a[140:143]
    s_mul_i32 s49, s53, 20480
    s_waitcnt lgkmcnt(4)
    v_mfma_f32_16x16x32_bf16 a[156:159], a[88:91], a[104:107], a[156:159]
    s_mul_i32 s50, s54, 20480
    ds_read_b64_tr_b16 a[120:121], v10 offset:2304
    v_mfma_f32_16x16x32_bf16 a[156:159], a[92:95], a[108:111], a[156:159]
    s_add_u32 m0, s61, 34816
    ds_read_b64_tr_b16 a[122:123], v10 offset:3328
    v_mfma_f32_16x16x32_bf16 a[152:155], a[84:87], a[108:111], a[152:155]
    s_add_u32 s40, s45, s42
    ds_read_b64_tr_b16 a[124:125], v10 offset:10496
    v_mfma_f32_16x16x32_bf16 a[152:155], a[80:83], a[104:107], a[152:155]
    ds_read_b64_tr_b16 a[126:127], v10 offset:11520
    v_mfma_f32_16x16x32_bf16 a[148:151], a[72:75], a[104:107], a[148:151]
    buffer_load_dwordx4 v2, s[4:7], s40 offen lds
    v_mfma_f32_16x16x32_bf16 a[148:151], a[76:79], a[108:111], a[148:151]
    v_mfma_f32_16x16x32_bf16 a[144:147], a[68:71], a[108:111], a[144:147]
    buffer_load_dwordx4 v3, s[4:7], s40 offen offset:1024 lds
    v_mfma_f32_16x16x32_bf16 a[144:147], a[64:67], a[104:107], a[144:147]
    s_mul_i32 s51, s55, 20480
    s_waitcnt lgkmcnt(4)
    v_mfma_f32_16x16x32_bf16 a[160:163], a[64:67], a[112:115], a[160:163]
    s_add_u32 m0, s61, 36864
    ds_read_b64_tr_b16 a[96:97], v9 offset:2560
    v_mfma_f32_16x16x32_bf16 a[160:163], a[68:71], a[116:119], a[160:163]
    ds_read_b64_tr_b16 a[98:99], v9 offset:3584
    v_mfma_f32_16x16x32_bf16 a[164:167], a[76:79], a[116:119], a[164:167]
    s_add_u32 s40, s46, s42
    ds_read_b64_tr_b16 a[100:101], v9 offset:10752
    v_mfma_f32_16x16x32_bf16 a[164:167], a[72:75], a[112:115], a[164:167]
    s_getpc_b64 s[0:1]
L_t2:
    ds_read_b64_tr_b16 a[102:103], v9 offset:11776
    v_mfma_f32_16x16x32_bf16 a[168:171], a[80:83], a[112:115], a[168:171]
    v_mfma_f32_16x16x32_bf16 a[168:171], a[84:87], a[116:119], a[168:171]
    buffer_load_dwordx4 v2, s[4:7], s40 offen lds
    v_mfma_f32_16x16x32_bf16 a[172:175], a[92:95], a[116:119], a[172:175]
    v_mfma_f32_16x16x32_bf16 a[172:175], a[88:91], a[112:115], a[172:175]
    s_lshr_b32 s39, s2, 3
    s_lshl_b32 s39, s39, 2
    s_waitcnt lgkmcnt(4)
    v_mfma_f32_16x16x32_bf16 a[188:191], a[88:91], a[120:123], a[188:191]
    s_add_u32 s39, s39, s36
    ds_read_b64_tr_b16 a[104:105], v10 offset:2560
    v_mfma_f32_16x16x32_bf16 a[188:191], a[92:95], a[124:127], a[188:191]
    ds_read_b64_tr_b16 a[106:107], v10 offset:3584
    v_mfma_f32_16x16x32_bf16 a[184:187], a[84:87], a[124:127], a[184:187]
    ds_read_b64_tr_b16 a[108:109], v10 offset:10752
    v_mfma_f32_16x16x32_bf16 a[184:187], a[80:83], a[120:123], a[184:187]
    s_lshl_b32 s39, s39, 7
    ds_read_b64_tr_b16 a[110:111], v10 offset:11776
    v_mfma_f32_16x16x32_bf16 a[180:183], a[72:75], a[120:123], a[180:183]
    v_mfma_f32_16x16x32_bf16 a[180:183], a[76:79], a[124:127], a[180:183]
    v_and_b32 v142, 1, v1
    v_mfma_f32_16x16x32_bf16 a[176:179], a[68:71], a[124:127], a[176:179]
    buffer_load_dwordx4 v3, s[4:7], s40 offen offset:1024 lds
    v_mfma_f32_16x16x32_bf16 a[176:179], a[64:67], a[120:123], a[176:179]
    s_add_u32 m0, s61, 38912
    s_waitcnt lgkmcnt(4)
    v_mfma_f32_16x16x32_bf16 a[192:195], a[64:67], a[96:99], a[192:195]
    s_add_u32 s40, s47, s42
    ds_read_b64_tr_b16 a[112:113], v9 offset:2816
    v_mfma_f32_16x16x32_bf16 a[192:195], a[68:71], a[100:103], a[192:195]
    ds_read_b64_tr_b16 a[114:115], v9 offset:3840
    v_mfma_f32_16x16x32_bf16 a[196:199], a[76:79], a[100:103], a[196:199]
    ds_read_b64_tr_b16 a[116:117], v9 offset:11008
    v_lshl_add_u32 v142, v142, 14, s39
    v_mfma_f32_16x16x32_bf16 a[196:199], a[72:75], a[96:99], a[196:199]
    ds_read_b64_tr_b16 a[118:119], v9 offset:12032
    v_add_u32 v142, L_q0-L_t2, v142
    v_mfma_f32_16x16x32_bf16 a[200:203], a[80:83], a[96:99], a[200:203]
    buffer_load_dwordx4 v2, s[4:7], s40 offen lds
    v_mfma_f32_16x16x32_bf16 a[200:203], a[84:87], a[100:103], a[200:203]
    v_min_u32 v142, L_code_end-L_t2-4, v142
    v_mfma_f32_16x16x32_bf16 a[204:207], a[92:95], a[100:103], a[204:207]
    buffer_load_dwordx4 v3, s[4:7], s40 offen offset:1024 lds
    v_mfma_f32_16x16x32_bf16 a[204:207], a[88:91], a[96:99], a[204:207]
    s_waitcnt lgkmcnt(4)
    v_mfma_f32_16x16x32_bf16 a[220:223], a[88:91], a[104:107], a[220:223]
    ds_read_b64_tr_b16 a[120:121], v10 offset:2816
    v_mov_b32 v143, 0
    v_mfma_f32_16x16x32_bf16 a[220:223], a[92:95], a[108:111], a[220:223]
    ds_read_b64_tr_b16 a[122:123], v10 offset:3840
    v_lshl_add_u64 v[142:143], v[142:143], 0, s[0:1]
    v_mfma_f32_16x16x32_bf16 a[216:219], a[84:87], a[108:111], a[216:219]
    ds_read_b64_tr_b16 a[124:125], v10 offset:11008
    v_mfma_f32_16x16x32_bf16 a[216:219], a[80:83], a[104:107], a[216:219]
    ds_read_b64_tr_b16 a[126:127], v10 offset:12032
    v_mfma_f32_16x16x32_bf16 a[212:215], a[72:75], a[104:107], a[212:215]
    s_add_u32 s56, s56, 1
    s_cmp_eq_u32 s56, 8
    s_cselect_b32 s56, 0, s56
    v_mfma_f32_16x16x32_bf16 a[212:215], a[76:79], a[108:111], a[212:215]
    global_load_dword v142, v[142:143], off
    v_mfma_f32_16x16x32_bf16 a[208:211], a[68:71], a[108:111], a[208:211]
    v_add_u32 v9, 32768, v12
    v_add_u32 v10, 32768, v13
    v_mfma_f32_16x16x32_bf16 a[208:211], a[64:67], a[104:107], a[208:211]
    s_waitcnt vmcnt(20) lgkmcnt(0)
    s_barrier
    v_mfma_f32_16x16x32_bf16 a[224:227], a[64:67], a[112:115], a[224:227]
    s_xor_b32 s0, s37, 2
    ds_read_b64_tr_b16 a[96:97], v9 offset:0
    v_mfma_f32_16x16x32_bf16 a[224:227], a[68:71], a[116:119], a[224:227]
    ds_read_b64_tr_b16 a[98:99], v9 offset:1024
    buffer_load_dword v141, v140, s[68:71], 0 offen sc0 sc1
    v_mfma_f32_16x16x32_bf16 a[228:231], a[76:79], a[116:119], a[228:231]
    s_lshl_b32 s0, s0, 8
    ds_read_b64_tr_b16 a[100:101], v9 offset:8192
    v_mfma_f32_16x16x32_bf16 a[228:231], a[72:75], a[112:115], a[228:231]
    s_add_u32 s0, s0, 1835008
    ds_read_b64_tr_b16 a[102:103], v9 offset:9216
    v_mfma_f32_16x16x32_bf16 a[232:235], a[80:83], a[112:115], a[232:235]
    ds_read_b128 a[32:35], v7 offset:0
    v_mfma_f32_16x16x32_bf16 a[232:235], a[84:87], a[116:119], a[232:235]
    ds_read_b128 a[36:39], v8 offset:0
    v_mfma_f32_16x16x32_bf16 a[236:239], a[92:95], a[116:119], a[236:239]
    ds_read_b128 a[40:43], v7 offset:2048
    buffer_load_dword v135, v132, s[20:23], s0 offen
    v_mfma_f32_16x16x32_bf16 a[236:239], a[88:91], a[112:115], a[236:239]
    ds_read_b128 a[44:47], v8 offset:2048
    v_mfma_f32_16x16x32_bf16 a[252:255], a[88:91], a[120:123], a[252:255]
    s_lshl_b32 s0, s95, 7
    ds_read_b128 a[48:51], v7 offset:4096
    v_mfma_f32_16x16x32_bf16 a[252:255], a[92:95], a[124:127], a[252:255]
    s_add_u32 s0, s0, 774144
    ds_read_b128 a[52:55], v8 offset:4096
    v_mfma_f32_16x16x32_bf16 a[248:251], a[84:87], a[124:127], a[248:251]
    ds_read_b128 a[56:59], v7 offset:6144
    buffer_load_dword v135, v131, s[24:27], s0 offen offset:2048
    v_mfma_f32_16x16x32_bf16 a[248:251], a[80:83], a[120:123], a[248:251]
    ds_read_b128 a[60:63], v8 offset:6144
    v_mfma_f32_16x16x32_bf16 a[244:247], a[72:75], a[120:123], a[244:247]
    ds_read_b64_tr_b16 a[104:105], v10 offset:0
    v_mfma_f32_16x16x32_bf16 a[244:247], a[76:79], a[124:127], a[244:247]
    ds_read_b64_tr_b16 a[106:107], v10 offset:1024
    v_mfma_f32_16x16x32_bf16 a[240:243], a[68:71], a[124:127], a[240:243]
    ds_read_b64_tr_b16 a[108:109], v10 offset:8192
    buffer_load_dwordx2 v[148:149], v167, s[16:19], s84 offen offset:512
    v_mfma_f32_16x16x32_bf16 a[240:243], a[64:67], a[120:123], a[240:243]
    ds_read_b64_tr_b16 a[110:111], v10 offset:9216
    s_waitcnt lgkmcnt(4)
    v_mfma_f32_16x16x32_bf16 v[32:35], a[96:99], a[32:35], v[32:35]
    ds_read_b64_tr_b16 a[112:113], v9 offset:256
    v_mfma_f32_16x16x32_bf16 v[32:35], a[100:103], a[36:39], v[32:35]
    ds_read_b64_tr_b16 a[114:115], v9 offset:1280
    v_mfma_f32_16x16x32_bf16 v[36:39], a[100:103], a[44:47], v[36:39]
    ds_read_b64_tr_b16 a[116:117], v9 offset:8448
    v_mfma_f32_16x16x32_bf16 v[36:39], a[96:99], a[40:43], v[36:39]
    ds_read_b64_tr_b16 a[118:119], v9 offset:9472
    v_mfma_f32_16x16x32_bf16 v[40:43], a[96:99], a[48:51], v[40:43]
    s_mul_i32 s40, s56, 524288
    s_add_u32 s40, s40, s57
    v_mfma_f32_16x16x32_bf16 v[40:43], a[100:103], a[52:55], v[40:43]
    s_add_u32 m0, s60, 0
    v_lshrrev_b32 v14, 3, v1
    v_mfma_f32_16x16x32_bf16 v[44:47], a[100:103], a[60:63], v[44:47]
    buffer_load_dwordx4 v250, s[8:11], s40 offen nt lds
    v_mfma_f32_16x16x32_bf16 v[44:47], a[96:99], a[56:59], v[44:47]
    s_waitcnt lgkmcnt(4)
    v_mfma_f32_16x16x32_bf16 v[60:63], a[104:107], a[56:59], v[60:63]
    ds_read_b64_tr_b16 a[120:121], v10 offset:256
    v_mfma_f32_16x16x32_bf16 v[60:63], a[108:111], a[60:63], v[60:63]
    ds_read_b64_tr_b16 a[122:123], v10 offset:1280
    v_mul_u32_u24 v14, 1280, v14
    v_mfma_f32_16x16x32_bf16 v[56:59], a[108:111], a[52:55], v[56:59]
    ds_read_b64_tr_b16 a[124:125], v10 offset:8448
    v_lshrrev_b32 v15, 4, v1
    v_mfma_f32_16x16x32_bf16 v[56:59], a[104:107], a[48:51], v[56:59]
    ds_read_b64_tr_b16 a[126:127], v10 offset:9472
    v_and_b32 v17, 7, v1
    v_mfma_f32_16x16x32_bf16 v[52:55], a[104:107], a[40:43], v[52:55]
    v_xor_b32 v15, v15, v17
    v_mfma_f32_16x16x32_bf16 v[52:55], a[108:111], a[44:47], v[52:55]
    buffer_load_dwordx4 v251, s[8:11], s40 offen offset:1024 nt lds
    v_mfma_f32_16x16x32_bf16 v[48:51], a[108:111], a[36:39], v[48:51]
    v_mfma_f32_16x16x32_bf16 v[48:51], a[104:107], a[32:35], v[48:51]
    s_waitcnt lgkmcnt(4)
    v_mfma_f32_16x16x32_bf16 v[64:67], a[112:115], a[32:35], v[64:67]
    ds_read_b64_tr_b16 a[96:97], v9 offset:512
    v_mfma_f32_16x16x32_bf16 v[64:67], a[116:119], a[36:39], v[64:67]
    ds_read_b64_tr_b16 a[98:99], v9 offset:1536
    v_mfma_f32_16x16x32_bf16 v[68:71], a[116:119], a[44:47], v[68:71]
    ds_read_b64_tr_b16 a[100:101], v9 offset:8704
    v_lshl_add_u32 v16, v15, 4, v14
    v_mfma_f32_16x16x32_bf16 v[68:71], a[112:115], a[40:43], v[68:71]
    ds_read_b64_tr_b16 a[102:103], v9 offset:9728
    v_mfma_f32_16x16x32_bf16 v[72:75], a[112:115], a[48:51], v[72:75]
    s_xor_b32 s41, s40, 512
    v_xor_b32 v15, 4, v15
    v_mfma_f32_16x16x32_bf16 v[72:75], a[116:119], a[52:55], v[72:75]
    buffer_load_dwordx4 v250, s[12:15], s41 offen offset:2048 nt lds
    v_mfma_f32_16x16x32_bf16 v[76:79], a[116:119], a[60:63], v[76:79]
    v_lshl_add_u32 v17, v15, 4, v14
    v_mfma_f32_16x16x32_bf16 v[76:79], a[112:115], a[56:59], v[76:79]
    s_waitcnt lgkmcnt(4)
    v_mfma_f32_16x16x32_bf16 v[92:95], a[120:123], a[56:59], v[92:95]
    ds_read_b64_tr_b16 a[104:105], v10 offset:512
    v_mfma_f32_16x16x32_bf16 v[92:95], a[124:127], a[60:63], v[92:95]
    ds_read_b64_tr_b16 a[106:107], v10 offset:1536
    v_mfma_f32_16x16x32_bf16 v[88:91], a[124:127], a[52:55], v[88:91]
    ds_read_b64_tr_b16 a[108:109], v10 offset:8704
    v_mfma_f32_16x16x32_bf16 v[88:91], a[120:123], a[48:51], v[88:91]
    ds_read_b64_tr_b16 a[110:111], v10 offset:9728
    v_mfma_f32_16x16x32_bf16 v[84:87], a[120:123], a[40:43], v[84:87]
    buffer_load_dwordx4 v251, s[12:15], s41 offen offset:3072 nt lds
    v_mfma_f32_16x16x32_bf16 v[84:87], a[124:127], a[44:47], v[84:87]
    v_mfma_f32_16x16x32_bf16 v[80:83], a[124:127], a[36:39], v[80:83]
    s_add_u32 s40, s40, 131072
    v_mfma_f32_16x16x32_bf16 v[80:83], a[120:123], a[32:35], v[80:83]
    v_add_u32 v17, 9216, v17
    s_waitcnt lgkmcnt(4)
    v_mfma_f32_16x16x32_bf16 v[96:99], a[96:99], a[32:35], v[96:99]
    ds_read_b64_tr_b16 a[112:113], v9 offset:768
    v_mfma_f32_16x16x32_bf16 v[96:99], a[100:103], a[36:39], v[96:99]
    ds_read_b64_tr_b16 a[114:115], v9 offset:1792
    v_mfma_f32_16x16x32_bf16 v[100:103], a[100:103], a[44:47], v[100:103]
    ds_read_b64_tr_b16 a[116:117], v9 offset:8960
    v_mfma_f32_16x16x32_bf16 v[100:103], a[96:99], a[40:43], v[100:103]
    s_add_u32 m0, s60, 4096
    ds_read_b64_tr_b16 a[118:119], v9 offset:9984
    v_mfma_f32_16x16x32_bf16 v[104:107], a[96:99], a[48:51], v[104:107]
    buffer_load_dwordx4 v250, s[8:11], s40 offen nt lds
    v_mfma_f32_16x16x32_bf16 v[104:107], a[100:103], a[52:55], v[104:107]
    v_mfma_f32_16x16x32_bf16 v[108:111], a[100:103], a[60:63], v[108:111]
    v_bfe_u32 v14, v1, 2, 2
    v_mfma_f32_16x16x32_bf16 v[108:111], a[96:99], a[56:59], v[108:111]
    s_waitcnt lgkmcnt(4)
    v_mfma_f32_16x16x32_bf16 v[124:127], a[104:107], a[56:59], v[124:127]
    ds_read_b64_tr_b16 a[120:121], v10 offset:768
    v_mfma_f32_16x16x32_bf16 v[124:127], a[108:111], a[60:63], v[124:127]
    ds_read_b64_tr_b16 a[122:123], v10 offset:1792
    v_mfma_f32_16x16x32_bf16 v[120:123], a[108:111], a[52:55], v[120:123]
    ds_read_b64_tr_b16 a[124:125], v10 offset:8960
    v_mfma_f32_16x16x32_bf16 v[120:123], a[104:107], a[48:51], v[120:123]
    ds_read_b64_tr_b16 a[126:127], v10 offset:9984
    v_mfma_f32_16x16x32_bf16 v[116:119], a[104:107], a[40:43], v[116:119]
    buffer_load_dwordx4 v251, s[8:11], s40 offen offset:1024 nt lds
    v_mfma_f32_16x16x32_bf16 v[116:119], a[108:111], a[44:47], v[116:119]
    s_xor_b32 s41, s40, 512
    v_lshrrev_b32 v15, 5, v1
    v_mfma_f32_16x16x32_bf16 v[112:115], a[108:111], a[36:39], v[112:115]
    buffer_load_dwordx4 v250, s[12:15], s41 offen offset:2048 nt lds
    v_mfma_f32_16x16x32_bf16 v[112:115], a[104:107], a[32:35], v[112:115]
    s_waitcnt lgkmcnt(4)
    v_mfma_f32_16x16x32_bf16 a[0:3], a[112:115], a[32:35], a[0:3]
    ds_read_b64_tr_b16 a[96:97], v9 offset:2048
    v_lshl_add_u32 v14, v15, 2, v14
    v_mfma_f32_16x16x32_bf16 a[0:3], a[116:119], a[36:39], a[0:3]
    ds_read_b64_tr_b16 a[98:99], v9 offset:3072
    v_mfma_f32_16x16x32_bf16 a[4:7], a[116:119], a[44:47], a[4:7]
    ds_read_b64_tr_b16 a[100:101], v9 offset:10240
    v_mfma_f32_16x16x32_bf16 a[4:7], a[112:115], a[40:43], a[4:7]
    ds_read_b64_tr_b16 a[102:103], v9 offset:11264
    v_mfma_f32_16x16x32_bf16 a[8:11], a[112:115], a[48:51], a[8:11]
    buffer_load_dwordx4 v251, s[12:15], s41 offen offset:3072 nt lds
    v_mfma_f32_16x16x32_bf16 a[8:11], a[116:119], a[52:55], a[8:11]
    s_lshl_b32 s42, s56, 7
    v_mfma_f32_16x16x32_bf16 a[12:15], a[116:119], a[60:63], a[12:15]
    v_mfma_f32_16x16x32_bf16 a[12:15], a[112:115], a[56:59], a[12:15]
    s_waitcnt lgkmcnt(4)
    v_mfma_f32_16x16x32_bf16 a[28:31], a[120:123], a[56:59], a[28:31]
    s_add_u32 m0, s61, 0
    ds_read_b64_tr_b16 a[104:105], v10 offset:2048
    v_mfma_f32_16x16x32_bf16 a[28:31], a[124:127], a[60:63], a[28:31]
    s_add_u32 s40, s44, s42
    ds_read_b64_tr_b16 a[106:107], v10 offset:3072
    v_mfma_f32_16x16x32_bf16 a[24:27], a[124:127], a[52:55], a[24:27]
    ds_read_b64_tr_b16 a[108:109], v10 offset:10240
    v_mfma_f32_16x16x32_bf16 a[24:27], a[120:123], a[48:51], a[24:27]
    ds_read_b64_tr_b16 a[110:111], v10 offset:11264
    v_mul_u32_u24 v14, 3456, v14
    v_mfma_f32_16x16x32_bf16 a[20:23], a[120:123], a[40:43], a[20:23]
    buffer_load_dwordx4 v2, s[4:7], s40 offen lds
    v_mfma_f32_16x16x32_bf16 a[20:23], a[124:127], a[44:47], a[20:23]
    v_mfma_f32_16x16x32_bf16 a[16:19], a[124:127], a[36:39], a[16:19]
    v_mfma_f32_16x16x32_bf16 a[16:19], a[120:123], a[32:35], a[16:19]
    s_waitcnt lgkmcnt(4)
    v_mfma_f32_16x16x32_bf16 a[128:131], a[32:35], a[96:99], a[128:131]
    ds_read_b64_tr_b16 a[112:113], v9 offset:2304
    v_mfma_f32_16x16x32_bf16 a[128:131], a[36:39], a[100:103], a[128:131]
    ds_read_b64_tr_b16 a[114:115], v9 offset:3328
    v_mfma_f32_16x16x32_bf16 a[132:135], a[44:47], a[100:103], a[132:135]
    ds_read_b64_tr_b16 a[116:117], v9 offset:10496
    v_mfma_f32_16x16x32_bf16 a[132:135], a[40:43], a[96:99], a[132:135]
    ds_read_b64_tr_b16 a[118:119], v9 offset:11520
    v_mfma_f32_16x16x32_bf16 a[136:139], a[48:51], a[96:99], a[136:139]
    v_mfma_f32_16x16x32_bf16 a[136:139], a[52:55], a[100:103], a[136:139]
    buffer_load_dwordx4 v3, s[4:7], s40 offen offset:1024 lds
    v_mfma_f32_16x16x32_bf16 a[140:143], a[60:63], a[100:103], a[140:143]
    v_bfe_u32 v15, v1, 4, 1
    v_mfma_f32_16x16x32_bf16 a[140:143], a[56:59], a[96:99], a[140:143]
    s_waitcnt lgkmcnt(4)
    v_mfma_f32_16x16x32_bf16 a[156:159], a[56:59], a[104:107], a[156:159]
    ds_read_b64_tr_b16 a[120:121], v10 offset:2304
    v_mfma_f32_16x16x32_bf16 a[156:159], a[60:63], a[108:111], a[156:159]
    s_add_u32 m0, s61, 2048
    ds_read_b64_tr_b16 a[122:123], v10 offset:3328
    v_mfma_f32_16x16x32_bf16 a[152:155], a[52:55], a[108:111], a[152:155]
    ds_read_b64_tr_b16 a[124:125], v10 offset:10496
    v_mfma_f32_16x16x32_bf16 a[152:155], a[48:51], a[104:107], a[152:155]
    s_add_u32 s40, s45, s42
    ds_read_b64_tr_b16 a[126:127], v10 offset:11520
    v_mfma_f32_16x16x32_bf16 a[148:151], a[40:43], a[104:107], a[148:151]
    v_mfma_f32_16x16x32_bf16 a[148:151], a[44:47], a[108:111], a[148:151]
    buffer_load_dwordx4 v2, s[4:7], s40 offen lds
    v_mfma_f32_16x16x32_bf16 a[144:147], a[36:39], a[108:111], a[144:147]
    s_cmp_lt_u32 s94, 46
    s_cselect_b32 s0, 6, 30
    v_lshl_add_u32 v14, v15, s0, v14
    v_mfma_f32_16x16x32_bf16 a[144:147], a[32:35], a[104:107], a[144:147]
    s_waitcnt lgkmcnt(4)
    v_mfma_f32_16x16x32_bf16 a[160:163], a[32:35], a[112:115], a[160:163]
    ds_read_b64_tr_b16 a[96:97], v9 offset:2560
    v_mfma_f32_16x16x32_bf16 a[160:163], a[36:39], a[116:119], a[160:163]
    ds_read_b64_tr_b16 a[98:99], v9 offset:3584
    v_mfma_f32_16x16x32_bf16 a[164:167], a[44:47], a[116:119], a[164:167]
    ds_read_b64_tr_b16 a[100:101], v9 offset:10752
    v_mfma_f32_16x16x32_bf16 a[164:167], a[40:43], a[112:115], a[164:167]
    ds_read_b64_tr_b16 a[102:103], v9 offset:11776
    v_lshl_add_u32 v6, v31, 4, v14
    v_mfma_f32_16x16x32_bf16 a[168:171], a[48:51], a[112:115], a[168:171]
    buffer_load_dwordx4 v3, s[4:7], s40 offen offset:1024 lds
    v_mfma_f32_16x16x32_bf16 a[168:171], a[52:55], a[116:119], a[168:171]
    v_mfma_f32_16x16x32_bf16 a[172:175], a[60:63], a[116:119], a[172:175]
    v_mfma_f32_16x16x32_bf16 a[172:175], a[56:59], a[112:115], a[172:175]
    s_add_u32 m0, s61, 4096
    s_waitcnt lgkmcnt(4)
    v_mfma_f32_16x16x32_bf16 a[188:191], a[56:59], a[120:123], a[188:191]
    s_add_u32 s40, s46, s42
    ds_read_b64_tr_b16 a[104:105], v10 offset:2560
    v_mfma_f32_16x16x32_bf16 a[188:191], a[60:63], a[124:127], a[188:191]
    s_mul_i32 s58, s58, 3456
    ds_read_b64_tr_b16 a[106:107], v10 offset:3584
    v_mfma_f32_16x16x32_bf16 a[184:187], a[52:55], a[124:127], a[184:187]
    ds_read_b64_tr_b16 a[108:109], v10 offset:10752
    v_mfma_f32_16x16x32_bf16 a[184:187], a[48:51], a[120:123], a[184:187]
    ds_read_b64_tr_b16 a[110:111], v10 offset:11776
    v_mfma_f32_16x16x32_bf16 a[180:183], a[40:43], a[120:123], a[180:183]
    buffer_load_dwordx4 v2, s[4:7], s40 offen lds
    v_mfma_f32_16x16x32_bf16 a[180:183], a[44:47], a[124:127], a[180:183]
    v_mfma_f32_16x16x32_bf16 a[176:179], a[36:39], a[124:127], a[176:179]
    buffer_load_dwordx4 v3, s[4:7], s40 offen offset:1024 lds
    v_mfma_f32_16x16x32_bf16 a[176:179], a[32:35], a[120:123], a[176:179]
    s_waitcnt lgkmcnt(4)
    v_mfma_f32_16x16x32_bf16 a[192:195], a[32:35], a[96:99], a[192:195]
    ds_read_b64_tr_b16 a[112:113], v9 offset:2816
    v_mfma_f32_16x16x32_bf16 a[192:195], a[36:39], a[100:103], a[192:195]
    ds_read_b64_tr_b16 a[114:115], v9 offset:3840
    v_mfma_f32_16x16x32_bf16 a[196:199], a[44:47], a[100:103], a[196:199]
    ds_read_b64_tr_b16 a[116:117], v9 offset:11008
    v_mfma_f32_16x16x32_bf16 a[196:199], a[40:43], a[96:99], a[196:199]
    ds_read_b64_tr_b16 a[118:119], v9 offset:12032
    v_mfma_f32_16x16x32_bf16 a[200:203], a[48:51], a[96:99], a[200:203]
L_ws_1631:
    s_cbranch_execz L_ws_3877
    s_add_u32 m0, s61, 6144
    v_mfma_f32_16x16x32_bf16 a[200:203], a[52:55], a[100:103], a[200:203]
    s_add_u32 s40, s47, s42
    s_lshl_b32 s0, s94, 6
    v_mfma_f32_16x16x32_bf16 a[204:207], a[60:63], a[100:103], a[204:207]
    buffer_load_dwordx4 v2, s[4:7], s40 offen lds
    v_mfma_f32_16x16x32_bf16 a[204:207], a[56:59], a[96:99], a[204:207]
    s_waitcnt lgkmcnt(4)
    v_mfma_f32_16x16x32_bf16 a[220:223], a[56:59], a[104:107], a[220:223]
    s_add_u32 s58, s58, s0
    ds_read_b64_tr_b16 a[120:121], v10 offset:2816
    v_mfma_f32_16x16x32_bf16 a[220:223], a[60:63], a[108:111], a[220:223]
    ds_read_b64_tr_b16 a[122:123], v10 offset:3840
    v_mfma_f32_16x16x32_bf16 a[216:219], a[52:55], a[108:111], a[216:219]
    ds_read_b64_tr_b16 a[124:125], v10 offset:11008
    v_mfma_f32_16x16x32_bf16 a[216:219], a[48:51], a[104:107], a[216:219]
    ds_read_b64_tr_b16 a[126:127], v10 offset:12032
    v_mfma_f32_16x16x32_bf16 a[212:215], a[40:43], a[104:107], a[212:215]
    buffer_load_dwordx4 v3, s[4:7], s40 offen offset:1024 lds
    v_mfma_f32_16x16x32_bf16 a[212:215], a[44:47], a[108:111], a[212:215]
    s_add_u32 s56, s56, 1
    s_cmp_eq_u32 s56, 8
    s_cselect_b32 s56, 0, s56
    v_mfma_f32_16x16x32_bf16 a[208:211], a[36:39], a[108:111], a[208:211]
    v_add_u32 v9, 65536, v12
    v_add_u32 v10, 65536, v13
    v_mfma_f32_16x16x32_bf16 a[208:211], a[32:35], a[104:107], a[208:211]
    s_waitcnt vmcnt(21) lgkmcnt(0)
    s_barrier
    v_mfma_f32_16x16x32_bf16 a[224:227], a[32:35], a[112:115], a[224:227]
    s_xor_b32 s0, s37, 3
    ds_read_b64_tr_b16 a[96:97], v9 offset:0
    v_mfma_f32_16x16x32_bf16 a[224:227], a[36:39], a[116:119], a[224:227]
    s_lshl_b32 s0, s0, 8
    ds_read_b64_tr_b16 a[98:99], v9 offset:1024
    v_mfma_f32_16x16x32_bf16 a[228:231], a[44:47], a[116:119], a[228:231]
    ds_read_b64_tr_b16 a[100:101], v9 offset:8192
    v_mfma_f32_16x16x32_bf16 a[228:231], a[40:43], a[112:115], a[228:231]
    s_add_u32 s0, s0, 2752512
    ds_read_b64_tr_b16 a[102:103], v9 offset:9216
    v_mfma_f32_16x16x32_bf16 a[232:235], a[48:51], a[112:115], a[232:235]
    ds_read_b128 a[64:67], v7 offset:32768
    buffer_load_dword v135, v132, s[20:23], s0 offen
    v_mfma_f32_16x16x32_bf16 a[232:235], a[52:55], a[116:119], a[232:235]
    ds_read_b128 a[68:71], v8 offset:32768
    v_mfma_f32_16x16x32_bf16 a[236:239], a[60:63], a[116:119], a[236:239]
    ds_read_b128 a[72:75], v7 offset:34816
    v_mfma_f32_16x16x32_bf16 a[236:239], a[56:59], a[112:115], a[236:239]
    ds_read_b128 a[76:79], v8 offset:34816
    v_mfma_f32_16x16x32_bf16 a[252:255], a[56:59], a[120:123], a[252:255]
    ds_read_b128 a[80:83], v7 offset:36864
    v_mfma_f32_16x16x32_bf16 a[252:255], a[60:63], a[124:127], a[252:255]
    ds_read_b128 a[84:87], v8 offset:36864
    v_mfma_f32_16x16x32_bf16 a[248:251], a[52:55], a[124:127], a[248:251]
    ds_read_b128 a[88:91], v7 offset:38912
    buffer_load_dwordx2 v[150:151], v167, s[16:19], s84 offen offset:768
    v_mfma_f32_16x16x32_bf16 a[248:251], a[48:51], a[120:123], a[248:251]
    ds_read_b128 a[92:95], v8 offset:38912
    v_mfma_f32_16x16x32_bf16 a[244:247], a[40:43], a[120:123], a[244:247]
    ds_read_b64_tr_b16 a[104:105], v10 offset:0
    v_mfma_f32_16x16x32_bf16 a[244:247], a[44:47], a[124:127], a[244:247]
    ds_read_b64_tr_b16 a[106:107], v10 offset:1024
    v_mfma_f32_16x16x32_bf16 a[240:243], a[36:39], a[124:127], a[240:243]
    ds_read_b64_tr_b16 a[108:109], v10 offset:8192
    buffer_load_dwordx2 v[152:153], v167, s[16:19], s84 offen offset:1024
    v_mfma_f32_16x16x32_bf16 a[240:243], a[32:35], a[120:123], a[240:243]
    ds_read_b64_tr_b16 a[110:111], v10 offset:9216
    s_waitcnt vmcnt(22)
    v_cmp_ne_u32 vcc, 1, v141
    s_nop 0
    s_cmp_eq_u64 vcc, 0
    s_cbranch_scc1 L_iw_ok
L_iw_no:
    s_mov_b32 s39, 0x40000
L_iw_spin:
    buffer_load_dword v141, v140, s[68:71], 0 offen sc0 sc1
    s_waitcnt vmcnt(0)
    v_cmp_ne_u32 vcc, 1, v141
    s_nop 0
    s_cmp_eq_u64 vcc, 0
    s_cbranch_scc1 L_iw_ok
L_iw_again:
    s_sleep 4
    s_sub_u32 s39, s39, 1
    s_cmp_lg_u32 s39, 0
    s_cbranch_scc1 L_iw_spin
L_iw_ok:
    s_waitcnt lgkmcnt(4)
    v_mfma_f32_16x16x32_bf16 v[32:35], a[96:99], a[64:67], v[32:35]
    ds_read_b64_tr_b16 a[112:113], v9 offset:256
    v_mfma_f32_16x16x32_bf16 v[32:35], a[100:103], a[68:71], v[32:35]
    ds_read_b64_tr_b16 a[114:115], v9 offset:1280
    v_mfma_f32_16x16x32_bf16 v[36:39], a[100:103], a[76:79], v[36:39]
    ds_read_b64_tr_b16 a[116:117], v9 offset:8448
    v_mfma_f32_16x16x32_bf16 v[36:39], a[96:99], a[72:75], v[36:39]
    ds_read_b64_tr_b16 a[118:119], v9 offset:9472
    v_mfma_f32_16x16x32_bf16 v[40:43], a[96:99], a[80:83], v[40:43]
    s_mul_i32 s40, s56, 524288
    s_add_u32 s40, s40, s57
    v_mfma_f32_16x16x32_bf16 v[40:43], a[100:103], a[84:87], v[40:43]
    v_mfma_f32_16x16x32_bf16 v[44:47], a[100:103], a[92:95], v[44:47]
    s_add_u32 m0, s60, 32768
    v_mfma_f32_16x16x32_bf16 v[44:47], a[96:99], a[88:91], v[44:47]
    s_waitcnt lgkmcnt(4)
    v_mfma_f32_16x16x32_bf16 v[60:63], a[104:107], a[88:91], v[60:63]
    ds_read_b64_tr_b16 a[120:121], v10 offset:256
    v_mfma_f32_16x16x32_bf16 v[60:63], a[108:111], a[92:95], v[60:63]
    ds_read_b64_tr_b16 a[122:123], v10 offset:1280
    v_mfma_f32_16x16x32_bf16 v[56:59], a[108:111], a[84:87], v[56:59]
    ds_read_b64_tr_b16 a[124:125], v10 offset:8448
    v_mfma_f32_16x16x32_bf16 v[56:59], a[104:107], a[80:83], v[56:59]
    ds_read_b64_tr_b16 a[126:127], v10 offset:9472
    v_mfma_f32_16x16x32_bf16 v[52:55], a[104:107], a[72:75], v[52:55]
    v_mfma_f32_16x16x32_bf16 v[52:55], a[108:111], a[76:79], v[52:55]
    buffer_load_dwordx4 v250, s[8:11], s40 offen nt lds
    v_mfma_f32_16x16x32_bf16 v[48:51], a[108:111], a[68:71], v[48:51]
    v_mfma_f32_16x16x32_bf16 v[48:51], a[104:107], a[64:67], v[48:51]
    s_waitcnt lgkmcnt(4)
    v_mfma_f32_16x16x32_bf16 v[64:67], a[112:115], a[64:67], v[64:67]
    ds_read_b64_tr_b16 a[96:97], v9 offset:512
    v_mfma_f32_16x16x32_bf16 v[64:67], a[116:119], a[68:71], v[64:67]
    ds_read_b64_tr_b16 a[98:99], v9 offset:1536
    v_mfma_f32_16x16x32_bf16 v[68:71], a[116:119], a[76:79], v[68:71]
    ds_read_b64_tr_b16 a[100:101], v9 offset:8704
    v_mfma_f32_16x16x32_bf16 v[68:71], a[112:115], a[72:75], v[68:71]
    ds_read_b64_tr_b16 a[102:103], v9 offset:9728
    v_mfma_f32_16x16x32_bf16 v[72:75], a[112:115], a[80:83], v[72:75]
    buffer_load_dwordx4 v251, s[8:11], s40 offen offset:1024 nt lds
    v_mfma_f32_16x16x32_bf16 v[72:75], a[116:119], a[84:87], v[72:75]
    v_mfma_f32_16x16x32_bf16 v[76:79], a[116:119], a[92:95], v[76:79]
    v_mfma_f32_16x16x32_bf16 v[76:79], a[112:115], a[88:91], v[76:79]
    s_waitcnt lgkmcnt(4)
    v_mfma_f32_16x16x32_bf16 v[92:95], a[120:123], a[88:91], v[92:95]
    ds_read_b64_tr_b16 a[104:105], v10 offset:512
    v_mfma_f32_16x16x32_bf16 v[92:95], a[124:127], a[92:95], v[92:95]
    ds_read_b64_tr_b16 a[106:107], v10 offset:1536
    v_mfma_f32_16x16x32_bf16 v[88:91], a[124:127], a[84:87], v[88:91]
    ds_read_b64_tr_b16 a[108:109], v10 offset:8704
    v_mfma_f32_16x16x32_bf16 v[88:91], a[120:123], a[80:83], v[88:91]
    s_xor_b32 s41, s40, 512
    ds_read_b64_tr_b16 a[110:111], v10 offset:9728
    v_mfma_f32_16x16x32_bf16 v[84:87], a[120:123], a[72:75], v[84:87]
    buffer_load_dwordx4 v250, s[12:15], s41 offen offset:2048 nt lds
    v_mfma_f32_16x16x32_bf16 v[84:87], a[124:127], a[76:79], v[84:87]
    v_mfma_f32_16x16x32_bf16 v[80:83], a[124:127], a[68:71], v[80:83]
    v_mfma_f32_16x16x32_bf16 v[80:83], a[120:123], a[64:67], v[80:83]
    s_waitcnt lgkmcnt(4)
    v_mfma_f32_16x16x32_bf16 v[96:99], a[96:99], a[64:67], v[96:99]
    ds_read_b64_tr_b16 a[112:113], v9 offset:768
    v_mfma_f32_16x16x32_bf16 v[96:99], a[100:103], a[68:71], v[96:99]
    ds_read_b64_tr_b16 a[114:115], v9 offset:1792
    v_mfma_f32_16x16x32_bf16 v[100:103], a[100:103], a[76:79], v[100:103]
    ds_read_b64_tr_b16 a[116:117], v9 offset:8960
    v_mfma_f32_16x16x32_bf16 v[100:103], a[96:99], a[72:75], v[100:103]
    ds_read_b64_tr_b16 a[118:119], v9 offset:9984
    v_mfma_f32_16x16x32_bf16 v[104:107], a[96:99], a[80:83], v[104:107]
    v_mfma_f32_16x16x32_bf16 v[104:107], a[100:103], a[84:87], v[104:107]
    buffer_load_dwordx4 v251, s[12:15], s41 offen offset:3072 nt lds
    v_mfma_f32_16x16x32_bf16 v[108:111], a[100:103], a[92:95], v[108:111]
    v_mfma_f32_16x16x32_bf16 v[108:111], a[96:99], a[88:91], v[108:111]
    s_waitcnt lgkmcnt(4)
    v_mfma_f32_16x16x32_bf16 v[124:127], a[104:107], a[88:91], v[124:127]
    s_add_u32 s40, s40, 131072
    ds_read_b64_tr_b16 a[120:121], v10 offset:768
    v_mfma_f32_16x16x32_bf16 v[124:127], a[108:111], a[92:95], v[124:127]
    ds_read_b64_tr_b16 a[122:123], v10 offset:1792
    v_mfma_f32_16x16x32_bf16 v[120:123], a[108:111], a[84:87], v[120:123]
    s_add_u32 m0, s60, 36864
    ds_read_b64_tr_b16 a[124:125], v10 offset:8960
    v_mfma_f32_16x16x32_bf16 v[120:123], a[104:107], a[80:83], v[120:123]
    ds_read_b64_tr_b16 a[126:127], v10 offset:9984
    v_mfma_f32_16x16x32_bf16 v[116:119], a[104:107], a[72:75], v[116:119]
    buffer_load_dwordx4 v250, s[8:11], s40 offen nt lds
    v_mfma_f32_16x16x32_bf16 v[116:119], a[108:111], a[76:79], v[116:119]
    v_mfma_f32_16x16x32_bf16 v[112:115], a[108:111], a[68:71], v[112:115]
    buffer_load_dwordx4 v251, s[8:11], s40 offen offset:1024 nt lds
    v_mfma_f32_16x16x32_bf16 v[112:115], a[104:107], a[64:67], v[112:115]
    s_xor_b32 s41, s40, 512
    s_waitcnt lgkmcnt(4)
    v_mfma_f32_16x16x32_bf16 a[0:3], a[112:115], a[64:67], a[0:3]
    ds_read_b64_tr_b16 a[96:97], v9 offset:2048
    v_mfma_f32_16x16x32_bf16 a[0:3], a[116:119], a[68:71], a[0:3]
    ds_read_b64_tr_b16 a[98:99], v9 offset:3072
    v_mfma_f32_16x16x32_bf16 a[4:7], a[116:119], a[76:79], a[4:7]
    ds_read_b64_tr_b16 a[100:101], v9 offset:10240
    v_mfma_f32_16x16x32_bf16 a[4:7], a[112:115], a[72:75], a[4:7]
    ds_read_b64_tr_b16 a[102:103], v9 offset:11264
    v_mfma_f32_16x16x32_bf16 a[8:11], a[112:115], a[80:83], a[8:11]
    buffer_load_dwordx4 v250, s[12:15], s41 offen offset:2048 nt lds
    v_mfma_f32_16x16x32_bf16 a[8:11], a[116:119], a[84:87], a[8:11]
    v_mfma_f32_16x16x32_bf16 a[12:15], a[116:119], a[92:95], a[12:15]
    buffer_load_dwordx4 v251, s[12:15], s41 offen offset:3072 nt lds
    v_mfma_f32_16x16x32_bf16 a[12:15], a[112:115], a[88:91], a[12:15]
    s_waitcnt lgkmcnt(4)
    v_mfma_f32_16x16x32_bf16 a[28:31], a[120:123], a[88:91], a[28:31]
    s_lshl_b32 s42, s56, 7
    ds_read_b64_tr_b16 a[104:105], v10 offset:2048
    v_mfma_f32_16x16x32_bf16 a[28:31], a[124:127], a[92:95], a[28:31]
    ds_read_b64_tr_b16 a[106:107], v10 offset:3072
    v_mfma_f32_16x16x32_bf16 a[24:27], a[124:127], a[84:87], a[24:27]
    s_add_u32 m0, s61, 32768
    ds_read_b64_tr_b16 a[108:109], v10 offset:10240
    v_mfma_f32_16x16x32_bf16 a[24:27], a[120:123], a[80:83], a[24:27]
    s_add_u32 s40, s44, s42
    ds_read_b64_tr_b16 a[110:111], v10 offset:11264
    v_mfma_f32_16x16x32_bf16 a[20:23], a[120:123], a[72:75], a[20:23]
    v_mfma_f32_16x16x32_bf16 a[20:23], a[124:127], a[76:79], a[20:23]
    buffer_load_dwordx4 v2, s[4:7], s40 offen lds
    v_mfma_f32_16x16x32_bf16 a[16:19], a[124:127], a[68:71], a[16:19]
    v_mfma_f32_16x16x32_bf16 a[16:19], a[120:123], a[64:67], a[16:19]
    s_waitcnt lgkmcnt(4)
    v_mfma_f32_16x16x32_bf16 a[128:131], a[64:67], a[96:99], a[128:131]
    ds_read_b64_tr_b16 a[112:113], v9 offset:2304
    v_mfma_f32_16x16x32_bf16 a[128:131], a[68:71], a[100:103], a[128:131]
    ds_read_b64_tr_b16 a[114:115], v9 offset:3328
    v_mfma_f32_16x16x32_bf16 a[132:135], a[76:79], a[100:103], a[132:135]
    ds_read_b64_tr_b16 a[116:117], v9 offset:10496
    v_mfma_f32_16x16x32_bf16 a[132:135], a[72:75], a[96:99], a[132:135]
    ds_read_b64_tr_b16 a[118:119], v9 offset:11520
    v_mfma_f32_16x16x32_bf16 a[136:139], a[80:83], a[96:99], a[136:139]
    v_mfma_f32_16x16x32_bf16 a[136:139], a[84:87], a[100:103], a[136:139]
    buffer_load_dwordx4 v3, s[4:7], s40 offen offset:1024 lds
    v_mfma_f32_16x16x32_bf16 a[140:143], a[92:95], a[100:103], a[140:143]
    v_mfma_f32_16x16x32_bf16 a[140:143], a[88:91], a[96:99], a[140:143]
    s_waitcnt lgkmcnt(4)
    v_mfma_f32_16x16x32_bf16 a[156:159], a[88:91], a[104:107], a[156:159]
    ds_read_b64_tr_b16 a[120:121], v10 offset:2304
    v_mfma_f32_16x16x32_bf16 a[156:159], a[92:95], a[108:111], a[156:159]
    s_add_u32 m0, s61, 34816
    ds_read_b64_tr_b16 a[122:123], v10 offset:3328
    v_mfma_f32_16x16x32_bf16 a[152:155], a[84:87], a[108:111], a[152:155]
    s_add_u32 s40, s45, s42
    ds_read_b64_tr_b16 a[124:125], v10 offset:10496
    v_mfma_f32_16x16x32_bf16 a[152:155], a[80:83], a[104:107], a[152:155]
    ds_read_b64_tr_b16 a[126:127], v10 offset:11520
    v_mfma_f32_16x16x32_bf16 a[148:151], a[72:75], a[104:107], a[148:151]
    buffer_load_dwordx4 v2, s[4:7], s40 offen lds
    v_mfma_f32_16x16x32_bf16 a[148:151], a[76:79], a[108:111], a[148:151]
    v_mfma_f32_16x16x32_bf16 a[144:147], a[68:71], a[108:111], a[144:147]
    v_mfma_f32_16x16x32_bf16 a[144:147], a[64:67], a[104:107], a[144:147]
    s_waitcnt lgkmcnt(4)
    v_mfma_f32_16x16x32_bf16 a[160:163], a[64:67], a[112:115], a[160:163]
    ds_read_b64_tr_b16 a[96:97], v9 offset:2560
    v_mfma_f32_16x16x32_bf16 a[160:163], a[68:71], a[116:119], a[160:163]
    ds_read_b64_tr_b16 a[98:99], v9 offset:3584
    v_mfma_f32_16x16x32_bf16 a[164:167], a[76:79], a[116:119], a[164:167]
    ds_read_b64_tr_b16 a[100:101], v9 offset:10752
    v_mfma_f32_16x16x32_bf16 a[164:167], a[72:75], a[112:115], a[164:167]
    ds_read_b64_tr_b16 a[102:103], v9 offset:11776
    v_mfma_f32_16x16x32_bf16 a[168:171], a[80:83], a[112:115], a[168:171]
    v_mfma_f32_16x16x32_bf16 a[168:171], a[84:87], a[116:119], a[168:171]
    buffer_load_dwordx4 v3, s[4:7], s40 offen offset:1024 lds
    v_mfma_f32_16x16x32_bf16 a[172:175], a[92:95], a[116:119], a[172:175]
    s_add_u32 m0, s61, 36864
    v_mfma_f32_16x16x32_bf16 a[172:175], a[88:91], a[112:115], a[172:175]
    s_waitcnt lgkmcnt(4)
    v_mfma_f32_16x16x32_bf16 a[188:191], a[88:91], a[120:123], a[188:191]
    ds_read_b64_tr_b16 a[104:105], v10 offset:2560
    v_mfma_f32_16x16x32_bf16 a[188:191], a[92:95], a[124:127], a[188:191]
    s_add_u32 s40, s46, s42
    ds_read_b64_tr_b16 a[106:107], v10 offset:3584
    v_mfma_f32_16x16x32_bf16 a[184:187], a[84:87], a[124:127], a[184:187]
    ds_read_b64_tr_b16 a[108:109], v10 offset:10752
    v_mfma_f32_16x16x32_bf16 a[184:187], a[80:83], a[120:123], a[184:187]
    ds_read_b64_tr_b16 a[110:111], v10 offset:11776
    v_mfma_f32_16x16x32_bf16 a[180:183], a[72:75], a[120:123], a[180:183]
    buffer_load_dwordx4 v2, s[4:7], s40 offen lds
    v_mfma_f32_16x16x32_bf16 a[180:183], a[76:79], a[124:127], a[180:183]
    v_mfma_f32_16x16x32_bf16 a[176:179], a[68:71], a[124:127], a[176:179]
    buffer_load_dwordx4 v3, s[4:7], s40 offen offset:1024 lds
    v_mfma_f32_16x16x32_bf16 a[176:179], a[64:67], a[120:123], a[176:179]
    s_waitcnt lgkmcnt(4)
    v_mfma_f32_16x16x32_bf16 a[192:195], a[64:67], a[96:99], a[192:195]
    ds_read_b64_tr_b16 a[112:113], v9 offset:2816
    v_mfma_f32_16x16x32_bf16 a[192:195], a[68:71], a[100:103], a[192:195]
    s_add_u32 m0, s61, 38912
    ds_read_b64_tr_b16 a[114:115], v9 offset:3840
    v_mfma_f32_16x16x32_bf16 a[196:199], a[76:79], a[100:103], a[196:199]
    s_add_u32 s40, s47, s42
    ds_read_b64_tr_b16 a[116:117], v9 offset:11008
    v_mfma_f32_16x16x32_bf16 a[196:199], a[72:75], a[96:99], a[196:199]
    ds_read_b64_tr_b16 a[118:119], v9 offset:12032
    v_mfma_f32_16x16x32_bf16 a[200:203], a[80:83], a[96:99], a[200:203]
    v_mfma_f32_16x16x32_bf16 a[200:203], a[84:87], a[100:103], a[200:203]
    v_mfma_f32_16x16x32_bf16 a[204:207], a[92:95], a[100:103], a[204:207]
    buffer_load_dwordx4 v2, s[4:7], s40 offen lds
    v_mfma_f32_16x16x32_bf16 a[204:207], a[88:91], a[96:99], a[204:207]
    s_waitcnt lgkmcnt(4)
    v_mfma_f32_16x16x32_bf16 a[220:223], a[88:91], a[104:107], a[220:223]
    ds_read_b64_tr_b16 a[120:121], v10 offset:2816
    v_mfma_f32_16x16x32_bf16 a[220:223], a[92:95], a[108:111], a[220:223]
    ds_read_b64_tr_b16 a[122:123], v10 offset:3840
    v_mfma_f32_16x16x32_bf16 a[216:219], a[84:87], a[108:111], a[216:219]
    ds_read_b64_tr_b16 a[124:125], v10 offset:11008
    v_mfma_f32_16x16x32_bf16 a[216:219], a[80:83], a[104:107], a[216:219]
    ds_read_b64_tr_b16 a[126:127], v10 offset:12032
    v_mfma_f32_16x16x32_bf16 a[212:215], a[72:75], a[104:107], a[212:215]
    buffer_load_dwordx4 v3, s[4:7], s40 offen offset:1024 lds
    v_mfma_f32_16x16x32_bf16 a[212:215], a[76:79], a[108:111], a[212:215]
    s_add_u32 s56, s56, 1
    s_cmp_eq_u32 s56, 8
    s_cselect_b32 s56, 0, s56
    v_mfma_f32_16x16x32_bf16 a[208:211], a[68:71], a[108:111], a[208:211]
    v_add_u32 v9, 0, v12
    v_add_u32 v10, 0, v13
    v_mfma_f32_16x16x32_bf16 a[208:211], a[64:67], a[104:107], a[208:211]
    s_waitcnt vmcnt(19) lgkmcnt(0)
    s_barrier
    v_mfma_f32_16x16x32_bf16 a[224:227], a[64:67], a[112:115], a[224:227]
    s_xor_b32 s0, s37, 0
    ds_read_b64_tr_b16 a[96:97], v9 offset:0
    v_mfma_f32_16x16x32_bf16 a[224:227], a[68:71], a[116:119], a[224:227]
    s_lshl_b32 s0, s0, 8
    ds_read_b64_tr_b16 a[98:99], v9 offset:1024
    v_mfma_f32_16x16x32_bf16 a[228:231], a[76:79], a[116:119], a[228:231]
    s_add_u32 s0, s0, 3670016
    ds_read_b64_tr_b16 a[100:101], v9 offset:8192
    v_mfma_f32_16x16x32_bf16 a[228:231], a[72:75], a[112:115], a[228:231]
    ds_read_b64_tr_b16 a[102:103], v9 offset:9216
    v_mfma_f32_16x16x32_bf16 a[232:235], a[80:83], a[112:115], a[232:235]
    ds_read_b128 a[32:35], v7 offset:0
    v_mfma_f32_16x16x32_bf16 a[232:235], a[84:87], a[116:119], a[232:235]
    ds_read_b128 a[36:39], v8 offset:0
    buffer_load_dword v135, v132, s[20:23], s0 offen
    v_mfma_f32_16x16x32_bf16 a[236:239], a[92:95], a[116:119], a[236:239]
    s_xor_b32 s0, s37, 1
    ds_read_b128 a[40:43], v7 offset:2048
    v_mfma_f32_16x16x32_bf16 a[236:239], a[88:91], a[112:115], a[236:239]
    ds_read_b128 a[44:47], v8 offset:2048
    v_mfma_f32_16x16x32_bf16 a[252:255], a[88:91], a[120:123], a[252:255]
    s_lshl_b32 s0, s0, 8
    ds_read_b128 a[48:51], v7 offset:4096
    v_mfma_f32_16x16x32_bf16 a[252:255], a[92:95], a[124:127], a[252:255]
    s_add_u32 s0, s0, 4587520
    ds_read_b128 a[52:55], v8 offset:4096
    v_mfma_f32_16x16x32_bf16 a[248:251], a[84:87], a[124:127], a[248:251]
    ds_read_b128 a[56:59], v7 offset:6144
    buffer_load_dword v135, v132, s[20:23], s0 offen
    v_mfma_f32_16x16x32_bf16 a[248:251], a[80:83], a[120:123], a[248:251]
    s_lshl_b32 s0, s95, 7
    ds_read_b128 a[60:63], v8 offset:6144
    v_mfma_f32_16x16x32_bf16 a[244:247], a[72:75], a[120:123], a[244:247]
    ds_read_b64_tr_b16 a[104:105], v10 offset:0
    v_mfma_f32_16x16x32_bf16 a[244:247], a[76:79], a[124:127], a[244:247]
    s_add_u32 s0, s0, 1548288
    ds_read_b64_tr_b16 a[106:107], v10 offset:1024
    v_mfma_f32_16x16x32_bf16 a[240:243], a[68:71], a[124:127], a[240:243]
    ds_read_b64_tr_b16 a[108:109], v10 offset:8192
    buffer_load_dword v135, v131, s[24:27], s0 offen offset:2048
    v_mfma_f32_16x16x32_bf16 a[240:243], a[64:67], a[120:123], a[240:243]
    ds_read_b64_tr_b16 a[110:111], v10 offset:9216
    s_waitcnt lgkmcnt(4)
    v_mfma_f32_16x16x32_bf16 v[32:35], a[96:99], a[32:35], v[32:35]
    s_waitcnt vmcnt(19)
    ds_read_b64_tr_b16 a[112:113], v9 offset:256
    v_mfma_f32_16x16x32_bf16 v[32:35], a[100:103], a[36:39], v[32:35]
    ds_read_b64_tr_b16 a[114:115], v9 offset:1280
    v_mfma_f32_16x16x32_bf16 v[36:39], a[100:103], a[44:47], v[36:39]
    ds_read_b64_tr_b16 a[116:117], v9 offset:8448
    v_mov_b32 v168, 0
    v_mfma_f32_16x16x32_bf16 v[36:39], a[96:99], a[40:43], v[36:39]
    ds_read_b64_tr_b16 a[118:119], v9 offset:9472
    v_dot2_f32_bf16 v168, v144, v154, v168
    v_dot2_f32_bf16 v168, v145, v155, v168
    v_dot2_f32_bf16 v168, v146, v156, v168
    v_dot2_f32_bf16 v168, v147, v157, v168
    v_dot2_f32_bf16 v168, v148, v158, v168
    v_dot2_f32_bf16 v168, v149, v159, v168
    v_dot2_f32_bf16 v168, v150, v160, v168
    v_dot2_f32_bf16 v168, v151, v161, v168
    v_dot2_f32_bf16 v168, v152, v162, v168
    v_dot2_f32_bf16 v168, v153, v163, v168
    v_mfma_f32_16x16x32_bf16 v[40:43], a[96:99], a[48:51], v[40:43]
    s_cmp_lt_u32 s94, 54
    s_cselect_b32 s26, s26, 0
    v_mfma_f32_16x16x32_bf16 v[40:43], a[100:103], a[52:55], v[40:43]
    s_and_b32 s40, s37, 1
    s_lshl_b32 s40, s40, 8
    s_add_u32 s57, s57, s40
    v_mfma_f32_16x16x32_bf16 v[44:47], a[100:103], a[60:63], v[44:47]
    s_add_u32 s56, s37, s38
    s_and_b32 s56, s56, 0
    v_mfma_f32_16x16x32_bf16 v[44:47], a[96:99], a[56:59], v[44:47]
    s_mul_i32 s40, s56, 524288
    s_add_u32 s40, s40, s57
    s_waitcnt lgkmcnt(4)
    v_mfma_f32_16x16x32_bf16 v[60:63], a[104:107], a[56:59], v[60:63]
    ds_read_b64_tr_b16 a[120:121], v10 offset:256
    v_mfma_f32_16x16x32_bf16 v[60:63], a[108:111], a[60:63], v[60:63]
    s_add_u32 m0, s60, 65536
    ds_read_b64_tr_b16 a[122:123], v10 offset:1280
    v_mfma_f32_16x16x32_bf16 v[56:59], a[108:111], a[52:55], v[56:59]
    ds_read_b64_tr_b16 a[124:125], v10 offset:8448
    v_mfma_f32_16x16x32_bf16 v[56:59], a[104:107], a[48:51], v[56:59]
    ds_read_b64_tr_b16 a[126:127], v10 offset:9472
    v_mfma_f32_16x16x32_bf16 v[52:55], a[104:107], a[40:43], v[52:55]
    v_add_f32_dpp v168, v168, v168 row_ror:8 row_mask:0xf bank_mask:0xf
    v_mfma_f32_16x16x32_bf16 v[52:55], a[108:111], a[44:47], v[52:55]
    buffer_load_dwordx4 v4, s[20:23], s40 offen lds
    v_mfma_f32_16x16x32_bf16 v[48:51], a[108:111], a[36:39], v[48:51]
    v_mfma_f32_16x16x32_bf16 v[48:51], a[104:107], a[32:35], v[48:51]
    s_waitcnt lgkmcnt(4)
    v_mfma_f32_16x16x32_bf16 v[64:67], a[112:115], a[32:35], v[64:67]
    ds_read_b64_tr_b16 a[96:97], v9 offset:512
    v_mfma_f32_16x16x32_bf16 v[64:67], a[116:119], a[36:39], v[64:67]
    ds_read_b64_tr_b16 a[98:99], v9 offset:1536
    v_mfma_f32_16x16x32_bf16 v[68:71], a[116:119], a[44:47], v[68:71]
    ds_read_b64_tr_b16 a[100:101], v9 offset:8704
    v_add_f32_dpp v168, v168, v168 row_ror:4 row_mask:0xf bank_mask:0xf
    v_mfma_f32_16x16x32_bf16 v[68:71], a[112:115], a[40:43], v[68:71]
    ds_read_b64_tr_b16 a[102:103], v9 offset:9728
    v_mfma_f32_16x16x32_bf16 v[72:75], a[112:115], a[48:51], v[72:75]
    v_mfma_f32_16x16x32_bf16 v[72:75], a[116:119], a[52:55], v[72:75]
    buffer_load_dwordx4 v5, s[20:23], s40 offen offset:1024 lds
    v_mfma_f32_16x16x32_bf16 v[76:79], a[116:119], a[60:63], v[76:79]
    s_mul_i32 s41, s56, 221184
    s_add_u32 s41, s41, s58
    v_mfma_f32_16x16x32_bf16 v[76:79], a[112:115], a[56:59], v[76:79]
    s_waitcnt lgkmcnt(4)
    v_mfma_f32_16x16x32_bf16 v[92:95], a[120:123], a[56:59], v[92:95]
    ds_read_b64_tr_b16 a[104:105], v10 offset:512
    v_mfma_f32_16x16x32_bf16 v[92:95], a[124:127], a[60:63], v[92:95]
    ds_read_b64_tr_b16 a[106:107], v10 offset:1536
    v_mfma_f32_16x16x32_bf16 v[88:91], a[124:127], a[52:55], v[88:91]
    ds_read_b64_tr_b16 a[108:109], v10 offset:8704
    v_mfma_f32_16x16x32_bf16 v[88:91], a[120:123], a[48:51], v[88:91]
    ds_read_b64_tr_b16 a[110:111], v10 offset:9728
    v_add_f32_dpp v168, v168, v168 row_ror:2 row_mask:0xf bank_mask:0xf
    v_mfma_f32_16x16x32_bf16 v[84:87], a[120:123], a[40:43], v[84:87]
    buffer_load_dwordx4 v6, s[24:27], s41 offen offset:2048 lds
    v_mfma_f32_16x16x32_bf16 v[84:87], a[124:127], a[44:47], v[84:87]
    v_mfma_f32_16x16x32_bf16 v[80:83], a[124:127], a[36:39], v[80:83]
    s_add_u32 s40, s40, 131072
    v_mfma_f32_16x16x32_bf16 v[80:83], a[120:123], a[32:35], v[80:83]
    v_add_f32_dpp v168, v168, v168 row_ror:1 row_mask:0xf bank_mask:0xf
    s_waitcnt lgkmcnt(4)
    v_mfma_f32_16x16x32_bf16 v[96:99], a[96:99], a[32:35], v[96:99]
    ds_read_b64_tr_b16 a[112:113], v9 offset:768
    v_mfma_f32_16x16x32_bf16 v[96:99], a[100:103], a[36:39], v[96:99]
    ds_read_b64_tr_b16 a[114:115], v9 offset:1792
    v_mov_b32 v167, v168
    v_mfma_f32_16x16x32_bf16 v[100:103], a[100:103], a[44:47], v[100:103]
    s_add_u32 m0, s60, 69632
    ds_read_b64_tr_b16 a[116:117], v9 offset:8960
    v_mfma_f32_16x16x32_bf16 v[100:103], a[96:99], a[40:43], v[100:103]
    ds_read_b64_tr_b16 a[118:119], v9 offset:9984
    v_permlane16_swap_b32 v168, v167
    v_mfma_f32_16x16x32_bf16 v[104:107], a[96:99], a[48:51], v[104:107]
    v_add_f32 v168, v168, v167
    v_mul_f32 v168, 0xbfb8aa3b, v168
    v_mfma_f32_16x16x32_bf16 v[104:107], a[100:103], a[52:55], v[104:107]
    v_exp_f32 v168, v168
    v_mfma_f32_16x16x32_bf16 v[108:111], a[100:103], a[60:63], v[108:111]
    buffer_load_dwordx4 v4, s[20:23], s40 offen lds
    v_mfma_f32_16x16x32_bf16 v[108:111], a[96:99], a[56:59], v[108:111]
    s_waitcnt lgkmcnt(4)
    v_mfma_f32_16x16x32_bf16 v[124:127], a[104:107], a[56:59], v[124:127]
    ds_read_b64_tr_b16 a[120:121], v10 offset:768
    v_mfma_f32_16x16x32_bf16 v[124:127], a[108:111], a[60:63], v[124:127]
    ds_read_b64_tr_b16 a[122:123], v10 offset:1792
    v_mfma_f32_16x16x32_bf16 v[120:123], a[108:111], a[52:55], v[120:123]
    ds_read_b64_tr_b16 a[124:125], v10 offset:8960
    v_mfma_f32_16x16x32_bf16 v[120:123], a[104:107], a[48:51], v[120:123]
    ds_read_b64_tr_b16 a[126:127], v10 offset:9984
    v_add_f32 v168, 1.0, v168
    v_mfma_f32_16x16x32_bf16 v[116:119], a[104:107], a[40:43], v[116:119]
    v_rcp_f32 v168, v168
    v_mfma_f32_16x16x32_bf16 v[116:119], a[108:111], a[44:47], v[116:119]
    buffer_load_dwordx4 v5, s[20:23], s40 offen offset:1024 lds
    v_mfma_f32_16x16x32_bf16 v[112:115], a[108:111], a[36:39], v[112:115]
    s_add_u32 s41, s41, 55296
    v_mfma_f32_16x16x32_bf16 v[112:115], a[104:107], a[32:35], v[112:115]
    v_lshlrev_b32 v166, 2, v166
    s_waitcnt lgkmcnt(4)
    v_mfma_f32_16x16x32_bf16 a[0:3], a[112:115], a[32:35], a[0:3]
    ds_read_b64_tr_b16 a[96:97], v9 offset:2048
    v_mfma_f32_16x16x32_bf16 a[0:3], a[116:119], a[36:39], a[0:3]
    ds_read_b64_tr_b16 a[98:99], v9 offset:3072
    v_mfma_f32_16x16x32_bf16 a[4:7], a[116:119], a[44:47], a[4:7]
    ds_read_b64_tr_b16 a[100:101], v9 offset:10240
    v_mfma_f32_16x16x32_bf16 a[4:7], a[112:115], a[40:43], a[4:7]
    ds_read_b64_tr_b16 a[102:103], v9 offset:11264
    v_mfma_f32_16x16x32_bf16 a[8:11], a[112:115], a[48:51], a[8:11]
    buffer_load_dwordx4 v6, s[24:27], s41 offen offset:2048 lds
    v_mfma_f32_16x16x32_bf16 a[8:11], a[116:119], a[52:55], a[8:11]
    s_lshl_b32 s42, s56, 7
    v_min_u32 v165, 8, v165
    v_mfma_f32_16x16x32_bf16 a[12:15], a[116:119], a[60:63], a[12:15]
    s_add_u32 m0, s61, 0
    v_lshl_add_u32 v166, v165, 27, v166
    v_mfma_f32_16x16x32_bf16 a[12:15], a[112:115], a[56:59], a[12:15]
    s_add_u32 s40, s48, s42
    s_waitcnt lgkmcnt(4)
    v_mfma_f32_16x16x32_bf16 a[28:31], a[120:123], a[56:59], a[28:31]
    ds_read_b64_tr_b16 a[104:105], v10 offset:2048
    buffer_load_dwordx4 v16, s[16:19], s40 offen lds
    v_mfma_f32_16x16x32_bf16 a[28:31], a[124:127], a[60:63], a[28:31]
    ds_read_b64_tr_b16 a[106:107], v10 offset:3072
    v_mfma_f32_16x16x32_bf16 a[24:27], a[124:127], a[52:55], a[24:27]
    s_lshl_b32 s0, s66, 2
    ds_read_b64_tr_b16 a[108:109], v10 offset:10240
    v_mfma_f32_16x16x32_bf16 a[24:27], a[120:123], a[48:51], a[24:27]
    s_add_u32 s0, s0, 83886080
    ds_read_b64_tr_b16 a[110:111], v10 offset:11264
    v_mfma_f32_16x16x32_bf16 a[20:23], a[120:123], a[40:43], a[20:23]
    buffer_store_dword v168, v166, s[28:31], s0 offen sc1
    v_mfma_f32_16x16x32_bf16 a[20:23], a[124:127], a[44:47], a[20:23]
    s_mov_b32 s32, s80
    s_mov_b32 s33, s81
    v_mfma_f32_16x16x32_bf16 a[16:19], a[124:127], a[36:39], a[16:19]
    buffer_load_dwordx4 v17, s[16:19], s40 offen offset:1024 lds
    v_mfma_f32_16x16x32_bf16 a[16:19], a[120:123], a[32:35], a[16:19]
    s_waitcnt lgkmcnt(4)
    v_mfma_f32_16x16x32_bf16 a[128:131], a[32:35], a[96:99], a[128:131]
    s_add_u32 m0, s61, 2048
    ds_read_b64_tr_b16 a[112:113], v9 offset:2304
    v_mfma_f32_16x16x32_bf16 a[128:131], a[36:39], a[100:103], a[128:131]
    ds_read_b64_tr_b16 a[114:115], v9 offset:3328
    v_mfma_f32_16x16x32_bf16 a[132:135], a[44:47], a[100:103], a[132:135]
    s_add_u32 s40, s49, s42
    ds_read_b64_tr_b16 a[116:117], v9 offset:10496
    v_mfma_f32_16x16x32_bf16 a[132:135], a[40:43], a[96:99], a[132:135]
    ds_read_b64_tr_b16 a[118:119], v9 offset:11520
    v_mfma_f32_16x16x32_bf16 a[136:139], a[48:51], a[96:99], a[136:139]
    buffer_load_dwordx4 v16, s[16:19], s40 offen lds
    v_mfma_f32_16x16x32_bf16 a[136:139], a[52:55], a[100:103], a[136:139]
    s_mov_b32 s34, 3456
    v_mfma_f32_16x16x32_bf16 a[140:143], a[60:63], a[100:103], a[140:143]
    buffer_load_dwordx4 v17, s[16:19], s40 offen offset:1024 lds
    v_mfma_f32_16x16x32_bf16 a[140:143], a[56:59], a[96:99], a[140:143]
    s_add_u32 m0, s61, 4096
    s_waitcnt lgkmcnt(4)
    v_mfma_f32_16x16x32_bf16 a[156:159], a[56:59], a[104:107], a[156:159]
    ds_read_b64_tr_b16 a[120:121], v10 offset:2304
    v_lshrrev_b32 v128, 4, v1
    v_mfma_f32_16x16x32_bf16 a[156:159], a[60:63], a[108:111], a[156:159]
    ds_read_b64_tr_b16 a[122:123], v10 offset:3328
    v_lshlrev_b32 v128, 3, v128
    v_mfma_f32_16x16x32_bf16 a[152:155], a[52:55], a[108:111], a[152:155]
    ds_read_b64_tr_b16 a[124:125], v10 offset:10496
    v_mfma_f32_16x16x32_bf16 a[152:155], a[48:51], a[104:107], a[152:155]
    s_lshl_b32 s0, s94, 6
    ds_read_b64_tr_b16 a[126:127], v10 offset:11520
    v_mfma_f32_16x16x32_bf16 a[148:151], a[40:43], a[104:107], a[148:151]
    buffer_load_dwordx2 v[18:19], v128, s[32:35], s0 offen offset:0
    v_mfma_f32_16x16x32_bf16 a[148:151], a[44:47], a[108:111], a[148:151]
    buffer_load_dwordx2 v[20:21], v128, s[32:35], s0 offen offset:32
    v_mfma_f32_16x16x32_bf16 a[144:147], a[36:39], a[108:111], a[144:147]
    buffer_load_dwordx2 v[22:23], v128, s[32:35], s0 offen offset:64
    v_mfma_f32_16x16x32_bf16 a[144:147], a[32:35], a[104:107], a[144:147]
    s_add_u32 s40, s50, s42
    s_waitcnt lgkmcnt(4)
    v_mfma_f32_16x16x32_bf16 a[160:163], a[32:35], a[112:115], a[160:163]
    ds_read_b64_tr_b16 a[96:97], v9 offset:2560
    v_mfma_f32_16x16x32_bf16 a[160:163], a[36:39], a[116:119], a[160:163]
    ds_read_b64_tr_b16 a[98:99], v9 offset:3584
    v_mfma_f32_16x16x32_bf16 a[164:167], a[44:47], a[116:119], a[164:167]
    ds_read_b64_tr_b16 a[100:101], v9 offset:10752
    v_mfma_f32_16x16x32_bf16 a[164:167], a[40:43], a[112:115], a[164:167]
    ds_read_b64_tr_b16 a[102:103], v9 offset:11776
    v_mfma_f32_16x16x32_bf16 a[168:171], a[48:51], a[112:115], a[168:171]
    buffer_load_dwordx2 v[24:25], v128, s[32:35], s0 offen offset:96
    v_mfma_f32_16x16x32_bf16 a[168:171], a[52:55], a[116:119], a[168:171]
    s_mov_b32 s84, 0x3e0293ee
    s_lshl_b32 s1, s63, 14
L_ws_2197:
    s_cbranch_execz L_ws_4429
    v_mfma_f32_16x16x32_bf16 a[172:175], a[60:63], a[116:119], a[172:175]
    buffer_load_dwordx4 v16, s[16:19], s40 offen lds
    v_mfma_f32_16x16x32_bf16 a[172:175], a[56:59], a[112:115], a[172:175]
    s_xor_b32 s0, s37, 0
    s_mul_i32 s0, s0, 1081344
    s_waitcnt lgkmcnt(4)
    v_mfma_f32_16x16x32_bf16 a[188:191], a[56:59], a[120:123], a[188:191]
    ds_read_b64_tr_b16 a[104:105], v10 offset:2560
    v_mfma_f32_16x16x32_bf16 a[188:191], a[60:63], a[124:127], a[188:191]
    s_add_u32 s63, s1, s0
    ds_read_b64_tr_b16 a[106:107], v10 offset:3584
    v_mfma_f32_16x16x32_bf16 a[184:187], a[52:55], a[124:127], a[184:187]
    s_xor_b32 s0, s37, 1
    ds_read_b64_tr_b16 a[108:109], v10 offset:10752
    v_mfma_f32_16x16x32_bf16 a[184:187], a[48:51], a[120:123], a[184:187]
    s_mul_i32 s0, s0, 1081344
    ds_read_b64_tr_b16 a[110:111], v10 offset:11776
    v_mfma_f32_16x16x32_bf16 a[180:183], a[40:43], a[120:123], a[180:183]
    s_add_u32 s59, s1, s0
    v_mfma_f32_16x16x32_bf16 a[180:183], a[44:47], a[124:127], a[180:183]
    buffer_load_dwordx4 v17, s[16:19], s40 offen offset:1024 lds
    v_mfma_f32_16x16x32_bf16 a[176:179], a[36:39], a[124:127], a[176:179]
    s_xor_b32 s0, s37, 2
    v_mfma_f32_16x16x32_bf16 a[176:179], a[32:35], a[120:123], a[176:179]
    s_waitcnt lgkmcnt(4)
    v_mfma_f32_16x16x32_bf16 a[192:195], a[32:35], a[96:99], a[192:195]
    ds_read_b64_tr_b16 a[112:113], v9 offset:2816
    v_mfma_f32_16x16x32_bf16 a[192:195], a[36:39], a[100:103], a[192:195]
    s_add_u32 m0, s61, 6144
    ds_read_b64_tr_b16 a[114:115], v9 offset:3840
    v_mfma_f32_16x16x32_bf16 a[196:199], a[44:47], a[100:103], a[196:199]
    s_mul_i32 s0, s0, 1081344
    ds_read_b64_tr_b16 a[116:117], v9 offset:11008
    v_mfma_f32_16x16x32_bf16 a[196:199], a[40:43], a[96:99], a[196:199]
    s_add_u32 s62, s1, s0
    ds_read_b64_tr_b16 a[118:119], v9 offset:12032
    v_mfma_f32_16x16x32_bf16 a[200:203], a[48:51], a[96:99], a[200:203]
    v_mfma_f32_16x16x32_bf16 a[200:203], a[52:55], a[100:103], a[200:203]
    s_add_u32 s40, s51, s42
    v_mfma_f32_16x16x32_bf16 a[204:207], a[60:63], a[100:103], a[204:207]
    buffer_load_dwordx4 v16, s[16:19], s40 offen lds
    v_mfma_f32_16x16x32_bf16 a[204:207], a[56:59], a[96:99], a[204:207]
    s_xor_b32 s0, s37, 3
    s_waitcnt lgkmcnt(4)
    v_mfma_f32_16x16x32_bf16 a[220:223], a[56:59], a[104:107], a[220:223]
    ds_read_b64_tr_b16 a[120:121], v10 offset:2816
    v_mfma_f32_16x16x32_bf16 a[220:223], a[60:63], a[108:111], a[220:223]
    ds_read_b64_tr_b16 a[122:123], v10 offset:3840
    v_mfma_f32_16x16x32_bf16 a[216:219], a[52:55], a[108:111], a[216:219]
    ds_read_b64_tr_b16 a[124:125], v10 offset:11008
    v_mfma_f32_16x16x32_bf16 a[216:219], a[48:51], a[104:107], a[216:219]
    s_mul_i32 s0, s0, 1081344
    ds_read_b64_tr_b16 a[126:127], v10 offset:12032
    v_mfma_f32_16x16x32_bf16 a[212:215], a[40:43], a[104:107], a[212:215]
    buffer_load_dwordx4 v17, s[16:19], s40 offen offset:1024 lds
    v_mfma_f32_16x16x32_bf16 a[212:215], a[44:47], a[108:111], a[212:215]
    s_add_u32 s56, s56, 1
    s_cmp_eq_u32 s56, 10
    s_cselect_b32 s56, 0, s56
    v_mfma_f32_16x16x32_bf16 a[208:211], a[36:39], a[108:111], a[208:211]
    s_add_u32 s95, s1, s0
    v_add_u32 v9, 32768, v12
    v_add_u32 v10, 32768, v13
    v_mfma_f32_16x16x32_bf16 a[208:211], a[32:35], a[104:107], a[208:211]
    s_waitcnt vmcnt(22) lgkmcnt(0)
    s_barrier
    v_mfma_f32_16x16x32_bf16 a[224:227], a[32:35], a[112:115], a[224:227]
    ds_read_b64_tr_b16 a[96:97], v9 offset:0
    v_mfma_f32_16x16x32_bf16 a[224:227], a[36:39], a[116:119], a[224:227]
    ds_read_b64_tr_b16 a[98:99], v9 offset:1024
    v_mfma_f32_16x16x32_bf16 a[228:231], a[44:47], a[116:119], a[228:231]
    ds_read_b64_tr_b16 a[100:101], v9 offset:8192
    v_mfma_f32_16x16x32_bf16 a[228:231], a[40:43], a[112:115], a[228:231]
    ds_read_b64_tr_b16 a[102:103], v9 offset:9216
    v_mfma_f32_16x16x32_bf16 a[232:235], a[48:51], a[112:115], a[232:235]
    ds_read_b128 a[64:67], v7 offset:32768
    v_mfma_f32_16x16x32_bf16 a[232:235], a[52:55], a[116:119], a[232:235]
    ds_read_b128 a[68:71], v8 offset:32768
    v_mfma_f32_16x16x32_bf16 a[236:239], a[60:63], a[116:119], a[236:239]
    ds_read_b128 a[72:75], v7 offset:34816
    v_mfma_f32_16x16x32_bf16 a[236:239], a[56:59], a[112:115], a[236:239]
    ds_read_b128 a[76:79], v8 offset:34816
    v_mfma_f32_16x16x32_bf16 a[252:255], a[56:59], a[120:123], a[252:255]
    ds_read_b128 a[80:83], v7 offset:36864
    v_mfma_f32_16x16x32_bf16 a[252:255], a[60:63], a[124:127], a[252:255]
    ds_read_b128 a[84:87], v8 offset:36864
    v_mfma_f32_16x16x32_bf16 a[248:251], a[52:55], a[124:127], a[248:251]
    ds_read_b128 a[88:91], v7 offset:38912
    v_mfma_f32_16x16x32_bf16 a[248:251], a[48:51], a[120:123], a[248:251]
    ds_read_b128 a[92:95], v8 offset:38912
    v_mfma_f32_16x16x32_bf16 a[244:247], a[40:43], a[120:123], a[244:247]
    ds_read_b64_tr_b16 a[104:105], v10 offset:0
    v_mfma_f32_16x16x32_bf16 a[244:247], a[44:47], a[124:127], a[244:247]
    ds_read_b64_tr_b16 a[106:107], v10 offset:1024
    v_mfma_f32_16x16x32_bf16 a[240:243], a[36:39], a[124:127], a[240:243]
    ds_read_b64_tr_b16 a[108:109], v10 offset:8192
    v_mfma_f32_16x16x32_bf16 a[240:243], a[32:35], a[120:123], a[240:243]
    ds_read_b64_tr_b16 a[110:111], v10 offset:9216
    s_waitcnt lgkmcnt(4)
    v_mfma_f32_16x16x32_bf16 v[32:35], a[96:99], a[64:67], v[32:35]
    ds_read_b64_tr_b16 a[112:113], v9 offset:256
    v_mfma_f32_16x16x32_bf16 v[32:35], a[100:103], a[68:71], v[32:35]
    s_mul_i32 s40, s56, 524288
    s_add_u32 s40, s40, s57
    ds_read_b64_tr_b16 a[114:115], v9 offset:1280
    v_mfma_f32_16x16x32_bf16 v[36:39], a[100:103], a[76:79], v[36:39]
    s_add_u32 m0, s60, 0
    ds_read_b64_tr_b16 a[116:117], v9 offset:8448
    v_mfma_f32_16x16x32_bf16 v[36:39], a[96:99], a[72:75], v[36:39]
    ds_read_b64_tr_b16 a[118:119], v9 offset:9472
    v_mfma_f32_16x16x32_bf16 v[40:43], a[96:99], a[80:83], v[40:43]
    buffer_load_dwordx4 v4, s[20:23], s40 offen lds
    v_mfma_f32_16x16x32_bf16 v[40:43], a[100:103], a[84:87], v[40:43]
    v_mfma_f32_16x16x32_bf16 v[44:47], a[100:103], a[92:95], v[44:47]
    buffer_load_dwordx4 v5, s[20:23], s40 offen offset:1024 lds
    v_mfma_f32_16x16x32_bf16 v[44:47], a[96:99], a[88:91], v[44:47]
    s_mul_i32 s41, s56, 221184
    s_add_u32 s41, s41, s58
    s_waitcnt lgkmcnt(4)
    v_mfma_f32_16x16x32_bf16 v[48:51], a[104:107], a[64:67], v[48:51]
    ds_read_b64_tr_b16 a[120:121], v10 offset:256
    v_mfma_f32_16x16x32_bf16 v[48:51], a[108:111], a[68:71], v[48:51]
    ds_read_b64_tr_b16 a[122:123], v10 offset:1280
    v_mfma_f32_16x16x32_bf16 v[52:55], a[108:111], a[76:79], v[52:55]
    ds_read_b64_tr_b16 a[124:125], v10 offset:8448
    buffer_load_dwordx4 v6, s[24:27], s41 offen offset:2048 lds
    v_mfma_f32_16x16x32_bf16 v[52:55], a[104:107], a[72:75], v[52:55]
    s_add_u32 s40, s40, 131072
    ds_read_b64_tr_b16 a[126:127], v10 offset:9472
    v_mfma_f32_16x16x32_bf16 v[56:59], a[104:107], a[80:83], v[56:59]
    v_mfma_f32_16x16x32_bf16 v[56:59], a[108:111], a[84:87], v[56:59]
    s_add_u32 m0, s60, 4096
    v_mfma_f32_16x16x32_bf16 v[60:63], a[108:111], a[92:95], v[60:63]
    buffer_load_dwordx4 v4, s[20:23], s40 offen lds
    v_mfma_f32_16x16x32_bf16 v[60:63], a[104:107], a[88:91], v[60:63]
    s_waitcnt lgkmcnt(4)
    v_mfma_f32_16x16x32_bf16 v[64:67], a[112:115], a[64:67], v[64:67]
    ds_read_b64_tr_b16 a[96:97], v9 offset:512
    v_mfma_f32_16x16x32_bf16 v[64:67], a[116:119], a[68:71], v[64:67]
    s_add_u32 s3, s63, 8192
    ds_read_b64_tr_b16 a[98:99], v9 offset:1536
    v_mfma_f32_16x16x32_bf16 v[68:71], a[116:119], a[76:79], v[68:71]
    ds_read_b64_tr_b16 a[100:101], v9 offset:8704
    v_mfma_f32_16x16x32_bf16 v[68:71], a[112:115], a[72:75], v[68:71]
    ds_read_b64_tr_b16 a[102:103], v9 offset:9728
    v_mfma_f32_16x16x32_bf16 v[72:75], a[112:115], a[80:83], v[72:75]
    buffer_load_dwordx4 v5, s[20:23], s40 offen offset:1024 lds
    v_mfma_f32_16x16x32_bf16 v[72:75], a[116:119], a[84:87], v[72:75]
    s_add_u32 s41, s41, 55296
    v_mfma_f32_16x16x32_bf16 v[76:79], a[116:119], a[92:95], v[76:79]
    buffer_load_dwordx4 v6, s[24:27], s41 offen offset:2048 lds
    v_mfma_f32_16x16x32_bf16 v[76:79], a[112:115], a[88:91], v[76:79]
    s_waitcnt lgkmcnt(4)
    v_mfma_f32_16x16x32_bf16 v[80:83], a[120:123], a[64:67], v[80:83]
    ds_read_b64_tr_b16 a[104:105], v10 offset:512
    v_mul_f32 v32, s84, v32
    v_mul_f32 v33, s84, v33
    v_mfma_f32_16x16x32_bf16 v[80:83], a[124:127], a[68:71], v[80:83]
    ds_read_b64_tr_b16 a[106:107], v10 offset:1536
    v_mul_f32 v34, s84, v34
    v_mul_f32 v35, s84, v35
    v_mfma_f32_16x16x32_bf16 v[84:87], a[124:127], a[76:79], v[84:87]
    ds_read_b64_tr_b16 a[108:109], v10 offset:8704
    v_mul_f32 v48, s84, v48
    v_mfma_f32_16x16x32_bf16 v[84:87], a[120:123], a[72:75], v[84:87]
    ds_read_b64_tr_b16 a[110:111], v10 offset:9728
    v_mul_f32 v49, s84, v49
    v_mul_f32 v50, s84, v50
    v_mul_f32 v51, s84, v51
    v_mfma_f32_16x16x32_bf16 v[88:91], a[120:123], a[80:83], v[88:91]
    s_lshl_b32 s42, s56, 7
    v_cvt_pk_bf16_f32 v32, v32, v33
    v_cvt_pk_bf16_f32 v33, v34, v35
    v_cvt_pk_bf16_f32 v34, v48, v49
    v_cvt_pk_bf16_f32 v35, v50, v51
    v_mul_f32 v36, s84, v36
    v_mfma_f32_16x16x32_bf16 v[88:91], a[124:127], a[84:87], v[88:91]
    s_add_u32 m0, s61, 32768
    v_mul_f32 v37, s84, v37
    v_mul_f32 v38, s84, v38
    v_mul_f32 v39, s84, v39
    v_mfma_f32_16x16x32_bf16 v[92:95], a[124:127], a[92:95], v[92:95]
    v_mul_f32 v52, s84, v52
    v_mul_f32 v53, s84, v53
    v_mfma_f32_16x16x32_bf16 v[92:95], a[120:123], a[88:91], v[92:95]
    v_mul_f32 v54, s84, v54
    s_waitcnt lgkmcnt(4)
    v_mfma_f32_16x16x32_bf16 v[96:99], a[96:99], a[64:67], v[96:99]
    ds_read_b64_tr_b16 a[112:113], v9 offset:768
    v_mul_f32 v55, s84, v55
    v_cvt_pk_bf16_f32 v36, v36, v37
    v_mfma_f32_16x16x32_bf16 v[96:99], a[100:103], a[68:71], v[96:99]
    ds_read_b64_tr_b16 a[114:115], v9 offset:1792
    v_cvt_pk_bf16_f32 v37, v38, v39
    v_mfma_f32_16x16x32_bf16 v[100:103], a[100:103], a[76:79], v[100:103]
    ds_read_b64_tr_b16 a[116:117], v9 offset:8960
    v_cvt_pk_bf16_f32 v38, v52, v53
    v_cvt_pk_bf16_f32 v39, v54, v55
    v_mfma_f32_16x16x32_bf16 v[100:103], a[96:99], a[72:75], v[100:103]
    ds_read_b64_tr_b16 a[118:119], v9 offset:9984
    v_mul_f32 v40, s84, v40
    v_mfma_f32_16x16x32_bf16 v[104:107], a[96:99], a[80:83], v[104:107]
    s_add_u32 s40, s48, s42
    v_mul_f32 v41, s84, v41
    v_mul_f32 v42, s84, v42
    v_mfma_f32_16x16x32_bf16 v[104:107], a[100:103], a[84:87], v[104:107]
    v_mul_f32 v43, s84, v43
    v_mul_f32 v56, s84, v56
    v_mfma_f32_16x16x32_bf16 v[108:111], a[100:103], a[92:95], v[108:111]
    buffer_store_dwordx4 v[32:35], v11, s[28:31], s3 offen sc1
    v_mfma_f32_16x16x32_bf16 v[108:111], a[96:99], a[88:91], v[108:111]
    v_mul_f32 v57, s84, v57
    s_waitcnt lgkmcnt(4)
    v_mfma_f32_16x16x32_bf16 v[112:115], a[104:107], a[64:67], v[112:115]
    ds_read_b64_tr_b16 a[120:121], v10 offset:768
    v_mul_f32 v58, s84, v58
    v_mfma_f32_16x16x32_bf16 v[112:115], a[108:111], a[68:71], v[112:115]
    ds_read_b64_tr_b16 a[122:123], v10 offset:1792
    v_mul_f32 v59, s84, v59
    v_mfma_f32_16x16x32_bf16 v[116:119], a[108:111], a[76:79], v[116:119]
    ds_read_b64_tr_b16 a[124:125], v10 offset:8960
    v_cvt_pk_bf16_f32 v40, v40, v41
    v_mfma_f32_16x16x32_bf16 v[116:119], a[104:107], a[72:75], v[116:119]
    ds_read_b64_tr_b16 a[126:127], v10 offset:9984
    v_cvt_pk_bf16_f32 v41, v42, v43
    v_mfma_f32_16x16x32_bf16 v[120:123], a[104:107], a[80:83], v[120:123]
    v_cvt_pk_bf16_f32 v42, v56, v57
    v_cvt_pk_bf16_f32 v43, v58, v59
    v_mfma_f32_16x16x32_bf16 v[120:123], a[108:111], a[84:87], v[120:123]
    v_mul_f32 v44, s84, v44
    v_mul_f32 v45, s84, v45
    v_mfma_f32_16x16x32_bf16 v[124:127], a[108:111], a[92:95], v[124:127]
    buffer_load_dwordx4 v16, s[16:19], s40 offen lds
    v_mfma_f32_16x16x32_bf16 v[124:127], a[104:107], a[88:91], v[124:127]
    s_add_u32 s3, s63, 12288
    v_mul_f32 v46, s84, v46
    s_waitcnt lgkmcnt(4)
    v_mfma_f32_16x16x32_bf16 a[0:3], a[112:115], a[64:67], a[0:3]
    ds_read_b64_tr_b16 a[96:97], v9 offset:2048
    v_mul_f32 v47, s84, v47
    v_mul_f32 v60, s84, v60
    v_mfma_f32_16x16x32_bf16 a[0:3], a[116:119], a[68:71], a[0:3]
    ds_read_b64_tr_b16 a[98:99], v9 offset:3072
    v_mul_f32 v61, s84, v61
    v_mfma_f32_16x16x32_bf16 a[4:7], a[116:119], a[76:79], a[4:7]
    ds_read_b64_tr_b16 a[100:101], v9 offset:10240
    v_mul_f32 v62, s84, v62
    v_mfma_f32_16x16x32_bf16 a[4:7], a[112:115], a[72:75], a[4:7]
    ds_read_b64_tr_b16 a[102:103], v9 offset:11264
    v_mul_f32 v63, s84, v63
    v_mfma_f32_16x16x32_bf16 a[8:11], a[112:115], a[80:83], a[8:11]
    buffer_load_dwordx4 v17, s[16:19], s40 offen offset:1024 lds
    v_mfma_f32_16x16x32_bf16 a[8:11], a[116:119], a[84:87], a[8:11]
    v_cvt_pk_bf16_f32 v44, v44, v45
    v_mfma_f32_16x16x32_bf16 a[12:15], a[116:119], a[92:95], a[12:15]
    buffer_store_dwordx4 v[36:39], v11, s[28:31], s3 offen sc1
    v_mfma_f32_16x16x32_bf16 a[12:15], a[112:115], a[88:91], a[12:15]
    s_waitcnt lgkmcnt(4)
    v_mfma_f32_16x16x32_bf16 a[16:19], a[120:123], a[64:67], a[16:19]
    ds_read_b64_tr_b16 a[104:105], v10 offset:2048
    v_cvt_pk_bf16_f32 v45, v46, v47
    v_mfma_f32_16x16x32_bf16 a[16:19], a[124:127], a[68:71], a[16:19]
    ds_read_b64_tr_b16 a[106:107], v10 offset:3072
    v_mfma_f32_16x16x32_bf16 a[20:23], a[124:127], a[76:79], a[20:23]
    s_add_u32 s3, s63, 532480
    ds_read_b64_tr_b16 a[108:109], v10 offset:10240
    v_mfma_f32_16x16x32_bf16 a[20:23], a[120:123], a[72:75], a[20:23]
    ds_read_b64_tr_b16 a[110:111], v10 offset:11264
    v_cvt_pk_bf16_f32 v46, v60, v61
    v_mfma_f32_16x16x32_bf16 a[24:27], a[120:123], a[80:83], a[24:27]
    s_add_u32 m0, s61, 34816
    v_cvt_pk_bf16_f32 v47, v62, v63
    v_mul_f32 v64, s84, v64
    v_mfma_f32_16x16x32_bf16 a[24:27], a[124:127], a[84:87], a[24:27]
    s_add_u32 s40, s49, s42
    v_mul_f32 v65, s84, v65
    v_mul_f32 v66, s84, v66
    v_mfma_f32_16x16x32_bf16 a[28:31], a[124:127], a[92:95], a[28:31]
    buffer_load_dwordx4 v16, s[16:19], s40 offen lds
    v_mfma_f32_16x16x32_bf16 a[28:31], a[120:123], a[88:91], a[28:31]
    v_mul_f32 v67, s84, v67
    s_waitcnt lgkmcnt(4)
    v_mfma_f32_16x16x32_bf16 a[128:131], a[64:67], a[96:99], a[128:131]
    ds_read_b64_tr_b16 a[112:113], v9 offset:2304
    v_mfma_f32_16x16x32_bf16 a[128:131], a[68:71], a[100:103], a[128:131]
    ds_read_b64_tr_b16 a[114:115], v9 offset:3328
    v_mfma_f32_16x16x32_bf16 a[132:135], a[76:79], a[100:103], a[132:135]
    ds_read_b64_tr_b16 a[116:117], v9 offset:10496
    v_mfma_f32_16x16x32_bf16 a[132:135], a[72:75], a[96:99], a[132:135]
    ds_read_b64_tr_b16 a[118:119], v9 offset:11520
    v_mul_f32 v80, s84, v80
    v_mfma_f32_16x16x32_bf16 a[136:139], a[80:83], a[96:99], a[136:139]
    v_mul_f32 v81, s84, v81
    v_mfma_f32_16x16x32_bf16 a[136:139], a[84:87], a[100:103], a[136:139]
    v_mul_f32 v82, s84, v82
    v_mul_f32 v83, s84, v83
    v_mfma_f32_16x16x32_bf16 a[140:143], a[92:95], a[100:103], a[140:143]
    buffer_store_dwordx4 v[40:43], v11, s[28:31], s3 offen sc1
    v_mfma_f32_16x16x32_bf16 a[140:143], a[88:91], a[96:99], a[140:143]
    v_cvt_pk_bf16_f32 v64, v64, v65
    s_waitcnt lgkmcnt(4)
    v_mfma_f32_16x16x32_bf16 a[144:147], a[64:67], a[104:107], a[144:147]
    ds_read_b64_tr_b16 a[120:121], v10 offset:2304
    v_cvt_pk_bf16_f32 v65, v66, v67
    v_mfma_f32_16x16x32_bf16 a[144:147], a[68:71], a[108:111], a[144:147]
    ds_read_b64_tr_b16 a[122:123], v10 offset:3328
    v_cvt_pk_bf16_f32 v66, v80, v81
    v_mfma_f32_16x16x32_bf16 a[148:151], a[76:79], a[108:111], a[148:151]
    ds_read_b64_tr_b16 a[124:125], v10 offset:10496
    v_cvt_pk_bf16_f32 v67, v82, v83
    v_mfma_f32_16x16x32_bf16 a[148:151], a[72:75], a[104:107], a[148:151]
    ds_read_b64_tr_b16 a[126:127], v10 offset:11520
    v_mfma_f32_16x16x32_bf16 a[152:155], a[80:83], a[104:107], a[152:155]
    v_mfma_f32_16x16x32_bf16 a[152:155], a[84:87], a[108:111], a[152:155]
    s_add_u32 s3, s63, 536576
    v_mfma_f32_16x16x32_bf16 a[156:159], a[92:95], a[108:111], a[156:159]
    buffer_load_dwordx4 v17, s[16:19], s40 offen offset:1024 lds
    v_mfma_f32_16x16x32_bf16 a[156:159], a[88:91], a[104:107], a[156:159]
    v_mul_f32 v68, s84, v68
    s_waitcnt lgkmcnt(4)
    v_mfma_f32_16x16x32_bf16 a[160:163], a[64:67], a[112:115], a[160:163]
    ds_read_b64_tr_b16 a[96:97], v9 offset:2560
    v_mul_f32 v69, s84, v69
    v_mfma_f32_16x16x32_bf16 a[160:163], a[68:71], a[116:119], a[160:163]
    ds_read_b64_tr_b16 a[98:99], v9 offset:3584
    v_mfma_f32_16x16x32_bf16 a[164:167], a[76:79], a[116:119], a[164:167]
    ds_read_b64_tr_b16 a[100:101], v9 offset:10752
    buffer_store_dwordx4 v[44:47], v11, s[28:31], s3 offen sc1
    v_mfma_f32_16x16x32_bf16 a[164:167], a[72:75], a[112:115], a[164:167]
    s_add_u32 m0, s61, 36864
    ds_read_b64_tr_b16 a[102:103], v9 offset:11776
    v_mfma_f32_16x16x32_bf16 a[168:171], a[80:83], a[112:115], a[168:171]
    v_mul_f32 v70, s84, v70
    v_mul_f32 v71, s84, v71
    v_mfma_f32_16x16x32_bf16 a[168:171], a[84:87], a[116:119], a[168:171]
    s_add_u32 s40, s50, s42
    v_mul_f32 v84, s84, v84
    v_mul_f32 v85, s84, v85
    v_mfma_f32_16x16x32_bf16 a[172:175], a[92:95], a[116:119], a[172:175]
    buffer_load_dwordx4 v16, s[16:19], s40 offen lds
    v_mfma_f32_16x16x32_bf16 a[172:175], a[88:91], a[112:115], a[172:175]
    s_add_u32 s3, s63, 9216
    v_mul_f32 v86, s84, v86
    s_waitcnt lgkmcnt(4)
    v_mfma_f32_16x16x32_bf16 a[176:179], a[64:67], a[120:123], a[176:179]
    ds_read_b64_tr_b16 a[104:105], v10 offset:2560
    v_mul_f32 v87, s84, v87
    v_mfma_f32_16x16x32_bf16 a[176:179], a[68:71], a[124:127], a[176:179]
    ds_read_b64_tr_b16 a[106:107], v10 offset:3584
    v_cvt_pk_bf16_f32 v68, v68, v69
    v_mfma_f32_16x16x32_bf16 a[180:183], a[76:79], a[124:127], a[180:183]
    ds_read_b64_tr_b16 a[108:109], v10 offset:10752
    v_cvt_pk_bf16_f32 v69, v70, v71
    v_mfma_f32_16x16x32_bf16 a[180:183], a[72:75], a[120:123], a[180:183]
    ds_read_b64_tr_b16 a[110:111], v10 offset:11776
    v_mfma_f32_16x16x32_bf16 a[184:187], a[80:83], a[120:123], a[184:187]
    buffer_load_dwordx4 v17, s[16:19], s40 offen offset:1024 lds
    v_mfma_f32_16x16x32_bf16 a[184:187], a[84:87], a[124:127], a[184:187]
    s_add_u32 m0, s61, 38912
    v_cvt_pk_bf16_f32 v70, v84, v85
    v_cvt_pk_bf16_f32 v71, v86, v87
    v_mfma_f32_16x16x32_bf16 a[188:191], a[92:95], a[124:127], a[188:191]
    v_mfma_f32_16x16x32_bf16 a[188:191], a[88:91], a[120:123], a[188:191]
    s_add_u32 s40, s51, s42
    v_mul_f32 v72, s84, v72
    s_waitcnt lgkmcnt(4)
    v_mfma_f32_16x16x32_bf16 a[192:195], a[64:67], a[96:99], a[192:195]
    ds_read_b64_tr_b16 a[112:113], v9 offset:2816
    v_mfma_f32_16x16x32_bf16 a[192:195], a[68:71], a[100:103], a[192:195]
    ds_read_b64_tr_b16 a[114:115], v9 offset:3840
    buffer_load_dwordx4 v16, s[16:19], s40 offen lds
    v_mfma_f32_16x16x32_bf16 a[196:199], a[76:79], a[100:103], a[196:199]
    ds_read_b64_tr_b16 a[116:117], v9 offset:11008
    v_mul_f32 v73, s84, v73
    v_mfma_f32_16x16x32_bf16 a[196:199], a[72:75], a[96:99], a[196:199]
    ds_read_b64_tr_b16 a[118:119], v9 offset:12032
    v_mul_f32 v74, s84, v74
    v_mfma_f32_16x16x32_bf16 a[200:203], a[80:83], a[96:99], a[200:203]
    v_mul_f32 v75, s84, v75
    v_mul_f32 v88, s84, v88
    v_mfma_f32_16x16x32_bf16 a[200:203], a[84:87], a[100:103], a[200:203]
    buffer_store_dwordx4 v[64:67], v11, s[28:31], s3 offen sc1
    v_mfma_f32_16x16x32_bf16 a[204:207], a[92:95], a[100:103], a[204:207]
    v_mul_f32 v89, s84, v89
    v_mul_f32 v90, s84, v90
    v_mfma_f32_16x16x32_bf16 a[204:207], a[88:91], a[96:99], a[204:207]
    s_add_u32 s3, s63, 13312
    v_mul_f32 v91, s84, v91
    s_waitcnt lgkmcnt(4)
    v_mfma_f32_16x16x32_bf16 a[208:211], a[64:67], a[104:107], a[208:211]
    ds_read_b64_tr_b16 a[120:121], v10 offset:2816
    v_cvt_pk_bf16_f32 v72, v72, v73
    v_mfma_f32_16x16x32_bf16 a[208:211], a[68:71], a[108:111], a[208:211]
    ds_read_b64_tr_b16 a[122:123], v10 offset:3840
    buffer_load_dwordx4 v17, s[16:19], s40 offen offset:1024 lds
    v_mfma_f32_16x16x32_bf16 a[212:215], a[76:79], a[108:111], a[212:215]
    ds_read_b64_tr_b16 a[124:125], v10 offset:11008
    v_cvt_pk_bf16_f32 v73, v74, v75
    v_mfma_f32_16x16x32_bf16 a[212:215], a[72:75], a[104:107], a[212:215]
    ds_read_b64_tr_b16 a[126:127], v10 offset:12032
    v_cvt_pk_bf16_f32 v74, v88, v89
    v_mfma_f32_16x16x32_bf16 a[216:219], a[80:83], a[104:107], a[216:219]
    s_add_u32 s56, s56, 1
    s_cmp_eq_u32 s56, 10
    s_cselect_b32 s56, 0, s56
    v_mfma_f32_16x16x32_bf16 a[216:219], a[84:87], a[108:111], a[216:219]
    v_cvt_pk_bf16_f32 v75, v90, v91
    v_mul_f32 v76, s84, v76
    v_mfma_f32_16x16x32_bf16 a[220:223], a[92:95], a[108:111], a[220:223]
    v_add_u32 v9, 65536, v12
    v_add_u32 v10, 65536, v13
    v_mfma_f32_16x16x32_bf16 a[220:223], a[88:91], a[104:107], a[220:223]
    s_waitcnt vmcnt(19) lgkmcnt(0)
    s_barrier
    v_mfma_f32_16x16x32_bf16 a[224:227], a[64:67], a[112:115], a[224:227]
    ds_read_b64_tr_b16 a[96:97], v9 offset:0
    v_mfma_f32_16x16x32_bf16 a[224:227], a[68:71], a[116:119], a[224:227]
    ds_read_b64_tr_b16 a[98:99], v9 offset:1024
    buffer_store_dwordx4 v[68:71], v11, s[28:31], s3 offen sc1
    v_mfma_f32_16x16x32_bf16 a[228:231], a[76:79], a[116:119], a[228:231]
    ds_read_b64_tr_b16 a[100:101], v9 offset:8192
    v_mul_f32 v77, s84, v77
    v_mfma_f32_16x16x32_bf16 a[228:231], a[72:75], a[112:115], a[228:231]
    ds_read_b64_tr_b16 a[102:103], v9 offset:9216
    v_mul_f32 v78, s84, v78
    v_mfma_f32_16x16x32_bf16 a[232:235], a[80:83], a[112:115], a[232:235]
    ds_read_b128 a[32:35], v7 offset:0
    v_mul_f32 v79, s84, v79
    v_mfma_f32_16x16x32_bf16 a[232:235], a[84:87], a[116:119], a[232:235]
    ds_read_b128 a[36:39], v8 offset:0
    v_mul_f32 v92, s84, v92
    v_mfma_f32_16x16x32_bf16 a[236:239], a[92:95], a[116:119], a[236:239]
    ds_read_b128 a[40:43], v7 offset:2048
    v_mul_f32 v93, s84, v93
    v_mfma_f32_16x16x32_bf16 a[236:239], a[88:91], a[112:115], a[236:239]
    ds_read_b128 a[44:47], v8 offset:2048
    v_mfma_f32_16x16x32_bf16 a[240:243], a[64:67], a[120:123], a[240:243]
    ds_read_b128 a[48:51], v7 offset:4096
    v_mul_f32 v94, s84, v94
    v_mfma_f32_16x16x32_bf16 a[240:243], a[68:71], a[124:127], a[240:243]
    ds_read_b128 a[52:55], v8 offset:4096
    v_mfma_f32_16x16x32_bf16 a[244:247], a[76:79], a[124:127], a[244:247]
    ds_read_b128 a[56:59], v7 offset:6144
    v_mul_f32 v95, s84, v95
    v_mfma_f32_16x16x32_bf16 a[244:247], a[72:75], a[120:123], a[244:247]
    ds_read_b128 a[60:63], v8 offset:6144
    v_cvt_pk_bf16_f32 v76, v76, v77
    v_mfma_f32_16x16x32_bf16 a[248:251], a[80:83], a[120:123], a[248:251]
    ds_read_b64_tr_b16 a[104:105], v10 offset:0
    v_cvt_pk_bf16_f32 v77, v78, v79
    v_mfma_f32_16x16x32_bf16 a[248:251], a[84:87], a[124:127], a[248:251]
    ds_read_b64_tr_b16 a[106:107], v10 offset:1024
    v_cvt_pk_bf16_f32 v78, v92, v93
    v_mfma_f32_16x16x32_bf16 a[252:255], a[92:95], a[124:127], a[252:255]
    ds_read_b64_tr_b16 a[108:109], v10 offset:8192
    v_cvt_pk_bf16_f32 v79, v94, v95
    v_mfma_f32_16x16x32_bf16 a[252:255], a[88:91], a[120:123], a[252:255]
    ds_read_b64_tr_b16 a[110:111], v10 offset:9216
L_q0:
    s_waitcnt lgkmcnt(4)
    v_mfma_f32_16x16x32_bf16 v[128:131], a[96:99], a[32:35], 0
    ds_read_b64_tr_b16 a[112:113], v9 offset:256
    v_mul_f32 v96, s84, v96
    v_mfma_f32_16x16x32_bf16 v[128:131], a[100:103], a[36:39], v[128:131]
    ds_read_b64_tr_b16 a[114:115], v9 offset:1280
    v_mul_f32 v97, s84, v97
    v_mfma_f32_16x16x32_bf16 v[132:135], a[100:103], a[44:47], 0
    ds_read_b64_tr_b16 a[116:117], v9 offset:8448
    v_mul_f32 v98, s84, v98
    v_mfma_f32_16x16x32_bf16 v[132:135], a[96:99], a[40:43], v[132:135]
    s_mul_i32 s40, s56, 524288
    s_add_u32 s40, s40, s57
    ds_read_b64_tr_b16 a[118:119], v9 offset:9472
    v_mfma_f32_16x16x32_bf16 v[136:139], a[96:99], a[48:51], 0
    s_add_u32 m0, s60, 32768
    v_mul_f32 v99, s84, v99
    v_mul_f32 v112, s84, v112
    v_mfma_f32_16x16x32_bf16 v[136:139], a[100:103], a[52:55], v[136:139]
    v_mul_f32 v113, s84, v113
    v_mul_f32 v114, s84, v114
    v_mfma_f32_16x16x32_bf16 v[140:143], a[100:103], a[60:63], 0
    buffer_load_dwordx4 v4, s[20:23], s40 offen lds
    v_mfma_f32_16x16x32_bf16 v[140:143], a[96:99], a[56:59], v[140:143]
    v_mul_f32 v115, s84, v115
    s_waitcnt lgkmcnt(4)
    v_mfma_f32_16x16x32_bf16 v[144:147], a[104:107], a[32:35], 0
    ds_read_b64_tr_b16 a[120:121], v10 offset:256
    v_cvt_pk_bf16_f32 v96, v96, v97
    v_mfma_f32_16x16x32_bf16 v[144:147], a[108:111], a[36:39], v[144:147]
    ds_read_b64_tr_b16 a[122:123], v10 offset:1280
    v_cvt_pk_bf16_f32 v97, v98, v99
    v_mfma_f32_16x16x32_bf16 v[148:151], a[108:111], a[44:47], 0
    ds_read_b64_tr_b16 a[124:125], v10 offset:8448
    v_cvt_pk_bf16_f32 v98, v112, v113
    v_mfma_f32_16x16x32_bf16 v[148:151], a[104:107], a[40:43], v[148:151]
    ds_read_b64_tr_b16 a[126:127], v10 offset:9472
    v_cvt_pk_bf16_f32 v99, v114, v115
    v_mfma_f32_16x16x32_bf16 v[152:155], a[104:107], a[48:51], 0
    buffer_load_dwordx4 v5, s[20:23], s40 offen offset:1024 lds
    v_mfma_f32_16x16x32_bf16 v[152:155], a[108:111], a[52:55], v[152:155]
    v_mul_f32 v100, s84, v100
    v_mul_f32 v101, s84, v101
    v_mfma_f32_16x16x32_bf16 v[156:159], a[108:111], a[60:63], 0
    v_mul_f32 v102, s84, v102
    v_mul_f32 v103, s84, v103
    v_mfma_f32_16x16x32_bf16 v[156:159], a[104:107], a[56:59], v[156:159]
    s_mul_i32 s41, s56, 221184
    s_add_u32 s41, s41, s58
    s_waitcnt lgkmcnt(4)
    v_mfma_f32_16x16x32_bf16 v[160:163], a[112:115], a[32:35], 0
    ds_read_b64_tr_b16 a[96:97], v9 offset:512
    v_mul_f32 v116, s84, v116
    v_mfma_f32_16x16x32_bf16 v[160:163], a[116:119], a[36:39], v[160:163]
    ds_read_b64_tr_b16 a[98:99], v9 offset:1536
    v_mul_f32 v117, s84, v117
    v_mfma_f32_16x16x32_bf16 v[164:167], a[116:119], a[44:47], 0
    ds_read_b64_tr_b16 a[100:101], v9 offset:8704
    v_mul_f32 v118, s84, v118
    v_mfma_f32_16x16x32_bf16 v[164:167], a[112:115], a[40:43], v[164:167]
    ds_read_b64_tr_b16 a[102:103], v9 offset:9728
    v_mul_f32 v119, s84, v119
    v_mfma_f32_16x16x32_bf16 v[168:171], a[112:115], a[48:51], 0
    v_cvt_pk_bf16_f32 v100, v100, v101
    v_cvt_pk_bf16_f32 v101, v102, v103
    v_mfma_f32_16x16x32_bf16 v[168:171], a[116:119], a[52:55], v[168:171]
    buffer_load_dwordx4 v6, s[24:27], s41 offen offset:2048 lds
    v_mfma_f32_16x16x32_bf16 v[172:175], a[116:119], a[60:63], 0
    s_add_u32 s40, s40, 131072
    v_cvt_pk_bf16_f32 v102, v116, v117
    v_cvt_pk_bf16_f32 v103, v118, v119
    v_mfma_f32_16x16x32_bf16 v[172:175], a[112:115], a[56:59], v[172:175]
    s_add_u32 m0, s60, 36864
    v_mul_f32 v104, s84, v104
    s_waitcnt lgkmcnt(4)
    v_mfma_f32_16x16x32_bf16 v[176:179], a[120:123], a[32:35], 0
    ds_read_b64_tr_b16 a[104:105], v10 offset:512
    v_mul_f32 v105, s84, v105
    v_mfma_f32_16x16x32_bf16 v[176:179], a[124:127], a[36:39], v[176:179]
    ds_read_b64_tr_b16 a[106:107], v10 offset:1536
    buffer_load_dwordx4 v4, s[20:23], s40 offen lds
    v_mfma_f32_16x16x32_bf16 v[180:183], a[124:127], a[44:47], 0
    ds_read_b64_tr_b16 a[108:109], v10 offset:8704
    v_mul_f32 v106, s84, v106
    v_mfma_f32_16x16x32_bf16 v[180:183], a[120:123], a[40:43], v[180:183]
    ds_read_b64_tr_b16 a[110:111], v10 offset:9728
    v_mul_f32 v107, s84, v107
    v_mfma_f32_16x16x32_bf16 v[184:187], a[120:123], a[48:51], 0
    v_mul_f32 v120, s84, v120
    v_mul_f32 v121, s84, v121
    v_mfma_f32_16x16x32_bf16 v[184:187], a[124:127], a[52:55], v[184:187]
    buffer_load_dwordx4 v5, s[20:23], s40 offen offset:1024 lds
    v_mul_f32 v122, s84, v122
    v_mfma_f32_16x16x32_bf16 v[188:191], a[124:127], a[60:63], 0
    v_mul_f32 v123, s84, v123
    v_cvt_pk_bf16_f32 v104, v104, v105
    v_mfma_f32_16x16x32_bf16 v[188:191], a[120:123], a[56:59], v[188:191]
    s_add_u32 s41, s41, 55296
    v_cvt_pk_bf16_f32 v105, v106, v107
    s_waitcnt lgkmcnt(4)
    v_mfma_f32_16x16x32_bf16 v[192:195], a[96:99], a[32:35], 0
    ds_read_b64_tr_b16 a[112:113], v9 offset:768
    v_cvt_pk_bf16_f32 v106, v120, v121
    v_mfma_f32_16x16x32_bf16 v[192:195], a[100:103], a[36:39], v[192:195]
    ds_read_b64_tr_b16 a[114:115], v9 offset:1792
    v_cvt_pk_bf16_f32 v107, v122, v123
    v_mfma_f32_16x16x32_bf16 v[196:199], a[100:103], a[44:47], 0
    ds_read_b64_tr_b16 a[116:117], v9 offset:8960
    v_mul_f32 v108, s84, v108
    v_mfma_f32_16x16x32_bf16 v[196:199], a[96:99], a[40:43], v[196:199]
    ds_read_b64_tr_b16 a[118:119], v9 offset:9984
    v_mul_f32 v109, s84, v109
    v_mfma_f32_16x16x32_bf16 v[200:203], a[96:99], a[48:51], 0
    v_mul_f32 v110, s84, v110
    v_mul_f32 v111, s84, v111
    v_mfma_f32_16x16x32_bf16 v[200:203], a[100:103], a[52:55], v[200:203]
    buffer_load_dwordx4 v6, s[24:27], s41 offen offset:2048 lds
    v_mfma_f32_16x16x32_bf16 v[204:207], a[100:103], a[60:63], 0
    s_lshl_b32 s42, s56, 7
    v_mul_f32 v124, s84, v124
    v_mul_f32 v125, s84, v125
    v_mfma_f32_16x16x32_bf16 v[204:207], a[96:99], a[56:59], v[204:207]
    s_add_u32 m0, s61, 0
    s_waitcnt lgkmcnt(4)
    v_mfma_f32_16x16x32_bf16 v[208:211], a[104:107], a[32:35], 0
    s_add_u32 s40, s48, s42
    ds_read_b64_tr_b16 a[120:121], v10 offset:768
    v_mfma_f32_16x16x32_bf16 v[208:211], a[108:111], a[36:39], v[208:211]
L_ws_2785:
    s_cbranch_execz L_ws_4979
    ds_read_b64_tr_b16 a[122:123], v10 offset:1792
    v_mul_f32 v126, s84, v126
    v_mfma_f32_16x16x32_bf16 v[212:215], a[108:111], a[44:47], 0
    ds_read_b64_tr_b16 a[124:125], v10 offset:8960
    v_mul_f32 v127, s84, v127
    v_mfma_f32_16x16x32_bf16 v[212:215], a[104:107], a[40:43], v[212:215]
    ds_read_b64_tr_b16 a[126:127], v10 offset:9984
    v_cvt_pk_bf16_f32 v108, v108, v109
    v_mfma_f32_16x16x32_bf16 v[216:219], a[104:107], a[48:51], 0
    v_cvt_pk_bf16_f32 v109, v110, v111
    v_cvt_pk_bf16_f32 v110, v124, v125
    v_mfma_f32_16x16x32_bf16 v[216:219], a[108:111], a[52:55], v[216:219]
    buffer_load_dwordx4 v16, s[16:19], s40 offen lds
    v_mfma_f32_16x16x32_bf16 v[220:223], a[108:111], a[60:63], 0
    v_mfma_f32_16x16x32_bf16 v[220:223], a[104:107], a[56:59], v[220:223]
    v_cvt_pk_bf16_f32 v111, v126, v127
    s_waitcnt lgkmcnt(4)
    v_mfma_f32_16x16x32_bf16 v[224:227], a[112:115], a[32:35], 0
    ds_read_b64_tr_b16 a[96:97], v9 offset:2048
    v_mfma_f32_16x16x32_bf16 v[224:227], a[116:119], a[36:39], v[224:227]
    ds_read_b64_tr_b16 a[98:99], v9 offset:2560
    buffer_load_dwordx4 v17, s[16:19], s40 offen offset:1024 lds
    v_mfma_f32_16x16x32_bf16 v[228:231], a[116:119], a[44:47], 0
    ds_read_b64_tr_b16 a[100:101], v9 offset:10240
    v_mfma_f32_16x16x32_bf16 v[228:231], a[112:115], a[40:43], v[228:231]
    s_add_u32 m0, s61, 2048
    ds_read_b64_tr_b16 a[102:103], v9 offset:10752
    v_mfma_f32_16x16x32_bf16 v[232:235], a[112:115], a[48:51], 0
    v_lshlrev_b32 v60, 16, v18
    v_mfma_f32_16x16x32_bf16 v[232:235], a[116:119], a[52:55], v[232:235]
    s_add_u32 s40, s49, s42
    v_and_b32 v61, 0xffff0000, v18
    v_lshlrev_b32 v62, 16, v19
    v_mfma_f32_16x16x32_bf16 v[236:239], a[116:119], a[60:63], 0
    buffer_load_dwordx4 v16, s[16:19], s40 offen lds
    v_mfma_f32_16x16x32_bf16 v[236:239], a[112:115], a[56:59], v[236:239]
    v_and_b32 v63, 0xffff0000, v19
    s_waitcnt lgkmcnt(4)
    v_mfma_f32_16x16x32_bf16 v[240:243], a[120:123], a[32:35], 0
    ds_read_b64_tr_b16 a[104:105], v10 offset:2048
    v_lshlrev_b32 v92, 16, v20
    v_mfma_f32_16x16x32_bf16 v[240:243], a[124:127], a[36:39], v[240:243]
    ds_read_b64_tr_b16 a[106:107], v10 offset:2560
    v_and_b32 v93, 0xffff0000, v20
    v_mfma_f32_16x16x32_bf16 v[244:247], a[124:127], a[44:47], 0
    ds_read_b64_tr_b16 a[108:109], v10 offset:10240
    buffer_load_dwordx4 v17, s[16:19], s40 offen offset:1024 lds
    v_mfma_f32_16x16x32_bf16 v[244:247], a[120:123], a[40:43], v[244:247]
    s_add_u32 m0, s61, 4096
    ds_read_b64_tr_b16 a[110:111], v10 offset:10752
    v_mfma_f32_16x16x32_bf16 v[248:251], a[120:123], a[48:51], 0
    s_add_u32 s40, s50, s42
    v_lshlrev_b32 v94, 16, v21
    v_mfma_f32_16x16x32_bf16 v[248:251], a[124:127], a[52:55], v[248:251]
    v_mfma_f32_16x16x32_bf16 v[252:255], a[124:127], a[60:63], 0
    buffer_load_dwordx4 v16, s[16:19], s40 offen lds
    v_mfma_f32_16x16x32_bf16 v[252:255], a[120:123], a[56:59], v[252:255]
    v_and_b32 v95, 0xffff0000, v21
    s_waitcnt lgkmcnt(4)
    v_mfma_f32_16x16x32_bf16 v[48:51], a[96:99], a[32:35], v[60:63]
    ds_read_b64_tr_b16 a[112:113], v9 offset:2304
    v_lshlrev_b32 v124, 16, v22
    v_mfma_f32_16x16x32_bf16 v[48:51], a[100:103], a[36:39], v[48:51]
    ds_read_b64_tr_b16 a[114:115], v9 offset:2816
    v_mfma_f32_16x16x32_bf16 v[52:55], a[100:103], a[44:47], v[60:63]
    ds_read_b64_tr_b16 a[116:117], v9 offset:10496
    v_mfma_f32_16x16x32_bf16 v[52:55], a[96:99], a[40:43], v[52:55]
    ds_read_b64_tr_b16 a[118:119], v9 offset:11008
    v_and_b32 v125, 0xffff0000, v22
    v_mfma_f32_16x16x32_bf16 v[56:59], a[96:99], a[48:51], v[60:63]
    buffer_load_dwordx4 v17, s[16:19], s40 offen offset:1024 lds
    v_mfma_f32_16x16x32_bf16 v[56:59], a[100:103], a[52:55], v[56:59]
    s_add_u32 m0, s61, 6144
    v_lshlrev_b32 v126, 16, v23
    v_mfma_f32_16x16x32_bf16 v[60:63], a[100:103], a[60:63], v[60:63]
    s_add_u32 s40, s51, s42
    v_and_b32 v127, 0xffff0000, v23
    v_lshlrev_b32 v44, 16, v24
    v_mfma_f32_16x16x32_bf16 v[60:63], a[96:99], a[56:59], v[60:63]
    v_and_b32 v45, 0xffff0000, v24
    s_waitcnt lgkmcnt(4)
    v_mfma_f32_16x16x32_bf16 v[80:83], a[104:107], a[32:35], v[92:95]
    ds_read_b64_tr_b16 a[120:121], v10 offset:2304
    buffer_load_dwordx4 v16, s[16:19], s40 offen lds
    v_mfma_f32_16x16x32_bf16 v[80:83], a[108:111], a[36:39], v[80:83]
    ds_read_b64_tr_b16 a[122:123], v10 offset:2816
    v_lshlrev_b32 v46, 16, v25
    v_mfma_f32_16x16x32_bf16 v[84:87], a[108:111], a[44:47], v[92:95]
    ds_read_b64_tr_b16 a[124:125], v10 offset:10496
    v_and_b32 v47, 0xffff0000, v25
    v_mfma_f32_16x16x32_bf16 v[84:87], a[104:107], a[40:43], v[84:87]
    ds_read_b64_tr_b16 a[126:127], v10 offset:11008
    v_mfma_f32_16x16x32_bf16 v[88:91], a[104:107], a[48:51], v[92:95]
    buffer_load_dwordx4 v17, s[16:19], s40 offen offset:1024 lds
    v_mfma_f32_16x16x32_bf16 v[88:91], a[108:111], a[52:55], v[88:91]
    s_add_u32 s56, s56, 1
    s_cmp_eq_u32 s56, 10
    s_cselect_b32 s56, 0, s56
    v_mfma_f32_16x16x32_bf16 v[92:95], a[108:111], a[60:63], v[92:95]
    v_add_u32 v9, 0, v12
    v_add_u32 v10, 0, v13
    v_mfma_f32_16x16x32_bf16 v[92:95], a[104:107], a[56:59], v[92:95]
    s_waitcnt vmcnt(15) lgkmcnt(0)
    s_barrier
    v_mfma_f32_16x16x32_bf16 v[112:115], a[112:115], a[32:35], v[124:127]
    ds_read_b64_tr_b16 a[96:97], v9 offset:0
    v_mfma_f32_16x16x32_bf16 v[112:115], a[116:119], a[36:39], v[112:115]
    ds_read_b64_tr_b16 a[98:99], v9 offset:1024
    v_mfma_f32_16x16x32_bf16 v[116:119], a[116:119], a[44:47], v[124:127]
    ds_read_b64_tr_b16 a[100:101], v9 offset:8192
    v_mfma_f32_16x16x32_bf16 v[116:119], a[112:115], a[40:43], v[116:119]
    ds_read_b64_tr_b16 a[102:103], v9 offset:9216
    v_mfma_f32_16x16x32_bf16 v[120:123], a[112:115], a[48:51], v[124:127]
    ds_read_b128 a[64:67], v7 offset:32768
    v_mfma_f32_16x16x32_bf16 v[120:123], a[116:119], a[52:55], v[120:123]
    ds_read_b128 a[68:71], v8 offset:32768
    v_mfma_f32_16x16x32_bf16 v[124:127], a[116:119], a[60:63], v[124:127]
    s_add_u32 s3, s59, 10240
    ds_read_b128 a[72:75], v7 offset:34816
    v_mfma_f32_16x16x32_bf16 v[124:127], a[112:115], a[56:59], v[124:127]
    ds_read_b128 a[76:79], v8 offset:34816
    v_mfma_f32_16x16x32_bf16 v[32:35], a[120:123], a[32:35], v[44:47]
    ds_read_b128 a[80:83], v7 offset:36864
    buffer_store_dwordx4 v[96:99], v11, s[28:31], s3 offen sc1
    v_mfma_f32_16x16x32_bf16 v[32:35], a[124:127], a[36:39], v[32:35]
    ds_read_b128 a[84:87], v8 offset:36864
    v_mfma_f32_16x16x32_bf16 v[36:39], a[124:127], a[44:47], v[44:47]
    s_add_u32 s3, s59, 14336
    ds_read_b128 a[88:91], v7 offset:38912
    v_mfma_f32_16x16x32_bf16 v[36:39], a[120:123], a[40:43], v[36:39]
    ds_read_b128 a[92:95], v8 offset:38912
    v_mfma_f32_16x16x32_bf16 v[40:43], a[120:123], a[48:51], v[44:47]
    ds_read_b64_tr_b16 a[104:105], v10 offset:0
    v_mfma_f32_16x16x32_bf16 v[40:43], a[124:127], a[52:55], v[40:43]
    ds_read_b64_tr_b16 a[106:107], v10 offset:1024
    buffer_store_dwordx4 v[100:103], v11, s[28:31], s3 offen sc1
    v_mfma_f32_16x16x32_bf16 v[44:47], a[124:127], a[60:63], v[44:47]
    ds_read_b64_tr_b16 a[108:109], v10 offset:8192
    v_mfma_f32_16x16x32_bf16 v[44:47], a[120:123], a[56:59], v[44:47]
    ds_read_b64_tr_b16 a[110:111], v10 offset:9216
    s_waitcnt lgkmcnt(4)
    v_mfma_f32_16x16x32_bf16 v[128:131], a[96:99], a[64:67], v[128:131]
    ds_read_b64_tr_b16 a[112:113], v9 offset:256
    v_mfma_f32_16x16x32_bf16 v[128:131], a[100:103], a[68:71], v[128:131]
    ds_read_b64_tr_b16 a[114:115], v9 offset:1280
    v_accvgpr_read_b32 v64, a0
    v_mfma_f32_16x16x32_bf16 v[132:135], a[100:103], a[76:79], v[132:135]
    ds_read_b64_tr_b16 a[116:117], v9 offset:8448
    v_accvgpr_read_b32 v65, a1
    v_mfma_f32_16x16x32_bf16 v[132:135], a[96:99], a[72:75], v[132:135]
    ds_read_b64_tr_b16 a[118:119], v9 offset:9472
    v_mfma_f32_16x16x32_bf16 v[136:139], a[96:99], a[80:83], v[136:139]
    s_mul_i32 s40, s56, 524288
    s_add_u32 s40, s40, s57
    v_mfma_f32_16x16x32_bf16 v[136:139], a[100:103], a[84:87], v[136:139]
    s_add_u32 m0, s60, 65536
    v_mfma_f32_16x16x32_bf16 v[140:143], a[100:103], a[92:95], v[140:143]
    buffer_load_dwordx4 v4, s[20:23], s40 offen lds
    v_mfma_f32_16x16x32_bf16 v[140:143], a[96:99], a[88:91], v[140:143]
    v_accvgpr_read_b32 v66, a2
    s_waitcnt lgkmcnt(4)
    v_mfma_f32_16x16x32_bf16 v[156:159], a[104:107], a[88:91], v[156:159]
    ds_read_b64_tr_b16 a[120:121], v10 offset:256
    v_accvgpr_read_b32 v67, a3
    v_mfma_f32_16x16x32_bf16 v[156:159], a[108:111], a[92:95], v[156:159]
    ds_read_b64_tr_b16 a[122:123], v10 offset:1280
    v_accvgpr_read_b32 v68, a16
    v_mfma_f32_16x16x32_bf16 v[152:155], a[108:111], a[84:87], v[152:155]
    ds_read_b64_tr_b16 a[124:125], v10 offset:8448
    v_accvgpr_read_b32 v69, a17
    v_mfma_f32_16x16x32_bf16 v[152:155], a[104:107], a[80:83], v[152:155]
    ds_read_b64_tr_b16 a[126:127], v10 offset:9472
    v_accvgpr_read_b32 v70, a18
    v_mfma_f32_16x16x32_bf16 v[148:151], a[104:107], a[72:75], v[148:151]
    v_accvgpr_read_b32 v71, a19
    v_mfma_f32_16x16x32_bf16 v[148:151], a[108:111], a[76:79], v[148:151]
    buffer_load_dwordx4 v5, s[20:23], s40 offen offset:1024 lds
    v_mfma_f32_16x16x32_bf16 v[144:147], a[108:111], a[68:71], v[144:147]
    v_mul_f32 v64, s84, v64
    v_mul_f32 v65, s84, v65
    v_mfma_f32_16x16x32_bf16 v[144:147], a[104:107], a[64:67], v[144:147]
    s_mul_i32 s41, s56, 221184
    s_add_u32 s41, s41, s58
    s_waitcnt lgkmcnt(4)
    v_mfma_f32_16x16x32_bf16 v[160:163], a[112:115], a[64:67], v[160:163]
    ds_read_b64_tr_b16 a[96:97], v9 offset:512
    v_mul_f32 v66, s84, v66
    v_mfma_f32_16x16x32_bf16 v[160:163], a[116:119], a[68:71], v[160:163]
    ds_read_b64_tr_b16 a[98:99], v9 offset:1536
    buffer_load_dwordx4 v6, s[24:27], s41 offen offset:2048 lds
    v_mfma_f32_16x16x32_bf16 v[164:167], a[116:119], a[76:79], v[164:167]
    ds_read_b64_tr_b16 a[100:101], v9 offset:8704
    v_mul_f32 v67, s84, v67
    v_mfma_f32_16x16x32_bf16 v[164:167], a[112:115], a[72:75], v[164:167]
    s_add_u32 s40, s40, 131072
    ds_read_b64_tr_b16 a[102:103], v9 offset:9728
    v_mfma_f32_16x16x32_bf16 v[168:171], a[112:115], a[80:83], v[168:171]
    s_add_u32 m0, s60, 69632
    v_mul_f32 v68, s84, v68
    v_mul_f32 v69, s84, v69
    v_mfma_f32_16x16x32_bf16 v[168:171], a[116:119], a[84:87], v[168:171]
    v_mul_f32 v70, s84, v70
    v_mfma_f32_16x16x32_bf16 v[172:175], a[116:119], a[92:95], v[172:175]
    buffer_load_dwordx4 v4, s[20:23], s40 offen lds
    v_mfma_f32_16x16x32_bf16 v[172:175], a[112:115], a[88:91], v[172:175]
    v_mul_f32 v71, s84, v71
    s_waitcnt lgkmcnt(4)
    v_mfma_f32_16x16x32_bf16 v[188:191], a[120:123], a[88:91], v[188:191]
    ds_read_b64_tr_b16 a[104:105], v10 offset:512
    v_cvt_pk_bf16_f32 v64, v64, v65
    v_mfma_f32_16x16x32_bf16 v[188:191], a[124:127], a[92:95], v[188:191]
    ds_read_b64_tr_b16 a[106:107], v10 offset:1536
    v_cvt_pk_bf16_f32 v65, v66, v67
    v_mfma_f32_16x16x32_bf16 v[184:187], a[124:127], a[84:87], v[184:187]
    ds_read_b64_tr_b16 a[108:109], v10 offset:8704
    v_mfma_f32_16x16x32_bf16 v[184:187], a[120:123], a[80:83], v[184:187]
    ds_read_b64_tr_b16 a[110:111], v10 offset:9728
    v_cvt_pk_bf16_f32 v66, v68, v69
    v_mfma_f32_16x16x32_bf16 v[180:183], a[120:123], a[72:75], v[180:183]
    buffer_load_dwordx4 v5, s[20:23], s40 offen offset:1024 lds
    v_mfma_f32_16x16x32_bf16 v[180:183], a[124:127], a[76:79], v[180:183]
    s_add_u32 s41, s41, 55296
    v_mfma_f32_16x16x32_bf16 v[176:179], a[124:127], a[68:71], v[176:179]
    buffer_load_dwordx4 v6, s[24:27], s41 offen offset:2048 lds
    v_mfma_f32_16x16x32_bf16 v[176:179], a[120:123], a[64:67], v[176:179]
    s_lshl_b32 s42, s56, 7
    v_cvt_pk_bf16_f32 v67, v70, v71
    s_waitcnt lgkmcnt(4)
    v_mfma_f32_16x16x32_bf16 v[192:195], a[96:99], a[64:67], v[192:195]
    s_add_u32 s3, s59, 11264
    ds_read_b64_tr_b16 a[112:113], v9 offset:768
    v_mfma_f32_16x16x32_bf16 v[192:195], a[100:103], a[68:71], v[192:195]
    s_add_u32 m0, s61, 32768
    ds_read_b64_tr_b16 a[114:115], v9 offset:1792
    v_mfma_f32_16x16x32_bf16 v[196:199], a[100:103], a[76:79], v[196:199]
    ds_read_b64_tr_b16 a[116:117], v9 offset:8960
    v_mfma_f32_16x16x32_bf16 v[196:199], a[96:99], a[72:75], v[196:199]
    s_add_u32 s40, s48, s42
    ds_read_b64_tr_b16 a[118:119], v9 offset:9984
    v_mfma_f32_16x16x32_bf16 v[200:203], a[96:99], a[80:83], v[200:203]
    buffer_store_dwordx4 v[64:67], v11, s[28:31], s3 offen sc1
    v_mfma_f32_16x16x32_bf16 v[200:203], a[100:103], a[84:87], v[200:203]
    v_accvgpr_read_b32 v96, a4
    v_mfma_f32_16x16x32_bf16 v[204:207], a[100:103], a[92:95], v[204:207]
    buffer_load_dwordx4 v16, s[16:19], s40 offen lds
    v_mfma_f32_16x16x32_bf16 v[204:207], a[96:99], a[88:91], v[204:207]
    v_accvgpr_read_b32 v97, a5
    s_waitcnt lgkmcnt(4)
    v_mfma_f32_16x16x32_bf16 v[220:223], a[104:107], a[88:91], v[220:223]
    ds_read_b64_tr_b16 a[120:121], v10 offset:768
    v_mfma_f32_16x16x32_bf16 v[220:223], a[108:111], a[92:95], v[220:223]
    ds_read_b64_tr_b16 a[122:123], v10 offset:1792
    v_accvgpr_read_b32 v98, a6
    v_mfma_f32_16x16x32_bf16 v[216:219], a[108:111], a[84:87], v[216:219]
    ds_read_b64_tr_b16 a[124:125], v10 offset:8960
    v_accvgpr_read_b32 v99, a7
    v_mfma_f32_16x16x32_bf16 v[216:219], a[104:107], a[80:83], v[216:219]
    ds_read_b64_tr_b16 a[126:127], v10 offset:9984
    v_accvgpr_read_b32 v100, a20
    v_mfma_f32_16x16x32_bf16 v[212:215], a[104:107], a[72:75], v[212:215]
    buffer_load_dwordx4 v17, s[16:19], s40 offen offset:1024 lds
    v_mfma_f32_16x16x32_bf16 v[212:215], a[108:111], a[76:79], v[212:215]
    s_add_u32 m0, s61, 34816
    v_accvgpr_read_b32 v101, a21
    v_accvgpr_read_b32 v102, a22
    v_mfma_f32_16x16x32_bf16 v[208:211], a[108:111], a[68:71], v[208:211]
    v_mfma_f32_16x16x32_bf16 v[208:211], a[104:107], a[64:67], v[208:211]
    s_add_u32 s40, s49, s42
    v_accvgpr_read_b32 v103, a23
    s_waitcnt lgkmcnt(4)
    v_mfma_f32_16x16x32_bf16 v[224:227], a[112:115], a[64:67], v[224:227]
    ds_read_b64_tr_b16 a[96:97], v9 offset:2048
    v_mul_f32 v96, s84, v96
    v_mfma_f32_16x16x32_bf16 v[224:227], a[116:119], a[68:71], v[224:227]
    ds_read_b64_tr_b16 a[98:99], v9 offset:2560
    buffer_load_dwordx4 v16, s[16:19], s40 offen lds
    v_mfma_f32_16x16x32_bf16 v[228:231], a[116:119], a[76:79], v[228:231]
    ds_read_b64_tr_b16 a[100:101], v9 offset:10240
    v_mul_f32 v97, s84, v97
    v_mfma_f32_16x16x32_bf16 v[228:231], a[112:115], a[72:75], v[228:231]
    ds_read_b64_tr_b16 a[102:103], v9 offset:10752
    v_mul_f32 v98, s84, v98
    v_mfma_f32_16x16x32_bf16 v[232:235], a[112:115], a[80:83], v[232:235]
    buffer_load_dwordx4 v17, s[16:19], s40 offen offset:1024 lds
    v_mfma_f32_16x16x32_bf16 v[232:235], a[116:119], a[84:87], v[232:235]
    v_mfma_f32_16x16x32_bf16 v[236:239], a[116:119], a[92:95], v[236:239]
    s_add_u32 m0, s61, 36864
    v_mul_f32 v99, s84, v99
    v_mfma_f32_16x16x32_bf16 v[236:239], a[112:115], a[88:91], v[236:239]
    s_add_u32 s40, s50, s42
    v_mul_f32 v100, s84, v100
    s_waitcnt lgkmcnt(4)
    v_mfma_f32_16x16x32_bf16 v[252:255], a[120:123], a[88:91], v[252:255]
    ds_read_b64_tr_b16 a[104:105], v10 offset:2048
    v_mul_f32 v101, s84, v101
    v_mfma_f32_16x16x32_bf16 v[252:255], a[124:127], a[92:95], v[252:255]
    ds_read_b64_tr_b16 a[106:107], v10 offset:2560
    v_mul_f32 v102, s84, v102
    v_mfma_f32_16x16x32_bf16 v[248:251], a[124:127], a[84:87], v[248:251]
    ds_read_b64_tr_b16 a[108:109], v10 offset:10240
    v_mul_f32 v103, s84, v103
    v_mfma_f32_16x16x32_bf16 v[248:251], a[120:123], a[80:83], v[248:251]
    ds_read_b64_tr_b16 a[110:111], v10 offset:10752
    v_cvt_pk_bf16_f32 v96, v96, v97
    v_mfma_f32_16x16x32_bf16 v[244:247], a[120:123], a[72:75], v[244:247]
    buffer_load_dwordx4 v16, s[16:19], s40 offen lds
    v_mfma_f32_16x16x32_bf16 v[244:247], a[124:127], a[76:79], v[244:247]
    v_mfma_f32_16x16x32_bf16 v[240:243], a[124:127], a[68:71], v[240:243]
    buffer_load_dwordx4 v17, s[16:19], s40 offen offset:1024 lds
    v_mfma_f32_16x16x32_bf16 v[240:243], a[120:123], a[64:67], v[240:243]
    s_add_u32 m0, s61, 38912
    v_cvt_pk_bf16_f32 v97, v98, v99
    s_waitcnt lgkmcnt(4)
    v_mfma_f32_16x16x32_bf16 v[48:51], a[96:99], a[64:67], v[48:51]
    s_add_u32 s40, s51, s42
    ds_read_b64_tr_b16 a[112:113], v9 offset:2304
    v_mfma_f32_16x16x32_bf16 v[48:51], a[100:103], a[68:71], v[48:51]
    ds_read_b64_tr_b16 a[114:115], v9 offset:2816
    v_mfma_f32_16x16x32_bf16 v[52:55], a[100:103], a[76:79], v[52:55]
    ds_read_b64_tr_b16 a[116:117], v9 offset:10496
    buffer_load_dwordx4 v16, s[16:19], s40 offen lds
    v_mfma_f32_16x16x32_bf16 v[52:55], a[96:99], a[72:75], v[52:55]
    ds_read_b64_tr_b16 a[118:119], v9 offset:11008
    v_cvt_pk_bf16_f32 v98, v100, v101
    v_mfma_f32_16x16x32_bf16 v[56:59], a[96:99], a[80:83], v[56:59]
    v_cvt_pk_bf16_f32 v99, v102, v103
    v_mfma_f32_16x16x32_bf16 v[56:59], a[100:103], a[84:87], v[56:59]
    s_add_u32 s3, s59, 15360
    v_mfma_f32_16x16x32_bf16 v[60:63], a[100:103], a[92:95], v[60:63]
    buffer_store_dwordx4 v[96:99], v11, s[28:31], s3 offen sc1
    v_mfma_f32_16x16x32_bf16 v[60:63], a[96:99], a[88:91], v[60:63]
    v_accvgpr_read_b32 v64, a128
    s_waitcnt lgkmcnt(4)
    v_mfma_f32_16x16x32_bf16 v[92:95], a[104:107], a[88:91], v[92:95]
    ds_read_b64_tr_b16 a[120:121], v10 offset:2304
    v_mfma_f32_16x16x32_bf16 v[92:95], a[108:111], a[92:95], v[92:95]
    ds_read_b64_tr_b16 a[122:123], v10 offset:2816
    v_accvgpr_read_b32 v65, a129
    v_mfma_f32_16x16x32_bf16 v[88:91], a[108:111], a[84:87], v[88:91]
    ds_read_b64_tr_b16 a[124:125], v10 offset:10496
    v_accvgpr_read_b32 v66, a130
    v_mfma_f32_16x16x32_bf16 v[88:91], a[104:107], a[80:83], v[88:91]
    ds_read_b64_tr_b16 a[126:127], v10 offset:11008
    v_mfma_f32_16x16x32_bf16 v[84:87], a[104:107], a[72:75], v[84:87]
    buffer_load_dwordx4 v17, s[16:19], s40 offen offset:1024 lds
    v_mfma_f32_16x16x32_bf16 v[84:87], a[108:111], a[76:79], v[84:87]
    s_add_u32 s56, s56, 1
    s_cmp_eq_u32 s56, 10
    s_cselect_b32 s56, 0, s56
    v_mfma_f32_16x16x32_bf16 v[80:83], a[108:111], a[68:71], v[80:83]
    v_add_u32 v9, 32768, v12
    v_add_u32 v10, 32768, v13
    v_mfma_f32_16x16x32_bf16 v[80:83], a[104:107], a[64:67], v[80:83]
    s_waitcnt vmcnt(18) lgkmcnt(0)
    s_barrier
    v_mfma_f32_16x16x32_bf16 v[112:115], a[112:115], a[64:67], v[112:115]
    ds_read_b64_tr_b16 a[96:97], v9 offset:0
    v_mfma_f32_16x16x32_bf16 v[112:115], a[116:119], a[68:71], v[112:115]
    ds_read_b64_tr_b16 a[98:99], v9 offset:1024
    v_accvgpr_read_b32 v67, a131
    v_mfma_f32_16x16x32_bf16 v[116:119], a[116:119], a[76:79], v[116:119]
    ds_read_b64_tr_b16 a[100:101], v9 offset:8192
    v_mfma_f32_16x16x32_bf16 v[116:119], a[112:115], a[72:75], v[116:119]
    ds_read_b64_tr_b16 a[102:103], v9 offset:9216
    v_accvgpr_read_b32 v68, a132
    v_mfma_f32_16x16x32_bf16 v[120:123], a[112:115], a[80:83], v[120:123]
    ds_read_b128 a[32:35], v7 offset:0
    v_accvgpr_read_b32 v69, a133
    v_mfma_f32_16x16x32_bf16 v[120:123], a[116:119], a[84:87], v[120:123]
    ds_read_b128 a[36:39], v8 offset:0
    v_accvgpr_read_b32 v70, a134
    v_mfma_f32_16x16x32_bf16 v[124:127], a[116:119], a[92:95], v[124:127]
    ds_read_b128 a[40:43], v7 offset:2048
    v_mfma_f32_16x16x32_bf16 v[124:127], a[112:115], a[88:91], v[124:127]
    ds_read_b128 a[44:47], v8 offset:2048
    v_mfma_f32_16x16x32_bf16 v[44:47], a[120:123], a[88:91], v[44:47]
    ds_read_b128 a[48:51], v7 offset:4096
    v_accvgpr_read_b32 v71, a135
    v_mfma_f32_16x16x32_bf16 v[44:47], a[124:127], a[92:95], v[44:47]
    ds_read_b128 a[52:55], v8 offset:4096
    v_cvt_pk_bf16_f32 v64, v64, v65
    v_mfma_f32_16x16x32_bf16 v[40:43], a[124:127], a[84:87], v[40:43]
    ds_read_b128 a[56:59], v7 offset:6144
    v_cvt_pk_bf16_f32 v65, v66, v67
    v_mfma_f32_16x16x32_bf16 v[40:43], a[120:123], a[80:83], v[40:43]
    ds_read_b128 a[60:63], v8 offset:6144
    v_cvt_pk_bf16_f32 v66, v68, v69
    v_mfma_f32_16x16x32_bf16 v[36:39], a[120:123], a[72:75], v[36:39]
    ds_read_b64_tr_b16 a[104:105], v10 offset:0
    v_cvt_pk_bf16_f32 v67, v70, v71
    v_mfma_f32_16x16x32_bf16 v[36:39], a[124:127], a[76:79], v[36:39]
    s_add_u32 s3, s62, 32768
    ds_read_b64_tr_b16 a[106:107], v10 offset:1024
    v_mfma_f32_16x16x32_bf16 v[32:35], a[124:127], a[68:71], v[32:35]
    ds_read_b64_tr_b16 a[108:109], v10 offset:8192
    buffer_store_dwordx4 v[64:67], v11, s[28:31], s3 offen sc1
    v_mfma_f32_16x16x32_bf16 v[32:35], a[120:123], a[64:67], v[32:35]
    ds_read_b64_tr_b16 a[110:111], v10 offset:9216
    s_waitcnt lgkmcnt(4)
    v_mfma_f32_16x16x32_bf16 v[128:131], a[96:99], a[32:35], v[128:131]
    ds_read_b64_tr_b16 a[112:113], v9 offset:256
    v_mfma_f32_16x16x32_bf16 v[128:131], a[100:103], a[36:39], v[128:131]
    ds_read_b64_tr_b16 a[114:115], v9 offset:1280
    v_mfma_f32_16x16x32_bf16 v[132:135], a[100:103], a[44:47], v[132:135]
    ds_read_b64_tr_b16 a[116:117], v9 offset:8448
    v_accvgpr_read_b32 v96, a144
    v_mfma_f32_16x16x32_bf16 v[132:135], a[96:99], a[40:43], v[132:135]
    ds_read_b64_tr_b16 a[118:119], v9 offset:9472
    v_mfma_f32_16x16x32_bf16 v[136:139], a[96:99], a[48:51], v[136:139]
    s_mul_i32 s40, s56, 524288
    s_add_u32 s40, s40, s57
    v_mfma_f32_16x16x32_bf16 v[136:139], a[100:103], a[52:55], v[136:139]
    s_add_u32 m0, s60, 0
    v_mfma_f32_16x16x32_bf16 v[140:143], a[100:103], a[60:63], v[140:143]
    buffer_load_dwordx4 v4, s[20:23], s40 offen lds
    v_mfma_f32_16x16x32_bf16 v[140:143], a[96:99], a[56:59], v[140:143]
    s_waitcnt lgkmcnt(4)
    v_mfma_f32_16x16x32_bf16 v[156:159], a[104:107], a[56:59], v[156:159]
    ds_read_b64_tr_b16 a[120:121], v10 offset:256
    v_accvgpr_read_b32 v97, a145
    v_mfma_f32_16x16x32_bf16 v[156:159], a[108:111], a[60:63], v[156:159]
    ds_read_b64_tr_b16 a[122:123], v10 offset:1280
    v_accvgpr_read_b32 v98, a146
    v_mfma_f32_16x16x32_bf16 v[152:155], a[108:111], a[52:55], v[152:155]
    ds_read_b64_tr_b16 a[124:125], v10 offset:8448
    v_accvgpr_read_b32 v99, a147
    v_mfma_f32_16x16x32_bf16 v[152:155], a[104:107], a[48:51], v[152:155]
    ds_read_b64_tr_b16 a[126:127], v10 offset:9472
    v_mfma_f32_16x16x32_bf16 v[148:151], a[104:107], a[40:43], v[148:151]
    buffer_load_dwordx4 v5, s[20:23], s40 offen offset:1024 lds
    v_mfma_f32_16x16x32_bf16 v[148:151], a[108:111], a[44:47], v[148:151]
    s_mul_i32 s41, s56, 221184
    s_add_u32 s41, s41, s58
    v_mfma_f32_16x16x32_bf16 v[144:147], a[108:111], a[36:39], v[144:147]
    buffer_load_dwordx4 v6, s[24:27], s41 offen offset:2048 lds
    v_mfma_f32_16x16x32_bf16 v[144:147], a[104:107], a[32:35], v[144:147]
    s_waitcnt lgkmcnt(4)
    v_mfma_f32_16x16x32_bf16 v[160:163], a[112:115], a[32:35], v[160:163]
    s_add_u32 s40, s40, 131072
    ds_read_b64_tr_b16 a[96:97], v9 offset:512
    v_mfma_f32_16x16x32_bf16 v[160:163], a[116:119], a[36:39], v[160:163]
    ds_read_b64_tr_b16 a[98:99], v9 offset:1536
    v_accvgpr_read_b32 v100, a148
    v_mfma_f32_16x16x32_bf16 v[164:167], a[116:119], a[44:47], v[164:167]
    s_add_u32 m0, s60, 4096
    ds_read_b64_tr_b16 a[100:101], v9 offset:8704
    v_mfma_f32_16x16x32_bf16 v[164:167], a[112:115], a[40:43], v[164:167]
    ds_read_b64_tr_b16 a[102:103], v9 offset:9728
    v_mfma_f32_16x16x32_bf16 v[168:171], a[112:115], a[48:51], v[168:171]
    buffer_load_dwordx4 v4, s[20:23], s40 offen lds
    v_mfma_f32_16x16x32_bf16 v[168:171], a[116:119], a[52:55], v[168:171]
    v_accvgpr_read_b32 v101, a149
    v_mfma_f32_16x16x32_bf16 v[172:175], a[116:119], a[60:63], v[172:175]
    buffer_load_dwordx4 v5, s[20:23], s40 offen offset:1024 lds
    v_mfma_f32_16x16x32_bf16 v[172:175], a[112:115], a[56:59], v[172:175]
    s_add_u32 s41, s41, 55296
    s_waitcnt lgkmcnt(4)
    v_mfma_f32_16x16x32_bf16 v[188:191], a[120:123], a[56:59], v[188:191]
    ds_read_b64_tr_b16 a[104:105], v10 offset:512
    v_mfma_f32_16x16x32_bf16 v[188:191], a[124:127], a[60:63], v[188:191]
    ds_read_b64_tr_b16 a[106:107], v10 offset:1536
    v_mfma_f32_16x16x32_bf16 v[184:187], a[124:127], a[52:55], v[184:187]
    ds_read_b64_tr_b16 a[108:109], v10 offset:8704
    v_accvgpr_read_b32 v102, a150
    v_mfma_f32_16x16x32_bf16 v[184:187], a[120:123], a[48:51], v[184:187]
    ds_read_b64_tr_b16 a[110:111], v10 offset:9728
    v_accvgpr_read_b32 v103, a151
    v_mfma_f32_16x16x32_bf16 v[180:183], a[120:123], a[40:43], v[180:183]
    buffer_load_dwordx4 v6, s[24:27], s41 offen offset:2048 lds
    v_mfma_f32_16x16x32_bf16 v[180:183], a[124:127], a[44:47], v[180:183]
    v_cvt_pk_bf16_f32 v96, v96, v97
    v_cvt_pk_bf16_f32 v97, v98, v99
    v_mfma_f32_16x16x32_bf16 v[176:179], a[124:127], a[36:39], v[176:179]
    v_cvt_pk_bf16_f32 v98, v100, v101
    v_mfma_f32_16x16x32_bf16 v[176:179], a[120:123], a[32:35], v[176:179]
    s_lshl_b32 s42, s56, 7
    v_cvt_pk_bf16_f32 v99, v102, v103
    s_waitcnt lgkmcnt(4)
    v_mfma_f32_16x16x32_bf16 v[192:195], a[96:99], a[32:35], v[192:195]
    s_add_u32 m0, s61, 0
    ds_read_b64_tr_b16 a[112:113], v9 offset:768
    v_mfma_f32_16x16x32_bf16 v[192:195], a[100:103], a[36:39], v[192:195]
    s_add_u32 s3, s62, 33792
    ds_read_b64_tr_b16 a[114:115], v9 offset:1792
    v_mfma_f32_16x16x32_bf16 v[196:199], a[100:103], a[44:47], v[196:199]
    s_add_u32 s40, s48, s42
    ds_read_b64_tr_b16 a[116:117], v9 offset:8960
    v_mfma_f32_16x16x32_bf16 v[196:199], a[96:99], a[40:43], v[196:199]
    ds_read_b64_tr_b16 a[118:119], v9 offset:9984
    v_mfma_f32_16x16x32_bf16 v[200:203], a[96:99], a[48:51], v[200:203]
    buffer_store_dwordx4 v[96:99], v11, s[28:31], s3 offen sc1
    v_mfma_f32_16x16x32_bf16 v[200:203], a[100:103], a[52:55], v[200:203]
    v_accvgpr_read_b32 v64, a160
    v_accvgpr_read_b32 v65, a161
    v_mfma_f32_16x16x32_bf16 v[204:207], a[100:103], a[60:63], v[204:207]
    buffer_load_dwordx4 v16, s[16:19], s40 offen lds
    v_mfma_f32_16x16x32_bf16 v[204:207], a[96:99], a[56:59], v[204:207]
    s_waitcnt lgkmcnt(4)
    v_mfma_f32_16x16x32_bf16 v[220:223], a[104:107], a[56:59], v[220:223]
    ds_read_b64_tr_b16 a[120:121], v10 offset:768
    v_accvgpr_read_b32 v66, a162
    v_mfma_f32_16x16x32_bf16 v[220:223], a[108:111], a[60:63], v[220:223]
    ds_read_b64_tr_b16 a[122:123], v10 offset:1792
    v_mfma_f32_16x16x32_bf16 v[216:219], a[108:111], a[52:55], v[216:219]
    ds_read_b64_tr_b16 a[124:125], v10 offset:8960
    v_mfma_f32_16x16x32_bf16 v[216:219], a[104:107], a[48:51], v[216:219]
    ds_read_b64_tr_b16 a[126:127], v10 offset:9984
    v_mfma_f32_16x16x32_bf16 v[212:215], a[104:107], a[40:43], v[212:215]
    v_mfma_f32_16x16x32_bf16 v[212:215], a[108:111], a[44:47], v[212:215]
    buffer_load_dwordx4 v17, s[16:19], s40 offen offset:1024 lds
    v_mfma_f32_16x16x32_bf16 v[208:211], a[108:111], a[36:39], v[208:211]
    s_add_u32 m0, s61, 2048
    v_mfma_f32_16x16x32_bf16 v[208:211], a[104:107], a[32:35], v[208:211]
    v_accvgpr_read_b32 v67, a163
    s_waitcnt lgkmcnt(4)
    v_mfma_f32_16x16x32_bf16 v[224:227], a[112:115], a[32:35], v[224:227]
    s_add_u32 s40, s49, s42
    ds_read_b64_tr_b16 a[96:97], v9 offset:2048
    v_mfma_f32_16x16x32_bf16 v[224:227], a[116:119], a[36:39], v[224:227]
    ds_read_b64_tr_b16 a[98:99], v9 offset:2560
    v_mfma_f32_16x16x32_bf16 v[228:231], a[116:119], a[44:47], v[228:231]
    ds_read_b64_tr_b16 a[100:101], v9 offset:10240
    v_mfma_f32_16x16x32_bf16 v[228:231], a[112:115], a[40:43], v[228:231]
    ds_read_b64_tr_b16 a[102:103], v9 offset:10752
    v_mfma_f32_16x16x32_bf16 v[232:235], a[112:115], a[48:51], v[232:235]
    buffer_load_dwordx4 v16, s[16:19], s40 offen lds
    v_mfma_f32_16x16x32_bf16 v[232:235], a[116:119], a[52:55], v[232:235]
    v_mfma_f32_16x16x32_bf16 v[236:239], a[116:119], a[60:63], v[236:239]
    buffer_load_dwordx4 v17, s[16:19], s40 offen offset:1024 lds
    v_mfma_f32_16x16x32_bf16 v[236:239], a[112:115], a[56:59], v[236:239]
    v_accvgpr_read_b32 v68, a164
    s_waitcnt lgkmcnt(4)
    v_mfma_f32_16x16x32_bf16 v[252:255], a[120:123], a[56:59], v[252:255]
    s_add_u32 m0, s61, 4096
    ds_read_b64_tr_b16 a[104:105], v10 offset:2048
    v_mfma_f32_16x16x32_bf16 v[252:255], a[124:127], a[60:63], v[252:255]
    s_add_u32 s40, s50, s42
    ds_read_b64_tr_b16 a[106:107], v10 offset:2560
    v_mfma_f32_16x16x32_bf16 v[248:251], a[124:127], a[52:55], v[248:251]
    ds_read_b64_tr_b16 a[108:109], v10 offset:10240
    v_mfma_f32_16x16x32_bf16 v[248:251], a[120:123], a[48:51], v[248:251]
    ds_read_b64_tr_b16 a[110:111], v10 offset:10752
    v_accvgpr_read_b32 v69, a165
    v_mfma_f32_16x16x32_bf16 v[244:247], a[120:123], a[40:43], v[244:247]
    buffer_load_dwordx4 v16, s[16:19], s40 offen lds
    v_mfma_f32_16x16x32_bf16 v[244:247], a[124:127], a[44:47], v[244:247]
L_ws_3332:
    s_cbranch_execz L_ws_5578
    v_accvgpr_read_b32 v70, a166
    v_mfma_f32_16x16x32_bf16 v[240:243], a[124:127], a[36:39], v[240:243]
    buffer_load_dwordx4 v17, s[16:19], s40 offen offset:1024 lds
    v_mfma_f32_16x16x32_bf16 v[240:243], a[120:123], a[32:35], v[240:243]
    s_waitcnt lgkmcnt(4)
    v_mfma_f32_16x16x32_bf16 v[48:51], a[96:99], a[32:35], v[48:51]
    ds_read_b64_tr_b16 a[112:113], v9 offset:2304
    v_mfma_f32_16x16x32_bf16 v[48:51], a[100:103], a[36:39], v[48:51]
    s_add_u32 m0, s61, 6144
    ds_read_b64_tr_b16 a[114:115], v9 offset:2816
    v_mfma_f32_16x16x32_bf16 v[52:55], a[100:103], a[44:47], v[52:55]
    ds_read_b64_tr_b16 a[116:117], v9 offset:10496
    v_mfma_f32_16x16x32_bf16 v[52:55], a[96:99], a[40:43], v[52:55]
    s_add_u32 s40, s51, s42
    ds_read_b64_tr_b16 a[118:119], v9 offset:11008
    v_mfma_f32_16x16x32_bf16 v[56:59], a[96:99], a[48:51], v[56:59]
    v_mfma_f32_16x16x32_bf16 v[56:59], a[100:103], a[52:55], v[56:59]
    buffer_load_dwordx4 v16, s[16:19], s40 offen lds
    v_mfma_f32_16x16x32_bf16 v[60:63], a[100:103], a[60:63], v[60:63]
    v_mfma_f32_16x16x32_bf16 v[60:63], a[96:99], a[56:59], v[60:63]
    v_accvgpr_read_b32 v71, a167
    s_waitcnt lgkmcnt(4)
    v_mfma_f32_16x16x32_bf16 v[92:95], a[104:107], a[56:59], v[92:95]
    ds_read_b64_tr_b16 a[120:121], v10 offset:2304
    v_cvt_pk_bf16_f32 v64, v64, v65
    v_mfma_f32_16x16x32_bf16 v[92:95], a[108:111], a[60:63], v[92:95]
    ds_read_b64_tr_b16 a[122:123], v10 offset:2816
    v_mfma_f32_16x16x32_bf16 v[88:91], a[108:111], a[52:55], v[88:91]
    ds_read_b64_tr_b16 a[124:125], v10 offset:10496
    v_cvt_pk_bf16_f32 v65, v66, v67
    v_mfma_f32_16x16x32_bf16 v[88:91], a[104:107], a[48:51], v[88:91]
    ds_read_b64_tr_b16 a[126:127], v10 offset:11008
    v_mfma_f32_16x16x32_bf16 v[84:87], a[104:107], a[40:43], v[84:87]
    buffer_load_dwordx4 v17, s[16:19], s40 offen offset:1024 lds
    v_mfma_f32_16x16x32_bf16 v[84:87], a[108:111], a[44:47], v[84:87]
    s_add_u32 s56, s56, 1
    s_cmp_eq_u32 s56, 10
    s_cselect_b32 s56, 0, s56
    v_mfma_f32_16x16x32_bf16 v[80:83], a[108:111], a[36:39], v[80:83]
    v_add_u32 v9, 65536, v12
    v_add_u32 v10, 65536, v13
    v_mfma_f32_16x16x32_bf16 v[80:83], a[104:107], a[32:35], v[80:83]
    s_waitcnt vmcnt(16) lgkmcnt(0)
    s_barrier
    v_mfma_f32_16x16x32_bf16 v[112:115], a[112:115], a[32:35], v[112:115]
    ds_read_b64_tr_b16 a[96:97], v9 offset:0
    v_cvt_pk_bf16_f32 v66, v68, v69
    v_mfma_f32_16x16x32_bf16 v[112:115], a[116:119], a[36:39], v[112:115]
    ds_read_b64_tr_b16 a[98:99], v9 offset:1024
    v_mfma_f32_16x16x32_bf16 v[116:119], a[116:119], a[44:47], v[116:119]
    ds_read_b64_tr_b16 a[100:101], v9 offset:8192
    v_cvt_pk_bf16_f32 v67, v70, v71
    v_mfma_f32_16x16x32_bf16 v[116:119], a[112:115], a[40:43], v[116:119]
    ds_read_b64_tr_b16 a[102:103], v9 offset:9216
    v_mfma_f32_16x16x32_bf16 v[120:123], a[112:115], a[48:51], v[120:123]
    s_add_u32 s3, s62, 34816
    ds_read_b128 a[64:67], v7 offset:32768
    v_mfma_f32_16x16x32_bf16 v[120:123], a[116:119], a[52:55], v[120:123]
    ds_read_b128 a[68:71], v8 offset:32768
    v_mfma_f32_16x16x32_bf16 v[124:127], a[116:119], a[60:63], v[124:127]
    ds_read_b128 a[72:75], v7 offset:34816
    v_mfma_f32_16x16x32_bf16 v[124:127], a[112:115], a[56:59], v[124:127]
    ds_read_b128 a[76:79], v8 offset:34816
    v_mfma_f32_16x16x32_bf16 v[44:47], a[120:123], a[56:59], v[44:47]
    ds_read_b128 a[80:83], v7 offset:36864
    v_mfma_f32_16x16x32_bf16 v[44:47], a[124:127], a[60:63], v[44:47]
    ds_read_b128 a[84:87], v8 offset:36864
    buffer_store_dwordx4 v[64:67], v11, s[28:31], s3 offen sc1
    v_mfma_f32_16x16x32_bf16 v[40:43], a[124:127], a[52:55], v[40:43]
    ds_read_b128 a[88:91], v7 offset:38912
    v_mfma_f32_16x16x32_bf16 v[40:43], a[120:123], a[48:51], v[40:43]
    ds_read_b128 a[92:95], v8 offset:38912
    v_mfma_f32_16x16x32_bf16 v[36:39], a[120:123], a[40:43], v[36:39]
    ds_read_b64_tr_b16 a[104:105], v10 offset:0
    v_mfma_f32_16x16x32_bf16 v[36:39], a[124:127], a[44:47], v[36:39]
    ds_read_b64_tr_b16 a[106:107], v10 offset:1024
    v_mfma_f32_16x16x32_bf16 v[32:35], a[124:127], a[36:39], v[32:35]
    ds_read_b64_tr_b16 a[108:109], v10 offset:8192
    v_mfma_f32_16x16x32_bf16 v[32:35], a[120:123], a[32:35], v[32:35]
    ds_read_b64_tr_b16 a[110:111], v10 offset:9216
    s_waitcnt lgkmcnt(4)
    v_mfma_f32_16x16x32_bf16 v[128:131], a[96:99], a[64:67], v[128:131]
    ds_read_b64_tr_b16 a[112:113], v9 offset:256
    v_accvgpr_read_b32 v96, a176
    v_mfma_f32_16x16x32_bf16 v[128:131], a[100:103], a[68:71], v[128:131]
    ds_read_b64_tr_b16 a[114:115], v9 offset:1280
    v_accvgpr_read_b32 v97, a177
    v_mfma_f32_16x16x32_bf16 v[132:135], a[100:103], a[76:79], v[132:135]
    ds_read_b64_tr_b16 a[116:117], v9 offset:8448
    v_accvgpr_read_b32 v98, a178
    v_mfma_f32_16x16x32_bf16 v[132:135], a[96:99], a[72:75], v[132:135]
    ds_read_b64_tr_b16 a[118:119], v9 offset:9472
    v_mfma_f32_16x16x32_bf16 v[136:139], a[96:99], a[80:83], v[136:139]
    s_mul_i32 s40, s56, 524288
    s_add_u32 s40, s40, s57
    v_accvgpr_read_b32 v99, a179
    v_mfma_f32_16x16x32_bf16 v[136:139], a[100:103], a[84:87], v[136:139]
    s_add_u32 m0, s60, 32768
    v_mfma_f32_16x16x32_bf16 v[140:143], a[100:103], a[92:95], v[140:143]
    buffer_load_dwordx4 v4, s[20:23], s40 offen lds
    v_mfma_f32_16x16x32_bf16 v[140:143], a[96:99], a[88:91], v[140:143]
    s_waitcnt lgkmcnt(4)
    v_mfma_f32_16x16x32_bf16 v[156:159], a[104:107], a[88:91], v[156:159]
    ds_read_b64_tr_b16 a[120:121], v10 offset:256
    v_mfma_f32_16x16x32_bf16 v[156:159], a[108:111], a[92:95], v[156:159]
    ds_read_b64_tr_b16 a[122:123], v10 offset:1280
    v_mfma_f32_16x16x32_bf16 v[152:155], a[108:111], a[84:87], v[152:155]
    ds_read_b64_tr_b16 a[124:125], v10 offset:8448
    v_mfma_f32_16x16x32_bf16 v[152:155], a[104:107], a[80:83], v[152:155]
    ds_read_b64_tr_b16 a[126:127], v10 offset:9472
    v_mfma_f32_16x16x32_bf16 v[148:151], a[104:107], a[72:75], v[148:151]
    buffer_load_dwordx4 v5, s[20:23], s40 offen offset:1024 lds
    v_mfma_f32_16x16x32_bf16 v[148:151], a[108:111], a[76:79], v[148:151]
    v_accvgpr_read_b32 v100, a180
    v_accvgpr_read_b32 v101, a181
    v_mfma_f32_16x16x32_bf16 v[144:147], a[108:111], a[68:71], v[144:147]
    s_mul_i32 s41, s56, 221184
    s_add_u32 s41, s41, s58
    v_accvgpr_read_b32 v102, a182
    v_mfma_f32_16x16x32_bf16 v[144:147], a[104:107], a[64:67], v[144:147]
    v_accvgpr_read_b32 v103, a183
    s_waitcnt lgkmcnt(4)
    v_mfma_f32_16x16x32_bf16 v[160:163], a[112:115], a[64:67], v[160:163]
    ds_read_b64_tr_b16 a[96:97], v9 offset:512
    v_cvt_pk_bf16_f32 v96, v96, v97
    v_mfma_f32_16x16x32_bf16 v[160:163], a[116:119], a[68:71], v[160:163]
    ds_read_b64_tr_b16 a[98:99], v9 offset:1536
    v_mfma_f32_16x16x32_bf16 v[164:167], a[116:119], a[76:79], v[164:167]
    ds_read_b64_tr_b16 a[100:101], v9 offset:8704
    v_mfma_f32_16x16x32_bf16 v[164:167], a[112:115], a[72:75], v[164:167]
    ds_read_b64_tr_b16 a[102:103], v9 offset:9728
    v_mfma_f32_16x16x32_bf16 v[168:171], a[112:115], a[80:83], v[168:171]
    v_cvt_pk_bf16_f32 v97, v98, v99
    v_cvt_pk_bf16_f32 v98, v100, v101
    v_mfma_f32_16x16x32_bf16 v[168:171], a[116:119], a[84:87], v[168:171]
    buffer_load_dwordx4 v6, s[24:27], s41 offen offset:2048 lds
    v_mfma_f32_16x16x32_bf16 v[172:175], a[116:119], a[92:95], v[172:175]
    v_mfma_f32_16x16x32_bf16 v[172:175], a[112:115], a[88:91], v[172:175]
    s_waitcnt lgkmcnt(4)
    v_mfma_f32_16x16x32_bf16 v[188:191], a[120:123], a[88:91], v[188:191]
    ds_read_b64_tr_b16 a[104:105], v10 offset:512
    v_mfma_f32_16x16x32_bf16 v[188:191], a[124:127], a[92:95], v[188:191]
    s_add_u32 s40, s40, 131072
    ds_read_b64_tr_b16 a[106:107], v10 offset:1536
    v_mfma_f32_16x16x32_bf16 v[184:187], a[124:127], a[84:87], v[184:187]
    ds_read_b64_tr_b16 a[108:109], v10 offset:8704
    v_cvt_pk_bf16_f32 v99, v102, v103
    v_mfma_f32_16x16x32_bf16 v[184:187], a[120:123], a[80:83], v[184:187]
    s_add_u32 m0, s60, 36864
    ds_read_b64_tr_b16 a[110:111], v10 offset:9728
    v_mfma_f32_16x16x32_bf16 v[180:183], a[120:123], a[72:75], v[180:183]
    buffer_load_dwordx4 v4, s[20:23], s40 offen lds
    v_mfma_f32_16x16x32_bf16 v[180:183], a[124:127], a[76:79], v[180:183]
    s_add_u32 s3, s62, 35840
    v_mfma_f32_16x16x32_bf16 v[176:179], a[124:127], a[68:71], v[176:179]
    buffer_store_dwordx4 v[96:99], v11, s[28:31], s3 offen sc1
    v_mfma_f32_16x16x32_bf16 v[176:179], a[120:123], a[64:67], v[176:179]
    s_waitcnt lgkmcnt(4)
    v_mfma_f32_16x16x32_bf16 v[192:195], a[96:99], a[64:67], v[192:195]
    ds_read_b64_tr_b16 a[112:113], v9 offset:768
    v_accvgpr_read_b32 v64, a192
    v_mfma_f32_16x16x32_bf16 v[192:195], a[100:103], a[68:71], v[192:195]
    ds_read_b64_tr_b16 a[114:115], v9 offset:1792
    v_accvgpr_read_b32 v65, a193
    v_mfma_f32_16x16x32_bf16 v[196:199], a[100:103], a[76:79], v[196:199]
    ds_read_b64_tr_b16 a[116:117], v9 offset:8960
    v_accvgpr_read_b32 v66, a194
    v_mfma_f32_16x16x32_bf16 v[196:199], a[96:99], a[72:75], v[196:199]
    ds_read_b64_tr_b16 a[118:119], v9 offset:9984
    v_mfma_f32_16x16x32_bf16 v[200:203], a[96:99], a[80:83], v[200:203]
    buffer_load_dwordx4 v5, s[20:23], s40 offen offset:1024 lds
    v_mfma_f32_16x16x32_bf16 v[200:203], a[100:103], a[84:87], v[200:203]
    s_add_u32 s41, s41, 55296
    v_accvgpr_read_b32 v67, a195
    v_mfma_f32_16x16x32_bf16 v[204:207], a[100:103], a[92:95], v[204:207]
    buffer_load_dwordx4 v6, s[24:27], s41 offen offset:2048 lds
    v_mfma_f32_16x16x32_bf16 v[204:207], a[96:99], a[88:91], v[204:207]
    s_waitcnt lgkmcnt(4)
    v_mfma_f32_16x16x32_bf16 v[220:223], a[104:107], a[88:91], v[220:223]
    s_lshl_b32 s42, s56, 7
    ds_read_b64_tr_b16 a[120:121], v10 offset:768
    v_mfma_f32_16x16x32_bf16 v[220:223], a[108:111], a[92:95], v[220:223]
    ds_read_b64_tr_b16 a[122:123], v10 offset:1792
    v_mfma_f32_16x16x32_bf16 v[216:219], a[108:111], a[84:87], v[216:219]
    s_add_u32 m0, s61, 32768
    ds_read_b64_tr_b16 a[124:125], v10 offset:8960
    v_mfma_f32_16x16x32_bf16 v[216:219], a[104:107], a[80:83], v[216:219]
    s_add_u32 s40, s48, s42
    ds_read_b64_tr_b16 a[126:127], v10 offset:9984
    v_mfma_f32_16x16x32_bf16 v[212:215], a[104:107], a[72:75], v[212:215]
    buffer_load_dwordx4 v16, s[16:19], s40 offen lds
    v_mfma_f32_16x16x32_bf16 v[212:215], a[108:111], a[76:79], v[212:215]
    v_accvgpr_read_b32 v68, a196
    v_mfma_f32_16x16x32_bf16 v[208:211], a[108:111], a[68:71], v[208:211]
    buffer_load_dwordx4 v17, s[16:19], s40 offen offset:1024 lds
    v_mfma_f32_16x16x32_bf16 v[208:211], a[104:107], a[64:67], v[208:211]
    v_accvgpr_read_b32 v69, a197
    s_waitcnt lgkmcnt(4)
    v_mfma_f32_16x16x32_bf16 v[224:227], a[112:115], a[64:67], v[224:227]
    ds_read_b64_tr_b16 a[96:97], v9 offset:2048
    v_accvgpr_read_b32 v70, a198
    v_mfma_f32_16x16x32_bf16 v[224:227], a[116:119], a[68:71], v[224:227]
    s_add_u32 m0, s61, 34816
    ds_read_b64_tr_b16 a[98:99], v9 offset:2560
    v_mfma_f32_16x16x32_bf16 v[228:231], a[116:119], a[76:79], v[228:231]
    s_add_u32 s40, s49, s42
    ds_read_b64_tr_b16 a[100:101], v9 offset:10240
    v_mfma_f32_16x16x32_bf16 v[228:231], a[112:115], a[72:75], v[228:231]
    ds_read_b64_tr_b16 a[102:103], v9 offset:10752
    v_accvgpr_read_b32 v71, a199
    v_mfma_f32_16x16x32_bf16 v[232:235], a[112:115], a[80:83], v[232:235]
    buffer_load_dwordx4 v16, s[16:19], s40 offen lds
    v_mfma_f32_16x16x32_bf16 v[232:235], a[116:119], a[84:87], v[232:235]
    v_cvt_pk_bf16_f32 v64, v64, v65
    v_mfma_f32_16x16x32_bf16 v[236:239], a[116:119], a[92:95], v[236:239]
    v_mfma_f32_16x16x32_bf16 v[236:239], a[112:115], a[88:91], v[236:239]
    v_cvt_pk_bf16_f32 v65, v66, v67
    s_waitcnt lgkmcnt(4)
    v_mfma_f32_16x16x32_bf16 v[252:255], a[120:123], a[88:91], v[252:255]
    ds_read_b64_tr_b16 a[104:105], v10 offset:2048
    buffer_load_dwordx4 v17, s[16:19], s40 offen offset:1024 lds
    v_mfma_f32_16x16x32_bf16 v[252:255], a[124:127], a[92:95], v[252:255]
    ds_read_b64_tr_b16 a[106:107], v10 offset:2560
    v_cvt_pk_bf16_f32 v66, v68, v69
    v_mfma_f32_16x16x32_bf16 v[248:251], a[124:127], a[84:87], v[248:251]
    s_add_u32 m0, s61, 36864
    ds_read_b64_tr_b16 a[108:109], v10 offset:10240
    v_mfma_f32_16x16x32_bf16 v[248:251], a[120:123], a[80:83], v[248:251]
    s_add_u32 s40, s50, s42
    ds_read_b64_tr_b16 a[110:111], v10 offset:10752
    v_mfma_f32_16x16x32_bf16 v[244:247], a[120:123], a[72:75], v[244:247]
    buffer_load_dwordx4 v16, s[16:19], s40 offen lds
    v_mfma_f32_16x16x32_bf16 v[244:247], a[124:127], a[76:79], v[244:247]
    v_cvt_pk_bf16_f32 v67, v70, v71
    v_mfma_f32_16x16x32_bf16 v[240:243], a[124:127], a[68:71], v[240:243]
    buffer_load_dwordx4 v17, s[16:19], s40 offen offset:1024 lds
    v_mfma_f32_16x16x32_bf16 v[240:243], a[120:123], a[64:67], v[240:243]
    s_add_u32 s3, s95, 36864
    s_waitcnt lgkmcnt(4)
    v_mfma_f32_16x16x32_bf16 v[48:51], a[96:99], a[64:67], v[48:51]
    ds_read_b64_tr_b16 a[112:113], v9 offset:2304
    v_mfma_f32_16x16x32_bf16 v[48:51], a[100:103], a[68:71], v[48:51]
    ds_read_b64_tr_b16 a[114:115], v9 offset:2816
    v_mfma_f32_16x16x32_bf16 v[52:55], a[100:103], a[76:79], v[52:55]
    ds_read_b64_tr_b16 a[116:117], v9 offset:10496
    v_mfma_f32_16x16x32_bf16 v[52:55], a[96:99], a[72:75], v[52:55]
    s_add_u32 m0, s61, 38912
    ds_read_b64_tr_b16 a[118:119], v9 offset:11008
    v_mfma_f32_16x16x32_bf16 v[56:59], a[96:99], a[80:83], v[56:59]
    buffer_store_dwordx4 v[64:67], v11, s[28:31], s3 offen sc1
    v_mfma_f32_16x16x32_bf16 v[56:59], a[100:103], a[84:87], v[56:59]
    s_add_u32 s40, s51, s42
    v_accvgpr_read_b32 v96, a208
    v_mfma_f32_16x16x32_bf16 v[60:63], a[100:103], a[92:95], v[60:63]
    buffer_load_dwordx4 v16, s[16:19], s40 offen lds
    v_mfma_f32_16x16x32_bf16 v[60:63], a[96:99], a[88:91], v[60:63]
    v_accvgpr_read_b32 v97, a209
    s_waitcnt lgkmcnt(4)
    v_mfma_f32_16x16x32_bf16 v[92:95], a[104:107], a[88:91], v[92:95]
    ds_read_b64_tr_b16 a[120:121], v10 offset:2304
    v_accvgpr_read_b32 v98, a210
    v_mfma_f32_16x16x32_bf16 v[92:95], a[108:111], a[92:95], v[92:95]
    ds_read_b64_tr_b16 a[122:123], v10 offset:2816
    v_mfma_f32_16x16x32_bf16 v[88:91], a[108:111], a[84:87], v[88:91]
    ds_read_b64_tr_b16 a[124:125], v10 offset:10496
    v_mfma_f32_16x16x32_bf16 v[88:91], a[104:107], a[80:83], v[88:91]
    ds_read_b64_tr_b16 a[126:127], v10 offset:11008
    v_mfma_f32_16x16x32_bf16 v[84:87], a[104:107], a[72:75], v[84:87]
    buffer_load_dwordx4 v17, s[16:19], s40 offen offset:1024 lds
    v_mfma_f32_16x16x32_bf16 v[84:87], a[108:111], a[76:79], v[84:87]
    s_add_u32 s56, s56, 1
    s_cmp_eq_u32 s56, 10
    s_cselect_b32 s56, 0, s56
    v_mfma_f32_16x16x32_bf16 v[80:83], a[108:111], a[68:71], v[80:83]
    v_add_u32 v9, 0, v12
    v_add_u32 v10, 0, v13
    v_mfma_f32_16x16x32_bf16 v[80:83], a[104:107], a[64:67], v[80:83]
    s_waitcnt vmcnt(17) lgkmcnt(0)
    s_barrier
    v_mfma_f32_16x16x32_bf16 v[112:115], a[112:115], a[64:67], v[112:115]
    ds_read_b64_tr_b16 a[96:97], v9 offset:0
    v_accvgpr_read_b32 v99, a211
    v_mfma_f32_16x16x32_bf16 v[112:115], a[116:119], a[68:71], v[112:115]
    ds_read_b64_tr_b16 a[98:99], v9 offset:1024
    v_accvgpr_read_b32 v100, a212
    v_mfma_f32_16x16x32_bf16 v[116:119], a[116:119], a[76:79], v[116:119]
    ds_read_b64_tr_b16 a[100:101], v9 offset:8192
    v_accvgpr_read_b32 v101, a213
    v_mfma_f32_16x16x32_bf16 v[116:119], a[112:115], a[72:75], v[116:119]
    ds_read_b64_tr_b16 a[102:103], v9 offset:9216
    v_accvgpr_read_b32 v102, a214
    v_mfma_f32_16x16x32_bf16 v[120:123], a[112:115], a[80:83], v[120:123]
    ds_read_b128 a[32:35], v7 offset:0
    v_accvgpr_read_b32 v103, a215
    v_mfma_f32_16x16x32_bf16 v[120:123], a[116:119], a[84:87], v[120:123]
    ds_read_b128 a[36:39], v8 offset:0
    v_mfma_f32_16x16x32_bf16 v[124:127], a[116:119], a[92:95], v[124:127]
    ds_read_b128 a[40:43], v7 offset:2048
    v_mfma_f32_16x16x32_bf16 v[124:127], a[112:115], a[88:91], v[124:127]
    ds_read_b128 a[44:47], v8 offset:2048
    v_mfma_f32_16x16x32_bf16 v[44:47], a[120:123], a[88:91], v[44:47]
    ds_read_b128 a[48:51], v7 offset:4096
    v_cvt_pk_bf16_f32 v96, v96, v97
    v_mfma_f32_16x16x32_bf16 v[44:47], a[124:127], a[92:95], v[44:47]
    ds_read_b128 a[52:55], v8 offset:4096
    v_cvt_pk_bf16_f32 v97, v98, v99
    v_mfma_f32_16x16x32_bf16 v[40:43], a[124:127], a[84:87], v[40:43]
    ds_read_b128 a[56:59], v7 offset:6144
    v_cvt_pk_bf16_f32 v98, v100, v101
    v_mfma_f32_16x16x32_bf16 v[40:43], a[120:123], a[80:83], v[40:43]
    ds_read_b128 a[60:63], v8 offset:6144
    v_cvt_pk_bf16_f32 v99, v102, v103
    v_mfma_f32_16x16x32_bf16 v[36:39], a[120:123], a[72:75], v[36:39]
    s_add_u32 s3, s95, 37888
    ds_read_b64_tr_b16 a[104:105], v10 offset:0
    v_mfma_f32_16x16x32_bf16 v[36:39], a[124:127], a[76:79], v[36:39]
    ds_read_b64_tr_b16 a[106:107], v10 offset:1024
    buffer_store_dwordx4 v[96:99], v11, s[28:31], s3 offen sc1
    v_mfma_f32_16x16x32_bf16 v[32:35], a[124:127], a[68:71], v[32:35]
    ds_read_b64_tr_b16 a[108:109], v10 offset:8192
    v_mfma_f32_16x16x32_bf16 v[32:35], a[120:123], a[64:67], v[32:35]
    ds_read_b64_tr_b16 a[110:111], v10 offset:9216
    s_waitcnt lgkmcnt(4)
    v_mfma_f32_16x16x32_bf16 v[128:131], a[96:99], a[32:35], v[128:131]
    ds_read_b64_tr_b16 a[112:113], v9 offset:256
    v_mfma_f32_16x16x32_bf16 v[128:131], a[100:103], a[36:39], v[128:131]
    ds_read_b64_tr_b16 a[114:115], v9 offset:1280
    v_mfma_f32_16x16x32_bf16 v[132:135], a[100:103], a[44:47], v[132:135]
    ds_read_b64_tr_b16 a[116:117], v9 offset:8448
    v_accvgpr_read_b32 v64, a224
    v_mfma_f32_16x16x32_bf16 v[132:135], a[96:99], a[40:43], v[132:135]
    ds_read_b64_tr_b16 a[118:119], v9 offset:9472
    v_mfma_f32_16x16x32_bf16 v[136:139], a[96:99], a[48:51], v[136:139]
    s_mul_i32 s40, s56, 524288
    s_add_u32 s40, s40, s57
    v_mfma_f32_16x16x32_bf16 v[136:139], a[100:103], a[52:55], v[136:139]
    s_add_u32 m0, s60, 65536
    v_mfma_f32_16x16x32_bf16 v[140:143], a[100:103], a[60:63], v[140:143]
    buffer_load_dwordx4 v4, s[20:23], s40 offen lds
    v_mfma_f32_16x16x32_bf16 v[140:143], a[96:99], a[56:59], v[140:143]
    s_waitcnt lgkmcnt(4)
    v_mfma_f32_16x16x32_bf16 v[156:159], a[104:107], a[56:59], v[156:159]
    ds_read_b64_tr_b16 a[120:121], v10 offset:256
    v_accvgpr_read_b32 v65, a225
    v_mfma_f32_16x16x32_bf16 v[156:159], a[108:111], a[60:63], v[156:159]
    ds_read_b64_tr_b16 a[122:123], v10 offset:1280
    v_accvgpr_read_b32 v66, a226
    v_mfma_f32_16x16x32_bf16 v[152:155], a[108:111], a[52:55], v[152:155]
    ds_read_b64_tr_b16 a[124:125], v10 offset:8448
    v_accvgpr_read_b32 v67, a227
    v_mfma_f32_16x16x32_bf16 v[152:155], a[104:107], a[48:51], v[152:155]
    ds_read_b64_tr_b16 a[126:127], v10 offset:9472
    v_mfma_f32_16x16x32_bf16 v[148:151], a[104:107], a[40:43], v[148:151]
    buffer_load_dwordx4 v5, s[20:23], s40 offen offset:1024 lds
    v_mfma_f32_16x16x32_bf16 v[148:151], a[108:111], a[44:47], v[148:151]
    s_mul_i32 s41, s56, 221184
    s_add_u32 s41, s41, s58
    v_mfma_f32_16x16x32_bf16 v[144:147], a[108:111], a[36:39], v[144:147]
    buffer_load_dwordx4 v6, s[24:27], s41 offen offset:2048 lds
    v_mfma_f32_16x16x32_bf16 v[144:147], a[104:107], a[32:35], v[144:147]
    s_waitcnt lgkmcnt(4)
    v_mfma_f32_16x16x32_bf16 v[160:163], a[112:115], a[32:35], v[160:163]
    s_add_u32 s40, s40, 131072
    ds_read_b64_tr_b16 a[96:97], v9 offset:512
    v_mfma_f32_16x16x32_bf16 v[160:163], a[116:119], a[36:39], v[160:163]
    ds_read_b64_tr_b16 a[98:99], v9 offset:1536
    v_accvgpr_read_b32 v68, a228
    v_mfma_f32_16x16x32_bf16 v[164:167], a[116:119], a[44:47], v[164:167]
    s_add_u32 m0, s60, 69632
    ds_read_b64_tr_b16 a[100:101], v9 offset:8704
    v_mfma_f32_16x16x32_bf16 v[164:167], a[112:115], a[40:43], v[164:167]
    ds_read_b64_tr_b16 a[102:103], v9 offset:9728
    v_mfma_f32_16x16x32_bf16 v[168:171], a[112:115], a[48:51], v[168:171]
    buffer_load_dwordx4 v4, s[20:23], s40 offen lds
    v_mfma_f32_16x16x32_bf16 v[168:171], a[116:119], a[52:55], v[168:171]
    v_accvgpr_read_b32 v69, a229
    v_mfma_f32_16x16x32_bf16 v[172:175], a[116:119], a[60:63], v[172:175]
    buffer_load_dwordx4 v5, s[20:23], s40 offen offset:1024 lds
    v_mfma_f32_16x16x32_bf16 v[172:175], a[112:115], a[56:59], v[172:175]
    s_add_u32 s41, s41, 55296
    s_waitcnt lgkmcnt(4)
    v_mfma_f32_16x16x32_bf16 v[188:191], a[120:123], a[56:59], v[188:191]
    ds_read_b64_tr_b16 a[104:105], v10 offset:512
    v_mfma_f32_16x16x32_bf16 v[188:191], a[124:127], a[60:63], v[188:191]
    ds_read_b64_tr_b16 a[106:107], v10 offset:1536
    v_mfma_f32_16x16x32_bf16 v[184:187], a[124:127], a[52:55], v[184:187]
    ds_read_b64_tr_b16 a[108:109], v10 offset:8704
    v_accvgpr_read_b32 v70, a230
    v_mfma_f32_16x16x32_bf16 v[184:187], a[120:123], a[48:51], v[184:187]
    ds_read_b64_tr_b16 a[110:111], v10 offset:9728
    v_accvgpr_read_b32 v71, a231
    v_mfma_f32_16x16x32_bf16 v[180:183], a[120:123], a[40:43], v[180:183]
    buffer_load_dwordx4 v6, s[24:27], s41 offen offset:2048 lds
    v_mfma_f32_16x16x32_bf16 v[180:183], a[124:127], a[44:47], v[180:183]
    v_cvt_pk_bf16_f32 v64, v64, v65
    v_cvt_pk_bf16_f32 v65, v66, v67
    v_mfma_f32_16x16x32_bf16 v[176:179], a[124:127], a[36:39], v[176:179]
    v_cvt_pk_bf16_f32 v66, v68, v69
    v_mfma_f32_16x16x32_bf16 v[176:179], a[120:123], a[32:35], v[176:179]
    s_lshl_b32 s42, s56, 7
    v_cvt_pk_bf16_f32 v67, v70, v71
    s_waitcnt lgkmcnt(4)
    v_mfma_f32_16x16x32_bf16 v[192:195], a[96:99], a[32:35], v[192:195]
    s_add_u32 m0, s61, 0
    ds_read_b64_tr_b16 a[112:113], v9 offset:768
    v_mfma_f32_16x16x32_bf16 v[192:195], a[100:103], a[36:39], v[192:195]
    s_add_u32 s3, s95, 38912
    ds_read_b64_tr_b16 a[114:115], v9 offset:1792
    v_mfma_f32_16x16x32_bf16 v[196:199], a[100:103], a[44:47], v[196:199]
    s_add_u32 s40, s48, s42
    ds_read_b64_tr_b16 a[116:117], v9 offset:8960
    v_mfma_f32_16x16x32_bf16 v[196:199], a[96:99], a[40:43], v[196:199]
    ds_read_b64_tr_b16 a[118:119], v9 offset:9984
    v_mfma_f32_16x16x32_bf16 v[200:203], a[96:99], a[48:51], v[200:203]
    buffer_store_dwordx4 v[64:67], v11, s[28:31], s3 offen sc1
    v_mfma_f32_16x16x32_bf16 v[200:203], a[100:103], a[52:55], v[200:203]
    v_accvgpr_read_b32 v96, a240
    v_accvgpr_read_b32 v97, a241
    v_mfma_f32_16x16x32_bf16 v[204:207], a[100:103], a[60:63], v[204:207]
    buffer_load_dwordx4 v16, s[16:19], s40 offen lds
    v_mfma_f32_16x16x32_bf16 v[204:207], a[96:99], a[56:59], v[204:207]
    s_waitcnt lgkmcnt(4)
    v_mfma_f32_16x16x32_bf16 v[220:223], a[104:107], a[56:59], v[220:223]
    ds_read_b64_tr_b16 a[120:121], v10 offset:768
    v_accvgpr_read_b32 v98, a242
    v_mfma_f32_16x16x32_bf16 v[220:223], a[108:111], a[60:63], v[220:223]
    ds_read_b64_tr_b16 a[122:123], v10 offset:1792
    v_mfma_f32_16x16x32_bf16 v[216:219], a[108:111], a[52:55], v[216:219]
    ds_read_b64_tr_b16 a[124:125], v10 offset:8960
    v_mfma_f32_16x16x32_bf16 v[216:219], a[104:107], a[48:51], v[216:219]
    ds_read_b64_tr_b16 a[126:127], v10 offset:9984
    v_mfma_f32_16x16x32_bf16 v[212:215], a[104:107], a[40:43], v[212:215]
    v_mfma_f32_16x16x32_bf16 v[212:215], a[108:111], a[44:47], v[212:215]
    buffer_load_dwordx4 v17, s[16:19], s40 offen offset:1024 lds
    v_mfma_f32_16x16x32_bf16 v[208:211], a[108:111], a[36:39], v[208:211]
    s_add_u32 m0, s61, 2048
    v_mfma_f32_16x16x32_bf16 v[208:211], a[104:107], a[32:35], v[208:211]
    v_accvgpr_read_b32 v99, a243
    s_waitcnt lgkmcnt(4)
    v_mfma_f32_16x16x32_bf16 v[224:227], a[112:115], a[32:35], v[224:227]
    s_add_u32 s40, s49, s42
    ds_read_b64_tr_b16 a[96:97], v9 offset:2048
    v_mfma_f32_16x16x32_bf16 v[224:227], a[116:119], a[36:39], v[224:227]
    ds_read_b64_tr_b16 a[98:99], v9 offset:2560
    v_mfma_f32_16x16x32_bf16 v[228:231], a[116:119], a[44:47], v[228:231]
    ds_read_b64_tr_b16 a[100:101], v9 offset:10240
    v_mfma_f32_16x16x32_bf16 v[228:231], a[112:115], a[40:43], v[228:231]
    ds_read_b64_tr_b16 a[102:103], v9 offset:10752
    v_mfma_f32_16x16x32_bf16 v[232:235], a[112:115], a[48:51], v[232:235]
    buffer_load_dwordx4 v16, s[16:19], s40 offen lds
    v_mfma_f32_16x16x32_bf16 v[232:235], a[116:119], a[52:55], v[232:235]
    v_mfma_f32_16x16x32_bf16 v[236:239], a[116:119], a[60:63], v[236:239]
    buffer_load_dwordx4 v17, s[16:19], s40 offen offset:1024 lds
    v_mfma_f32_16x16x32_bf16 v[236:239], a[112:115], a[56:59], v[236:239]
    v_accvgpr_read_b32 v100, a244
    s_waitcnt lgkmcnt(4)
    v_mfma_f32_16x16x32_bf16 v[252:255], a[120:123], a[56:59], v[252:255]
    s_add_u32 m0, s61, 4096
    ds_read_b64_tr_b16 a[104:105], v10 offset:2048
    v_mfma_f32_16x16x32_bf16 v[252:255], a[124:127], a[60:63], v[252:255]
    s_add_u32 s40, s50, s42
    ds_read_b64_tr_b16 a[106:107], v10 offset:2560
    v_mfma_f32_16x16x32_bf16 v[248:251], a[124:127], a[52:55], v[248:251]
    ds_read_b64_tr_b16 a[108:109], v10 offset:10240
    v_mfma_f32_16x16x32_bf16 v[248:251], a[120:123], a[48:51], v[248:251]
    ds_read_b64_tr_b16 a[110:111], v10 offset:10752
    v_accvgpr_read_b32 v101, a245
    v_mfma_f32_16x16x32_bf16 v[244:247], a[120:123], a[40:43], v[244:247]
    buffer_load_dwordx4 v16, s[16:19], s40 offen lds
    v_mfma_f32_16x16x32_bf16 v[244:247], a[124:127], a[44:47], v[244:247]
    v_accvgpr_read_b32 v102, a246
    v_mfma_f32_16x16x32_bf16 v[240:243], a[124:127], a[36:39], v[240:243]
    buffer_load_dwordx4 v17, s[16:19], s40 offen offset:1024 lds
    v_mfma_f32_16x16x32_bf16 v[240:243], a[120:123], a[32:35], v[240:243]
    s_waitcnt lgkmcnt(4)
    v_mfma_f32_16x16x32_bf16 v[48:51], a[96:99], a[32:35], v[48:51]
    ds_read_b64_tr_b16 a[112:113], v9 offset:2304
    v_mfma_f32_16x16x32_bf16 v[48:51], a[100:103], a[36:39], v[48:51]
    s_add_u32 m0, s61, 6144
    ds_read_b64_tr_b16 a[114:115], v9 offset:2816
    v_mfma_f32_16x16x32_bf16 v[52:55], a[100:103], a[44:47], v[52:55]
    ds_read_b64_tr_b16 a[116:117], v9 offset:10496
    v_mfma_f32_16x16x32_bf16 v[52:55], a[96:99], a[40:43], v[52:55]
    s_add_u32 s40, s51, s42
    ds_read_b64_tr_b16 a[118:119], v9 offset:11008
    v_mfma_f32_16x16x32_bf16 v[56:59], a[96:99], a[48:51], v[56:59]
    v_mfma_f32_16x16x32_bf16 v[56:59], a[100:103], a[52:55], v[56:59]
    buffer_load_dwordx4 v16, s[16:19], s40 offen lds
    v_mfma_f32_16x16x32_bf16 v[60:63], a[100:103], a[60:63], v[60:63]
    v_mfma_f32_16x16x32_bf16 v[60:63], a[96:99], a[56:59], v[60:63]
    v_accvgpr_read_b32 v103, a247
    s_waitcnt lgkmcnt(4)
    v_mfma_f32_16x16x32_bf16 v[92:95], a[104:107], a[56:59], v[92:95]
    ds_read_b64_tr_b16 a[120:121], v10 offset:2304
    v_cvt_pk_bf16_f32 v96, v96, v97
    v_mfma_f32_16x16x32_bf16 v[92:95], a[108:111], a[60:63], v[92:95]
    ds_read_b64_tr_b16 a[122:123], v10 offset:2816
    v_mfma_f32_16x16x32_bf16 v[88:91], a[108:111], a[52:55], v[88:91]
    ds_read_b64_tr_b16 a[124:125], v10 offset:10496
    v_cvt_pk_bf16_f32 v97, v98, v99
    v_mfma_f32_16x16x32_bf16 v[88:91], a[104:107], a[48:51], v[88:91]
    ds_read_b64_tr_b16 a[126:127], v10 offset:11008
    v_mfma_f32_16x16x32_bf16 v[84:87], a[104:107], a[40:43], v[84:87]
    buffer_load_dwordx4 v17, s[16:19], s40 offen offset:1024 lds
    v_mfma_f32_16x16x32_bf16 v[84:87], a[108:111], a[44:47], v[84:87]
    s_add_u32 s56, s56, 1
    s_cmp_eq_u32 s56, 10
    s_cselect_b32 s56, 0, s56
    v_mfma_f32_16x16x32_bf16 v[80:83], a[108:111], a[36:39], v[80:83]
    v_add_u32 v9, 32768, v12
    v_add_u32 v10, 32768, v13
    v_mfma_f32_16x16x32_bf16 v[80:83], a[104:107], a[32:35], v[80:83]
    s_waitcnt vmcnt(16) lgkmcnt(0)
    s_barrier
    v_mfma_f32_16x16x32_bf16 v[112:115], a[112:115], a[32:35], v[112:115]
    ds_read_b64_tr_b16 a[96:97], v9 offset:0
    v_cvt_pk_bf16_f32 v98, v100, v101
    v_mfma_f32_16x16x32_bf16 v[112:115], a[116:119], a[36:39], v[112:115]
    ds_read_b64_tr_b16 a[98:99], v9 offset:1024
    v_mfma_f32_16x16x32_bf16 v[116:119], a[116:119], a[44:47], v[116:119]
    ds_read_b64_tr_b16 a[100:101], v9 offset:8192
    v_cvt_pk_bf16_f32 v99, v102, v103
    v_mfma_f32_16x16x32_bf16 v[116:119], a[112:115], a[40:43], v[116:119]
    ds_read_b64_tr_b16 a[102:103], v9 offset:9216
    v_mfma_f32_16x16x32_bf16 v[120:123], a[112:115], a[48:51], v[120:123]
    s_add_u32 s3, s95, 39936
    ds_read_b128 a[64:67], v7 offset:32768
    v_mfma_f32_16x16x32_bf16 v[120:123], a[116:119], a[52:55], v[120:123]
    ds_read_b128 a[68:71], v8 offset:32768
    v_mfma_f32_16x16x32_bf16 v[124:127], a[116:119], a[60:63], v[124:127]
    ds_read_b128 a[72:75], v7 offset:34816
    v_mfma_f32_16x16x32_bf16 v[124:127], a[112:115], a[56:59], v[124:127]
    ds_read_b128 a[76:79], v8 offset:34816
    v_mfma_f32_16x16x32_bf16 v[44:47], a[120:123], a[56:59], v[44:47]
    ds_read_b128 a[80:83], v7 offset:36864
    v_mfma_f32_16x16x32_bf16 v[44:47], a[124:127], a[60:63], v[44:47]
    ds_read_b128 a[84:87], v8 offset:36864
    buffer_store_dwordx4 v[96:99], v11, s[28:31], s3 offen sc1
    v_mfma_f32_16x16x32_bf16 v[40:43], a[124:127], a[52:55], v[40:43]
    ds_read_b128 a[88:91], v7 offset:38912
    v_mfma_f32_16x16x32_bf16 v[40:43], a[120:123], a[48:51], v[40:43]
    ds_read_b128 a[92:95], v8 offset:38912
    v_mfma_f32_16x16x32_bf16 v[36:39], a[120:123], a[40:43], v[36:39]
    ds_read_b64_tr_b16 a[104:105], v10 offset:0
L_ws_3877:
    s_cbranch_execz L_ws_6205
    v_mfma_f32_16x16x32_bf16 v[36:39], a[124:127], a[44:47], v[36:39]
    ds_read_b64_tr_b16 a[106:107], v10 offset:1024
    v_mfma_f32_16x16x32_bf16 v[32:35], a[124:127], a[36:39], v[32:35]
    ds_read_b64_tr_b16 a[108:109], v10 offset:8192
    v_mfma_f32_16x16x32_bf16 v[32:35], a[120:123], a[32:35], v[32:35]
    ds_read_b64_tr_b16 a[110:111], v10 offset:9216
    s_waitcnt lgkmcnt(4)
    v_mfma_f32_16x16x32_bf16 v[128:131], a[96:99], a[64:67], v[128:131]
    s_getpc_b64 s[0:1]
L_t3:
    ds_read_b64_tr_b16 a[112:113], v9 offset:256
    v_mfma_f32_16x16x32_bf16 v[128:131], a[100:103], a[68:71], v[128:131]
    ds_read_b64_tr_b16 a[114:115], v9 offset:1280
    v_mfma_f32_16x16x32_bf16 v[132:135], a[100:103], a[76:79], v[132:135]
    ds_read_b64_tr_b16 a[116:117], v9 offset:8448
    v_mfma_f32_16x16x32_bf16 v[132:135], a[96:99], a[72:75], v[132:135]
    ds_read_b64_tr_b16 a[118:119], v9 offset:9472
    v_mfma_f32_16x16x32_bf16 v[136:139], a[96:99], a[80:83], v[136:139]
    s_mul_i32 s40, s56, 524288
    s_add_u32 s40, s40, s57
    v_mfma_f32_16x16x32_bf16 v[136:139], a[100:103], a[84:87], v[136:139]
    s_add_u32 m0, s60, 0
    s_lshr_b32 s39, s2, 3
    v_mfma_f32_16x16x32_bf16 v[140:143], a[100:103], a[92:95], v[140:143]
    buffer_load_dwordx4 v4, s[20:23], s40 offen lds
    v_mfma_f32_16x16x32_bf16 v[140:143], a[96:99], a[88:91], v[140:143]
    s_lshl_b32 s39, s39, 2
    s_waitcnt lgkmcnt(4)
    v_mfma_f32_16x16x32_bf16 v[156:159], a[104:107], a[88:91], v[156:159]
    ds_read_b64_tr_b16 a[120:121], v10 offset:256
    v_mfma_f32_16x16x32_bf16 v[156:159], a[108:111], a[92:95], v[156:159]
    s_add_u32 s39, s39, s36
    ds_read_b64_tr_b16 a[122:123], v10 offset:1280
    v_mfma_f32_16x16x32_bf16 v[152:155], a[108:111], a[84:87], v[152:155]
    ds_read_b64_tr_b16 a[124:125], v10 offset:8448
    v_mfma_f32_16x16x32_bf16 v[152:155], a[104:107], a[80:83], v[152:155]
    s_lshl_b32 s39, s39, 7
    ds_read_b64_tr_b16 a[126:127], v10 offset:9472
    v_mfma_f32_16x16x32_bf16 v[148:151], a[104:107], a[72:75], v[148:151]
    buffer_load_dwordx4 v5, s[20:23], s40 offen offset:1024 lds
    v_mfma_f32_16x16x32_bf16 v[148:151], a[108:111], a[76:79], v[148:151]
    s_mul_i32 s41, s56, 221184
    s_add_u32 s41, s41, s58
    v_mfma_f32_16x16x32_bf16 v[144:147], a[108:111], a[68:71], v[144:147]
    buffer_load_dwordx4 v6, s[24:27], s41 offen offset:2048 lds
    v_mfma_f32_16x16x32_bf16 v[144:147], a[104:107], a[64:67], v[144:147]
    s_waitcnt lgkmcnt(4)
    v_mfma_f32_16x16x32_bf16 v[160:163], a[112:115], a[64:67], v[160:163]
    s_add_u32 s40, s40, 131072
    ds_read_b64_tr_b16 a[96:97], v9 offset:512
    v_mfma_f32_16x16x32_bf16 v[160:163], a[116:119], a[68:71], v[160:163]
    s_add_u32 m0, s60, 4096
    ds_read_b64_tr_b16 a[98:99], v9 offset:1536
    v_mfma_f32_16x16x32_bf16 v[164:167], a[116:119], a[76:79], v[164:167]
    ds_read_b64_tr_b16 a[100:101], v9 offset:8704
    v_mfma_f32_16x16x32_bf16 v[164:167], a[112:115], a[72:75], v[164:167]
    ds_read_b64_tr_b16 a[102:103], v9 offset:9728
    v_mfma_f32_16x16x32_bf16 v[168:171], a[112:115], a[80:83], v[168:171]
    buffer_load_dwordx4 v4, s[20:23], s40 offen lds
    v_mfma_f32_16x16x32_bf16 v[168:171], a[116:119], a[84:87], v[168:171]
    v_mfma_f32_16x16x32_bf16 v[172:175], a[116:119], a[92:95], v[172:175]
    buffer_load_dwordx4 v5, s[20:23], s40 offen offset:1024 lds
    v_mfma_f32_16x16x32_bf16 v[172:175], a[112:115], a[88:91], v[172:175]
    v_and_b32 v24, 1, v1
    s_waitcnt lgkmcnt(4)
    v_mfma_f32_16x16x32_bf16 v[188:191], a[120:123], a[88:91], v[188:191]
    ds_read_b64_tr_b16 a[104:105], v10 offset:512
    v_mfma_f32_16x16x32_bf16 v[188:191], a[124:127], a[92:95], v[188:191]
    s_add_u32 s41, s41, 55296
    ds_read_b64_tr_b16 a[106:107], v10 offset:1536
    v_mfma_f32_16x16x32_bf16 v[184:187], a[124:127], a[84:87], v[184:187]
    ds_read_b64_tr_b16 a[108:109], v10 offset:8704
    v_mfma_f32_16x16x32_bf16 v[184:187], a[120:123], a[80:83], v[184:187]
    ds_read_b64_tr_b16 a[110:111], v10 offset:9728
    v_mfma_f32_16x16x32_bf16 v[180:183], a[120:123], a[72:75], v[180:183]
    buffer_load_dwordx4 v6, s[24:27], s41 offen offset:2048 lds
    v_mfma_f32_16x16x32_bf16 v[180:183], a[124:127], a[76:79], v[180:183]
    s_lshl_b32 s42, s56, 7
    v_mfma_f32_16x16x32_bf16 v[176:179], a[124:127], a[68:71], v[176:179]
    s_add_u32 s3, s63, 533504
    v_lshl_add_u32 v24, v24, 14, s39
    v_mfma_f32_16x16x32_bf16 v[176:179], a[120:123], a[64:67], v[176:179]
    s_add_u32 m0, s61, 32768
    s_waitcnt lgkmcnt(4)
    v_mfma_f32_16x16x32_bf16 v[192:195], a[96:99], a[64:67], v[192:195]
    ds_read_b64_tr_b16 a[112:113], v9 offset:768
    v_mfma_f32_16x16x32_bf16 v[192:195], a[100:103], a[68:71], v[192:195]
    ds_read_b64_tr_b16 a[114:115], v9 offset:1792
    v_mfma_f32_16x16x32_bf16 v[196:199], a[100:103], a[76:79], v[196:199]
    s_add_u32 s40, s48, s42
    ds_read_b64_tr_b16 a[116:117], v9 offset:8960
    v_mfma_f32_16x16x32_bf16 v[196:199], a[96:99], a[72:75], v[196:199]
    ds_read_b64_tr_b16 a[118:119], v9 offset:9984
    v_mfma_f32_16x16x32_bf16 v[200:203], a[96:99], a[80:83], v[200:203]
    buffer_load_dwordx4 v16, s[16:19], s40 offen lds
    v_mfma_f32_16x16x32_bf16 v[200:203], a[100:103], a[84:87], v[200:203]
    v_mfma_f32_16x16x32_bf16 v[204:207], a[100:103], a[92:95], v[204:207]
    buffer_load_dwordx4 v17, s[16:19], s40 offen offset:1024 lds
    v_mfma_f32_16x16x32_bf16 v[204:207], a[96:99], a[88:91], v[204:207]
    s_waitcnt lgkmcnt(4)
    v_mfma_f32_16x16x32_bf16 v[220:223], a[104:107], a[88:91], v[220:223]
    ds_read_b64_tr_b16 a[120:121], v10 offset:768
    v_mfma_f32_16x16x32_bf16 v[220:223], a[108:111], a[92:95], v[220:223]
    ds_read_b64_tr_b16 a[122:123], v10 offset:1792
    v_mfma_f32_16x16x32_bf16 v[216:219], a[108:111], a[84:87], v[216:219]
    ds_read_b64_tr_b16 a[124:125], v10 offset:8960
    v_mfma_f32_16x16x32_bf16 v[216:219], a[104:107], a[80:83], v[216:219]
    s_add_u32 m0, s61, 34816
    ds_read_b64_tr_b16 a[126:127], v10 offset:9984
    v_mfma_f32_16x16x32_bf16 v[212:215], a[104:107], a[72:75], v[212:215]
    v_add_u32 v24, L_kvw_ok-L_t3, v24
    v_mfma_f32_16x16x32_bf16 v[212:215], a[108:111], a[76:79], v[212:215]
    v_mfma_f32_16x16x32_bf16 v[208:211], a[108:111], a[68:71], v[208:211]
    buffer_store_dwordx4 v[72:75], v11, s[28:31], s3 offen sc1
    v_mfma_f32_16x16x32_bf16 v[208:211], a[104:107], a[64:67], v[208:211]
    s_waitcnt lgkmcnt(4)
    v_mfma_f32_16x16x32_bf16 v[224:227], a[112:115], a[64:67], v[224:227]
    ds_read_b64_tr_b16 a[96:97], v9 offset:2048
    v_mfma_f32_16x16x32_bf16 v[224:227], a[116:119], a[68:71], v[224:227]
    s_add_u32 s40, s49, s42
    ds_read_b64_tr_b16 a[98:99], v9 offset:2560
    v_mfma_f32_16x16x32_bf16 v[228:231], a[116:119], a[76:79], v[228:231]
    ds_read_b64_tr_b16 a[100:101], v9 offset:10240
    v_mfma_f32_16x16x32_bf16 v[228:231], a[112:115], a[72:75], v[228:231]
    ds_read_b64_tr_b16 a[102:103], v9 offset:10752
    v_mfma_f32_16x16x32_bf16 v[232:235], a[112:115], a[80:83], v[232:235]
    buffer_load_dwordx4 v16, s[16:19], s40 offen lds
    v_mfma_f32_16x16x32_bf16 v[232:235], a[116:119], a[84:87], v[232:235]
    v_mfma_f32_16x16x32_bf16 v[236:239], a[116:119], a[92:95], v[236:239]
    buffer_load_dwordx4 v17, s[16:19], s40 offen offset:1024 lds
    v_mfma_f32_16x16x32_bf16 v[236:239], a[112:115], a[88:91], v[236:239]
    s_add_u32 m0, s61, 36864
    s_waitcnt lgkmcnt(4)
    v_mfma_f32_16x16x32_bf16 v[252:255], a[120:123], a[88:91], v[252:255]
    ds_read_b64_tr_b16 a[104:105], v10 offset:2048
    v_mfma_f32_16x16x32_bf16 v[252:255], a[124:127], a[92:95], v[252:255]
    ds_read_b64_tr_b16 a[106:107], v10 offset:2560
    v_mfma_f32_16x16x32_bf16 v[248:251], a[124:127], a[84:87], v[248:251]
    ds_read_b64_tr_b16 a[108:109], v10 offset:10240
    v_min_u32 v24, L_code_end-L_t3-4, v24
    v_mfma_f32_16x16x32_bf16 v[248:251], a[120:123], a[80:83], v[248:251]
    s_add_u32 s40, s50, s42
    ds_read_b64_tr_b16 a[110:111], v10 offset:10752
    v_mfma_f32_16x16x32_bf16 v[244:247], a[120:123], a[72:75], v[244:247]
    buffer_load_dwordx4 v16, s[16:19], s40 offen lds
    v_mfma_f32_16x16x32_bf16 v[244:247], a[124:127], a[76:79], v[244:247]
    v_mfma_f32_16x16x32_bf16 v[240:243], a[124:127], a[68:71], v[240:243]
    buffer_load_dwordx4 v17, s[16:19], s40 offen offset:1024 lds
    v_mfma_f32_16x16x32_bf16 v[240:243], a[120:123], a[64:67], v[240:243]
    s_add_u32 m0, s61, 38912
    s_waitcnt lgkmcnt(4)
    v_mfma_f32_16x16x32_bf16 v[48:51], a[96:99], a[64:67], v[48:51]
    ds_read_b64_tr_b16 a[112:113], v9 offset:2304
    v_mfma_f32_16x16x32_bf16 v[48:51], a[100:103], a[68:71], v[48:51]
    ds_read_b64_tr_b16 a[114:115], v9 offset:2816
    v_mfma_f32_16x16x32_bf16 v[52:55], a[100:103], a[76:79], v[52:55]
    ds_read_b64_tr_b16 a[116:117], v9 offset:10496
    v_mfma_f32_16x16x32_bf16 v[52:55], a[96:99], a[72:75], v[52:55]
    s_add_u32 s40, s51, s42
    ds_read_b64_tr_b16 a[118:119], v9 offset:11008
    v_mfma_f32_16x16x32_bf16 v[56:59], a[96:99], a[80:83], v[56:59]
    buffer_load_dwordx4 v16, s[16:19], s40 offen lds
    v_mfma_f32_16x16x32_bf16 v[56:59], a[100:103], a[84:87], v[56:59]
    v_mfma_f32_16x16x32_bf16 v[60:63], a[100:103], a[92:95], v[60:63]
    buffer_load_dwordx4 v17, s[16:19], s40 offen offset:1024 lds
    v_mfma_f32_16x16x32_bf16 v[60:63], a[96:99], a[88:91], v[60:63]
    s_add_u32 s3, s63, 537600
    v_mov_b32 v25, 0
    s_waitcnt lgkmcnt(4)
    v_mfma_f32_16x16x32_bf16 v[92:95], a[104:107], a[88:91], v[92:95]
    ds_read_b64_tr_b16 a[120:121], v10 offset:2304
    v_mfma_f32_16x16x32_bf16 v[92:95], a[108:111], a[92:95], v[92:95]
    ds_read_b64_tr_b16 a[122:123], v10 offset:2816
    v_lshl_add_u64 v[24:25], v[24:25], 0, s[0:1]
    v_mfma_f32_16x16x32_bf16 v[88:91], a[108:111], a[84:87], v[88:91]
    ds_read_b64_tr_b16 a[124:125], v10 offset:10496
    v_mfma_f32_16x16x32_bf16 v[88:91], a[104:107], a[80:83], v[88:91]
    ds_read_b64_tr_b16 a[126:127], v10 offset:11008
    v_mfma_f32_16x16x32_bf16 v[84:87], a[104:107], a[72:75], v[84:87]
    buffer_store_dwordx4 v[76:79], v11, s[28:31], s3 offen sc1
    v_mfma_f32_16x16x32_bf16 v[84:87], a[108:111], a[76:79], v[84:87]
    s_add_u32 s56, s56, 1
    s_cmp_eq_u32 s56, 10
    s_cselect_b32 s56, 0, s56
    v_mfma_f32_16x16x32_bf16 v[80:83], a[108:111], a[68:71], v[80:83]
    v_add_u32 v9, 65536, v12
    v_add_u32 v10, 65536, v13
    v_mfma_f32_16x16x32_bf16 v[80:83], a[104:107], a[64:67], v[80:83]
    s_waitcnt vmcnt(16) lgkmcnt(0)
    s_barrier
    v_mfma_f32_16x16x32_bf16 v[112:115], a[112:115], a[64:67], v[112:115]
    ds_read_b64_tr_b16 a[96:97], v9 offset:0
    v_mfma_f32_16x16x32_bf16 v[112:115], a[116:119], a[68:71], v[112:115]
    ds_read_b64_tr_b16 a[98:99], v9 offset:1024
    buffer_store_dword v30, v0, s[28:31], s88 offen sc1
    v_mfma_f32_16x16x32_bf16 v[116:119], a[116:119], a[76:79], v[116:119]
    s_add_u32 s3, s59, 534528
    ds_read_b64_tr_b16 a[100:101], v9 offset:8192
    v_mfma_f32_16x16x32_bf16 v[116:119], a[112:115], a[72:75], v[116:119]
    ds_read_b64_tr_b16 a[102:103], v9 offset:9216
    v_mfma_f32_16x16x32_bf16 v[120:123], a[112:115], a[80:83], v[120:123]
    ds_read_b128 a[32:35], v7 offset:0
    v_mfma_f32_16x16x32_bf16 v[120:123], a[116:119], a[84:87], v[120:123]
    ds_read_b128 a[36:39], v8 offset:0
    v_mfma_f32_16x16x32_bf16 v[124:127], a[116:119], a[92:95], v[124:127]
    ds_read_b128 a[40:43], v7 offset:2048
    v_mfma_f32_16x16x32_bf16 v[124:127], a[112:115], a[88:91], v[124:127]
    ds_read_b128 a[44:47], v8 offset:2048
    v_mfma_f32_16x16x32_bf16 v[44:47], a[120:123], a[88:91], v[44:47]
    ds_read_b128 a[48:51], v7 offset:4096
    global_load_dword v24, v[24:25], off
    v_mfma_f32_16x16x32_bf16 v[44:47], a[124:127], a[92:95], v[44:47]
    ds_read_b128 a[52:55], v8 offset:4096
    v_mfma_f32_16x16x32_bf16 v[40:43], a[124:127], a[84:87], v[40:43]
    ds_read_b128 a[56:59], v7 offset:6144
    v_mfma_f32_16x16x32_bf16 v[40:43], a[120:123], a[80:83], v[40:43]
    ds_read_b128 a[60:63], v8 offset:6144
    v_mfma_f32_16x16x32_bf16 v[36:39], a[120:123], a[72:75], v[36:39]
    ds_read_b64_tr_b16 a[104:105], v10 offset:0
    v_mfma_f32_16x16x32_bf16 v[36:39], a[124:127], a[76:79], v[36:39]
    ds_read_b64_tr_b16 a[106:107], v10 offset:1024
    v_mfma_f32_16x16x32_bf16 v[32:35], a[124:127], a[68:71], v[32:35]
    ds_read_b64_tr_b16 a[108:109], v10 offset:8192
    buffer_store_dwordx4 v[104:107], v11, s[28:31], s3 offen sc1
    v_mfma_f32_16x16x32_bf16 v[32:35], a[120:123], a[64:67], v[32:35]
    ds_read_b64_tr_b16 a[110:111], v10 offset:9216
    s_waitcnt lgkmcnt(4)
    v_mfma_f32_16x16x32_bf16 v[128:131], a[96:99], a[32:35], v[128:131]
    ds_read_b64_tr_b16 a[112:113], v9 offset:256
    v_mfma_f32_16x16x32_bf16 v[128:131], a[100:103], a[36:39], v[128:131]
    ds_read_b64_tr_b16 a[114:115], v9 offset:1280
    v_mfma_f32_16x16x32_bf16 v[132:135], a[100:103], a[44:47], v[132:135]
    ds_read_b64_tr_b16 a[116:117], v9 offset:8448
    v_mfma_f32_16x16x32_bf16 v[132:135], a[96:99], a[40:43], v[132:135]
    s_add_u32 s3, s59, 538624
    ds_read_b64_tr_b16 a[118:119], v9 offset:9472
    v_mfma_f32_16x16x32_bf16 v[136:139], a[96:99], a[48:51], v[136:139]
    buffer_store_dwordx4 v[108:111], v11, s[28:31], s3 offen sc1
    v_mfma_f32_16x16x32_bf16 v[136:139], a[100:103], a[52:55], v[136:139]
    s_mul_i32 s40, s56, 524288
    s_add_u32 s40, s40, s57
    v_mfma_f32_16x16x32_bf16 v[140:143], a[100:103], a[60:63], v[140:143]
    v_mfma_f32_16x16x32_bf16 v[140:143], a[96:99], a[56:59], v[140:143]
    s_add_u32 m0, s60, 32768
    s_waitcnt lgkmcnt(4)
    v_mfma_f32_16x16x32_bf16 v[156:159], a[104:107], a[56:59], v[156:159]
    ds_read_b64_tr_b16 a[120:121], v10 offset:256
    buffer_load_dwordx4 v4, s[20:23], s40 offen lds
    v_mfma_f32_16x16x32_bf16 v[156:159], a[108:111], a[60:63], v[156:159]
    ds_read_b64_tr_b16 a[122:123], v10 offset:1280
    v_accvgpr_read_b32 v72, a8
    v_mfma_f32_16x16x32_bf16 v[152:155], a[108:111], a[52:55], v[152:155]
    ds_read_b64_tr_b16 a[124:125], v10 offset:8448
    v_mfma_f32_16x16x32_bf16 v[152:155], a[104:107], a[48:51], v[152:155]
    ds_read_b64_tr_b16 a[126:127], v10 offset:9472
    v_accvgpr_read_b32 v73, a9
    v_mfma_f32_16x16x32_bf16 v[148:151], a[104:107], a[40:43], v[148:151]
    buffer_load_dwordx4 v5, s[20:23], s40 offen offset:1024 lds
    v_mfma_f32_16x16x32_bf16 v[148:151], a[108:111], a[44:47], v[148:151]
    s_mul_i32 s41, s56, 221184
    s_add_u32 s41, s41, s58
    v_mfma_f32_16x16x32_bf16 v[144:147], a[108:111], a[36:39], v[144:147]
    buffer_load_dwordx4 v6, s[24:27], s41 offen offset:2048 lds
    v_mfma_f32_16x16x32_bf16 v[144:147], a[104:107], a[32:35], v[144:147]
    s_and_b32 s43, s88, 0xfffffe00
    s_waitcnt lgkmcnt(4)
    v_mfma_f32_16x16x32_bf16 v[160:163], a[112:115], a[32:35], v[160:163]
    ds_read_b64_tr_b16 a[96:97], v9 offset:512
    v_mfma_f32_16x16x32_bf16 v[160:163], a[116:119], a[36:39], v[160:163]
    ds_read_b64_tr_b16 a[98:99], v9 offset:1536
    v_accvgpr_read_b32 v74, a10
    v_mfma_f32_16x16x32_bf16 v[164:167], a[116:119], a[44:47], v[164:167]
    s_add_u32 s40, s40, 131072
    ds_read_b64_tr_b16 a[100:101], v9 offset:8704
    v_mfma_f32_16x16x32_bf16 v[164:167], a[112:115], a[40:43], v[164:167]
    s_add_u32 m0, s60, 36864
    ds_read_b64_tr_b16 a[102:103], v9 offset:9728
    v_mfma_f32_16x16x32_bf16 v[168:171], a[112:115], a[48:51], v[168:171]
    buffer_load_dwordx4 v4, s[20:23], s40 offen lds
    v_mfma_f32_16x16x32_bf16 v[168:171], a[116:119], a[52:55], v[168:171]
    v_mfma_f32_16x16x32_bf16 v[172:175], a[116:119], a[60:63], v[172:175]
    buffer_load_dwordx4 v5, s[20:23], s40 offen offset:1024 lds
    v_mfma_f32_16x16x32_bf16 v[172:175], a[112:115], a[56:59], v[172:175]
    s_waitcnt lgkmcnt(4)
    v_mfma_f32_16x16x32_bf16 v[188:191], a[120:123], a[56:59], v[188:191]
    s_add_u32 s41, s41, 55296
    ds_read_b64_tr_b16 a[104:105], v10 offset:512
    v_mfma_f32_16x16x32_bf16 v[188:191], a[124:127], a[60:63], v[188:191]
    ds_read_b64_tr_b16 a[106:107], v10 offset:1536
    v_mfma_f32_16x16x32_bf16 v[184:187], a[124:127], a[52:55], v[184:187]
    ds_read_b64_tr_b16 a[108:109], v10 offset:8704
    v_accvgpr_read_b32 v75, a11
    v_mfma_f32_16x16x32_bf16 v[184:187], a[120:123], a[48:51], v[184:187]
    ds_read_b64_tr_b16 a[110:111], v10 offset:9728
    v_mfma_f32_16x16x32_bf16 v[180:183], a[120:123], a[40:43], v[180:183]
    v_lshlrev_b32 v18, 2, v1
    v_and_b32 v19, 28, v18
    v_mfma_f32_16x16x32_bf16 v[180:183], a[124:127], a[44:47], v[180:183]
    buffer_load_dwordx4 v6, s[24:27], s41 offen offset:2048 lds
    v_mfma_f32_16x16x32_bf16 v[176:179], a[124:127], a[36:39], v[176:179]
    s_lshl_b32 s42, s56, 7
    v_accvgpr_read_b32 v76, a24
    v_mfma_f32_16x16x32_bf16 v[176:179], a[120:123], a[32:35], v[176:179]
    s_waitcnt lgkmcnt(4)
    v_mfma_f32_16x16x32_bf16 v[192:195], a[96:99], a[32:35], v[192:195]
    ds_read_b64_tr_b16 a[112:113], v9 offset:768
    v_mfma_f32_16x16x32_bf16 v[192:195], a[100:103], a[36:39], v[192:195]
    s_add_u32 m0, s61, 0
    ds_read_b64_tr_b16 a[114:115], v9 offset:1792
    v_mfma_f32_16x16x32_bf16 v[196:199], a[100:103], a[44:47], v[196:199]
    s_add_u32 s40, s48, s42
    ds_read_b64_tr_b16 a[116:117], v9 offset:8960
    v_mfma_f32_16x16x32_bf16 v[196:199], a[96:99], a[40:43], v[196:199]
    ds_read_b64_tr_b16 a[118:119], v9 offset:9984
    v_mfma_f32_16x16x32_bf16 v[200:203], a[96:99], a[48:51], v[200:203]
    buffer_load_dwordx4 v16, s[16:19], s40 offen lds
    v_mfma_f32_16x16x32_bf16 v[200:203], a[100:103], a[52:55], v[200:203]
    v_mfma_f32_16x16x32_bf16 v[204:207], a[100:103], a[60:63], v[204:207]
    buffer_load_dwordx4 v17, s[16:19], s40 offen offset:1024 lds
    v_mfma_f32_16x16x32_bf16 v[204:207], a[96:99], a[56:59], v[204:207]
    s_add_u32 m0, s61, 2048
    v_accvgpr_read_b32 v77, a25
    s_waitcnt lgkmcnt(4)
    v_mfma_f32_16x16x32_bf16 v[220:223], a[104:107], a[56:59], v[220:223]
    ds_read_b64_tr_b16 a[120:121], v10 offset:768
    v_mfma_f32_16x16x32_bf16 v[220:223], a[108:111], a[60:63], v[220:223]
    s_add_u32 s40, s49, s42
    ds_read_b64_tr_b16 a[122:123], v10 offset:1792
    v_mfma_f32_16x16x32_bf16 v[216:219], a[108:111], a[52:55], v[216:219]
    ds_read_b64_tr_b16 a[124:125], v10 offset:8960
    v_accvgpr_read_b32 v78, a26
    v_mfma_f32_16x16x32_bf16 v[216:219], a[104:107], a[48:51], v[216:219]
    ds_read_b64_tr_b16 a[126:127], v10 offset:9984
    v_mfma_f32_16x16x32_bf16 v[212:215], a[104:107], a[40:43], v[212:215]
    v_accvgpr_read_b32 v79, a27
    v_mfma_f32_16x16x32_bf16 v[212:215], a[108:111], a[44:47], v[212:215]
    v_and_b32 v20, 96, v18
    v_mfma_f32_16x16x32_bf16 v[208:211], a[108:111], a[36:39], v[208:211]
    buffer_load_dwordx4 v16, s[16:19], s40 offen lds
    v_mfma_f32_16x16x32_bf16 v[208:211], a[104:107], a[32:35], v[208:211]
    v_mul_f32 v72, s84, v72
    s_waitcnt lgkmcnt(4)
    v_mfma_f32_16x16x32_bf16 v[224:227], a[112:115], a[32:35], v[224:227]
    ds_read_b64_tr_b16 a[96:97], v9 offset:2048
    v_mfma_f32_16x16x32_bf16 v[224:227], a[116:119], a[36:39], v[224:227]
    ds_read_b64_tr_b16 a[98:99], v9 offset:2560
    v_mul_f32 v73, s84, v73
    v_mfma_f32_16x16x32_bf16 v[228:231], a[116:119], a[44:47], v[228:231]
    ds_read_b64_tr_b16 a[100:101], v9 offset:10240
    v_mfma_f32_16x16x32_bf16 v[228:231], a[112:115], a[40:43], v[228:231]
    ds_read_b64_tr_b16 a[102:103], v9 offset:10752
    v_mul_f32 v74, s84, v74
    v_mfma_f32_16x16x32_bf16 v[232:235], a[112:115], a[48:51], v[232:235]
    v_lshl_add_u32 v19, v20, 2, v19
    v_mfma_f32_16x16x32_bf16 v[232:235], a[116:119], a[52:55], v[232:235]
    buffer_load_dwordx4 v17, s[16:19], s40 offen offset:1024 lds
    v_mfma_f32_16x16x32_bf16 v[236:239], a[116:119], a[60:63], v[236:239]
    s_add_u32 m0, s61, 4096
    v_mfma_f32_16x16x32_bf16 v[236:239], a[112:115], a[56:59], v[236:239]
    s_add_u32 s40, s50, s42
    v_mul_f32 v75, s84, v75
    s_waitcnt lgkmcnt(4)
    v_mfma_f32_16x16x32_bf16 v[252:255], a[120:123], a[56:59], v[252:255]
    ds_read_b64_tr_b16 a[104:105], v10 offset:2048
    v_mfma_f32_16x16x32_bf16 v[252:255], a[124:127], a[60:63], v[252:255]
    ds_read_b64_tr_b16 a[106:107], v10 offset:2560
    v_mfma_f32_16x16x32_bf16 v[248:251], a[124:127], a[52:55], v[248:251]
    ds_read_b64_tr_b16 a[108:109], v10 offset:10240
    v_mfma_f32_16x16x32_bf16 v[248:251], a[120:123], a[48:51], v[248:251]
    ds_read_b64_tr_b16 a[110:111], v10 offset:10752
    v_mul_f32 v76, s84, v76
    v_mfma_f32_16x16x32_bf16 v[244:247], a[120:123], a[40:43], v[244:247]
    buffer_load_dwordx4 v16, s[16:19], s40 offen lds
    v_mfma_f32_16x16x32_bf16 v[244:247], a[124:127], a[44:47], v[244:247]
    v_mfma_f32_16x16x32_bf16 v[240:243], a[124:127], a[36:39], v[240:243]
    buffer_load_dwordx4 v17, s[16:19], s40 offen offset:1024 lds
    v_mfma_f32_16x16x32_bf16 v[240:243], a[120:123], a[32:35], v[240:243]
    s_add_u32 m0, s61, 6144
    v_mul_f32 v77, s84, v77
    s_waitcnt lgkmcnt(4)
    v_mfma_f32_16x16x32_bf16 v[48:51], a[96:99], a[32:35], v[48:51]
    ds_read_b64_tr_b16 a[112:113], v9 offset:2304
    v_mfma_f32_16x16x32_bf16 v[48:51], a[100:103], a[36:39], v[48:51]
    ds_read_b64_tr_b16 a[114:115], v9 offset:2816
    v_mfma_f32_16x16x32_bf16 v[52:55], a[100:103], a[44:47], v[52:55]
    ds_read_b64_tr_b16 a[116:117], v9 offset:10496
    v_mul_f32 v78, s84, v78
    v_mfma_f32_16x16x32_bf16 v[52:55], a[96:99], a[40:43], v[52:55]
    ds_read_b64_tr_b16 a[118:119], v9 offset:11008
    v_mfma_f32_16x16x32_bf16 v[56:59], a[96:99], a[48:51], v[56:59]
    s_add_u32 s40, s51, s42
    v_mfma_f32_16x16x32_bf16 v[56:59], a[100:103], a[52:55], v[56:59]
    buffer_load_dwordx4 v16, s[16:19], s40 offen lds
    v_mfma_f32_16x16x32_bf16 v[60:63], a[100:103], a[60:63], v[60:63]
    v_mfma_f32_16x16x32_bf16 v[60:63], a[96:99], a[56:59], v[60:63]
    s_waitcnt lgkmcnt(4)
    v_mfma_f32_16x16x32_bf16 v[92:95], a[104:107], a[56:59], v[92:95]
    ds_read_b64_tr_b16 a[120:121], v10 offset:2304
    v_mfma_f32_16x16x32_bf16 v[92:95], a[108:111], a[60:63], v[92:95]
    ds_read_b64_tr_b16 a[122:123], v10 offset:2816
    v_mul_f32 v79, s84, v79
    v_mfma_f32_16x16x32_bf16 v[88:91], a[108:111], a[52:55], v[88:91]
    ds_read_b64_tr_b16 a[124:125], v10 offset:10496
    v_mfma_f32_16x16x32_bf16 v[88:91], a[104:107], a[48:51], v[88:91]
    ds_read_b64_tr_b16 a[126:127], v10 offset:11008
    v_mfma_f32_16x16x32_bf16 v[84:87], a[104:107], a[40:43], v[84:87]
    buffer_load_dwordx4 v17, s[16:19], s40 offen offset:1024 lds
    v_mfma_f32_16x16x32_bf16 v[84:87], a[108:111], a[44:47], v[84:87]
    s_add_u32 s56, s56, 1
    s_cmp_eq_u32 s56, 10
    s_cselect_b32 s56, 0, s56
    v_mfma_f32_16x16x32_bf16 v[80:83], a[108:111], a[36:39], v[80:83]
    v_add_u32 v9, 0, v12
    v_add_u32 v10, 0, v13
    v_mfma_f32_16x16x32_bf16 v[80:83], a[104:107], a[32:35], v[80:83]
    s_waitcnt vmcnt(19) lgkmcnt(0)
    s_barrier
    v_mfma_f32_16x16x32_bf16 v[112:115], a[112:115], a[32:35], v[112:115]
    ds_read_b64_tr_b16 a[96:97], v9 offset:0
    v_mfma_f32_16x16x32_bf16 v[112:115], a[116:119], a[36:39], v[112:115]
    ds_read_b64_tr_b16 a[98:99], v9 offset:1024
    v_mfma_f32_16x16x32_bf16 v[116:119], a[116:119], a[44:47], v[116:119]
    ds_read_b64_tr_b16 a[100:101], v9 offset:8192
    v_cvt_pk_bf16_f32 v72, v72, v73
    v_mfma_f32_16x16x32_bf16 v[116:119], a[112:115], a[40:43], v[116:119]
    ds_read_b64_tr_b16 a[102:103], v9 offset:9216
    v_mfma_f32_16x16x32_bf16 v[120:123], a[112:115], a[48:51], v[120:123]
    ds_read_b128 a[64:67], v7 offset:32768
    v_mfma_f32_16x16x32_bf16 v[120:123], a[116:119], a[52:55], v[120:123]
    ds_read_b128 a[68:71], v8 offset:32768
    v_cvt_pk_bf16_f32 v73, v74, v75
    v_mfma_f32_16x16x32_bf16 v[124:127], a[116:119], a[60:63], v[124:127]
    ds_read_b128 a[72:75], v7 offset:34816
    v_cvt_pk_bf16_f32 v74, v76, v77
    v_mfma_f32_16x16x32_bf16 v[124:127], a[112:115], a[56:59], v[124:127]
    ds_read_b128 a[76:79], v8 offset:34816
    v_mfma_f32_16x16x32_bf16 v[44:47], a[120:123], a[56:59], v[44:47]
    ds_read_b128 a[80:83], v7 offset:36864
    v_mfma_f32_16x16x32_bf16 v[44:47], a[124:127], a[60:63], v[44:47]
    ds_read_b128 a[84:87], v8 offset:36864
    v_mfma_f32_16x16x32_bf16 v[40:43], a[124:127], a[52:55], v[40:43]
    ds_read_b128 a[88:91], v7 offset:38912
    v_cvt_pk_bf16_f32 v75, v78, v79
    v_mfma_f32_16x16x32_bf16 v[40:43], a[120:123], a[48:51], v[40:43]
    ds_read_b128 a[92:95], v8 offset:38912
    v_mfma_f32_16x16x32_bf16 v[36:39], a[120:123], a[40:43], v[36:39]
    ds_read_b64_tr_b16 a[104:105], v10 offset:0
    v_mfma_f32_16x16x32_bf16 v[36:39], a[124:127], a[44:47], v[36:39]
    s_add_u32 s3, s59, 535552
    ds_read_b64_tr_b16 a[106:107], v10 offset:1024
    v_mfma_f32_16x16x32_bf16 v[32:35], a[124:127], a[36:39], v[32:35]
    ds_read_b64_tr_b16 a[108:109], v10 offset:8192
    buffer_store_dwordx4 v[72:75], v11, s[28:31], s3 offen sc1
    v_mfma_f32_16x16x32_bf16 v[32:35], a[120:123], a[32:35], v[32:35]
    ds_read_b64_tr_b16 a[110:111], v10 offset:9216
    s_waitcnt lgkmcnt(4)
    v_mfma_f32_16x16x32_bf16 v[128:131], a[96:99], a[64:67], v[128:131]
    ds_read_b64_tr_b16 a[112:113], v9 offset:256
    v_mfma_f32_16x16x32_bf16 v[128:131], a[100:103], a[68:71], v[128:131]
    ds_read_b64_tr_b16 a[114:115], v9 offset:1280
    v_accvgpr_read_b32 v64, a12
    v_mfma_f32_16x16x32_bf16 v[132:135], a[100:103], a[76:79], v[132:135]
    ds_read_b64_tr_b16 a[116:117], v9 offset:8448
    v_mfma_f32_16x16x32_bf16 v[132:135], a[96:99], a[72:75], v[132:135]
    ds_read_b64_tr_b16 a[118:119], v9 offset:9472
    v_accvgpr_read_b32 v65, a13
    v_mfma_f32_16x16x32_bf16 v[136:139], a[96:99], a[80:83], v[136:139]
    s_mul_i32 s40, s56, 524288
    s_add_u32 s40, s40, s57
    v_accvgpr_read_b32 v66, a14
    v_mfma_f32_16x16x32_bf16 v[136:139], a[100:103], a[84:87], v[136:139]
    s_add_u32 m0, s60, 65536
    v_accvgpr_read_b32 v67, a15
    v_mfma_f32_16x16x32_bf16 v[140:143], a[100:103], a[92:95], v[140:143]
    buffer_load_dwordx4 v4, s[20:23], s40 offen lds
    v_mfma_f32_16x16x32_bf16 v[140:143], a[96:99], a[88:91], v[140:143]
    v_accvgpr_read_b32 v68, a28
    s_waitcnt lgkmcnt(4)
    v_mfma_f32_16x16x32_bf16 v[156:159], a[104:107], a[88:91], v[156:159]
    ds_read_b64_tr_b16 a[120:121], v10 offset:256
    v_accvgpr_read_b32 v69, a29
    v_mfma_f32_16x16x32_bf16 v[156:159], a[108:111], a[92:95], v[156:159]
    ds_read_b64_tr_b16 a[122:123], v10 offset:1280
    v_accvgpr_read_b32 v70, a30
    v_mfma_f32_16x16x32_bf16 v[152:155], a[108:111], a[84:87], v[152:155]
    ds_read_b64_tr_b16 a[124:125], v10 offset:8448
    v_mfma_f32_16x16x32_bf16 v[152:155], a[104:107], a[80:83], v[152:155]
    ds_read_b64_tr_b16 a[126:127], v10 offset:9472
    v_accvgpr_read_b32 v71, a31
    v_mfma_f32_16x16x32_bf16 v[148:151], a[104:107], a[72:75], v[148:151]
    v_mul_f32 v64, s84, v64
    v_mul_f32 v65, s84, v65
    v_mfma_f32_16x16x32_bf16 v[148:151], a[108:111], a[76:79], v[148:151]
    v_mul_f32 v66, s84, v66
    v_mul_f32 v67, s84, v67
    v_mfma_f32_16x16x32_bf16 v[144:147], a[108:111], a[68:71], v[144:147]
    buffer_load_dwordx4 v5, s[20:23], s40 offen offset:1024 lds
    v_mfma_f32_16x16x32_bf16 v[144:147], a[104:107], a[64:67], v[144:147]
    s_waitcnt lgkmcnt(4)
    v_mfma_f32_16x16x32_bf16 v[160:163], a[112:115], a[64:67], v[160:163]
    ds_read_b64_tr_b16 a[96:97], v9 offset:512
    v_mfma_f32_16x16x32_bf16 v[160:163], a[116:119], a[68:71], v[160:163]
    ds_read_b64_tr_b16 a[98:99], v9 offset:1536
    v_mul_f32 v68, s84, v68
    v_mfma_f32_16x16x32_bf16 v[164:167], a[116:119], a[76:79], v[164:167]
    ds_read_b64_tr_b16 a[100:101], v9 offset:8704
    v_mul_f32 v69, s84, v69
    v_mfma_f32_16x16x32_bf16 v[164:167], a[112:115], a[72:75], v[164:167]
    ds_read_b64_tr_b16 a[102:103], v9 offset:9728
    v_mfma_f32_16x16x32_bf16 v[168:171], a[112:115], a[80:83], v[168:171]
    s_mul_i32 s41, s56, 221184
    s_add_u32 s41, s41, s58
    v_mul_f32 v70, s84, v70
    v_mfma_f32_16x16x32_bf16 v[168:171], a[116:119], a[84:87], v[168:171]
    v_mfma_f32_16x16x32_bf16 v[172:175], a[116:119], a[92:95], v[172:175]
    buffer_load_dwordx4 v6, s[24:27], s41 offen offset:2048 lds
    v_mfma_f32_16x16x32_bf16 v[172:175], a[112:115], a[88:91], v[172:175]
    s_add_u32 s40, s40, 131072
    v_mul_f32 v71, s84, v71
    s_waitcnt lgkmcnt(4)
    v_mfma_f32_16x16x32_bf16 v[188:191], a[120:123], a[88:91], v[188:191]
    ds_read_b64_tr_b16 a[104:105], v10 offset:512
    v_cvt_pk_bf16_f32 v64, v64, v65
    v_mfma_f32_16x16x32_bf16 v[188:191], a[124:127], a[92:95], v[188:191]
    ds_read_b64_tr_b16 a[106:107], v10 offset:1536
    v_mfma_f32_16x16x32_bf16 v[184:187], a[124:127], a[84:87], v[184:187]
    ds_read_b64_tr_b16 a[108:109], v10 offset:8704
    v_mfma_f32_16x16x32_bf16 v[184:187], a[120:123], a[80:83], v[184:187]
    ds_read_b64_tr_b16 a[110:111], v10 offset:9728
    v_cvt_pk_bf16_f32 v65, v66, v67
    v_mfma_f32_16x16x32_bf16 v[180:183], a[120:123], a[72:75], v[180:183]
    s_add_u32 m0, s60, 69632
    v_cvt_pk_bf16_f32 v66, v68, v69
    v_cvt_pk_bf16_f32 v67, v70, v71
    v_mfma_f32_16x16x32_bf16 v[180:183], a[124:127], a[76:79], v[180:183]
    buffer_load_dwordx4 v4, s[20:23], s40 offen lds
    v_mfma_f32_16x16x32_bf16 v[176:179], a[124:127], a[68:71], v[176:179]
    s_add_u32 s3, s59, 539648
    v_mfma_f32_16x16x32_bf16 v[176:179], a[120:123], a[64:67], v[176:179]
    s_waitcnt lgkmcnt(4)
    v_mfma_f32_16x16x32_bf16 v[192:195], a[96:99], a[64:67], v[192:195]
    ds_read_b64_tr_b16 a[112:113], v9 offset:768
    v_mfma_f32_16x16x32_bf16 v[192:195], a[100:103], a[68:71], v[192:195]
    ds_read_b64_tr_b16 a[114:115], v9 offset:1792
    buffer_store_dwordx4 v[64:67], v11, s[28:31], s3 offen sc1
    v_mfma_f32_16x16x32_bf16 v[196:199], a[100:103], a[76:79], v[196:199]
    ds_read_b64_tr_b16 a[116:117], v9 offset:8960
    v_accvgpr_read_b32 v72, a136
    v_mfma_f32_16x16x32_bf16 v[196:199], a[96:99], a[72:75], v[196:199]
    ds_read_b64_tr_b16 a[118:119], v9 offset:9984
    v_mfma_f32_16x16x32_bf16 v[200:203], a[96:99], a[80:83], v[200:203]
L_ws_4429:
    s_cbranch_execz L_ws_6790
    v_accvgpr_read_b32 v73, a137
    v_accvgpr_read_b32 v74, a138
    v_mfma_f32_16x16x32_bf16 v[200:203], a[100:103], a[84:87], v[200:203]
    buffer_load_dwordx4 v5, s[20:23], s40 offen offset:1024 lds
    v_mfma_f32_16x16x32_bf16 v[204:207], a[100:103], a[92:95], v[204:207]
    s_add_u32 s41, s41, 55296
    v_accvgpr_read_b32 v75, a139
    v_accvgpr_read_b32 v76, a140
    v_mfma_f32_16x16x32_bf16 v[204:207], a[96:99], a[88:91], v[204:207]
    v_accvgpr_read_b32 v77, a141
    s_waitcnt lgkmcnt(4)
    v_mfma_f32_16x16x32_bf16 v[220:223], a[104:107], a[88:91], v[220:223]
    ds_read_b64_tr_b16 a[120:121], v10 offset:768
    v_mfma_f32_16x16x32_bf16 v[220:223], a[108:111], a[92:95], v[220:223]
    ds_read_b64_tr_b16 a[122:123], v10 offset:1792
    buffer_load_dwordx4 v6, s[24:27], s41 offen offset:2048 lds
    v_mfma_f32_16x16x32_bf16 v[216:219], a[108:111], a[84:87], v[216:219]
    s_lshl_b32 s42, s56, 7
    ds_read_b64_tr_b16 a[124:125], v10 offset:8960
    v_mfma_f32_16x16x32_bf16 v[216:219], a[104:107], a[80:83], v[216:219]
    s_add_u32 m0, s61, 32768
    ds_read_b64_tr_b16 a[126:127], v10 offset:9984
    v_mfma_f32_16x16x32_bf16 v[212:215], a[104:107], a[72:75], v[212:215]
    s_add_u32 s40, s48, s42
    v_mfma_f32_16x16x32_bf16 v[212:215], a[108:111], a[76:79], v[212:215]
    buffer_load_dwordx4 v16, s[16:19], s40 offen lds
    v_mfma_f32_16x16x32_bf16 v[208:211], a[108:111], a[68:71], v[208:211]
    buffer_load_dwordx4 v17, s[16:19], s40 offen offset:1024 lds
    v_mfma_f32_16x16x32_bf16 v[208:211], a[104:107], a[64:67], v[208:211]
    s_add_u32 m0, s61, 34816
    v_accvgpr_read_b32 v78, a142
    s_waitcnt lgkmcnt(4)
    v_mfma_f32_16x16x32_bf16 v[224:227], a[112:115], a[64:67], v[224:227]
    s_add_u32 s40, s49, s42
    ds_read_b64_tr_b16 a[96:97], v9 offset:2048
    v_mfma_f32_16x16x32_bf16 v[224:227], a[116:119], a[68:71], v[224:227]
    ds_read_b64_tr_b16 a[98:99], v9 offset:2560
    v_accvgpr_read_b32 v79, a143
    v_mfma_f32_16x16x32_bf16 v[228:231], a[116:119], a[76:79], v[228:231]
    ds_read_b64_tr_b16 a[100:101], v9 offset:10240
    v_mfma_f32_16x16x32_bf16 v[228:231], a[112:115], a[72:75], v[228:231]
    ds_read_b64_tr_b16 a[102:103], v9 offset:10752
    v_cvt_pk_bf16_f32 v72, v72, v73
    v_mfma_f32_16x16x32_bf16 v[232:235], a[112:115], a[80:83], v[232:235]
    buffer_load_dwordx4 v16, s[16:19], s40 offen lds
    v_mfma_f32_16x16x32_bf16 v[232:235], a[116:119], a[84:87], v[232:235]
    buffer_load_dwordx4 v17, s[16:19], s40 offen offset:1024 lds
    v_mfma_f32_16x16x32_bf16 v[236:239], a[116:119], a[92:95], v[236:239]
    v_mfma_f32_16x16x32_bf16 v[236:239], a[112:115], a[88:91], v[236:239]
    s_add_u32 m0, s61, 36864
    v_cvt_pk_bf16_f32 v73, v74, v75
    s_waitcnt lgkmcnt(4)
    v_mfma_f32_16x16x32_bf16 v[252:255], a[120:123], a[88:91], v[252:255]
    ds_read_b64_tr_b16 a[104:105], v10 offset:2048
    v_cvt_pk_bf16_f32 v74, v76, v77
    v_mfma_f32_16x16x32_bf16 v[252:255], a[124:127], a[92:95], v[252:255]
    s_add_u32 s40, s50, s42
    ds_read_b64_tr_b16 a[106:107], v10 offset:2560
    v_mfma_f32_16x16x32_bf16 v[248:251], a[124:127], a[84:87], v[248:251]
    ds_read_b64_tr_b16 a[108:109], v10 offset:10240
    v_cvt_pk_bf16_f32 v75, v78, v79
    v_mfma_f32_16x16x32_bf16 v[248:251], a[120:123], a[80:83], v[248:251]
    s_add_u32 s3, s62, 557056
    ds_read_b64_tr_b16 a[110:111], v10 offset:10752
    v_mfma_f32_16x16x32_bf16 v[244:247], a[120:123], a[72:75], v[244:247]
    buffer_load_dwordx4 v16, s[16:19], s40 offen lds
    v_mfma_f32_16x16x32_bf16 v[244:247], a[124:127], a[76:79], v[244:247]
    v_mfma_f32_16x16x32_bf16 v[240:243], a[124:127], a[68:71], v[240:243]
    buffer_store_dwordx4 v[72:75], v11, s[28:31], s3 offen sc1
    v_mfma_f32_16x16x32_bf16 v[240:243], a[120:123], a[64:67], v[240:243]
    v_accvgpr_read_b32 v64, a152
    s_waitcnt lgkmcnt(4)
    v_mfma_f32_16x16x32_bf16 v[48:51], a[96:99], a[64:67], v[48:51]
    ds_read_b64_tr_b16 a[112:113], v9 offset:2304
    v_mfma_f32_16x16x32_bf16 v[48:51], a[100:103], a[68:71], v[48:51]
    ds_read_b64_tr_b16 a[114:115], v9 offset:2816
    v_mfma_f32_16x16x32_bf16 v[52:55], a[100:103], a[76:79], v[52:55]
    ds_read_b64_tr_b16 a[116:117], v9 offset:10496
    buffer_load_dwordx4 v17, s[16:19], s40 offen offset:1024 lds
    v_mfma_f32_16x16x32_bf16 v[52:55], a[96:99], a[72:75], v[52:55]
    ds_read_b64_tr_b16 a[118:119], v9 offset:11008
    v_mfma_f32_16x16x32_bf16 v[56:59], a[96:99], a[80:83], v[56:59]
    s_add_u32 m0, s61, 38912
    v_accvgpr_read_b32 v65, a153
    v_mfma_f32_16x16x32_bf16 v[56:59], a[100:103], a[84:87], v[56:59]
    s_add_u32 s40, s51, s42
    v_mfma_f32_16x16x32_bf16 v[60:63], a[100:103], a[92:95], v[60:63]
    buffer_load_dwordx4 v16, s[16:19], s40 offen lds
    v_mfma_f32_16x16x32_bf16 v[60:63], a[96:99], a[88:91], v[60:63]
    v_accvgpr_read_b32 v66, a154
    s_waitcnt lgkmcnt(4)
    v_mfma_f32_16x16x32_bf16 v[92:95], a[104:107], a[88:91], v[92:95]
    ds_read_b64_tr_b16 a[120:121], v10 offset:2304
    v_mfma_f32_16x16x32_bf16 v[92:95], a[108:111], a[92:95], v[92:95]
    ds_read_b64_tr_b16 a[122:123], v10 offset:2816
    v_mfma_f32_16x16x32_bf16 v[88:91], a[108:111], a[84:87], v[88:91]
    ds_read_b64_tr_b16 a[124:125], v10 offset:10496
    v_accvgpr_read_b32 v67, a155
    v_mfma_f32_16x16x32_bf16 v[88:91], a[104:107], a[80:83], v[88:91]
    ds_read_b64_tr_b16 a[126:127], v10 offset:11008
    v_mfma_f32_16x16x32_bf16 v[84:87], a[104:107], a[72:75], v[84:87]
    buffer_load_dwordx4 v17, s[16:19], s40 offen offset:1024 lds
    v_mfma_f32_16x16x32_bf16 v[84:87], a[108:111], a[76:79], v[84:87]
    s_add_u32 s56, s56, 1
    s_cmp_eq_u32 s56, 10
    s_cselect_b32 s56, 0, s56
    v_mfma_f32_16x16x32_bf16 v[80:83], a[108:111], a[68:71], v[80:83]
    v_add_u32 v9, 32768, v12
    v_add_u32 v10, 32768, v13
    v_mfma_f32_16x16x32_bf16 v[80:83], a[104:107], a[64:67], v[80:83]
    s_waitcnt vmcnt(17) lgkmcnt(0)
    s_barrier
    v_mfma_f32_16x16x32_bf16 v[112:115], a[112:115], a[64:67], v[112:115]
    ds_read_b64_tr_b16 a[96:97], v9 offset:0
    v_mfma_f32_16x16x32_bf16 v[112:115], a[116:119], a[68:71], v[112:115]
    ds_read_b64_tr_b16 a[98:99], v9 offset:1024
    v_accvgpr_read_b32 v68, a156
    v_mfma_f32_16x16x32_bf16 v[116:119], a[116:119], a[76:79], v[116:119]
    ds_read_b64_tr_b16 a[100:101], v9 offset:8192
    v_accvgpr_read_b32 v69, a157
    v_mfma_f32_16x16x32_bf16 v[116:119], a[112:115], a[72:75], v[116:119]
    ds_read_b64_tr_b16 a[102:103], v9 offset:9216
    v_accvgpr_read_b32 v70, a158
    v_mfma_f32_16x16x32_bf16 v[120:123], a[112:115], a[80:83], v[120:123]
    ds_read_b128 a[32:35], v7 offset:0
    v_accvgpr_read_b32 v71, a159
    v_mfma_f32_16x16x32_bf16 v[120:123], a[116:119], a[84:87], v[120:123]
    ds_read_b128 a[36:39], v8 offset:0
    v_mfma_f32_16x16x32_bf16 v[124:127], a[116:119], a[92:95], v[124:127]
    ds_read_b128 a[40:43], v7 offset:2048
    v_cvt_pk_bf16_f32 v64, v64, v65
    v_mfma_f32_16x16x32_bf16 v[124:127], a[112:115], a[88:91], v[124:127]
    ds_read_b128 a[44:47], v8 offset:2048
    v_mfma_f32_16x16x32_bf16 v[44:47], a[120:123], a[88:91], v[44:47]
    ds_read_b128 a[48:51], v7 offset:4096
    v_cvt_pk_bf16_f32 v65, v66, v67
    v_mfma_f32_16x16x32_bf16 v[44:47], a[124:127], a[92:95], v[44:47]
    ds_read_b128 a[52:55], v8 offset:4096
    v_cvt_pk_bf16_f32 v66, v68, v69
    v_mfma_f32_16x16x32_bf16 v[40:43], a[124:127], a[84:87], v[40:43]
    ds_read_b128 a[56:59], v7 offset:6144
    v_mfma_f32_16x16x32_bf16 v[40:43], a[120:123], a[80:83], v[40:43]
    ds_read_b128 a[60:63], v8 offset:6144
    v_cvt_pk_bf16_f32 v67, v70, v71
    v_mfma_f32_16x16x32_bf16 v[36:39], a[120:123], a[72:75], v[36:39]
    s_add_u32 s3, s62, 558080
    ds_read_b64_tr_b16 a[104:105], v10 offset:0
    v_mfma_f32_16x16x32_bf16 v[36:39], a[124:127], a[76:79], v[36:39]
    ds_read_b64_tr_b16 a[106:107], v10 offset:1024
    v_mfma_f32_16x16x32_bf16 v[32:35], a[124:127], a[68:71], v[32:35]
    ds_read_b64_tr_b16 a[108:109], v10 offset:8192
    buffer_store_dwordx4 v[64:67], v11, s[28:31], s3 offen sc1
    v_mfma_f32_16x16x32_bf16 v[32:35], a[120:123], a[64:67], v[32:35]
    ds_read_b64_tr_b16 a[110:111], v10 offset:9216
    s_waitcnt lgkmcnt(4)
    v_mfma_f32_16x16x32_bf16 v[128:131], a[96:99], a[32:35], v[128:131]
    ds_read_b64_tr_b16 a[112:113], v9 offset:256
    buffer_load_dword v31, v19, s[28:31], s43 offen sc0 sc1
    v_mfma_f32_16x16x32_bf16 v[128:131], a[100:103], a[36:39], v[128:131]
    ds_read_b64_tr_b16 a[114:115], v9 offset:1280
    v_accvgpr_read_b32 v72, a168
    v_mfma_f32_16x16x32_bf16 v[132:135], a[100:103], a[44:47], v[132:135]
    ds_read_b64_tr_b16 a[116:117], v9 offset:8448
    v_accvgpr_read_b32 v73, a169
    v_mfma_f32_16x16x32_bf16 v[132:135], a[96:99], a[40:43], v[132:135]
    ds_read_b64_tr_b16 a[118:119], v9 offset:9472
    v_accvgpr_read_b32 v74, a170
    v_mfma_f32_16x16x32_bf16 v[136:139], a[96:99], a[48:51], v[136:139]
    s_mul_i32 s0, s37, 1081344
    v_accvgpr_read_b32 v75, a171
    v_accvgpr_read_b32 v76, a172
    v_mfma_f32_16x16x32_bf16 v[136:139], a[100:103], a[52:55], v[136:139]
    s_add_u32 s4, s90, s0
    s_addc_u32 s5, s91, 0
    v_accvgpr_read_b32 v77, a173
    v_mfma_f32_16x16x32_bf16 v[140:143], a[100:103], a[60:63], v[140:143]
    s_lshl_b32 s0, s38, 16
    v_accvgpr_read_b32 v78, a174
    v_accvgpr_read_b32 v79, a175
    v_mfma_f32_16x16x32_bf16 v[140:143], a[96:99], a[56:59], v[140:143]
    s_sub_u32 s6, 1081344, s0
    v_cvt_pk_bf16_f32 v72, v72, v73
    s_waitcnt lgkmcnt(4)
    v_mfma_f32_16x16x32_bf16 v[156:159], a[104:107], a[56:59], v[156:159]
    ds_read_b64_tr_b16 a[120:121], v10 offset:256
    v_cvt_pk_bf16_f32 v73, v74, v75
    v_mfma_f32_16x16x32_bf16 v[156:159], a[108:111], a[60:63], v[156:159]
    ds_read_b64_tr_b16 a[122:123], v10 offset:1280
    v_cvt_pk_bf16_f32 v74, v76, v77
    v_mfma_f32_16x16x32_bf16 v[152:155], a[108:111], a[52:55], v[152:155]
    ds_read_b64_tr_b16 a[124:125], v10 offset:8448
    v_cvt_pk_bf16_f32 v75, v78, v79
    v_mfma_f32_16x16x32_bf16 v[152:155], a[104:107], a[48:51], v[152:155]
    s_add_u32 s3, s62, 559104
    ds_read_b64_tr_b16 a[126:127], v10 offset:9472
    v_mfma_f32_16x16x32_bf16 v[148:151], a[104:107], a[40:43], v[148:151]
    buffer_store_dwordx4 v[72:75], v11, s[28:31], s3 offen sc1
    v_mfma_f32_16x16x32_bf16 v[148:151], a[108:111], a[44:47], v[148:151]
    v_accvgpr_read_b32 v64, a184
    v_accvgpr_read_b32 v65, a185
    v_mfma_f32_16x16x32_bf16 v[144:147], a[108:111], a[36:39], v[144:147]
    s_mov_b32 s7, 0x00020000
    s_lshl_b32 s56, s36, 13
    v_accvgpr_read_b32 v66, a186
    v_mfma_f32_16x16x32_bf16 v[144:147], a[104:107], a[32:35], v[144:147]
    s_and_b32 s58, s38, 1
    s_lshl_b32 s58, s58, 16
    s_waitcnt lgkmcnt(4)
    v_mfma_f32_16x16x32_bf16 v[160:163], a[112:115], a[32:35], v[160:163]
    ds_read_b64_tr_b16 a[96:97], v9 offset:512
    v_mfma_f32_16x16x32_bf16 v[160:163], a[116:119], a[36:39], v[160:163]
    ds_read_b64_tr_b16 a[98:99], v9 offset:1536
    v_accvgpr_read_b32 v67, a187
    v_mfma_f32_16x16x32_bf16 v[164:167], a[116:119], a[44:47], v[164:167]
    s_xor_b32 s58, s58, 0x18000
    ds_read_b64_tr_b16 a[100:101], v9 offset:8704
    v_mfma_f32_16x16x32_bf16 v[164:167], a[112:115], a[40:43], v[164:167]
    s_add_u32 s57, s56, s58
    ds_read_b64_tr_b16 a[102:103], v9 offset:9728
    v_mfma_f32_16x16x32_bf16 v[168:171], a[112:115], a[48:51], v[168:171]
    s_add_u32 s32, s90, 60817408
    s_addc_u32 s33, s91, 0
    v_accvgpr_read_b32 v68, a188
    v_mfma_f32_16x16x32_bf16 v[168:171], a[116:119], a[52:55], v[168:171]
    s_mov_b32 s34, 7454720
    v_accvgpr_read_b32 v69, a189
    v_accvgpr_read_b32 v70, a190
    v_mfma_f32_16x16x32_bf16 v[172:175], a[116:119], a[60:63], v[172:175]
    v_accvgpr_read_b32 v71, a191
    v_cvt_pk_bf16_f32 v64, v64, v65
    v_mfma_f32_16x16x32_bf16 v[172:175], a[112:115], a[56:59], v[172:175]
    s_mov_b32 s35, 0x00020000
    v_cvt_pk_bf16_f32 v65, v66, v67
    s_waitcnt lgkmcnt(4)
    v_mfma_f32_16x16x32_bf16 v[188:191], a[120:123], a[56:59], v[188:191]
    s_mov_b32 s59, 83906560
    ds_read_b64_tr_b16 a[104:105], v10 offset:512
    v_mfma_f32_16x16x32_bf16 v[188:191], a[124:127], a[60:63], v[188:191]
    ds_read_b64_tr_b16 a[106:107], v10 offset:1536
    v_cvt_pk_bf16_f32 v66, v68, v69
    v_mfma_f32_16x16x32_bf16 v[184:187], a[124:127], a[52:55], v[184:187]
    ds_read_b64_tr_b16 a[108:109], v10 offset:8704
    v_cvt_pk_bf16_f32 v67, v70, v71
    v_mfma_f32_16x16x32_bf16 v[184:187], a[120:123], a[48:51], v[184:187]
    ds_read_b64_tr_b16 a[110:111], v10 offset:9728
    v_mov_b32 v5, 0xff800000
    v_mfma_f32_16x16x32_bf16 v[180:183], a[120:123], a[40:43], v[180:183]
    v_and_b32 v14, 15, v1
    v_lshrrev_b32 v15, 4, v1
    v_mfma_f32_16x16x32_bf16 v[180:183], a[124:127], a[44:47], v[180:183]
    s_add_u32 s3, s62, 560128
    v_lshlrev_b32 v15, 2, v15
    v_sub_u32 v14, v14, v15
    v_mfma_f32_16x16x32_bf16 v[176:179], a[124:127], a[36:39], v[176:179]
    buffer_store_dwordx4 v[64:67], v11, s[28:31], s3 offen sc1
    v_mfma_f32_16x16x32_bf16 v[176:179], a[120:123], a[32:35], v[176:179]
    s_waitcnt lgkmcnt(4)
    v_mfma_f32_16x16x32_bf16 v[192:195], a[96:99], a[32:35], v[192:195]
    ds_read_b64_tr_b16 a[112:113], v9 offset:768
    v_accvgpr_read_b32 v72, a200
    v_mfma_f32_16x16x32_bf16 v[192:195], a[100:103], a[36:39], v[192:195]
    ds_read_b64_tr_b16 a[114:115], v9 offset:1792
    v_accvgpr_read_b32 v73, a201
    v_mfma_f32_16x16x32_bf16 v[196:199], a[100:103], a[44:47], v[196:199]
    ds_read_b64_tr_b16 a[116:117], v9 offset:8960
    v_accvgpr_read_b32 v74, a202
    v_mfma_f32_16x16x32_bf16 v[196:199], a[96:99], a[40:43], v[196:199]
    ds_read_b64_tr_b16 a[118:119], v9 offset:9984
    v_accvgpr_read_b32 v75, a203
    v_mfma_f32_16x16x32_bf16 v[200:203], a[96:99], a[48:51], v[200:203]
    s_lshl_b32 s0, s36, 4
    v_accvgpr_read_b32 v76, a204
    v_add_u32 v3, s0, v14
    v_mfma_f32_16x16x32_bf16 v[200:203], a[100:103], a[52:55], v[200:203]
    s_sub_u32 s0, 112, s0
    v_accvgpr_read_b32 v77, a205
    v_accvgpr_read_b32 v78, a206
    v_mfma_f32_16x16x32_bf16 v[204:207], a[100:103], a[60:63], v[204:207]
    v_add_u32 v4, s0, v14
    v_add_u32 v2, s58, v11
    v_mfma_f32_16x16x32_bf16 v[204:207], a[96:99], a[56:59], v[204:207]
    s_add_u32 s58, s58, 32768
    v_accvgpr_read_b32 v79, a207
    s_waitcnt lgkmcnt(4)
    v_mfma_f32_16x16x32_bf16 v[220:223], a[104:107], a[56:59], v[220:223]
    ds_read_b64_tr_b16 a[120:121], v10 offset:768
    v_cvt_pk_bf16_f32 v72, v72, v73
    v_mfma_f32_16x16x32_bf16 v[220:223], a[108:111], a[60:63], v[220:223]
    ds_read_b64_tr_b16 a[122:123], v10 offset:1792
    v_cvt_pk_bf16_f32 v73, v74, v75
    v_mfma_f32_16x16x32_bf16 v[216:219], a[108:111], a[52:55], v[216:219]
    ds_read_b64_tr_b16 a[124:125], v10 offset:8960
    v_cvt_pk_bf16_f32 v74, v76, v77
    v_mfma_f32_16x16x32_bf16 v[216:219], a[104:107], a[48:51], v[216:219]
    ds_read_b64_tr_b16 a[126:127], v10 offset:9984
    v_cvt_pk_bf16_f32 v75, v78, v79
    v_mfma_f32_16x16x32_bf16 v[212:215], a[104:107], a[40:43], v[212:215]
    s_and_b32 s58, s58, 0x1ffff
    s_lshl_b32 s0, s38, 7
    v_add_u32 v15, s0, v3
    v_mfma_f32_16x16x32_bf16 v[212:215], a[108:111], a[44:47], v[212:215]
    s_add_u32 s3, s95, 561152
    v_cmp_gt_i32 s[44:45], 0, v15
    v_cmp_gt_i32 s[46:47], 1, v15
    v_mfma_f32_16x16x32_bf16 v[208:211], a[108:111], a[36:39], v[208:211]
    buffer_store_dwordx4 v[72:75], v11, s[28:31], s3 offen sc1
    v_mfma_f32_16x16x32_bf16 v[208:211], a[104:107], a[32:35], v[208:211]
    v_accvgpr_read_b32 v64, a216
    s_waitcnt lgkmcnt(4)
    v_mfma_f32_16x16x32_bf16 v[224:227], a[112:115], a[32:35], v[224:227]
    ds_read_b64_tr_b16 a[96:97], v9 offset:2048
    v_cmp_gt_i32 s[48:49], 2, v15
    v_mfma_f32_16x16x32_bf16 v[224:227], a[116:119], a[36:39], v[224:227]
    ds_read_b64_tr_b16 a[98:99], v9 offset:2560
    v_accvgpr_read_b32 v65, a217
    v_mfma_f32_16x16x32_bf16 v[228:231], a[116:119], a[44:47], v[228:231]
    ds_read_b64_tr_b16 a[100:101], v9 offset:10240
    v_accvgpr_read_b32 v66, a218
    v_mfma_f32_16x16x32_bf16 v[228:231], a[112:115], a[40:43], v[228:231]
    ds_read_b64_tr_b16 a[102:103], v9 offset:10752
    v_cmp_gt_i32 s[50:51], 3, v15
    v_mfma_f32_16x16x32_bf16 v[232:235], a[112:115], a[48:51], v[232:235]
    v_accvgpr_read_b32 v67, a219
    v_accvgpr_read_b32 v68, a220
    v_accvgpr_read_b32 v69, a221
    v_mfma_f32_16x16x32_bf16 v[232:235], a[116:119], a[52:55], v[232:235]
    v_accvgpr_read_b32 v70, a222
    v_accvgpr_read_b32 v71, a223
    v_mfma_f32_16x16x32_bf16 v[236:239], a[116:119], a[60:63], v[236:239]
    v_cndmask_b32 v96, 0, v5, s[44:45]
    v_cndmask_b32 v97, 0, v5, s[46:47]
    v_mfma_f32_16x16x32_bf16 v[236:239], a[112:115], a[56:59], v[236:239]
    v_cndmask_b32 v98, 0, v5, s[48:49]
    s_waitcnt lgkmcnt(4)
    v_mfma_f32_16x16x32_bf16 v[252:255], a[120:123], a[56:59], v[252:255]
    ds_read_b64_tr_b16 a[104:105], v10 offset:2048
    v_cndmask_b32 v99, 0, v5, s[50:51]
    v_mfma_f32_16x16x32_bf16 v[252:255], a[124:127], a[60:63], v[252:255]
    ds_read_b64_tr_b16 a[106:107], v10 offset:2560
    v_cvt_pk_bf16_f32 v64, v64, v65
    v_cvt_pk_bf16_f32 v65, v66, v67
    v_mfma_f32_16x16x32_bf16 v[248:251], a[124:127], a[52:55], v[248:251]
    ds_read_b64_tr_b16 a[108:109], v10 offset:10240
    v_cvt_pk_bf16_f32 v66, v68, v69
    v_mfma_f32_16x16x32_bf16 v[248:251], a[120:123], a[48:51], v[248:251]
    ds_read_b64_tr_b16 a[110:111], v10 offset:10752
    v_cvt_pk_bf16_f32 v67, v70, v71
    v_mfma_f32_16x16x32_bf16 v[244:247], a[120:123], a[40:43], v[244:247]
    s_add_u32 s3, s95, 562176
    v_cmp_gt_i32 s[44:45], 16, v15
    v_cmp_gt_i32 s[46:47], 17, v15
    v_mfma_f32_16x16x32_bf16 v[244:247], a[124:127], a[44:47], v[244:247]
    buffer_store_dwordx4 v[64:67], v11, s[28:31], s3 offen sc1
    v_mfma_f32_16x16x32_bf16 v[240:243], a[124:127], a[36:39], v[240:243]
    v_accvgpr_read_b32 v72, a232
    v_accvgpr_read_b32 v73, a233
    v_accvgpr_read_b32 v74, a234
    v_mfma_f32_16x16x32_bf16 v[240:243], a[120:123], a[32:35], v[240:243]
    v_accvgpr_read_b32 v75, a235
    s_waitcnt lgkmcnt(4)
    v_mfma_f32_16x16x32_bf16 v[48:51], a[96:99], a[32:35], v[48:51]
    ds_read_b64_tr_b16 a[112:113], v9 offset:2304
    v_accvgpr_read_b32 v76, a236
    v_accvgpr_read_b32 v77, a237
    v_mfma_f32_16x16x32_bf16 v[48:51], a[100:103], a[36:39], v[48:51]
    ds_read_b64_tr_b16 a[114:115], v9 offset:2816
    v_accvgpr_read_b32 v78, a238
    v_cmp_gt_i32 s[48:49], 18, v15
    v_mfma_f32_16x16x32_bf16 v[52:55], a[100:103], a[44:47], v[52:55]
    ds_read_b64_tr_b16 a[116:117], v9 offset:10496
    v_cmp_gt_i32 s[50:51], 19, v15
    v_mfma_f32_16x16x32_bf16 v[52:55], a[96:99], a[40:43], v[52:55]
    ds_read_b64_tr_b16 a[118:119], v9 offset:11008
    v_cndmask_b32 v100, 0, v5, s[44:45]
    v_mfma_f32_16x16x32_bf16 v[56:59], a[96:99], a[48:51], v[56:59]
    v_accvgpr_read_b32 v79, a239
    v_cvt_pk_bf16_f32 v72, v72, v73
    v_mfma_f32_16x16x32_bf16 v[56:59], a[100:103], a[52:55], v[56:59]
    v_cvt_pk_bf16_f32 v73, v74, v75
    v_cvt_pk_bf16_f32 v74, v76, v77
    v_mfma_f32_16x16x32_bf16 v[60:63], a[100:103], a[60:63], v[60:63]
    v_cndmask_b32 v101, 0, v5, s[46:47]
    v_cndmask_b32 v102, 0, v5, s[48:49]
    v_mfma_f32_16x16x32_bf16 v[60:63], a[96:99], a[56:59], v[60:63]
    v_cndmask_b32 v103, 0, v5, s[50:51]
    s_waitcnt lgkmcnt(4)
    v_mfma_f32_16x16x32_bf16 v[92:95], a[104:107], a[56:59], v[92:95]
    ds_read_b64_tr_b16 a[120:121], v10 offset:2304
    v_cvt_pk_bf16_f32 v75, v78, v79
    v_mfma_f32_16x16x32_bf16 v[92:95], a[108:111], a[60:63], v[92:95]
    s_add_u32 s3, s95, 563200
    ds_read_b64_tr_b16 a[122:123], v10 offset:2816
    v_mfma_f32_16x16x32_bf16 v[88:91], a[108:111], a[52:55], v[88:91]
    ds_read_b64_tr_b16 a[124:125], v10 offset:10496
    buffer_store_dwordx4 v[72:75], v11, s[28:31], s3 offen sc1
    v_mfma_f32_16x16x32_bf16 v[88:91], a[104:107], a[48:51], v[88:91]
    ds_read_b64_tr_b16 a[126:127], v10 offset:11008
    v_accvgpr_read_b32 v64, a248
    v_and_b32 v14, 1, v1
    v_mfma_f32_16x16x32_bf16 v[84:87], a[104:107], a[40:43], v[84:87]
    v_accvgpr_read_b32 v65, a249
    v_mul_u32_u24 v14, 0xaaaa, v14
    v_mfma_f32_16x16x32_bf16 v[84:87], a[108:111], a[44:47], v[84:87]
    v_add_u32 v6, 0x4444, v14
    v_bfe_u32 v14, v1, 1, 1
    v_mfma_f32_16x16x32_bf16 v[80:83], a[108:111], a[36:39], v[80:83]
    v_add_u32 v9, 65536, v12
    v_add_u32 v10, 65536, v13
    v_mfma_f32_16x16x32_bf16 v[80:83], a[104:107], a[32:35], v[80:83]
    s_waitcnt vmcnt(7) lgkmcnt(0)
    s_barrier
    v_mfma_f32_16x16x32_bf16 v[112:115], a[112:115], a[32:35], v[112:115]
    ds_read_b64_tr_b16 a[96:97], v9 offset:0
    v_accvgpr_read_b32 v66, a250
    v_lshrrev_b32 v105, 5, v1
    v_mfma_f32_16x16x32_bf16 v[112:115], a[116:119], a[36:39], v[112:115]
    ds_read_b64_tr_b16 a[98:99], v9 offset:1024
    v_accvgpr_read_b32 v67, a251
    v_mfma_f32_16x16x32_bf16 v[116:119], a[116:119], a[44:47], v[116:119]
    ds_read_b64_tr_b16 a[100:101], v9 offset:8192
    v_accvgpr_read_b32 v68, a252
    v_mfma_f32_16x16x32_bf16 v[116:119], a[112:115], a[40:43], v[116:119]
    ds_read_b64_tr_b16 a[102:103], v9 offset:9216
    v_accvgpr_read_b32 v69, a253
    v_accvgpr_read_b32 v70, a254
    v_mfma_f32_16x16x32_bf16 v[120:123], a[112:115], a[48:51], v[120:123]
    ds_read_b128 a[64:67], v7 offset:32768
    v_xor_b32 v104, v14, v105
    v_mfma_f32_16x16x32_bf16 v[120:123], a[116:119], a[52:55], v[120:123]
    ds_read_b128 a[68:71], v8 offset:32768
    v_add_u32 v104, -1, v104
    v_mfma_f32_16x16x32_bf16 v[124:127], a[116:119], a[60:63], v[124:127]
    ds_read_b128 a[72:75], v7 offset:34816
    v_accvgpr_read_b32 v71, a255
    v_mfma_f32_16x16x32_bf16 v[124:127], a[112:115], a[56:59], v[124:127]
    ds_read_b128 a[76:79], v8 offset:34816
    v_mfma_f32_16x16x32_bf16 v[44:47], a[120:123], a[56:59], v[44:47]
    ds_read_b128 a[80:83], v7 offset:36864
    v_and_b32 v104, 0x3f803f80, v104
    v_mfma_f32_16x16x32_bf16 v[44:47], a[124:127], a[60:63], v[44:47]
    ds_read_b128 a[84:87], v8 offset:36864
    v_cvt_pk_bf16_f32 v64, v64, v65
    v_mfma_f32_16x16x32_bf16 v[40:43], a[124:127], a[52:55], v[40:43]
    ds_read_b128 a[88:91], v7 offset:38912
    v_cvt_pk_bf16_f32 v65, v66, v67
    v_mfma_f32_16x16x32_bf16 v[40:43], a[120:123], a[48:51], v[40:43]
    ds_read_b128 a[92:95], v8 offset:38912
    v_cvt_pk_bf16_f32 v66, v68, v69
    v_mfma_f32_16x16x32_bf16 v[36:39], a[120:123], a[40:43], v[36:39]
    ds_read_b64_tr_b16 a[104:105], v10 offset:0
    v_cvt_pk_bf16_f32 v67, v70, v71
    v_mfma_f32_16x16x32_bf16 v[36:39], a[124:127], a[44:47], v[36:39]
    s_add_u32 s3, s95, 564224
    ds_read_b64_tr_b16 a[106:107], v10 offset:1024
    buffer_store_dwordx4 v[64:67], v11, s[28:31], s3 offen sc1
    v_mfma_f32_16x16x32_bf16 v[32:35], a[124:127], a[36:39], v[32:35]
    ds_read_b64_tr_b16 a[108:109], v10 offset:8192
    v_mul_lo_u32 v105, v105, v104
    v_mfma_f32_16x16x32_bf16 v[32:35], a[120:123], a[32:35], v[32:35]
    ds_read_b64_tr_b16 a[110:111], v10 offset:9216
    s_waitcnt vmcnt(6)
    v_cmp_ne_u32 vcc, 1, v31
    s_nop 0
    s_cmp_eq_u64 vcc, 0
    s_cbranch_scc1 L_kvw_ok
L_kvw_no:
    s_mov_b32 s39, 0x40000
L_kvw_spin:
    buffer_load_dword v31, v19, s[28:31], s43 offen sc0 sc1
    s_waitcnt vmcnt(0)
    v_cmp_ne_u32 vcc, 1, v31
    s_nop 0
    s_cmp_eq_u64 vcc, 0
    s_cbranch_scc1 L_kvw_ok
L_kvw_again:
    s_sleep 4
    s_sub_u32 s39, s39, 1
    s_cmp_lg_u32 s39, 0
    s_cbranch_scc1 L_kvw_spin
L_kvw_ok:
    v_and_b32 v30, 60, v18
    s_waitcnt lgkmcnt(4)
    v_mfma_f32_16x16x32_bf16 v[128:131], a[96:99], a[64:67], v[128:131]
    ds_read_b64_tr_b16 a[112:113], v9 offset:256
    v_mfma_f32_16x16x32_bf16 v[128:131], a[100:103], a[68:71], v[128:131]
    s_lshl_b32 s39, s94, 17
    ds_read_b64_tr_b16 a[114:115], v9 offset:1280
    v_mfma_f32_16x16x32_bf16 v[132:135], a[100:103], a[76:79], v[132:135]
    s_lshl_b32 s40, s52, 6
    s_add_u32 s40, s40, 83886080
    ds_read_b64_tr_b16 a[116:117], v9 offset:8448
    v_mfma_f32_16x16x32_bf16 v[132:135], a[96:99], a[72:75], v[132:135]
    ds_read_b64_tr_b16 a[118:119], v9 offset:9472
    v_mfma_f32_16x16x32_bf16 v[136:139], a[96:99], a[80:83], v[136:139]
    buffer_load_dword v16, v30, s[28:31], s40 offen sc1
    v_mfma_f32_16x16x32_bf16 v[136:139], a[100:103], a[84:87], v[136:139]
    s_lshl_b32 s40, s53, 6
    s_add_u32 s40, s40, 83886080
    s_add_u32 s39, s39, 53477376
    v_mfma_f32_16x16x32_bf16 v[140:143], a[100:103], a[92:95], v[140:143]
    buffer_load_dword v18, v30, s[28:31], s40 offen sc1
    v_mfma_f32_16x16x32_bf16 v[140:143], a[96:99], a[88:91], v[140:143]
    s_lshl_b32 s40, s54, 6
    s_add_u32 s40, s40, 83886080
    s_waitcnt lgkmcnt(4)
    v_mfma_f32_16x16x32_bf16 v[144:147], a[104:107], a[64:67], v[144:147]
    ds_read_b64_tr_b16 a[120:121], v10 offset:256
    v_mfma_f32_16x16x32_bf16 v[144:147], a[108:111], a[68:71], v[144:147]
    s_lshl_b32 s101, s52, 10
    ds_read_b64_tr_b16 a[122:123], v10 offset:1280
    v_mfma_f32_16x16x32_bf16 v[148:151], a[108:111], a[76:79], v[148:151]
    ds_read_b64_tr_b16 a[124:125], v10 offset:8448
    v_mfma_f32_16x16x32_bf16 v[148:151], a[104:107], a[72:75], v[148:151]
    s_add_u32 s16, s101, s39
    ds_read_b64_tr_b16 a[126:127], v10 offset:9472
    v_mfma_f32_16x16x32_bf16 v[152:155], a[104:107], a[80:83], v[152:155]
    buffer_load_dword v20, v30, s[28:31], s40 offen sc1
    v_mfma_f32_16x16x32_bf16 v[152:155], a[108:111], a[84:87], v[152:155]
    s_lshl_b32 s40, s55, 6
    s_add_u32 s40, s40, 83886080
    s_add_u32 s20, s16, 131072
    v_mfma_f32_16x16x32_bf16 v[156:159], a[108:111], a[92:95], v[156:159]
    buffer_load_dword v22, v30, s[28:31], s40 offen sc1
    v_mfma_f32_16x16x32_bf16 v[156:159], a[104:107], a[88:91], v[156:159]
    s_add_u32 s41, s57, 32768
    s_and_b32 s41, s41, 0x1ffff
    s_waitcnt lgkmcnt(4)
    v_mfma_f32_16x16x32_bf16 v[160:163], a[112:115], a[64:67], v[160:163]
    s_add_u32 s40, s56, 32768
    ds_read_b64_tr_b16 a[96:97], v9 offset:512
    v_mfma_f32_16x16x32_bf16 v[160:163], a[116:119], a[68:71], v[160:163]
    ds_read_b64_tr_b16 a[98:99], v9 offset:1536
    v_cvt_pk_bf16_f32 v128, v128, v129
    v_mfma_f32_16x16x32_bf16 v[164:167], a[116:119], a[76:79], v[164:167]
    ds_read_b64_tr_b16 a[100:101], v9 offset:8704
    v_cvt_pk_bf16_f32 v129, v130, v131
    v_mfma_f32_16x16x32_bf16 v[164:167], a[112:115], a[72:75], v[164:167]
    ds_read_b64_tr_b16 a[102:103], v9 offset:9728
    v_cvt_pk_bf16_f32 v130, v144, v145
    v_mfma_f32_16x16x32_bf16 v[168:171], a[112:115], a[80:83], v[168:171]
    v_cvt_pk_bf16_f32 v131, v146, v147
    v_accvgpr_write_b32 a128, v128
    v_mfma_f32_16x16x32_bf16 v[168:171], a[116:119], a[84:87], v[168:171]
    s_add_u32 m0, s41, 32768
    v_accvgpr_write_b32 a129, v129
    v_accvgpr_write_b32 a130, v130
    v_mfma_f32_16x16x32_bf16 v[172:175], a[116:119], a[92:95], v[172:175]
    buffer_load_dwordx4 v11, s[4:7], s40 offen offset:0 sc1 lds
    v_mfma_f32_16x16x32_bf16 v[172:175], a[112:115], a[88:91], v[172:175]
L_ws_4979:
    s_cbranch_execz L_wr_a
    v_accvgpr_write_b32 a131, v131
    s_waitcnt lgkmcnt(4)
    v_mfma_f32_16x16x32_bf16 v[176:179], a[120:123], a[64:67], v[176:179]
    ds_read_b64_tr_b16 a[104:105], v10 offset:512
    buffer_load_dwordx4 v11, s[4:7], s40 offen offset:1024 sc1 lds
    v_mfma_f32_16x16x32_bf16 v[176:179], a[124:127], a[68:71], v[176:179]
    ds_read_b64_tr_b16 a[106:107], v10 offset:1536
    v_cvt_pk_bf16_f32 v132, v132, v133
    v_mfma_f32_16x16x32_bf16 v[180:183], a[124:127], a[76:79], v[180:183]
    ds_read_b64_tr_b16 a[108:109], v10 offset:8704
    v_cvt_pk_bf16_f32 v133, v134, v135
    v_mfma_f32_16x16x32_bf16 v[180:183], a[120:123], a[72:75], v[180:183]
    ds_read_b64_tr_b16 a[110:111], v10 offset:9728
    v_cvt_pk_bf16_f32 v134, v148, v149
    v_mfma_f32_16x16x32_bf16 v[184:187], a[120:123], a[80:83], v[184:187]
    buffer_load_dwordx4 v11, s[4:7], s40 offen offset:2048 sc1 lds
    v_cvt_pk_bf16_f32 v135, v150, v151
    v_accvgpr_write_b32 a144, v132
    v_mfma_f32_16x16x32_bf16 v[184:187], a[124:127], a[84:87], v[184:187]
    v_accvgpr_write_b32 a145, v133
    v_accvgpr_write_b32 a146, v134
    v_mfma_f32_16x16x32_bf16 v[188:191], a[124:127], a[92:95], v[188:191]
    v_accvgpr_write_b32 a147, v135
    v_cvt_pk_bf16_f32 v136, v136, v137
    v_mfma_f32_16x16x32_bf16 v[188:191], a[120:123], a[88:91], v[188:191]
    v_cvt_pk_bf16_f32 v137, v138, v139
    s_waitcnt lgkmcnt(4)
    v_mfma_f32_16x16x32_bf16 v[192:195], a[96:99], a[64:67], v[192:195]
    ds_read_b64_tr_b16 a[112:113], v9 offset:768
    v_cvt_pk_bf16_f32 v138, v152, v153
    v_mfma_f32_16x16x32_bf16 v[192:195], a[100:103], a[68:71], v[192:195]
    ds_read_b64_tr_b16 a[114:115], v9 offset:1792
    v_cvt_pk_bf16_f32 v139, v154, v155
    v_mfma_f32_16x16x32_bf16 v[196:199], a[100:103], a[76:79], v[196:199]
    ds_read_b64_tr_b16 a[116:117], v9 offset:8960
    buffer_load_dwordx4 v11, s[4:7], s40 offen offset:3072 sc1 lds
    v_accvgpr_write_b32 a160, v136
    v_mfma_f32_16x16x32_bf16 v[196:199], a[96:99], a[72:75], v[196:199]
    ds_read_b64_tr_b16 a[118:119], v9 offset:9984
    v_accvgpr_write_b32 a161, v137
    v_mfma_f32_16x16x32_bf16 v[200:203], a[96:99], a[80:83], v[200:203]
    s_add_u32 s40, s56, 36864
    v_accvgpr_write_b32 a162, v138
    v_accvgpr_write_b32 a163, v139
    v_cvt_pk_bf16_f32 v140, v140, v141
    v_cvt_pk_bf16_f32 v141, v142, v143
    v_cvt_pk_bf16_f32 v142, v156, v157
    v_mfma_f32_16x16x32_bf16 v[200:203], a[100:103], a[84:87], v[200:203]
    s_add_u32 m0, s41, 36864
    v_cvt_pk_bf16_f32 v143, v158, v159
    v_accvgpr_write_b32 a176, v140
    v_mfma_f32_16x16x32_bf16 v[204:207], a[100:103], a[92:95], v[204:207]
    buffer_load_dwordx4 v11, s[4:7], s40 offen offset:0 sc1 lds
    v_accvgpr_write_b32 a177, v141
    v_accvgpr_write_b32 a178, v142
    v_accvgpr_write_b32 a179, v143
    v_mfma_f32_16x16x32_bf16 v[204:207], a[96:99], a[88:91], v[204:207]
    s_lshl_b32 s101, s53, 10
    v_cvt_pk_bf16_f32 v160, v160, v161
    s_waitcnt lgkmcnt(4)
    v_mfma_f32_16x16x32_bf16 v[208:211], a[104:107], a[64:67], v[208:211]
    ds_read_b64_tr_b16 a[120:121], v10 offset:768
    v_cvt_pk_bf16_f32 v161, v162, v163
    v_mfma_f32_16x16x32_bf16 v[208:211], a[108:111], a[68:71], v[208:211]
    ds_read_b64_tr_b16 a[122:123], v10 offset:1792
    buffer_load_dwordx4 v11, s[4:7], s40 offen offset:1024 sc1 lds
    v_mfma_f32_16x16x32_bf16 v[212:215], a[108:111], a[76:79], v[212:215]
    ds_read_b64_tr_b16 a[124:125], v10 offset:8960
    v_cvt_pk_bf16_f32 v162, v176, v177
    v_mfma_f32_16x16x32_bf16 v[212:215], a[104:107], a[72:75], v[212:215]
    ds_read_b64_tr_b16 a[126:127], v10 offset:9984
    v_cvt_pk_bf16_f32 v163, v178, v179
    v_mfma_f32_16x16x32_bf16 v[216:219], a[104:107], a[80:83], v[216:219]
    s_add_u32 s17, s101, s39
    v_accvgpr_write_b32 a132, v160
    v_accvgpr_write_b32 a133, v161
    v_mfma_f32_16x16x32_bf16 v[216:219], a[108:111], a[84:87], v[216:219]
    buffer_load_dwordx4 v11, s[4:7], s40 offen offset:2048 sc1 lds
    v_mfma_f32_16x16x32_bf16 v[220:223], a[108:111], a[92:95], v[220:223]
    buffer_load_dwordx4 v11, s[4:7], s40 offen offset:3072 sc1 lds
    v_mfma_f32_16x16x32_bf16 v[220:223], a[104:107], a[88:91], v[220:223]
    s_add_u32 s41, s57, 98304
    s_and_b32 s41, s41, 0x1ffff
    s_waitcnt lgkmcnt(4)
    v_mfma_f32_16x16x32_bf16 v[224:227], a[112:115], a[64:67], v[224:227]
    s_add_u32 s40, s56, 98304
    ds_read_b64_tr_b16 a[96:97], v9 offset:2048
    v_mfma_f32_16x16x32_bf16 v[224:227], a[116:119], a[68:71], v[224:227]
    s_add_u32 m0, s41, 32768
    ds_read_b64_tr_b16 a[98:99], v9 offset:2560
    v_mfma_f32_16x16x32_bf16 v[228:231], a[116:119], a[76:79], v[228:231]
    ds_read_b64_tr_b16 a[100:101], v9 offset:10240
    v_accvgpr_write_b32 a134, v162
    v_mfma_f32_16x16x32_bf16 v[228:231], a[112:115], a[72:75], v[228:231]
    ds_read_b64_tr_b16 a[102:103], v9 offset:10752
    v_accvgpr_write_b32 a135, v163
    v_mfma_f32_16x16x32_bf16 v[232:235], a[112:115], a[80:83], v[232:235]
    buffer_load_dwordx4 v11, s[4:7], s40 offen offset:0 sc1 lds
    v_mfma_f32_16x16x32_bf16 v[232:235], a[116:119], a[84:87], v[232:235]
    s_add_u32 s21, s17, 131072
    v_cvt_pk_bf16_f32 v164, v164, v165
    v_cvt_pk_bf16_f32 v165, v166, v167
    v_mfma_f32_16x16x32_bf16 v[236:239], a[116:119], a[92:95], v[236:239]
    s_lshl_b32 s101, s54, 10
    v_cvt_pk_bf16_f32 v166, v180, v181
    v_cvt_pk_bf16_f32 v167, v182, v183
    v_mfma_f32_16x16x32_bf16 v[236:239], a[112:115], a[88:91], v[236:239]
    s_add_u32 s18, s101, s39
    v_accvgpr_write_b32 a148, v164
    s_waitcnt lgkmcnt(4)
    v_mfma_f32_16x16x32_bf16 v[240:243], a[120:123], a[64:67], v[240:243]
    ds_read_b64_tr_b16 a[104:105], v10 offset:2048
    v_accvgpr_write_b32 a149, v165
    v_accvgpr_write_b32 a150, v166
    v_mfma_f32_16x16x32_bf16 v[240:243], a[124:127], a[68:71], v[240:243]
    ds_read_b64_tr_b16 a[106:107], v10 offset:2560
    v_accvgpr_write_b32 a151, v167
    v_mfma_f32_16x16x32_bf16 v[244:247], a[124:127], a[76:79], v[244:247]
    ds_read_b64_tr_b16 a[108:109], v10 offset:10240
    v_cvt_pk_bf16_f32 v168, v168, v169
    v_mfma_f32_16x16x32_bf16 v[244:247], a[120:123], a[72:75], v[244:247]
    ds_read_b64_tr_b16 a[110:111], v10 offset:10752
    v_cvt_pk_bf16_f32 v169, v170, v171
    v_mfma_f32_16x16x32_bf16 v[248:251], a[120:123], a[80:83], v[248:251]
    buffer_load_dwordx4 v11, s[4:7], s40 offen offset:1024 sc1 lds
    v_cvt_pk_bf16_f32 v170, v184, v185
    v_mfma_f32_16x16x32_bf16 v[248:251], a[124:127], a[84:87], v[248:251]
    v_cvt_pk_bf16_f32 v171, v186, v187
    v_accvgpr_write_b32 a164, v168
    v_accvgpr_write_b32 a165, v169
    v_mfma_f32_16x16x32_bf16 v[252:255], a[124:127], a[92:95], v[252:255]
    s_add_u32 s22, s18, 131072
    v_accvgpr_write_b32 a166, v170
    v_accvgpr_write_b32 a167, v171
    v_mfma_f32_16x16x32_bf16 v[252:255], a[120:123], a[88:91], v[252:255]
    s_lshl_b32 s101, s55, 10
    v_cvt_pk_bf16_f32 v172, v172, v173
    s_waitcnt lgkmcnt(4)
    v_mfma_f32_16x16x32_bf16 v[48:51], a[96:99], a[64:67], v[48:51]
    ds_read_b64_tr_b16 a[112:113], v9 offset:2304
    buffer_load_dwordx4 v11, s[4:7], s40 offen offset:2048 sc1 lds
    v_mfma_f32_16x16x32_bf16 v[48:51], a[100:103], a[68:71], v[48:51]
    ds_read_b64_tr_b16 a[114:115], v9 offset:2816
    v_cvt_pk_bf16_f32 v173, v174, v175
    v_cvt_pk_bf16_f32 v174, v188, v189
    v_cvt_pk_bf16_f32 v175, v190, v191
    v_mfma_f32_16x16x32_bf16 v[52:55], a[100:103], a[76:79], v[52:55]
    ds_read_b64_tr_b16 a[116:117], v9 offset:10496
    v_accvgpr_write_b32 a180, v172
    v_mfma_f32_16x16x32_bf16 v[52:55], a[96:99], a[72:75], v[52:55]
    ds_read_b64_tr_b16 a[118:119], v9 offset:11008
    v_accvgpr_write_b32 a181, v173
    v_mfma_f32_16x16x32_bf16 v[56:59], a[96:99], a[80:83], v[56:59]
    buffer_load_dwordx4 v11, s[4:7], s40 offen offset:3072 sc1 lds
    v_mfma_f32_16x16x32_bf16 v[56:59], a[100:103], a[84:87], v[56:59]
    s_add_u32 s40, s56, 102400
    v_accvgpr_write_b32 a182, v174
    v_accvgpr_write_b32 a183, v175
    v_mfma_f32_16x16x32_bf16 v[60:63], a[100:103], a[92:95], v[60:63]
    s_add_u32 s19, s101, s39
    v_cvt_pk_bf16_f32 v192, v192, v193
    v_cvt_pk_bf16_f32 v193, v194, v195
    v_mfma_f32_16x16x32_bf16 v[60:63], a[96:99], a[88:91], v[60:63]
    s_add_u32 m0, s41, 36864
    v_cvt_pk_bf16_f32 v194, v208, v209
    v_cvt_pk_bf16_f32 v195, v210, v211
    s_waitcnt lgkmcnt(4)
    v_mfma_f32_16x16x32_bf16 v[80:83], a[104:107], a[64:67], v[80:83]
    ds_read_b64_tr_b16 a[120:121], v10 offset:2304
    buffer_load_dwordx4 v11, s[4:7], s40 offen offset:0 sc1 lds
    v_mfma_f32_16x16x32_bf16 v[80:83], a[108:111], a[68:71], v[80:83]
    ds_read_b64_tr_b16 a[122:123], v10 offset:2816
    v_accvgpr_write_b32 a136, v192
    v_accvgpr_write_b32 a137, v193
    v_mfma_f32_16x16x32_bf16 v[84:87], a[108:111], a[76:79], v[84:87]
    ds_read_b64_tr_b16 a[124:125], v10 offset:10496
    v_accvgpr_write_b32 a138, v194
    v_accvgpr_write_b32 a139, v195
    v_cvt_pk_bf16_f32 v196, v196, v197
    v_mfma_f32_16x16x32_bf16 v[84:87], a[104:107], a[72:75], v[84:87]
    ds_read_b64_tr_b16 a[126:127], v10 offset:11008
    v_cvt_pk_bf16_f32 v197, v198, v199
    v_cvt_pk_bf16_f32 v198, v212, v213
    v_mfma_f32_16x16x32_bf16 v[88:91], a[104:107], a[80:83], v[88:91]
    buffer_load_dwordx4 v11, s[4:7], s40 offen offset:1024 sc1 lds
    v_mfma_f32_16x16x32_bf16 v[88:91], a[108:111], a[84:87], v[88:91]
    v_cvt_pk_bf16_f32 v199, v214, v215
    v_accvgpr_write_b32 a152, v196
    v_accvgpr_write_b32 a153, v197
    v_accvgpr_write_b32 a154, v198
    v_mfma_f32_16x16x32_bf16 v[92:95], a[108:111], a[92:95], v[92:95]
    v_accvgpr_write_b32 a155, v199
    v_cvt_pk_bf16_f32 v200, v200, v201
    v_cvt_pk_bf16_f32 v201, v202, v203
    v_cvt_pk_bf16_f32 v202, v216, v217
    v_mfma_f32_16x16x32_bf16 v[92:95], a[104:107], a[88:91], v[92:95]
    s_waitcnt lgkmcnt(0)
    s_barrier
    v_mfma_f32_16x16x32_bf16 v[112:115], a[112:115], a[64:67], v[112:115]
    s_add_u32 s23, s19, 131072
    v_cvt_pk_bf16_f32 v203, v218, v219
    v_accvgpr_write_b32 a168, v200
    v_mfma_f32_16x16x32_bf16 v[112:115], a[116:119], a[68:71], v[112:115]
    v_accvgpr_write_b32 a169, v201
    v_accvgpr_write_b32 a170, v202
    v_mfma_f32_16x16x32_bf16 v[116:119], a[116:119], a[76:79], v[116:119]
    buffer_load_dwordx4 v11, s[4:7], s40 offen offset:2048 sc1 lds
    v_mfma_f32_16x16x32_bf16 v[116:119], a[112:115], a[72:75], v[116:119]
    v_accvgpr_write_b32 a171, v203
    v_cvt_pk_bf16_f32 v204, v204, v205
    v_cvt_pk_bf16_f32 v205, v206, v207
    v_mfma_f32_16x16x32_bf16 v[120:123], a[112:115], a[80:83], v[120:123]
    s_mov_b32 s0, 0x3fb8aa3b
    v_cvt_pk_bf16_f32 v206, v220, v221
    v_cvt_pk_bf16_f32 v207, v222, v223
    v_mfma_f32_16x16x32_bf16 v[120:123], a[116:119], a[84:87], v[120:123]
    buffer_load_dwordx4 v11, s[4:7], s40 offen offset:3072 sc1 lds
    v_accvgpr_write_b32 a184, v204
    v_accvgpr_write_b32 a185, v205
    v_accvgpr_write_b32 a186, v206
    v_accvgpr_write_b32 a187, v207
    v_cvt_pk_bf16_f32 v224, v224, v225
    v_cvt_pk_bf16_f32 v225, v226, v227
    v_mfma_f32_16x16x32_bf16 v[124:127], a[116:119], a[92:95], v[124:127]
    s_lshr_b32 s40, s36, 1
    s_lshl_b32 s40, s40, 1
    s_add_u32 s40, s40, s36
    v_cvt_pk_bf16_f32 v226, v240, v241
    v_mfma_f32_16x16x32_bf16 v[124:127], a[112:115], a[88:91], v[124:127]
    s_lshl_b32 s40, s40, 12
    s_add_u32 s40, s40, 8192
    v_cvt_pk_bf16_f32 v227, v242, v243
    v_accvgpr_write_b32 a140, v224
    v_mfma_f32_16x16x32_bf16 v[32:35], a[120:123], a[64:67], v[32:35]
    s_and_b32 s41, s57, 0x18000
    s_add_u32 s41, s41, s40
    v_accvgpr_write_b32 a141, v225
    v_accvgpr_write_b32 a142, v226
    v_accvgpr_write_b32 a143, v227
    v_cvt_pk_bf16_f32 v228, v228, v229
    v_cvt_pk_bf16_f32 v229, v230, v231
    v_cvt_pk_bf16_f32 v230, v244, v245
    v_mfma_f32_16x16x32_bf16 v[32:35], a[124:127], a[68:71], v[32:35]
    s_add_u32 m0, s41, 32768
    v_cvt_pk_bf16_f32 v231, v246, v247
    v_accvgpr_write_b32 a156, v228
    v_accvgpr_write_b32 a157, v229
    v_accvgpr_write_b32 a158, v230
    v_accvgpr_write_b32 a159, v231
    v_cvt_pk_bf16_f32 v232, v232, v233
    v_cvt_pk_bf16_f32 v233, v234, v235
    v_cvt_pk_bf16_f32 v234, v248, v249
    v_cvt_pk_bf16_f32 v235, v250, v251
    v_accvgpr_write_b32 a172, v232
    v_accvgpr_write_b32 a173, v233
    v_mfma_f32_16x16x32_bf16 v[36:39], a[124:127], a[76:79], v[36:39]
    buffer_load_dwordx4 v11, s[4:7], s40 offen offset:0 sc1 lds
    v_mfma_f32_16x16x32_bf16 v[36:39], a[120:123], a[72:75], v[36:39]
    s_mov_b32 s1, 0x3fb8aa3b
    v_accvgpr_write_b32 a174, v234
    v_accvgpr_write_b32 a175, v235
    v_mfma_f32_16x16x32_bf16 v[40:43], a[120:123], a[80:83], v[40:43]
    buffer_load_dwordx4 v11, s[4:7], s40 offen offset:1024 sc1 lds
    v_cvt_pk_bf16_f32 v236, v236, v237
    v_mfma_f32_16x16x32_bf16 v[40:43], a[124:127], a[84:87], v[40:43]
    buffer_load_dwordx4 v11, s[4:7], s40 offen offset:2048 sc1 lds
    v_cvt_pk_bf16_f32 v237, v238, v239
    v_cvt_pk_bf16_f32 v238, v252, v253
    v_cvt_pk_bf16_f32 v239, v254, v255
    v_accvgpr_write_b32 a188, v236
    v_mfma_f32_16x16x32_bf16 v[44:47], a[124:127], a[92:95], v[44:47]
    v_accvgpr_write_b32 a189, v237
    v_accvgpr_write_b32 a190, v238
    v_mfma_f32_16x16x32_bf16 v[44:47], a[120:123], a[88:91], v[44:47]
    buffer_load_dwordx4 v11, s[4:7], s40 offen offset:3072 sc1 lds
    v_accvgpr_write_b32 a191, v239
    s_waitcnt vmcnt(20)
    v_max3_u32 v14, v16, v18, v20
    v_max_u32 v14, v14, v22
    v_cmp_eq_u32 vcc, -1, v14
    s_nop 0
    s_cmp_eq_u64 vcc, 0
    s_cbranch_scc1 L_gw_ok
L_gw_no:
    s_mov_b32 s39, 0x40000
L_gw_spin:
    s_lshl_b32 s40, s52, 6
    s_add_u32 s40, s40, 83886080
    buffer_load_dword v16, v30, s[28:31], s40 offen sc1
    s_lshl_b32 s40, s53, 6
    s_add_u32 s40, s40, 83886080
    buffer_load_dword v18, v30, s[28:31], s40 offen sc1
    s_lshl_b32 s40, s54, 6
    s_add_u32 s40, s40, 83886080
    buffer_load_dword v20, v30, s[28:31], s40 offen sc1
    s_lshl_b32 s40, s55, 6
    s_add_u32 s40, s40, 83886080
    buffer_load_dword v22, v30, s[28:31], s40 offen sc1
    s_waitcnt vmcnt(0)
    v_max3_u32 v14, v16, v18, v20
    v_max_u32 v14, v14, v22
    v_cmp_eq_u32 vcc, -1, v14
    s_nop 0
    s_cmp_eq_u64 vcc, 0
    s_cbranch_scc1 L_gw_ok
L_gw_again:
    s_sleep 4
    s_sub_u32 s39, s39, 1
    s_cmp_lg_u32 s39, 0
    s_cbranch_scc1 L_gw_spin
L_gw_ok:
    v_mov_b32 v8, v16
    v_mov_b32 v9, v18
    v_mov_b32 v10, v20
    v_mov_b32 v12, v22
    v_sub_f32 v16, 1.0, v16
    v_sub_f32 v18, 1.0, v18
    v_sub_f32 v20, 1.0, v20
    v_sub_f32 v22, 1.0, v22
    s_cmp_lt_u32 s94, 54
    s_cbranch_scc1 L_act
    s_add_u32 s41, s57, 65536
    s_and_b32 s41, s41, 0x1ffff
    s_add_u32 s40, s56, 65536
    s_add_u32 m0, s41, 32768
    s_nop 0
    buffer_load_dwordx4 v11, s[4:7], s40 offen offset:0 sc1 lds
    buffer_load_dwordx4 v11, s[4:7], s40 offen offset:1024 sc1 lds
    buffer_load_dwordx4 v11, s[4:7], s40 offen offset:2048 sc1 lds
    buffer_load_dwordx4 v11, s[4:7], s40 offen offset:3072 sc1 lds
    s_add_u32 s40, s56, 69632
    s_add_u32 m0, s41, 36864
    s_nop 0
    buffer_load_dwordx4 v11, s[4:7], s40 offen offset:0 sc1 lds
    buffer_load_dwordx4 v11, s[4:7], s40 offen offset:1024 sc1 lds
    buffer_load_dwordx4 v11, s[4:7], s40 offen offset:2048 sc1 lds
    buffer_load_dwordx4 v11, s[4:7], s40 offen offset:3072 sc1 lds
    s_add_u32 s56, s56, 131072
    s_branch L_noact
L_act:
    v_pk_mul_f32 v[64:65], v[48:49], s[0:1]
    v_pk_mul_f32 v[66:67], v[50:51], s[0:1]
    v_pk_mul_f32 v[68:69], v[80:81], s[0:1]
    v_pk_mul_f32 v[70:71], v[82:83], s[0:1]
    v_pk_mul_f32 v[48:49], v[48:49], v[16:17] op_sel_hi:[1,0]
    v_pk_mul_f32 v[50:51], v[50:51], v[16:17] op_sel_hi:[1,0]
    v_pk_mul_f32 v[80:81], v[80:81], v[16:17] op_sel_hi:[1,0]
    v_pk_mul_f32 v[82:83], v[82:83], v[16:17] op_sel_hi:[1,0]
    v_exp_f32 v64, v64
    v_exp_f32 v65, v65
    v_exp_f32 v66, v66
    v_exp_f32 v67, v67
    v_exp_f32 v68, v68
    v_exp_f32 v69, v69
    v_exp_f32 v70, v70
    v_exp_f32 v71, v71
    v_pk_fma_f32 v[72:73], v[64:65], 0.5, 1.0 op_sel_hi:[1,0,0]
    v_pk_fma_f32 v[74:75], v[66:67], 0.5, 1.0 op_sel_hi:[1,0,0]
    v_pk_fma_f32 v[76:77], v[68:69], 0.5, 1.0 op_sel_hi:[1,0,0]
    v_pk_fma_f32 v[78:79], v[70:71], 0.5, 1.0 op_sel_hi:[1,0,0]
    v_pk_fma_f32 v[72:73], v[64:65], v[72:73], 1.0 op_sel_hi:[1,1,0]
    v_pk_fma_f32 v[74:75], v[66:67], v[74:75], 1.0 op_sel_hi:[1,1,0]
    v_pk_fma_f32 v[76:77], v[68:69], v[76:77], 1.0 op_sel_hi:[1,1,0]
    v_pk_fma_f32 v[78:79], v[70:71], v[78:79], 1.0 op_sel_hi:[1,1,0]
    v_rcp_f32 v72, v72
    s_add_u32 s41, s57, 65536
    s_and_b32 s41, s41, 0x1ffff
    s_add_u32 s40, s56, 65536
    s_add_u32 m0, s41, 32768
    s_nop 0
    buffer_load_dwordx4 v11, s[4:7], s40 offen offset:0 sc1 lds
    buffer_load_dwordx4 v11, s[4:7], s40 offen offset:1024 sc1 lds
    v_rcp_f32 v73, v73
    v_rcp_f32 v74, v74
    v_rcp_f32 v75, v75
    v_rcp_f32 v76, v76
    v_rcp_f32 v77, v77
    v_rcp_f32 v78, v78
    v_rcp_f32 v79, v79
    v_pk_fma_f32 v[48:49], v[48:49], v[72:73], v[48:49] neg_lo:[1,0,0] neg_hi:[1,0,0]
    v_pk_fma_f32 v[50:51], v[50:51], v[74:75], v[50:51] neg_lo:[1,0,0] neg_hi:[1,0,0]
    v_pk_fma_f32 v[80:81], v[80:81], v[76:77], v[80:81] neg_lo:[1,0,0] neg_hi:[1,0,0]
    v_pk_fma_f32 v[82:83], v[82:83], v[78:79], v[82:83] neg_lo:[1,0,0] neg_hi:[1,0,0]
    v_cvt_pk_bf16_f32 v48, v48, v49
    v_cvt_pk_bf16_f32 v49, v50, v51
    v_cvt_pk_bf16_f32 v50, v80, v81
    v_cvt_pk_bf16_f32 v51, v82, v83
    buffer_store_dwordx4 v[48:51], v11, s[28:31], s16 offen sc1
    v_pk_mul_f32 v[64:65], v[52:53], s[0:1]
    v_pk_mul_f32 v[66:67], v[54:55], s[0:1]
    v_pk_mul_f32 v[68:69], v[84:85], s[0:1]
    v_pk_mul_f32 v[70:71], v[86:87], s[0:1]
    v_pk_mul_f32 v[52:53], v[52:53], v[18:19] op_sel_hi:[1,0]
    v_pk_mul_f32 v[54:55], v[54:55], v[18:19] op_sel_hi:[1,0]
    v_pk_mul_f32 v[84:85], v[84:85], v[18:19] op_sel_hi:[1,0]
    v_pk_mul_f32 v[86:87], v[86:87], v[18:19] op_sel_hi:[1,0]
    v_exp_f32 v64, v64
    v_exp_f32 v65, v65
    v_exp_f32 v66, v66
    v_exp_f32 v67, v67
    v_exp_f32 v68, v68
    v_exp_f32 v69, v69
    v_exp_f32 v70, v70
    v_exp_f32 v71, v71
    v_pk_fma_f32 v[72:73], v[64:65], 0.5, 1.0 op_sel_hi:[1,0,0]
    v_pk_fma_f32 v[74:75], v[66:67], 0.5, 1.0 op_sel_hi:[1,0,0]
    v_pk_fma_f32 v[76:77], v[68:69], 0.5, 1.0 op_sel_hi:[1,0,0]
    v_pk_fma_f32 v[78:79], v[70:71], 0.5, 1.0 op_sel_hi:[1,0,0]
    v_pk_fma_f32 v[72:73], v[64:65], v[72:73], 1.0 op_sel_hi:[1,1,0]
    v_pk_fma_f32 v[74:75], v[66:67], v[74:75], 1.0 op_sel_hi:[1,1,0]
    v_pk_fma_f32 v[76:77], v[68:69], v[76:77], 1.0 op_sel_hi:[1,1,0]
    v_pk_fma_f32 v[78:79], v[70:71], v[78:79], 1.0 op_sel_hi:[1,1,0]
    v_rcp_f32 v72, v72
    buffer_load_dwordx4 v11, s[4:7], s40 offen offset:2048 sc1 lds
    buffer_load_dwordx4 v11, s[4:7], s40 offen offset:3072 sc1 lds
    v_rcp_f32 v73, v73
    v_rcp_f32 v74, v74
    v_rcp_f32 v75, v75
    v_rcp_f32 v76, v76
    v_rcp_f32 v77, v77
    v_rcp_f32 v78, v78
    v_rcp_f32 v79, v79
    v_pk_fma_f32 v[52:53], v[52:53], v[72:73], v[52:53] neg_lo:[1,0,0] neg_hi:[1,0,0]
    v_pk_fma_f32 v[54:55], v[54:55], v[74:75], v[54:55] neg_lo:[1,0,0] neg_hi:[1,0,0]
    v_pk_fma_f32 v[84:85], v[84:85], v[76:77], v[84:85] neg_lo:[1,0,0] neg_hi:[1,0,0]
    v_pk_fma_f32 v[86:87], v[86:87], v[78:79], v[86:87] neg_lo:[1,0,0] neg_hi:[1,0,0]
    v_cvt_pk_bf16_f32 v52, v52, v53
    v_cvt_pk_bf16_f32 v53, v54, v55
    v_cvt_pk_bf16_f32 v54, v84, v85
    v_cvt_pk_bf16_f32 v55, v86, v87
    buffer_store_dwordx4 v[52:55], v11, s[28:31], s17 offen sc1
    v_pk_mul_f32 v[64:65], v[56:57], s[0:1]
    v_pk_mul_f32 v[66:67], v[58:59], s[0:1]
    v_pk_mul_f32 v[68:69], v[88:89], s[0:1]
    v_pk_mul_f32 v[70:71], v[90:91], s[0:1]
    v_pk_mul_f32 v[56:57], v[56:57], v[20:21] op_sel_hi:[1,0]
    v_pk_mul_f32 v[58:59], v[58:59], v[20:21] op_sel_hi:[1,0]
    v_pk_mul_f32 v[88:89], v[88:89], v[20:21] op_sel_hi:[1,0]
    v_pk_mul_f32 v[90:91], v[90:91], v[20:21] op_sel_hi:[1,0]
    v_exp_f32 v64, v64
    v_exp_f32 v65, v65
    v_exp_f32 v66, v66
    v_exp_f32 v67, v67
    v_exp_f32 v68, v68
    v_exp_f32 v69, v69
    v_exp_f32 v70, v70
    v_exp_f32 v71, v71
    v_pk_fma_f32 v[72:73], v[64:65], 0.5, 1.0 op_sel_hi:[1,0,0]
    v_pk_fma_f32 v[74:75], v[66:67], 0.5, 1.0 op_sel_hi:[1,0,0]
    v_pk_fma_f32 v[76:77], v[68:69], 0.5, 1.0 op_sel_hi:[1,0,0]
    v_pk_fma_f32 v[78:79], v[70:71], 0.5, 1.0 op_sel_hi:[1,0,0]
    v_pk_fma_f32 v[72:73], v[64:65], v[72:73], 1.0 op_sel_hi:[1,1,0]
    v_pk_fma_f32 v[74:75], v[66:67], v[74:75], 1.0 op_sel_hi:[1,1,0]
    v_pk_fma_f32 v[76:77], v[68:69], v[76:77], 1.0 op_sel_hi:[1,1,0]
    v_pk_fma_f32 v[78:79], v[70:71], v[78:79], 1.0 op_sel_hi:[1,1,0]
    v_rcp_f32 v72, v72
    s_add_u32 s40, s56, 69632
    s_add_u32 m0, s41, 36864
    s_nop 0
    buffer_load_dwordx4 v11, s[4:7], s40 offen offset:0 sc1 lds
    buffer_load_dwordx4 v11, s[4:7], s40 offen offset:1024 sc1 lds
    v_rcp_f32 v73, v73
    v_rcp_f32 v74, v74
    v_rcp_f32 v75, v75
    v_rcp_f32 v76, v76
    v_rcp_f32 v77, v77
    v_rcp_f32 v78, v78
    v_rcp_f32 v79, v79
    v_pk_fma_f32 v[56:57], v[56:57], v[72:73], v[56:57] neg_lo:[1,0,0] neg_hi:[1,0,0]
    v_pk_fma_f32 v[58:59], v[58:59], v[74:75], v[58:59] neg_lo:[1,0,0] neg_hi:[1,0,0]
    v_pk_fma_f32 v[88:89], v[88:89], v[76:77], v[88:89] neg_lo:[1,0,0] neg_hi:[1,0,0]
    v_pk_fma_f32 v[90:91], v[90:91], v[78:79], v[90:91] neg_lo:[1,0,0] neg_hi:[1,0,0]
    v_cvt_pk_bf16_f32 v56, v56, v57
    v_cvt_pk_bf16_f32 v57, v58, v59
    v_cvt_pk_bf16_f32 v58, v88, v89
    v_cvt_pk_bf16_f32 v59, v90, v91
    buffer_store_dwordx4 v[56:59], v11, s[28:31], s18 offen sc1
    v_pk_mul_f32 v[64:65], v[60:61], s[0:1]
    v_pk_mul_f32 v[66:67], v[62:63], s[0:1]
    v_pk_mul_f32 v[68:69], v[92:93], s[0:1]
    v_pk_mul_f32 v[70:71], v[94:95], s[0:1]
    v_pk_mul_f32 v[60:61], v[60:61], v[22:23] op_sel_hi:[1,0]
    v_pk_mul_f32 v[62:63], v[62:63], v[22:23] op_sel_hi:[1,0]
    v_pk_mul_f32 v[92:93], v[92:93], v[22:23] op_sel_hi:[1,0]
    v_pk_mul_f32 v[94:95], v[94:95], v[22:23] op_sel_hi:[1,0]
    v_exp_f32 v64, v64
    v_exp_f32 v65, v65
    v_exp_f32 v66, v66
    v_exp_f32 v67, v67
    v_exp_f32 v68, v68
    v_exp_f32 v69, v69
    v_exp_f32 v70, v70
    v_exp_f32 v71, v71
    v_pk_fma_f32 v[72:73], v[64:65], 0.5, 1.0 op_sel_hi:[1,0,0]
    v_pk_fma_f32 v[74:75], v[66:67], 0.5, 1.0 op_sel_hi:[1,0,0]
    v_pk_fma_f32 v[76:77], v[68:69], 0.5, 1.0 op_sel_hi:[1,0,0]
    v_pk_fma_f32 v[78:79], v[70:71], 0.5, 1.0 op_sel_hi:[1,0,0]
    v_pk_fma_f32 v[72:73], v[64:65], v[72:73], 1.0 op_sel_hi:[1,1,0]
    v_pk_fma_f32 v[74:75], v[66:67], v[74:75], 1.0 op_sel_hi:[1,1,0]
    v_pk_fma_f32 v[76:77], v[68:69], v[76:77], 1.0 op_sel_hi:[1,1,0]
    v_pk_fma_f32 v[78:79], v[70:71], v[78:79], 1.0 op_sel_hi:[1,1,0]
    v_rcp_f32 v72, v72
    buffer_load_dwordx4 v11, s[4:7], s40 offen offset:2048 sc1 lds
    buffer_load_dwordx4 v11, s[4:7], s40 offen offset:3072 sc1 lds
    v_rcp_f32 v73, v73
    v_rcp_f32 v74, v74
    v_rcp_f32 v75, v75
    v_rcp_f32 v76, v76
    v_rcp_f32 v77, v77
    v_rcp_f32 v78, v78
    v_rcp_f32 v79, v79
    v_pk_fma_f32 v[60:61], v[60:61], v[72:73], v[60:61] neg_lo:[1,0,0] neg_hi:[1,0,0]
    v_pk_fma_f32 v[62:63], v[62:63], v[74:75], v[62:63] neg_lo:[1,0,0] neg_hi:[1,0,0]
    v_pk_fma_f32 v[92:93], v[92:93], v[76:77], v[92:93] neg_lo:[1,0,0] neg_hi:[1,0,0]
    v_pk_fma_f32 v[94:95], v[94:95], v[78:79], v[94:95] neg_lo:[1,0,0] neg_hi:[1,0,0]
    v_cvt_pk_bf16_f32 v60, v60, v61
    v_cvt_pk_bf16_f32 v61, v62, v63
    v_cvt_pk_bf16_f32 v62, v92, v93
    v_cvt_pk_bf16_f32 v63, v94, v95
    buffer_store_dwordx4 v[60:63], v11, s[28:31], s19 offen sc1
    s_add_u32 s56, s56, 131072
    s_cmp_ge_u32 s94, 46
    s_cbranch_scc1 L_noact
    v_pk_mul_f32 v[64:65], v[112:113], s[0:1]
    v_pk_mul_f32 v[66:67], v[114:115], s[0:1]
    v_pk_mul_f32 v[68:69], v[32:33], s[0:1]
    v_pk_mul_f32 v[70:71], v[34:35], s[0:1]
    v_pk_mul_f32 v[112:113], v[112:113], v[16:17] op_sel_hi:[1,0]
    v_pk_mul_f32 v[114:115], v[114:115], v[16:17] op_sel_hi:[1,0]
    v_pk_mul_f32 v[32:33], v[32:33], v[16:17] op_sel_hi:[1,0]
    v_pk_mul_f32 v[34:35], v[34:35], v[16:17] op_sel_hi:[1,0]
    v_exp_f32 v64, v64
    v_exp_f32 v65, v65
    v_exp_f32 v66, v66
    v_exp_f32 v67, v67
    v_exp_f32 v68, v68
    v_exp_f32 v69, v69
    v_exp_f32 v70, v70
    v_exp_f32 v71, v71
    v_pk_fma_f32 v[72:73], v[64:65], 0.5, 1.0 op_sel_hi:[1,0,0]
    v_pk_fma_f32 v[74:75], v[66:67], 0.5, 1.0 op_sel_hi:[1,0,0]
    v_pk_fma_f32 v[76:77], v[68:69], 0.5, 1.0 op_sel_hi:[1,0,0]
    v_pk_fma_f32 v[78:79], v[70:71], 0.5, 1.0 op_sel_hi:[1,0,0]
    v_pk_fma_f32 v[72:73], v[64:65], v[72:73], 1.0 op_sel_hi:[1,1,0]
    v_pk_fma_f32 v[74:75], v[66:67], v[74:75], 1.0 op_sel_hi:[1,1,0]
    v_pk_fma_f32 v[76:77], v[68:69], v[76:77], 1.0 op_sel_hi:[1,1,0]
    v_pk_fma_f32 v[78:79], v[70:71], v[78:79], 1.0 op_sel_hi:[1,1,0]
    v_rcp_f32 v72, v72
    v_rcp_f32 v73, v73
    v_rcp_f32 v74, v74
    v_rcp_f32 v75, v75
    v_rcp_f32 v76, v76
    v_rcp_f32 v77, v77
    v_rcp_f32 v78, v78
    v_rcp_f32 v79, v79
    v_pk_fma_f32 v[112:113], v[112:113], v[72:73], v[112:113] neg_lo:[1,0,0] neg_hi:[1,0,0]
    v_pk_fma_f32 v[114:115], v[114:115], v[74:75], v[114:115] neg_lo:[1,0,0] neg_hi:[1,0,0]
    v_pk_fma_f32 v[32:33], v[32:33], v[76:77], v[32:33] neg_lo:[1,0,0] neg_hi:[1,0,0]
    v_pk_fma_f32 v[34:35], v[34:35], v[78:79], v[34:35] neg_lo:[1,0,0] neg_hi:[1,0,0]
    v_cvt_pk_bf16_f32 v112, v112, v113
    v_cvt_pk_bf16_f32 v113, v114, v115
    v_cvt_pk_bf16_f32 v114, v32, v33
    v_cvt_pk_bf16_f32 v115, v34, v35
    buffer_store_dwordx4 v[112:115], v11, s[28:31], s20 offen sc1
    v_pk_mul_f32 v[64:65], v[116:117], s[0:1]
    v_pk_mul_f32 v[66:67], v[118:119], s[0:1]
    v_pk_mul_f32 v[68:69], v[36:37], s[0:1]
    v_pk_mul_f32 v[70:71], v[38:39], s[0:1]
    v_pk_mul_f32 v[116:117], v[116:117], v[18:19] op_sel_hi:[1,0]
    v_pk_mul_f32 v[118:119], v[118:119], v[18:19] op_sel_hi:[1,0]
    v_pk_mul_f32 v[36:37], v[36:37], v[18:19] op_sel_hi:[1,0]
    v_pk_mul_f32 v[38:39], v[38:39], v[18:19] op_sel_hi:[1,0]
    v_exp_f32 v64, v64
    v_exp_f32 v65, v65
    v_exp_f32 v66, v66
    v_exp_f32 v67, v67
    v_exp_f32 v68, v68
    v_exp_f32 v69, v69
    v_exp_f32 v70, v70
    v_exp_f32 v71, v71
    v_pk_fma_f32 v[72:73], v[64:65], 0.5, 1.0 op_sel_hi:[1,0,0]
    v_pk_fma_f32 v[74:75], v[66:67], 0.5, 1.0 op_sel_hi:[1,0,0]
    v_pk_fma_f32 v[76:77], v[68:69], 0.5, 1.0 op_sel_hi:[1,0,0]
    v_pk_fma_f32 v[78:79], v[70:71], 0.5, 1.0 op_sel_hi:[1,0,0]
    v_pk_fma_f32 v[72:73], v[64:65], v[72:73], 1.0 op_sel_hi:[1,1,0]
    v_pk_fma_f32 v[74:75], v[66:67], v[74:75], 1.0 op_sel_hi:[1,1,0]
    v_pk_fma_f32 v[76:77], v[68:69], v[76:77], 1.0 op_sel_hi:[1,1,0]
    v_pk_fma_f32 v[78:79], v[70:71], v[78:79], 1.0 op_sel_hi:[1,1,0]
    v_rcp_f32 v72, v72
    v_rcp_f32 v73, v73
    v_rcp_f32 v74, v74
    v_rcp_f32 v75, v75
    v_rcp_f32 v76, v76
    v_rcp_f32 v77, v77
    v_rcp_f32 v78, v78
    v_rcp_f32 v79, v79
    v_pk_fma_f32 v[116:117], v[116:117], v[72:73], v[116:117] neg_lo:[1,0,0] neg_hi:[1,0,0]
    v_pk_fma_f32 v[118:119], v[118:119], v[74:75], v[118:119] neg_lo:[1,0,0] neg_hi:[1,0,0]
L_ws_5578:
    s_cbranch_execz L_wr_a
    v_pk_fma_f32 v[36:37], v[36:37], v[76:77], v[36:37] neg_lo:[1,0,0] neg_hi:[1,0,0]
    v_pk_fma_f32 v[38:39], v[38:39], v[78:79], v[38:39] neg_lo:[1,0,0] neg_hi:[1,0,0]
    v_cvt_pk_bf16_f32 v116, v116, v117
    v_cvt_pk_bf16_f32 v117, v118, v119
    v_cvt_pk_bf16_f32 v118, v36, v37
    v_cvt_pk_bf16_f32 v119, v38, v39
    buffer_store_dwordx4 v[116:119], v11, s[28:31], s21 offen sc1
    v_pk_mul_f32 v[64:65], v[120:121], s[0:1]
    v_pk_mul_f32 v[66:67], v[122:123], s[0:1]
    v_pk_mul_f32 v[68:69], v[40:41], s[0:1]
    v_pk_mul_f32 v[70:71], v[42:43], s[0:1]
    v_pk_mul_f32 v[120:121], v[120:121], v[20:21] op_sel_hi:[1,0]
    v_pk_mul_f32 v[122:123], v[122:123], v[20:21] op_sel_hi:[1,0]
    v_pk_mul_f32 v[40:41], v[40:41], v[20:21] op_sel_hi:[1,0]
    v_pk_mul_f32 v[42:43], v[42:43], v[20:21] op_sel_hi:[1,0]
    v_exp_f32 v64, v64
    v_exp_f32 v65, v65
    v_exp_f32 v66, v66
    v_exp_f32 v67, v67
    v_exp_f32 v68, v68
    v_exp_f32 v69, v69
    v_exp_f32 v70, v70
    v_exp_f32 v71, v71
    v_pk_fma_f32 v[72:73], v[64:65], 0.5, 1.0 op_sel_hi:[1,0,0]
    v_pk_fma_f32 v[74:75], v[66:67], 0.5, 1.0 op_sel_hi:[1,0,0]
    v_pk_fma_f32 v[76:77], v[68:69], 0.5, 1.0 op_sel_hi:[1,0,0]
    v_pk_fma_f32 v[78:79], v[70:71], 0.5, 1.0 op_sel_hi:[1,0,0]
    v_pk_fma_f32 v[72:73], v[64:65], v[72:73], 1.0 op_sel_hi:[1,1,0]
    v_pk_fma_f32 v[74:75], v[66:67], v[74:75], 1.0 op_sel_hi:[1,1,0]
    v_pk_fma_f32 v[76:77], v[68:69], v[76:77], 1.0 op_sel_hi:[1,1,0]
    v_pk_fma_f32 v[78:79], v[70:71], v[78:79], 1.0 op_sel_hi:[1,1,0]
    v_rcp_f32 v72, v72
    v_rcp_f32 v73, v73
    v_rcp_f32 v74, v74
    v_rcp_f32 v75, v75
    v_rcp_f32 v76, v76
    v_rcp_f32 v77, v77
    v_rcp_f32 v78, v78
    v_rcp_f32 v79, v79
    v_pk_fma_f32 v[120:121], v[120:121], v[72:73], v[120:121] neg_lo:[1,0,0] neg_hi:[1,0,0]
    v_pk_fma_f32 v[122:123], v[122:123], v[74:75], v[122:123] neg_lo:[1,0,0] neg_hi:[1,0,0]
    v_pk_fma_f32 v[40:41], v[40:41], v[76:77], v[40:41] neg_lo:[1,0,0] neg_hi:[1,0,0]
    v_pk_fma_f32 v[42:43], v[42:43], v[78:79], v[42:43] neg_lo:[1,0,0] neg_hi:[1,0,0]
    v_cvt_pk_bf16_f32 v120, v120, v121
    v_cvt_pk_bf16_f32 v121, v122, v123
    v_cvt_pk_bf16_f32 v122, v40, v41
    v_cvt_pk_bf16_f32 v123, v42, v43
    buffer_store_dwordx4 v[120:123], v11, s[28:31], s22 offen sc1
    v_pk_mul_f32 v[64:65], v[124:125], s[0:1]
    v_pk_mul_f32 v[66:67], v[126:127], s[0:1]
    v_pk_mul_f32 v[68:69], v[44:45], s[0:1]
    v_pk_mul_f32 v[70:71], v[46:47], s[0:1]
    v_pk_mul_f32 v[124:125], v[124:125], v[22:23] op_sel_hi:[1,0]
    v_pk_mul_f32 v[126:127], v[126:127], v[22:23] op_sel_hi:[1,0]
    v_pk_mul_f32 v[44:45], v[44:45], v[22:23] op_sel_hi:[1,0]
    v_pk_mul_f32 v[46:47], v[46:47], v[22:23] op_sel_hi:[1,0]
    v_exp_f32 v64, v64
    v_exp_f32 v65, v65
    v_exp_f32 v66, v66
    v_exp_f32 v67, v67
    v_exp_f32 v68, v68
    v_exp_f32 v69, v69
    v_exp_f32 v70, v70
    v_exp_f32 v71, v71
    v_pk_fma_f32 v[72:73], v[64:65], 0.5, 1.0 op_sel_hi:[1,0,0]
    v_pk_fma_f32 v[74:75], v[66:67], 0.5, 1.0 op_sel_hi:[1,0,0]
    v_pk_fma_f32 v[76:77], v[68:69], 0.5, 1.0 op_sel_hi:[1,0,0]
    v_pk_fma_f32 v[78:79], v[70:71], 0.5, 1.0 op_sel_hi:[1,0,0]
    v_pk_fma_f32 v[72:73], v[64:65], v[72:73], 1.0 op_sel_hi:[1,1,0]
    v_pk_fma_f32 v[74:75], v[66:67], v[74:75], 1.0 op_sel_hi:[1,1,0]
    v_pk_fma_f32 v[76:77], v[68:69], v[76:77], 1.0 op_sel_hi:[1,1,0]
    v_pk_fma_f32 v[78:79], v[70:71], v[78:79], 1.0 op_sel_hi:[1,1,0]
    v_rcp_f32 v72, v72
    v_rcp_f32 v73, v73
    v_rcp_f32 v74, v74
    v_rcp_f32 v75, v75
    v_rcp_f32 v76, v76
    v_rcp_f32 v77, v77
    v_rcp_f32 v78, v78
    v_rcp_f32 v79, v79
    v_pk_fma_f32 v[124:125], v[124:125], v[72:73], v[124:125] neg_lo:[1,0,0] neg_hi:[1,0,0]
    v_pk_fma_f32 v[126:127], v[126:127], v[74:75], v[126:127] neg_lo:[1,0,0] neg_hi:[1,0,0]
    v_pk_fma_f32 v[44:45], v[44:45], v[76:77], v[44:45] neg_lo:[1,0,0] neg_hi:[1,0,0]
    v_pk_fma_f32 v[46:47], v[46:47], v[78:79], v[46:47] neg_lo:[1,0,0] neg_hi:[1,0,0]
    v_cvt_pk_bf16_f32 v124, v124, v125
    v_cvt_pk_bf16_f32 v125, v126, v127
    v_cvt_pk_bf16_f32 v126, v44, v45
    v_cvt_pk_bf16_f32 v127, v46, v47
    buffer_store_dwordx4 v[124:127], v11, s[28:31], s23 offen sc1
L_noact:
    s_waitcnt vmcnt(8)
    s_barrier
    ds_read_b128 a[0:3], v2 offset:40960
    ds_read_b128 a[4:7], v2 offset:41984
    ds_read_b128 a[8:11], v2 offset:43008
    ds_read_b128 a[12:15], v2 offset:44032
    ds_read_b128 a[16:19], v2 offset:45056
    ds_read_b128 a[20:23], v2 offset:46080
    ds_read_b128 a[24:27], v2 offset:47104
    ds_read_b128 a[28:31], v2 offset:48128
    s_waitcnt lgkmcnt(4)
    v_mfma_f32_16x16x32_bf16 v[32:35], a[0:3], a[128:131], v[96:99]
    v_accvgpr_write_b32 a80, v104
    v_accvgpr_write_b32 a81, v104
    v_mfma_f32_16x16x32_bf16 v[32:35], a[4:7], a[132:135], v[32:35]
    v_accvgpr_write_b32 a82, v104
    v_accvgpr_write_b32 a83, v104
    v_mfma_f32_16x16x32_bf16 v[32:35], a[8:11], a[136:139], v[32:35]
    v_accvgpr_write_b32 a72, v105
    v_accvgpr_write_b32 a73, v105
    v_mfma_f32_16x16x32_bf16 v[32:35], a[12:15], a[140:143], v[32:35]
    v_accvgpr_write_b32 a74, v105
    v_mfma_f32_16x16x32_bf16 v[36:39], a[0:3], a[144:147], 0
    v_accvgpr_write_b32 a75, v105
    v_accvgpr_write_b32 a64, 0
    v_mfma_f32_16x16x32_bf16 v[36:39], a[4:7], a[148:151], v[36:39]
    v_accvgpr_write_b32 a65, 0
    v_accvgpr_write_b32 a66, 0
    v_mfma_f32_16x16x32_bf16 v[36:39], a[8:11], a[152:155], v[36:39]
    v_accvgpr_write_b32 a67, 0
    v_accvgpr_write_b32 a68, 0
    v_mfma_f32_16x16x32_bf16 v[36:39], a[12:15], a[156:159], v[36:39]
    v_accvgpr_write_b32 a69, 0
    v_accvgpr_write_b32 a70, 0
    v_mfma_f32_16x16x32_bf16 v[40:43], a[0:3], a[160:163], 0
    v_accvgpr_write_b32 a71, 0
    v_mov_b32 v7, 1
    v_mfma_f32_16x16x32_bf16 v[40:43], a[4:7], a[164:167], v[40:43]
    v_accvgpr_write_b32 a84, v28
    v_accvgpr_write_b32 a85, v26
    v_mfma_f32_16x16x32_bf16 v[40:43], a[8:11], a[168:171], v[40:43]
    v_accvgpr_write_b32 a86, v19
    v_mfma_f32_16x16x32_bf16 v[40:43], a[12:15], a[172:175], v[40:43]
    v_max3_f32 v96, v32, v33, v34
    v_max_f32 v96, v96, v35
    v_mfma_f32_16x16x32_bf16 v[44:47], a[0:3], a[176:179], 0
    v_mov_b32 v97, v96
    v_mfma_f32_16x16x32_bf16 v[44:47], a[4:7], a[180:183], v[44:47]
    v_mfma_f32_16x16x32_bf16 v[44:47], a[8:11], a[184:187], v[44:47]
    v_permlane16_swap_b32 v96, v97
    v_mfma_f32_16x16x32_bf16 v[44:47], a[12:15], a[188:191], v[44:47]
    s_waitcnt lgkmcnt(0)
    v_mfma_f32_16x16x32_bf16 v[48:51], a[16:19], a[128:131], v[100:103]
    ds_read_b128 a[0:3], v2 offset:57344
    ds_read_b128 a[4:7], v2 offset:58368
    v_mfma_f32_16x16x32_bf16 v[48:51], a[20:23], a[132:135], v[48:51]
    v_max_f32 v96, v96, v97
    v_mov_b32 v97, v96
    v_mfma_f32_16x16x32_bf16 v[48:51], a[24:27], a[136:139], v[48:51]
    ds_read_b128 a[8:11], v2 offset:59392
    ds_read_b128 a[12:15], v2 offset:60416
    v_mfma_f32_16x16x32_bf16 v[48:51], a[28:31], a[140:143], v[48:51]
    v_max3_f32 v104, v40, v41, v42
    v_max_f32 v104, v104, v43
    v_mfma_f32_16x16x32_bf16 v[52:55], a[16:19], a[144:147], 0
    v_max3_f32 v100, v36, v37, v38
    v_mov_b32 v105, v104
    v_mfma_f32_16x16x32_bf16 v[52:55], a[20:23], a[148:151], v[52:55]
    v_permlane32_swap_b32 v96, v97
    v_max_f32 v100, v100, v39
    v_mfma_f32_16x16x32_bf16 v[52:55], a[24:27], a[152:155], v[52:55]
    v_max_f32 v96, v96, v97
    v_mov_b32 v101, v100
    v_mfma_f32_16x16x32_bf16 v[52:55], a[28:31], a[156:159], v[52:55]
    v_max3_f32 v108, v44, v45, v46
    v_max_f32 v108, v108, v47
    v_mfma_f32_16x16x32_bf16 v[56:59], a[16:19], a[160:163], 0
    v_permlane16_swap_b32 v100, v101
    v_mov_b32 v109, v108
    v_mfma_f32_16x16x32_bf16 v[56:59], a[20:23], a[164:167], v[56:59]
    v_max_f32 v100, v100, v101
    v_mov_b32 v101, v100
    v_mfma_f32_16x16x32_bf16 v[56:59], a[24:27], a[168:171], v[56:59]
    v_permlane16_swap_b32 v104, v105
    v_permlane16_swap_b32 v108, v109
    v_mfma_f32_16x16x32_bf16 v[56:59], a[28:31], a[172:175], v[56:59]
    v_max_f32 v108, v108, v109
    v_mov_b32 v109, v108
    v_mfma_f32_16x16x32_bf16 v[60:63], a[16:19], a[176:179], 0
    v_max_f32 v104, v104, v105
    v_mov_b32 v105, v104
    v_mfma_f32_16x16x32_bf16 v[60:63], a[20:23], a[180:183], v[60:63]
    v_permlane32_swap_b32 v100, v101
    v_max_f32 v100, v100, v101
    v_mfma_f32_16x16x32_bf16 v[60:63], a[24:27], a[184:187], v[60:63]
    v_permlane32_swap_b32 v108, v109
    v_max_f32 v108, v108, v109
    v_mfma_f32_16x16x32_bf16 v[60:63], a[28:31], a[188:191], v[60:63]
    v_permlane32_swap_b32 v104, v105
    v_max_f32 v104, v104, v105
    ds_read_b128 a[16:19], v2 offset:61440
    ds_read_b128 a[20:23], v2 offset:62464
    ds_read_b128 a[24:27], v2 offset:63488
    ds_read_b128 a[28:31], v2 offset:64512
    v_pk_mul_f32 v[98:99], v[96:97], -1.0 op_sel_hi:[0,0]
    v_pk_mul_f32 v[96:97], v[96:97], -1.0 op_sel_hi:[0,0]
    v_pk_add_f32 v[32:33], v[32:33], v[96:97]
    v_pk_add_f32 v[34:35], v[34:35], v[96:97]
    v_pk_add_f32 v[48:49], v[48:49], v[96:97]
    v_pk_add_f32 v[50:51], v[50:51], v[96:97]
    v_pk_mul_f32 v[102:103], v[100:101], -1.0 op_sel_hi:[0,0]
    v_pk_mul_f32 v[100:101], v[100:101], -1.0 op_sel_hi:[0,0]
    v_pk_add_f32 v[36:37], v[36:37], v[100:101]
    v_pk_add_f32 v[38:39], v[38:39], v[100:101]
    v_pk_add_f32 v[52:53], v[52:53], v[100:101]
    v_pk_add_f32 v[54:55], v[54:55], v[100:101]
    v_pk_mul_f32 v[106:107], v[104:105], -1.0 op_sel_hi:[0,0]
    v_pk_mul_f32 v[104:105], v[104:105], -1.0 op_sel_hi:[0,0]
    v_pk_add_f32 v[40:41], v[40:41], v[104:105]
    v_pk_add_f32 v[42:43], v[42:43], v[104:105]
    v_pk_add_f32 v[56:57], v[56:57], v[104:105]
    v_pk_add_f32 v[58:59], v[58:59], v[104:105]
    v_pk_mul_f32 v[110:111], v[108:109], -1.0 op_sel_hi:[0,0]
    v_pk_mul_f32 v[108:109], v[108:109], -1.0 op_sel_hi:[0,0]
    v_pk_add_f32 v[44:45], v[44:45], v[108:109]
    v_pk_add_f32 v[46:47], v[46:47], v[108:109]
    v_pk_add_f32 v[60:61], v[60:61], v[108:109]
    v_pk_add_f32 v[62:63], v[62:63], v[108:109]
    v_subrev_u32 v15, 32, v3
    v_cmp_gt_i32 s[44:45], 0, v15
    v_cmp_gt_i32 s[46:47], 1, v15
    v_cmp_gt_i32 s[48:49], 2, v15
    v_cmp_gt_i32 s[50:51], 3, v15
    v_cndmask_b32 v120, v96, v5, s[44:45]
    v_cndmask_b32 v121, v96, v5, s[46:47]
    v_cndmask_b32 v122, v96, v5, s[48:49]
    v_cndmask_b32 v123, v96, v5, s[50:51]
    v_cmp_gt_i32 s[44:45], 16, v15
    v_cmp_gt_i32 s[46:47], 17, v15
    v_cmp_gt_i32 s[48:49], 18, v15
    v_cmp_gt_i32 s[50:51], 19, v15
    v_cndmask_b32 v124, v96, v5, s[44:45]
    v_cndmask_b32 v125, v96, v5, s[46:47]
    v_cndmask_b32 v126, v96, v5, s[48:49]
    v_cndmask_b32 v127, v96, v5, s[50:51]
    v_exp_f32 v32, v32
    v_exp_f32 v33, v33
    v_exp_f32 v34, v34
    v_exp_f32 v35, v35
    v_exp_f32 v36, v36
    v_exp_f32 v37, v37
    v_exp_f32 v38, v38
    v_exp_f32 v39, v39
    v_exp_f32 v40, v40
    v_exp_f32 v41, v41
    v_exp_f32 v42, v42
    v_exp_f32 v43, v43
    v_exp_f32 v44, v44
    v_exp_f32 v45, v45
    v_exp_f32 v46, v46
    v_exp_f32 v47, v47
    v_exp_f32 v48, v48
    v_cvt_pk_bf16_f32 v64, v32, v33
    v_cvt_pk_bf16_f32 v65, v34, v35
    v_cvt_pk_bf16_f32 v68, v36, v37
    v_cvt_pk_bf16_f32 v69, v38, v39
    v_cvt_pk_bf16_f32 v72, v40, v41
    v_cvt_pk_bf16_f32 v73, v42, v43
    v_cvt_pk_bf16_f32 v76, v44, v45
    v_cvt_pk_bf16_f32 v77, v46, v47
    v_add_u32 v2, s58, v11
    s_waitcnt vmcnt(0) lgkmcnt(0)
    s_barrier
    buffer_store_dword v7, v0, s[28:31], s88 offen offset:32 sc1
    s_and_b32 s88, s88, 0xfffffe00
    s_lshl_b32 s39, s38, 1
    s_lshl_b32 s0, s38, 7
    v_add_u32 v15, s0, v3
    v_mov_b32 v13, v26
    v_xor_b32 v14, 32, v26
    s_cmp_lg_u32 s38, 0
    s_cbranch_scc1 L_trip1
    v_mov_b64 v[128:129], 0
    v_mov_b64 v[130:131], 0
    v_mov_b64 v[132:133], 0
    v_mov_b64 v[134:135], 0
    v_mov_b64 v[136:137], 0
    v_mov_b64 v[138:139], 0
    v_mov_b64 v[140:141], 0
    v_mov_b64 v[142:143], 0
    v_mov_b64 v[144:145], 0
    v_mov_b64 v[146:147], 0
    v_mov_b64 v[148:149], 0
    v_mov_b64 v[150:151], 0
    v_mov_b64 v[152:153], 0
    v_mov_b64 v[154:155], 0
    v_mov_b64 v[156:157], 0
    v_mov_b64 v[158:159], 0
    v_mov_b64 v[160:161], 0
    v_mov_b64 v[162:163], 0
    v_mov_b64 v[164:165], 0
    v_mov_b64 v[166:167], 0
    v_mov_b64 v[168:169], 0
    v_mov_b64 v[170:171], 0
    v_mov_b64 v[172:173], 0
    v_mov_b64 v[174:175], 0
    v_mov_b64 v[176:177], 0
    v_mov_b64 v[178:179], 0
    v_mov_b64 v[180:181], 0
    v_mov_b64 v[182:183], 0
    v_mov_b64 v[184:185], 0
    v_mov_b64 v[186:187], 0
    v_mov_b64 v[188:189], 0
    v_mov_b64 v[190:191], 0
    v_mov_b64 v[192:193], 0
    v_mov_b64 v[194:195], 0
    v_mov_b64 v[196:197], 0
    v_mov_b64 v[198:199], 0
    v_mov_b64 v[200:201], 0
    v_mov_b64 v[202:203], 0
    v_mov_b64 v[204:205], 0
    v_mov_b64 v[206:207], 0
    v_mov_b64 v[208:209], 0
    v_mov_b64 v[210:211], 0
    v_mov_b64 v[212:213], 0
    v_mov_b64 v[214:215], 0
    v_mov_b64 v[216:217], 0
    v_mov_b64 v[218:219], 0
    v_mov_b64 v[220:221], 0
    v_mov_b64 v[222:223], 0
    v_mov_b64 v[224:225], 0
    v_mov_b64 v[226:227], 0
    v_mov_b64 v[228:229], 0
    v_mov_b64 v[230:231], 0
    v_mov_b64 v[232:233], 0
    v_mov_b64 v[234:235], 0
    v_mov_b64 v[236:237], 0
    v_mov_b64 v[238:239], 0
    v_mov_b64 v[240:241], 0
    v_mov_b64 v[242:243], 0
    v_mov_b64 v[244:245], 0
    v_mov_b64 v[246:247], 0
    v_mov_b64 v[248:249], 0
    v_mov_b64 v[250:251], 0
    v_mov_b64 v[252:253], 0
    v_mov_b64 v[254:255], 0
    s_branch L_blkB
L_trip1:
    v_mfma_f32_16x16x32_bf16 v[32:35], a[0:3], a[128:131], v[96:99]
    v_exp_f32 v49, v49
    v_mfma_f32_16x16x32_bf16 v[32:35], a[4:7], a[132:135], v[32:35]
    ds_read_b128 a[32:35], v2 offset:32768
    ds_read_b128 a[36:39], v2 offset:33792
    v_mfma_f32_16x16x32_bf16 v[32:35], a[8:11], a[136:139], v[32:35]
    v_exp_f32 v50, v50
    v_mfma_f32_16x16x32_bf16 v[32:35], a[12:15], a[140:143], v[32:35]
    s_add_u32 m0, s61, 0
    v_exp_f32 v51, v51
    v_mfma_f32_16x16x32_bf16 v[36:39], a[12:15], a[156:159], v[100:103]
    s_add_u32 s40, s64, 0
    v_exp_f32 v52, v52
    v_mfma_f32_16x16x32_bf16 v[36:39], a[8:11], a[152:155], v[36:39]
    buffer_load_dwordx4 v13, s[72:75], s40 offen offset:0 nt lds
    v_mfma_f32_16x16x32_bf16 v[36:39], a[4:7], a[148:151], v[36:39]
    v_exp_f32 v53, v53
    v_mfma_f32_16x16x32_bf16 v[36:39], a[0:3], a[144:147], v[36:39]
    ds_read_b128 a[40:43], v2 offset:34816
    ds_read_b128 a[44:47], v2 offset:35840
    v_mfma_f32_16x16x32_bf16 v[40:43], a[0:3], a[160:163], v[104:107]
    s_add_u32 s40, s64, 4096
    v_exp_f32 v54, v54
    v_mfma_f32_16x16x32_bf16 v[40:43], a[4:7], a[164:167], v[40:43]
    buffer_load_dwordx4 v14, s[72:75], s40 offen offset:1024 nt lds
    v_mfma_f32_16x16x32_bf16 v[40:43], a[8:11], a[168:171], v[40:43]
    ds_read_b128 a[48:51], v2 offset:36864
    v_cvt_pk_bf16_f32 v70, v52, v53
    v_mfma_f32_16x16x32_bf16 v[40:43], a[12:15], a[172:175], v[40:43]
    s_add_u32 s40, s64, 8192
    v_subrev_u32 v15, 64, v15
    v_cmp_gt_i32 s[44:45], 0, v15
    v_mfma_f32_16x16x32_bf16 v[44:47], a[12:15], a[188:191], v[108:111]
    ds_read_b128 a[52:55], v2 offset:37888
    ds_read_b128 a[56:59], v2 offset:38912
    v_mfma_f32_16x16x32_bf16 v[44:47], a[8:11], a[184:187], v[44:47]
    buffer_load_dwordx4 v13, s[72:75], s40 offen offset:2048 nt lds
    v_mfma_f32_16x16x32_bf16 v[44:47], a[4:7], a[180:183], v[44:47]
    v_exp_f32 v55, v55
    v_mfma_f32_16x16x32_bf16 v[44:47], a[0:3], a[176:179], v[44:47]
    s_add_u32 s40, s64, 12288
    v_exp_f32 v56, v56
    v_mfma_f32_16x16x32_bf16 v[16:19], a[16:19], a[128:131], v[96:99]
    v_exp_f32 v57, v57
    v_mfma_f32_16x16x32_bf16 v[16:19], a[20:23], a[132:135], v[16:19]
    v_exp_f32 v58, v58
    v_mfma_f32_16x16x32_bf16 v[16:19], a[24:27], a[136:139], v[16:19]
    v_exp_f32 v59, v59
    v_mfma_f32_16x16x32_bf16 v[16:19], a[28:31], a[140:143], v[16:19]
    ds_read_b128 a[60:63], v2 offset:39936
    v_cmp_gt_i32 s[46:47], 1, v15
    v_mfma_f32_16x16x32_bf16 v[20:23], a[28:31], a[156:159], v[100:103]
    buffer_load_dwordx4 v14, s[72:75], s40 offen offset:3072 nt lds
    v_mfma_f32_16x16x32_bf16 v[20:23], a[24:27], a[152:155], v[20:23]
    s_add_u32 m0, s61, 4096
    v_exp_f32 v60, v60
    v_mfma_f32_16x16x32_bf16 v[20:23], a[20:23], a[148:151], v[20:23]
    ds_read_b128 a[0:3], v2 offset:40960
    v_cvt_pk_bf16_f32 v74, v56, v57
    v_mfma_f32_16x16x32_bf16 v[20:23], a[16:19], a[144:147], v[20:23]
    v_exp_f32 v61, v61
    v_mfma_f32_16x16x32_bf16 v[24:27], a[16:19], a[160:163], v[104:107]
    s_add_u32 s40, s64, 20480
    v_exp_f32 v62, v62
    v_mfma_f32_16x16x32_bf16 v[24:27], a[20:23], a[164:167], v[24:27]
    v_cvt_pk_bf16_f32 v71, v54, v55
    v_cvt_pk_bf16_f32 v75, v58, v59
    v_mfma_f32_16x16x32_bf16 v[24:27], a[24:27], a[168:171], v[24:27]
    buffer_load_dwordx4 v13, s[72:75], s40 offen offset:0 nt lds
    v_mfma_f32_16x16x32_bf16 v[24:27], a[28:31], a[172:175], v[24:27]
    ds_read_b128 a[4:7], v2 offset:41984
    v_mfma_f32_16x16x32_bf16 v[28:31], a[28:31], a[188:191], v[108:111]
    v_exp_f32 v63, v63
    v_mfma_f32_16x16x32_bf16 v[28:31], a[24:27], a[184:187], v[28:31]
    v_cvt_pk_bf16_f32 v67, v50, v51
    v_cvt_pk_bf16_f32 v78, v60, v61
    v_mfma_f32_16x16x32_bf16 v[28:31], a[20:23], a[180:183], v[28:31]
    v_cvt_pk_bf16_f32 v66, v48, v49
    v_cvt_pk_bf16_f32 v79, v62, v63
    v_mfma_f32_16x16x32_bf16 v[28:31], a[16:19], a[176:179], v[28:31]
    s_waitcnt lgkmcnt(6)
    v_cmp_gt_i32 s[48:49], 2, v15
    v_cmp_gt_i32 s[50:51], 3, v15
    v_mfma_f32_16x16x32_bf16 v[128:131], a[32:35], v[64:67], 0
    v_exp_f32 v32, v32
    v_mfma_f32_16x16x32_bf16 v[160:163], a[32:35], v[68:71], 0
    v_cndmask_b32 v112, v96, v5, s[44:45]
    v_cndmask_b32 v113, v96, v5, s[46:47]
    v_mfma_f32_16x16x32_bf16 v[192:195], a[32:35], v[72:75], 0
    v_exp_f32 v33, v33
    v_mfma_f32_16x16x32_bf16 v[224:227], a[32:35], v[76:79], 0
    v_exp_f32 v34, v34
    v_mfma_f32_16x16x32_bf16 v[228:231], a[36:39], v[76:79], 0
    ds_read_b128 a[8:11], v2 offset:43008
    v_cndmask_b32 v114, v96, v5, s[48:49]
    v_mfma_f32_16x16x32_bf16 v[196:199], a[36:39], v[72:75], 0
    v_exp_f32 v35, v35
    v_mfma_f32_16x16x32_bf16 v[164:167], a[36:39], v[68:71], 0
    v_exp_f32 v36, v36
    v_mfma_f32_16x16x32_bf16 v[132:135], a[36:39], v[64:67], 0
    v_exp_f32 v37, v37
    v_mfma_f32_16x16x32_bf16 v[136:139], a[40:43], v[64:67], 0
    s_add_u32 s40, s64, 24576
    v_exp_f32 v38, v38
    v_mfma_f32_16x16x32_bf16 v[168:171], a[40:43], v[68:71], 0
    v_exp_f32 v39, v39
    v_mfma_f32_16x16x32_bf16 v[200:203], a[40:43], v[72:75], 0
    v_exp_f32 v40, v40
    v_mfma_f32_16x16x32_bf16 v[232:235], a[40:43], v[76:79], 0
    ds_read_b128 a[12:15], v2 offset:44032
    v_cndmask_b32 v115, v96, v5, s[50:51]
    v_smfmac_f32_16x16x64_bf16 a[68:71], a[80:83], v[72:79], v6
    v_cmp_gt_i32 s[44:45], 16, v15
    v_mfma_f32_16x16x32_bf16 v[236:239], a[44:47], v[76:79], 0
    v_exp_f32 v41, v41
    v_mfma_f32_16x16x32_bf16 v[204:207], a[44:47], v[72:75], 0
    buffer_load_dwordx4 v14, s[72:75], s40 offen offset:1024 nt lds
    v_mfma_f32_16x16x32_bf16 v[172:175], a[44:47], v[68:71], 0
    s_add_u32 s40, s64, 28672
    v_exp_f32 v42, v42
    v_mfma_f32_16x16x32_bf16 v[140:143], a[44:47], v[64:67], 0
    s_waitcnt lgkmcnt(4)
    v_cvt_pk_bf16_f32 v81, v34, v35
    v_mfma_f32_16x16x32_bf16 v[144:147], a[48:51], v[64:67], 0
    buffer_load_dwordx4 v13, s[72:75], s40 offen offset:2048 nt lds
    v_mfma_f32_16x16x32_bf16 v[176:179], a[48:51], v[68:71], 0
    v_cmp_gt_i32 s[46:47], 17, v15
    v_cmp_gt_i32 s[48:49], 18, v15
    v_mfma_f32_16x16x32_bf16 v[208:211], a[48:51], v[72:75], 0
    s_add_u32 s40, s64, 32768
    v_exp_f32 v43, v43
    v_mfma_f32_16x16x32_bf16 v[240:243], a[48:51], v[76:79], 0
    ds_read_b128 a[16:19], v2 offset:45056
    v_cmp_gt_i32 s[50:51], 19, v15
    v_mfma_f32_16x16x32_bf16 v[244:247], a[52:55], v[76:79], 0
    v_exp_f32 v44, v44
    v_mfma_f32_16x16x32_bf16 v[212:215], a[52:55], v[72:75], 0
    buffer_load_dwordx4 v14, s[72:75], s40 offen offset:3072 nt lds
    v_mfma_f32_16x16x32_bf16 v[180:183], a[52:55], v[68:71], 0
    v_exp_f32 v45, v45
    v_mfma_f32_16x16x32_bf16 v[148:151], a[52:55], v[64:67], 0
    v_cndmask_b32 v116, v96, v5, s[44:45]
    v_cndmask_b32 v117, v96, v5, s[46:47]
    v_smfmac_f32_16x16x64_bf16 a[64:67], a[80:83], v[64:71], v6
    ds_read_b128 a[20:23], v2 offset:46080
    v_cndmask_b32 v118, v96, v5, s[48:49]
    v_mfma_f32_16x16x32_bf16 v[152:155], a[56:59], v[64:67], 0
    s_add_u32 s58, s58, 32768
    v_exp_f32 v46, v46
    v_mfma_f32_16x16x32_bf16 v[184:187], a[56:59], v[68:71], 0
    v_exp_f32 v47, v47
    v_mfma_f32_16x16x32_bf16 v[216:219], a[56:59], v[72:75], 0
    s_and_b32 s58, s58, 0x1ffff
    v_exp_f32 v16, v16
    v_mfma_f32_16x16x32_bf16 v[248:251], a[56:59], v[76:79], 0
    v_exp_f32 v17, v17
    v_mfma_f32_16x16x32_bf16 v[252:255], a[60:63], v[76:79], 0
    v_cvt_pk_bf16_f32 v80, v32, v33
    v_cvt_pk_bf16_f32 v92, v44, v45
    v_mfma_f32_16x16x32_bf16 v[220:223], a[60:63], v[72:75], 0
    v_cvt_pk_bf16_f32 v84, v36, v37
    v_cndmask_b32 v119, v96, v5, s[50:51]
    v_mfma_f32_16x16x32_bf16 v[188:191], a[60:63], v[68:71], 0
    ds_read_b128 a[24:27], v2 offset:47104
    v_cvt_pk_bf16_f32 v85, v38, v39
    v_mfma_f32_16x16x32_bf16 v[156:159], a[60:63], v[64:67], 0
    s_waitcnt lgkmcnt(3)
    v_exp_f32 v18, v18
    v_mfma_f32_16x16x32_bf16 v[32:35], a[0:3], a[128:131], v[112:115]
    s_add_u32 m0, s57, 32768
    v_exp_f32 v19, v19
    v_mfma_f32_16x16x32_bf16 v[32:35], a[4:7], a[132:135], v[32:35]
    v_exp_f32 v20, v20
    v_mfma_f32_16x16x32_bf16 v[32:35], a[8:11], a[136:139], v[32:35]
    v_exp_f32 v21, v21
    v_mfma_f32_16x16x32_bf16 v[32:35], a[12:15], a[140:143], v[32:35]
    ds_read_b128 a[28:31], v2 offset:48128
    v_cvt_pk_bf16_f32 v88, v40, v41
    v_mfma_f32_16x16x32_bf16 v[36:39], a[12:15], a[156:159], v[100:103]
    buffer_load_dwordx4 v11, s[4:7], s56 offen offset:0 sc1 lds
    v_mfma_f32_16x16x32_bf16 v[36:39], a[8:11], a[152:155], v[36:39]
    ds_read_b128 a[32:35], v2 offset:49152
    v_cvt_pk_bf16_f32 v89, v42, v43
    v_mfma_f32_16x16x32_bf16 v[36:39], a[4:7], a[148:151], v[36:39]
    ds_read_b128 a[36:39], v2 offset:50176
    v_cvt_pk_bf16_f32 v93, v46, v47
    v_mfma_f32_16x16x32_bf16 v[36:39], a[0:3], a[144:147], v[36:39]
    ds_read_b128 a[40:43], v2 offset:51200
    v_mfma_f32_16x16x32_bf16 v[40:43], a[0:3], a[160:163], v[104:107]
    ds_read_b128 a[44:47], v2 offset:52224
    v_mfma_f32_16x16x32_bf16 v[40:43], a[4:7], a[164:167], v[40:43]
    v_exp_f32 v22, v22
    v_mfma_f32_16x16x32_bf16 v[40:43], a[8:11], a[168:171], v[40:43]
    ds_read_b128 a[48:51], v2 offset:53248
    v_cvt_pk_bf16_f32 v83, v18, v19
    v_mfma_f32_16x16x32_bf16 v[40:43], a[12:15], a[172:175], v[40:43]
    buffer_load_dwordx4 v11, s[4:7], s56 offen offset:1024 sc1 lds
    v_mfma_f32_16x16x32_bf16 v[44:47], a[12:15], a[188:191], v[108:111]
    v_exp_f32 v23, v23
    v_mfma_f32_16x16x32_bf16 v[44:47], a[8:11], a[184:187], v[44:47]
    v_exp_f32 v24, v24
    v_mfma_f32_16x16x32_bf16 v[44:47], a[4:7], a[180:183], v[44:47]
    v_exp_f32 v25, v25
    v_mfma_f32_16x16x32_bf16 v[44:47], a[0:3], a[176:179], v[44:47]
    s_waitcnt lgkmcnt(5)
    v_exp_f32 v26, v26
    v_mfma_f32_16x16x32_bf16 v[48:51], a[16:19], a[128:131], v[116:119]
    buffer_load_dwordx4 v11, s[4:7], s56 offen offset:2048 sc1 lds
    v_mfma_f32_16x16x32_bf16 v[48:51], a[20:23], a[132:135], v[48:51]
    v_exp_f32 v27, v27
    v_mfma_f32_16x16x32_bf16 v[48:51], a[24:27], a[136:139], v[48:51]
    v_exp_f32 v28, v28
    v_mfma_f32_16x16x32_bf16 v[48:51], a[28:31], a[140:143], v[48:51]
    ds_read_b128 a[52:55], v2 offset:54272
    ds_read_b128 a[56:59], v2 offset:55296
    v_mfma_f32_16x16x32_bf16 v[52:55], a[28:31], a[156:159], v[100:103]
    buffer_load_dwordx4 v11, s[4:7], s56 offen offset:3072 sc1 lds
    v_mfma_f32_16x16x32_bf16 v[52:55], a[24:27], a[152:155], v[52:55]
    s_add_u32 s56, s56, 4096
    v_cvt_pk_bf16_f32 v82, v16, v17
    v_cvt_pk_bf16_f32 v91, v26, v27
    v_mfma_f32_16x16x32_bf16 v[52:55], a[20:23], a[148:151], v[52:55]
    v_cvt_pk_bf16_f32 v90, v24, v25
    v_mfma_f32_16x16x32_bf16 v[52:55], a[16:19], a[144:147], v[52:55]
    s_add_u32 m0, s57, 36864
    ds_read_b128 a[60:63], v2 offset:56320
    v_mfma_f32_16x16x32_bf16 v[56:59], a[16:19], a[160:163], v[104:107]
    buffer_load_dwordx4 v11, s[4:7], s56 offen offset:0 sc1 lds
    v_mfma_f32_16x16x32_bf16 v[56:59], a[20:23], a[164:167], v[56:59]
    v_exp_f32 v29, v29
    v_mfma_f32_16x16x32_bf16 v[56:59], a[24:27], a[168:171], v[56:59]
    v_cvt_pk_bf16_f32 v86, v20, v21
    v_cvt_pk_bf16_f32 v94, v28, v29
    v_mfma_f32_16x16x32_bf16 v[56:59], a[28:31], a[172:175], v[56:59]
    ds_read_b128 a[0:3], v2 offset:57344
    v_cvt_pk_bf16_f32 v87, v22, v23
    v_mfma_f32_16x16x32_bf16 v[60:63], a[28:31], a[188:191], v[108:111]
    v_exp_f32 v30, v30
    v_mfma_f32_16x16x32_bf16 v[60:63], a[24:27], a[184:187], v[60:63]
    v_exp_f32 v31, v31
    v_mfma_f32_16x16x32_bf16 v[60:63], a[20:23], a[180:183], v[60:63]
    ds_read_b128 a[4:7], v2 offset:58368
    v_cvt_pk_bf16_f32 v95, v30, v31
    v_mfma_f32_16x16x32_bf16 v[60:63], a[16:19], a[176:179], v[60:63]
    s_waitcnt lgkmcnt(6)
    v_mfma_f32_16x16x32_bf16 v[128:131], a[32:35], v[80:83], v[128:131]
    buffer_load_dwordx4 v11, s[4:7], s56 offen offset:1024 sc1 lds
    v_mfma_f32_16x16x32_bf16 v[160:163], a[32:35], v[84:87], v[160:163]
    v_exp_f32 v32, v32
    v_mfma_f32_16x16x32_bf16 v[192:195], a[32:35], v[88:91], v[192:195]
    v_exp_f32 v33, v33
    v_mfma_f32_16x16x32_bf16 v[224:227], a[32:35], v[92:95], v[224:227]
    ds_read_b128 a[8:11], v2 offset:59392
    v_mfma_f32_16x16x32_bf16 v[228:231], a[36:39], v[92:95], v[228:231]
    v_exp_f32 v34, v34
    v_mfma_f32_16x16x32_bf16 v[196:199], a[36:39], v[88:91], v[196:199]
    buffer_load_dwordx4 v11, s[4:7], s56 offen offset:2048 sc1 lds
    v_mfma_f32_16x16x32_bf16 v[164:167], a[36:39], v[84:87], v[164:167]
    v_cvt_pk_bf16_f32 v64, v32, v33
    v_mfma_f32_16x16x32_bf16 v[132:135], a[36:39], v[80:83], v[132:135]
    v_exp_f32 v35, v35
    v_mfma_f32_16x16x32_bf16 v[136:139], a[40:43], v[80:83], v[136:139]
    ds_read_b128 a[12:15], v2 offset:60416
    ds_read_b128 a[16:19], v2 offset:61440
    v_mfma_f32_16x16x32_bf16 v[168:171], a[40:43], v[84:87], v[168:171]
    v_exp_f32 v36, v36
    v_mfma_f32_16x16x32_bf16 v[200:203], a[40:43], v[88:91], v[200:203]
    v_exp_f32 v37, v37
    v_mfma_f32_16x16x32_bf16 v[232:235], a[40:43], v[92:95], v[232:235]
    ds_read_b128 a[20:23], v2 offset:62464
    ds_read_b128 a[24:27], v2 offset:63488
    v_smfmac_f32_16x16x64_bf16 a[68:71], a[80:83], v[88:95], v6
    buffer_load_dwordx4 v11, s[4:7], s56 offen offset:3072 sc1 lds
    v_mfma_f32_16x16x32_bf16 v[236:239], a[44:47], v[92:95], v[236:239]
    s_add_u32 s56, s56, 28672
    v_exp_f32 v38, v38
    v_mfma_f32_16x16x32_bf16 v[204:207], a[44:47], v[88:91], v[204:207]
    v_exp_f32 v39, v39
    v_mfma_f32_16x16x32_bf16 v[172:175], a[44:47], v[84:87], v[172:175]
    s_add_u32 s57, s57, 32768
    v_exp_f32 v40, v40
    v_mfma_f32_16x16x32_bf16 v[140:143], a[44:47], v[80:83], v[140:143]
    s_waitcnt lgkmcnt(7)
    v_exp_f32 v41, v41
    v_mfma_f32_16x16x32_bf16 v[144:147], a[48:51], v[80:83], v[144:147]
    s_and_b32 s57, s57, 0x1ffff
    v_exp_f32 v42, v42
    v_mfma_f32_16x16x32_bf16 v[176:179], a[48:51], v[84:87], v[176:179]
L_ws_6205:
    s_cbranch_execz L_wr_a
    v_exp_f32 v43, v43
    v_mfma_f32_16x16x32_bf16 v[208:211], a[48:51], v[88:91], v[208:211]
    s_add_u32 s62, s65, 4096
    v_exp_f32 v44, v44
    v_mfma_f32_16x16x32_bf16 v[240:243], a[48:51], v[92:95], v[240:243]
    s_cmp_ge_u32 s38, 3
    s_cselect_b32 s0, 1, 0
    v_cvt_pk_bf16_f32 v65, v34, v35
    v_mfma_f32_16x16x32_bf16 v[244:247], a[52:55], v[92:95], v[244:247]
    s_add_u32 s60, s38, s0
    v_cvt_pk_bf16_f32 v73, v42, v43
    v_mfma_f32_16x16x32_bf16 v[212:215], a[52:55], v[88:91], v[212:215]
    v_exp_f32 v45, v45
    v_mfma_f32_16x16x32_bf16 v[180:183], a[52:55], v[84:87], v[180:183]
    s_lshl_b32 s1, s38, 1
    v_cvt_pk_bf16_f32 v69, v38, v39
    v_cvt_pk_bf16_f32 v76, v44, v45
    v_mfma_f32_16x16x32_bf16 v[148:151], a[52:55], v[80:83], v[148:151]
    s_sub_u32 s1, s1, 3
    v_exp_f32 v46, v46
    v_smfmac_f32_16x16x64_bf16 a[64:67], a[80:83], v[80:87], v6
    ds_read_b128 a[28:31], v2 offset:64512
    v_add_u32 v2, s58, v11
    v_mfma_f32_16x16x32_bf16 v[152:155], a[56:59], v[80:83], v[152:155]
    v_exp_f32 v47, v47
    v_mfma_f32_16x16x32_bf16 v[184:187], a[56:59], v[84:87], v[184:187]
    s_and_b32 s0, s2, 0x9f
    v_mfma_f32_16x16x32_bf16 v[216:219], a[56:59], v[88:91], v[216:219]
    s_cmp_eq_u32 s0, 0x9e
    s_cselect_b32 s85, 1, 0
    s_cselect_b32 s60, s1, s60
    v_mfma_f32_16x16x32_bf16 v[248:251], a[56:59], v[92:95], v[248:251]
    v_cvt_pk_bf16_f32 v77, v46, v47
    v_mfma_f32_16x16x32_bf16 v[252:255], a[60:63], v[92:95], v[252:255]
    s_sub_u32 s39, s39, 1
    v_cvt_pk_bf16_f32 v68, v36, v37
    v_cvt_pk_bf16_f32 v72, v40, v41
    v_mfma_f32_16x16x32_bf16 v[220:223], a[60:63], v[88:91], v[220:223]
    s_waitcnt vmcnt(16) lgkmcnt(0)
    s_barrier
    v_mfma_f32_16x16x32_bf16 v[188:191], a[60:63], v[84:87], v[188:191]
    s_cmp_eq_u32 s39, 1
    v_exp_f32 v48, v48
    v_mfma_f32_16x16x32_bf16 v[156:159], a[60:63], v[80:83], v[156:159]
    s_cbranch_scc1 L_tripV
    .p2align 5
L_loopA:
    v_mfma_f32_16x16x32_bf16 v[32:35], a[0:3], a[128:131], v[96:99]
    s_add_u32 s58, s58, 32768
    v_exp_f32 v49, v49
    v_mfma_f32_16x16x32_bf16 v[32:35], a[4:7], a[132:135], v[32:35]
    v_exp_f32 v50, v50
    v_mfma_f32_16x16x32_bf16 v[32:35], a[8:11], a[136:139], v[32:35]
    v_exp_f32 v51, v51
    v_mfma_f32_16x16x32_bf16 v[32:35], a[12:15], a[140:143], v[32:35]
    ds_read_b128 a[32:35], v2 offset:32768
    v_cvt_pk_bf16_f32 v67, v50, v51
    v_mfma_f32_16x16x32_bf16 v[36:39], a[12:15], a[156:159], v[100:103]
    v_exp_f32 v52, v52
    v_mfma_f32_16x16x32_bf16 v[36:39], a[8:11], a[152:155], v[36:39]
    s_and_b32 s58, s58, 0x1ffff
    v_subrev_u32 v15, 64, v15
    v_cmp_gt_i32 s[44:45], 0, v15
    v_mfma_f32_16x16x32_bf16 v[36:39], a[4:7], a[148:151], v[36:39]
    ds_read_b128 a[36:39], v2 offset:33792
    v_mfma_f32_16x16x32_bf16 v[36:39], a[0:3], a[144:147], v[36:39]
    v_exp_f32 v53, v53
    v_mfma_f32_16x16x32_bf16 v[40:43], a[0:3], a[160:163], v[104:107]
    s_add_u32 m0, s57, 32768
    v_exp_f32 v54, v54
    v_mfma_f32_16x16x32_bf16 v[40:43], a[4:7], a[164:167], v[40:43]
    v_exp_f32 v55, v55
    v_mfma_f32_16x16x32_bf16 v[40:43], a[8:11], a[168:171], v[40:43]
    v_exp_f32 v56, v56
    v_mfma_f32_16x16x32_bf16 v[40:43], a[12:15], a[172:175], v[40:43]
    v_exp_f32 v57, v57
    v_mfma_f32_16x16x32_bf16 v[44:47], a[12:15], a[188:191], v[108:111]
    v_exp_f32 v58, v58
    v_mfma_f32_16x16x32_bf16 v[44:47], a[8:11], a[184:187], v[44:47]
    v_exp_f32 v59, v59
    v_mfma_f32_16x16x32_bf16 v[44:47], a[4:7], a[180:183], v[44:47]
    v_exp_f32 v60, v60
    v_mfma_f32_16x16x32_bf16 v[44:47], a[0:3], a[176:179], v[44:47]
    ds_read_b128 a[40:43], v2 offset:34816
    v_mfma_f32_16x16x32_bf16 v[16:19], a[16:19], a[128:131], v[96:99]
    buffer_load_dwordx4 v11, s[4:7], s56 offen offset:0 sc1 lds
    v_mfma_f32_16x16x32_bf16 v[16:19], a[20:23], a[132:135], v[16:19]
    v_exp_f32 v61, v61
    v_mfma_f32_16x16x32_bf16 v[16:19], a[24:27], a[136:139], v[16:19]
    ds_read_b128 a[44:47], v2 offset:35840
    v_cmp_gt_i32 s[46:47], 1, v15
    v_mfma_f32_16x16x32_bf16 v[16:19], a[28:31], a[140:143], v[16:19]
    v_cvt_pk_bf16_f32 v71, v54, v55
    v_mfma_f32_16x16x32_bf16 v[20:23], a[28:31], a[156:159], v[100:103]
    v_exp_f32 v62, v62
    v_mfma_f32_16x16x32_bf16 v[20:23], a[24:27], a[152:155], v[20:23]
    ds_read_b128 a[48:51], v2 offset:36864
    v_cvt_pk_bf16_f32 v78, v60, v61
    v_mfma_f32_16x16x32_bf16 v[20:23], a[20:23], a[148:151], v[20:23]
    v_cvt_pk_bf16_f32 v70, v52, v53
    v_cmp_gt_i32 s[48:49], 2, v15
    v_mfma_f32_16x16x32_bf16 v[20:23], a[16:19], a[144:147], v[20:23]
    ds_read_b128 a[52:55], v2 offset:37888
    v_cvt_pk_bf16_f32 v75, v58, v59
    v_mfma_f32_16x16x32_bf16 v[24:27], a[16:19], a[160:163], v[104:107]
    ds_read_b128 a[56:59], v2 offset:38912
    v_cvt_pk_bf16_f32 v74, v56, v57
    v_mfma_f32_16x16x32_bf16 v[24:27], a[20:23], a[164:167], v[24:27]
    ds_read_b128 a[60:63], v2 offset:39936
    v_cvt_pk_bf16_f32 v66, v48, v49
    v_mfma_f32_16x16x32_bf16 v[24:27], a[24:27], a[168:171], v[24:27]
    buffer_load_dwordx4 v11, s[4:7], s56 offen offset:1024 sc1 lds
    v_mfma_f32_16x16x32_bf16 v[24:27], a[28:31], a[172:175], v[24:27]
    v_exp_f32 v63, v63
    v_mfma_f32_16x16x32_bf16 v[28:31], a[28:31], a[188:191], v[108:111]
    ds_read_b128 a[0:3], v2 offset:40960
    v_cmp_gt_i32 s[50:51], 3, v15
    v_mfma_f32_16x16x32_bf16 v[28:31], a[24:27], a[184:187], v[28:31]
    v_cvt_pk_bf16_f32 v79, v62, v63
    v_mfma_f32_16x16x32_bf16 v[28:31], a[20:23], a[180:183], v[28:31]
    buffer_load_dwordx4 v11, s[4:7], s56 offen offset:2048 sc1 lds
    v_mfma_f32_16x16x32_bf16 v[28:31], a[16:19], a[176:179], v[28:31]
    s_waitcnt lgkmcnt(5)
    v_cndmask_b32 v112, v96, v5, s[44:45]
    v_cndmask_b32 v113, v96, v5, s[46:47]
    v_mfma_f32_16x16x32_bf16 v[128:131], a[32:35], v[64:67], v[128:131]
    v_exp_f32 v32, v32
    v_mfma_f32_16x16x32_bf16 v[160:163], a[32:35], v[68:71], v[160:163]
    v_exp_f32 v33, v33
    v_mfma_f32_16x16x32_bf16 v[192:195], a[32:35], v[72:75], v[192:195]
    v_exp_f32 v34, v34
    v_mfma_f32_16x16x32_bf16 v[224:227], a[32:35], v[76:79], v[224:227]
    v_exp_f32 v35, v35
    v_mfma_f32_16x16x32_bf16 v[228:231], a[36:39], v[76:79], v[228:231]
    v_exp_f32 v36, v36
    v_mfma_f32_16x16x32_bf16 v[196:199], a[36:39], v[72:75], v[196:199]
    buffer_load_dwordx4 v11, s[4:7], s56 offen offset:3072 sc1 lds
    v_mfma_f32_16x16x32_bf16 v[164:167], a[36:39], v[68:71], v[164:167]
    v_exp_f32 v37, v37
    v_mfma_f32_16x16x32_bf16 v[132:135], a[36:39], v[64:67], v[132:135]
    v_cndmask_b32 v114, v96, v5, s[48:49]
    v_mfma_f32_16x16x32_bf16 v[136:139], a[40:43], v[64:67], v[136:139]
    v_cndmask_b32 v115, v96, v5, s[50:51]
    v_cmp_gt_i32 s[44:45], 16, v15
    v_mfma_f32_16x16x32_bf16 v[168:171], a[40:43], v[68:71], v[168:171]
    ds_read_b128 a[4:7], v2 offset:41984
    v_cvt_pk_bf16_f32 v81, v34, v35
    v_mfma_f32_16x16x32_bf16 v[200:203], a[40:43], v[72:75], v[200:203]
    v_exp_f32 v38, v38
    v_mfma_f32_16x16x32_bf16 v[232:235], a[40:43], v[76:79], v[232:235]
    s_add_u32 s56, s56, 4096
    v_exp_f32 v39, v39
    v_smfmac_f32_16x16x64_bf16 a[68:71], a[80:83], v[72:79], v6
    ds_read_b128 a[8:11], v2 offset:43008
    v_cmp_gt_i32 s[46:47], 17, v15
    v_mfma_f32_16x16x32_bf16 v[236:239], a[44:47], v[76:79], v[236:239]
    v_exp_f32 v40, v40
    v_mfma_f32_16x16x32_bf16 v[204:207], a[44:47], v[72:75], v[204:207]
    v_exp_f32 v41, v41
    v_mfma_f32_16x16x32_bf16 v[172:175], a[44:47], v[68:71], v[172:175]
    v_exp_f32 v42, v42
    v_mfma_f32_16x16x32_bf16 v[140:143], a[44:47], v[64:67], v[140:143]
    s_waitcnt lgkmcnt(3)
    ds_read_b128 a[12:15], v2 offset:44032
    v_mfma_f32_16x16x32_bf16 v[144:147], a[48:51], v[64:67], v[144:147]
    v_exp_f32 v43, v43
    v_mfma_f32_16x16x32_bf16 v[176:179], a[48:51], v[68:71], v[176:179]
    s_add_u32 m0, s57, 36864
    v_cvt_pk_bf16_f32 v84, v36, v37
    v_cmp_gt_i32 s[48:49], 18, v15
    v_mfma_f32_16x16x32_bf16 v[208:211], a[48:51], v[72:75], v[208:211]
    buffer_load_dwordx4 v11, s[4:7], s56 offen offset:0 sc1 lds
    v_mfma_f32_16x16x32_bf16 v[240:243], a[48:51], v[76:79], v[240:243]
    v_cmp_gt_i32 s[50:51], 19, v15
    v_cndmask_b32 v116, v96, v5, s[44:45]
    v_mfma_f32_16x16x32_bf16 v[244:247], a[52:55], v[76:79], v[244:247]
    v_cvt_pk_bf16_f32 v88, v40, v41
    v_mfma_f32_16x16x32_bf16 v[212:215], a[52:55], v[72:75], v[212:215]
    v_exp_f32 v44, v44
    v_mfma_f32_16x16x32_bf16 v[180:183], a[52:55], v[68:71], v[180:183]
    buffer_load_dwordx4 v11, s[4:7], s56 offen offset:1024 sc1 lds
    v_mfma_f32_16x16x32_bf16 v[148:151], a[52:55], v[64:67], v[148:151]
    v_exp_f32 v45, v45
    v_smfmac_f32_16x16x64_bf16 a[64:67], a[80:83], v[64:71], v6
    ds_read_b128 a[16:19], v2 offset:45056
    v_cvt_pk_bf16_f32 v85, v38, v39
    v_mfma_f32_16x16x32_bf16 v[152:155], a[56:59], v[64:67], v[152:155]
    v_exp_f32 v46, v46
    v_mfma_f32_16x16x32_bf16 v[184:187], a[56:59], v[68:71], v[184:187]
    v_exp_f32 v47, v47
    v_mfma_f32_16x16x32_bf16 v[216:219], a[56:59], v[72:75], v[216:219]
    v_exp_f32 v16, v16
    v_mfma_f32_16x16x32_bf16 v[248:251], a[56:59], v[76:79], v[248:251]
    v_exp_f32 v17, v17
    v_mfma_f32_16x16x32_bf16 v[252:255], a[60:63], v[76:79], v[252:255]
    ds_read_b128 a[20:23], v2 offset:46080
    v_mfma_f32_16x16x32_bf16 v[220:223], a[60:63], v[72:75], v[220:223]
    v_cndmask_b32 v117, v96, v5, s[46:47]
    v_cndmask_b32 v118, v96, v5, s[48:49]
    v_mfma_f32_16x16x32_bf16 v[188:191], a[60:63], v[68:71], v[188:191]
    ds_read_b128 a[24:27], v2 offset:47104
    v_cndmask_b32 v119, v96, v5, s[50:51]
    v_mfma_f32_16x16x32_bf16 v[156:159], a[60:63], v[64:67], v[156:159]
    s_waitcnt lgkmcnt(3)
    v_cvt_pk_bf16_f32 v80, v32, v33
    v_mfma_f32_16x16x32_bf16 v[32:35], a[0:3], a[128:131], v[112:115]
    buffer_load_dwordx4 v11, s[4:7], s56 offen offset:2048 sc1 lds
    v_mfma_f32_16x16x32_bf16 v[32:35], a[4:7], a[132:135], v[32:35]
    ds_read_b128 a[28:31], v2 offset:48128
    v_mfma_f32_16x16x32_bf16 v[32:35], a[8:11], a[136:139], v[32:35]
    ds_read_b128 a[32:35], v2 offset:49152
    v_cvt_pk_bf16_f32 v92, v44, v45
    v_mfma_f32_16x16x32_bf16 v[32:35], a[12:15], a[140:143], v[32:35]
    v_exp_f32 v18, v18
    v_mfma_f32_16x16x32_bf16 v[36:39], a[12:15], a[156:159], v[100:103]
    buffer_load_dwordx4 v11, s[4:7], s56 offen offset:3072 sc1 lds
    v_mfma_f32_16x16x32_bf16 v[36:39], a[8:11], a[152:155], v[36:39]
    s_add_u32 s56, s56, 28672
    v_exp_f32 v19, v19
    v_mfma_f32_16x16x32_bf16 v[36:39], a[4:7], a[148:151], v[36:39]
    v_exp_f32 v20, v20
    v_mfma_f32_16x16x32_bf16 v[36:39], a[0:3], a[144:147], v[36:39]
    v_cvt_pk_bf16_f32 v89, v42, v43
    v_mfma_f32_16x16x32_bf16 v[40:43], a[0:3], a[160:163], v[104:107]
    v_exp_f32 v21, v21
    v_mfma_f32_16x16x32_bf16 v[40:43], a[4:7], a[164:167], v[40:43]
    ds_read_b128 a[36:39], v2 offset:50176
    v_mfma_f32_16x16x32_bf16 v[40:43], a[8:11], a[168:171], v[40:43]
    v_exp_f32 v22, v22
    v_mfma_f32_16x16x32_bf16 v[40:43], a[12:15], a[172:175], v[40:43]
    ds_read_b128 a[40:43], v2 offset:51200
    v_cvt_pk_bf16_f32 v93, v46, v47
    v_mfma_f32_16x16x32_bf16 v[44:47], a[12:15], a[188:191], v[108:111]
    v_exp_f32 v23, v23
    v_mfma_f32_16x16x32_bf16 v[44:47], a[8:11], a[184:187], v[44:47]
    v_exp_f32 v24, v24
    v_mfma_f32_16x16x32_bf16 v[44:47], a[4:7], a[180:183], v[44:47]
    ds_read_b128 a[44:47], v2 offset:52224
    v_cvt_pk_bf16_f32 v87, v22, v23
    v_mfma_f32_16x16x32_bf16 v[44:47], a[0:3], a[176:179], v[44:47]
    s_waitcnt lgkmcnt(4)
    v_exp_f32 v25, v25
    v_mfma_f32_16x16x32_bf16 v[48:51], a[16:19], a[128:131], v[116:119]
    v_exp_f32 v26, v26
    v_mfma_f32_16x16x32_bf16 v[48:51], a[20:23], a[132:135], v[48:51]
    v_exp_f32 v27, v27
    v_mfma_f32_16x16x32_bf16 v[48:51], a[24:27], a[136:139], v[48:51]
    v_cvt_pk_bf16_f32 v82, v16, v17
    v_mfma_f32_16x16x32_bf16 v[48:51], a[28:31], a[140:143], v[48:51]
    ds_read_b128 a[48:51], v2 offset:53248
    v_cvt_pk_bf16_f32 v90, v24, v25
    v_mfma_f32_16x16x32_bf16 v[52:55], a[28:31], a[156:159], v[100:103]
    v_exp_f32 v28, v28
    v_mfma_f32_16x16x32_bf16 v[52:55], a[24:27], a[152:155], v[52:55]
    ds_read_b128 a[52:55], v2 offset:54272
    v_cvt_pk_bf16_f32 v91, v26, v27
    v_mfma_f32_16x16x32_bf16 v[52:55], a[20:23], a[148:151], v[52:55]
    v_mfma_f32_16x16x32_bf16 v[52:55], a[16:19], a[144:147], v[52:55]
    v_exp_f32 v29, v29
    v_mfma_f32_16x16x32_bf16 v[56:59], a[16:19], a[160:163], v[104:107]
    v_cvt_pk_bf16_f32 v83, v18, v19
    v_mfma_f32_16x16x32_bf16 v[56:59], a[20:23], a[164:167], v[56:59]
    v_exp_f32 v30, v30
    v_mfma_f32_16x16x32_bf16 v[56:59], a[24:27], a[168:171], v[56:59]
    ds_read_b128 a[56:59], v2 offset:55296
    v_cvt_pk_bf16_f32 v86, v20, v21
    v_mfma_f32_16x16x32_bf16 v[56:59], a[28:31], a[172:175], v[56:59]
    ds_read_b128 a[60:63], v2 offset:56320
    v_mfma_f32_16x16x32_bf16 v[60:63], a[28:31], a[188:191], v[108:111]
    s_add_u32 s57, s57, 32768
    v_exp_f32 v31, v31
    v_mfma_f32_16x16x32_bf16 v[60:63], a[24:27], a[184:187], v[60:63]
    ds_read_b128 a[0:3], v2 offset:57344
    v_cvt_pk_bf16_f32 v95, v30, v31
    v_mfma_f32_16x16x32_bf16 v[60:63], a[20:23], a[180:183], v[60:63]
    v_cvt_pk_bf16_f32 v94, v28, v29
    v_mfma_f32_16x16x32_bf16 v[60:63], a[16:19], a[176:179], v[60:63]
    s_waitcnt lgkmcnt(5)
    s_and_b32 s57, s57, 0x1ffff
    v_mfma_f32_16x16x32_bf16 v[128:131], a[32:35], v[80:83], v[128:131]
    v_exp_f32 v32, v32
    v_mfma_f32_16x16x32_bf16 v[160:163], a[32:35], v[84:87], v[160:163]
    v_mfma_f32_16x16x32_bf16 v[192:195], a[32:35], v[88:91], v[192:195]
    ds_read_b128 a[4:7], v2 offset:58368
    v_mfma_f32_16x16x32_bf16 v[224:227], a[32:35], v[92:95], v[224:227]
    v_exp_f32 v33, v33
    v_mfma_f32_16x16x32_bf16 v[228:231], a[36:39], v[92:95], v[228:231]
    v_exp_f32 v34, v34
    v_mfma_f32_16x16x32_bf16 v[196:199], a[36:39], v[88:91], v[196:199]
    v_exp_f32 v35, v35
    v_mfma_f32_16x16x32_bf16 v[164:167], a[36:39], v[84:87], v[164:167]
    ds_read_b128 a[8:11], v2 offset:59392
    v_mfma_f32_16x16x32_bf16 v[132:135], a[36:39], v[80:83], v[132:135]
    v_exp_f32 v36, v36
    v_mfma_f32_16x16x32_bf16 v[136:139], a[40:43], v[80:83], v[136:139]
    s_sub_u32 s39, s39, 1
    v_exp_f32 v37, v37
    v_mfma_f32_16x16x32_bf16 v[168:171], a[40:43], v[84:87], v[168:171]
    v_exp_f32 v38, v38
    v_mfma_f32_16x16x32_bf16 v[200:203], a[40:43], v[88:91], v[200:203]
    v_mfma_f32_16x16x32_bf16 v[232:235], a[40:43], v[92:95], v[232:235]
    v_exp_f32 v39, v39
    v_smfmac_f32_16x16x64_bf16 a[68:71], a[80:83], v[88:95], v6
    ds_read_b128 a[12:15], v2 offset:60416
    v_mfma_f32_16x16x32_bf16 v[236:239], a[44:47], v[92:95], v[236:239]
    ds_read_b128 a[16:19], v2 offset:61440
    v_mfma_f32_16x16x32_bf16 v[204:207], a[44:47], v[88:91], v[204:207]
    v_exp_f32 v40, v40
    v_mfma_f32_16x16x32_bf16 v[172:175], a[44:47], v[84:87], v[172:175]
    v_exp_f32 v41, v41
    v_mfma_f32_16x16x32_bf16 v[140:143], a[44:47], v[80:83], v[140:143]
    s_waitcnt lgkmcnt(5)
    ds_read_b128 a[20:23], v2 offset:62464
    v_mfma_f32_16x16x32_bf16 v[144:147], a[48:51], v[80:83], v[144:147]
    v_cvt_pk_bf16_f32 v69, v38, v39
    v_mfma_f32_16x16x32_bf16 v[176:179], a[48:51], v[84:87], v[176:179]
    ds_read_b128 a[24:27], v2 offset:63488
    v_mfma_f32_16x16x32_bf16 v[208:211], a[48:51], v[88:91], v[208:211]
    v_exp_f32 v42, v42
    v_mfma_f32_16x16x32_bf16 v[240:243], a[48:51], v[92:95], v[240:243]
    v_cvt_pk_bf16_f32 v68, v36, v37
    v_mfma_f32_16x16x32_bf16 v[244:247], a[52:55], v[92:95], v[244:247]
    s_cmp_lg_u32 s39, s60
    v_exp_f32 v43, v43
    v_mfma_f32_16x16x32_bf16 v[212:215], a[52:55], v[88:91], v[212:215]
    v_cvt_pk_bf16_f32 v65, v34, v35
    v_cvt_pk_bf16_f32 v72, v40, v41
    v_mfma_f32_16x16x32_bf16 v[180:183], a[52:55], v[84:87], v[180:183]
    v_exp_f32 v44, v44
    v_mfma_f32_16x16x32_bf16 v[148:151], a[52:55], v[80:83], v[148:151]
    v_exp_f32 v45, v45
    v_smfmac_f32_16x16x64_bf16 a[64:67], a[80:83], v[80:87], v6
    ds_read_b128 a[28:31], v2 offset:64512
    v_mfma_f32_16x16x32_bf16 v[152:155], a[56:59], v[80:83], v[152:155]
    v_cvt_pk_bf16_f32 v73, v42, v43
    v_mfma_f32_16x16x32_bf16 v[184:187], a[56:59], v[84:87], v[184:187]
    v_exp_f32 v46, v46
    v_mfma_f32_16x16x32_bf16 v[216:219], a[56:59], v[88:91], v[216:219]
    v_cvt_pk_bf16_f32 v64, v32, v33
    v_cvt_pk_bf16_f32 v76, v44, v45
    v_mfma_f32_16x16x32_bf16 v[248:251], a[56:59], v[92:95], v[248:251]
    v_exp_f32 v47, v47
    v_mfma_f32_16x16x32_bf16 v[252:255], a[60:63], v[92:95], v[252:255]
    v_cvt_pk_bf16_f32 v77, v46, v47
    v_add_u32 v2, s58, v11
    v_mfma_f32_16x16x32_bf16 v[220:223], a[60:63], v[88:91], v[220:223]
    s_waitcnt vmcnt(16) lgkmcnt(0)
    s_barrier
    v_mfma_f32_16x16x32_bf16 v[188:191], a[60:63], v[84:87], v[188:191]
    v_exp_f32 v48, v48
    v_mfma_f32_16x16x32_bf16 v[156:159], a[60:63], v[80:83], v[156:159]
    s_cbranch_scc1 L_loopA
    s_cmp_eq_u32 s39, 0
    s_cbranch_scc1 L_blkB
L_tripV:
    v_mfma_f32_16x16x32_bf16 v[32:35], a[0:3], a[128:131], v[96:99]
    v_exp_f32 v49, v49
    v_accvgpr_read_b32 v13, a84
    v_mfma_f32_16x16x32_bf16 v[32:35], a[4:7], a[132:135], v[32:35]
    v_exp_f32 v50, v50
    v_mfma_f32_16x16x32_bf16 v[32:35], a[8:11], a[136:139], v[32:35]
    v_cvt_pk_bf16_f32 v66, v48, v49
    v_xor_b32 v14, 32, v13
    v_mfma_f32_16x16x32_bf16 v[32:35], a[12:15], a[140:143], v[32:35]
    v_exp_f32 v51, v51
    v_mfma_f32_16x16x32_bf16 v[36:39], a[12:15], a[156:159], v[100:103]
    v_subrev_u32 v15, 64, v15
    v_cmp_gt_i32 s[44:45], 0, v15
    v_mfma_f32_16x16x32_bf16 v[36:39], a[8:11], a[152:155], v[36:39]
    s_add_u32 s58, s58, 32768
    v_exp_f32 v52, v52
    v_mfma_f32_16x16x32_bf16 v[36:39], a[4:7], a[148:151], v[36:39]
    v_exp_f32 v53, v53
    v_mfma_f32_16x16x32_bf16 v[36:39], a[0:3], a[144:147], v[36:39]
    s_and_b32 s58, s58, 0x1ffff
    v_exp_f32 v54, v54
    v_mfma_f32_16x16x32_bf16 v[40:43], a[0:3], a[160:163], v[104:107]
    v_exp_f32 v55, v55
    v_mfma_f32_16x16x32_bf16 v[40:43], a[4:7], a[164:167], v[40:43]
    s_add_u32 m0, s57, 32768
    v_exp_f32 v56, v56
    v_cmp_gt_i32 s[46:47], 1, v15
    v_mfma_f32_16x16x32_bf16 v[40:43], a[8:11], a[168:171], v[40:43]
    ds_read_b128 a[32:35], v2 offset:32768
    buffer_load_dwordx4 v11, s[4:7], s56 offen offset:0 sc1 lds
    v_exp_f32 v57, v57
    v_mfma_f32_16x16x32_bf16 v[40:43], a[12:15], a[172:175], v[40:43]
    v_exp_f32 v58, v58
    v_mfma_f32_16x16x32_bf16 v[44:47], a[12:15], a[188:191], v[108:111]
    v_exp_f32 v59, v59
    v_mfma_f32_16x16x32_bf16 v[44:47], a[8:11], a[184:187], v[44:47]
    v_exp_f32 v60, v60
    v_mfma_f32_16x16x32_bf16 v[44:47], a[4:7], a[180:183], v[44:47]
    v_exp_f32 v61, v61
    v_mfma_f32_16x16x32_bf16 v[44:47], a[0:3], a[176:179], v[44:47]
    buffer_load_dwordx4 v11, s[4:7], s56 offen offset:1024 sc1 lds
    v_mfma_f32_16x16x32_bf16 v[16:19], a[16:19], a[128:131], v[96:99]
    v_cvt_pk_bf16_f32 v71, v54, v55
    v_cmp_gt_i32 s[48:49], 2, v15
    v_mfma_f32_16x16x32_bf16 v[16:19], a[20:23], a[132:135], v[16:19]
    v_cvt_pk_bf16_f32 v74, v56, v57
    v_cmp_gt_i32 s[50:51], 3, v15
    v_mfma_f32_16x16x32_bf16 v[16:19], a[24:27], a[136:139], v[16:19]
    v_cndmask_b32 v112, v96, v5, s[44:45]
    v_cndmask_b32 v113, v96, v5, s[46:47]
    v_mfma_f32_16x16x32_bf16 v[16:19], a[28:31], a[140:143], v[16:19]
    buffer_load_dwordx4 v11, s[4:7], s56 offen offset:2048 sc1 lds
    v_mfma_f32_16x16x32_bf16 v[20:23], a[28:31], a[156:159], v[100:103]
    v_exp_f32 v62, v62
    v_mfma_f32_16x16x32_bf16 v[20:23], a[24:27], a[152:155], v[20:23]
    ds_read_b128 a[36:39], v2 offset:33792
    v_cndmask_b32 v114, v96, v5, s[48:49]
    v_mfma_f32_16x16x32_bf16 v[20:23], a[20:23], a[148:151], v[20:23]
    s_waitcnt vmcnt(11)
    v_exp_f32 v63, v63
    v_mfma_f32_16x16x32_bf16 v[20:23], a[16:19], a[144:147], v[20:23]
    ds_read_b64_tr_b16 a[192:193], v13 offset:0
    ds_read_b64_tr_b16 a[194:195], v13 offset:4096
    v_mfma_f32_16x16x32_bf16 v[24:27], a[16:19], a[160:163], v[104:107]
    buffer_load_dwordx4 v11, s[4:7], s56 offen offset:3072 sc1 lds
    v_mfma_f32_16x16x32_bf16 v[24:27], a[20:23], a[164:167], v[24:27]
    ds_read_b128 a[40:43], v2 offset:34816
    ds_read_b64_tr_b16 a[196:197], v14 offset:0
    v_mfma_f32_16x16x32_bf16 v[24:27], a[24:27], a[168:171], v[24:27]
    ds_read_b128 a[44:47], v2 offset:35840
    v_cvt_pk_bf16_f32 v78, v60, v61
    v_mfma_f32_16x16x32_bf16 v[24:27], a[28:31], a[172:175], v[24:27]
    v_cvt_pk_bf16_f32 v67, v50, v51
    v_cvt_pk_bf16_f32 v75, v58, v59
    v_mfma_f32_16x16x32_bf16 v[28:31], a[28:31], a[188:191], v[108:111]
    ds_read_b64_tr_b16 a[198:199], v14 offset:4096
    ds_read_b64_tr_b16 a[200:201], v13 offset:256
    v_mfma_f32_16x16x32_bf16 v[28:31], a[24:27], a[184:187], v[28:31]
    ds_read_b128 a[48:51], v2 offset:36864
    ds_read_b128 a[52:55], v2 offset:37888
    v_mfma_f32_16x16x32_bf16 v[28:31], a[20:23], a[180:183], v[28:31]
    v_cvt_pk_bf16_f32 v70, v52, v53
    v_cvt_pk_bf16_f32 v79, v62, v63
    v_mfma_f32_16x16x32_bf16 v[28:31], a[16:19], a[176:179], v[28:31]
    s_waitcnt lgkmcnt(4)
    v_cndmask_b32 v115, v96, v5, s[50:51]
    v_cmp_gt_i32 s[44:45], 16, v15
    v_mfma_f32_16x16x32_bf16 v[128:131], a[32:35], v[64:67], v[128:131]
    ds_read_b128 a[56:59], v2 offset:38912
    v_cmp_gt_i32 s[46:47], 17, v15
    v_mfma_f32_16x16x32_bf16 v[160:163], a[32:35], v[68:71], v[160:163]
    v_exp_f32 v32, v32
    v_mfma_f32_16x16x32_bf16 v[192:195], a[32:35], v[72:75], v[192:195]
    ds_read_b64_tr_b16 a[202:203], v13 offset:4352
    v_exp_f32 v33, v33
    v_cmp_gt_i32 s[48:49], 18, v15
    v_mfma_f32_16x16x32_bf16 v[224:227], a[32:35], v[76:79], v[224:227]
    ds_read_b64_tr_b16 a[204:205], v14 offset:256
    ds_read_b64_tr_b16 a[206:207], v14 offset:4352
    ds_read_b64_tr_b16 a[208:209], v13 offset:512
    v_mfma_f32_16x16x32_bf16 v[228:231], a[36:39], v[76:79], v[228:231]
    ds_read_b64_tr_b16 a[210:211], v13 offset:4608
    ds_read_b64_tr_b16 a[212:213], v14 offset:512
    v_mfma_f32_16x16x32_bf16 v[196:199], a[36:39], v[72:75], v[196:199]
    v_exp_f32 v34, v34
    v_mfma_f32_16x16x32_bf16 v[164:167], a[36:39], v[68:71], v[164:167]
    v_exp_f32 v35, v35
    v_mfma_f32_16x16x32_bf16 v[132:135], a[36:39], v[64:67], v[132:135]
    ds_read_b64_tr_b16 a[214:215], v14 offset:4608
    v_cmp_gt_i32 s[50:51], 19, v15
    v_mfma_f32_16x16x32_bf16 v[136:139], a[40:43], v[64:67], v[136:139]
    ds_read_b128 a[60:63], v2 offset:39936
    ds_read_b64_tr_b16 a[216:217], v13 offset:768
    v_mfma_f32_16x16x32_bf16 v[168:171], a[40:43], v[68:71], v[168:171]
    ds_read_b128 a[0:3], v2 offset:40960
    ds_read_b64_tr_b16 a[218:219], v13 offset:4864
    ds_read_b64_tr_b16 a[220:221], v14 offset:768
    v_mfma_f32_16x16x32_bf16 v[200:203], a[40:43], v[72:75], v[200:203]
    ds_read_b128 a[4:7], v2 offset:41984
    ds_read_b64_tr_b16 a[222:223], v14 offset:4864
    v_cndmask_b32 v116, v96, v5, s[44:45]
    v_mfma_f32_16x16x32_bf16 v[232:235], a[40:43], v[76:79], v[232:235]
    v_cndmask_b32 v117, v96, v5, s[46:47]
    v_accvgpr_read_b32 v13, a86
    v_smfmac_f32_16x16x64_bf16 a[68:71], a[80:83], v[72:79], v6
    ds_read_b128 a[8:11], v2 offset:43008
    v_cvt_pk_bf16_f32 v81, v34, v35
    v_mfma_f32_16x16x32_bf16 v[236:239], a[44:47], v[76:79], v[236:239]
    buffer_load_dword v13, v13, s[28:31], s88 offen offset:32 sc0 sc1
    v_mfma_f32_16x16x32_bf16 v[204:207], a[44:47], v[72:75], v[204:207]
    v_exp_f32 v36, v36
    v_mfma_f32_16x16x32_bf16 v[172:175], a[44:47], v[68:71], v[172:175]
    s_add_u32 s56, s56, 4096
    v_exp_f32 v37, v37
    v_mfma_f32_16x16x32_bf16 v[140:143], a[44:47], v[64:67], v[140:143]
    s_waitcnt lgkmcnt(7)
    v_exp_f32 v38, v38
    v_mfma_f32_16x16x32_bf16 v[144:147], a[48:51], v[64:67], v[144:147]
    v_exp_f32 v39, v39
    v_mfma_f32_16x16x32_bf16 v[176:179], a[48:51], v[68:71], v[176:179]
    s_waitcnt lgkmcnt(1)
    v_exp_f32 v40, v40
    v_mfma_f32_16x16x32_bf16 v[208:211], a[48:51], v[72:75], v[208:211]
    v_exp_f32 v41, v41
    v_mfma_f32_16x16x32_bf16 v[240:243], a[48:51], v[76:79], v[240:243]
    buffer_store_dwordx4 a[192:195], v11, s[32:35], s65 offen offset:0 sc1
    v_mfma_f32_16x16x32_bf16 v[244:247], a[52:55], v[76:79], v[244:247]
    v_exp_f32 v42, v42
    v_mfma_f32_16x16x32_bf16 v[212:215], a[52:55], v[72:75], v[212:215]
    v_exp_f32 v43, v43
    v_mfma_f32_16x16x32_bf16 v[180:183], a[52:55], v[68:71], v[180:183]
    v_exp_f32 v44, v44
    v_mfma_f32_16x16x32_bf16 v[148:151], a[52:55], v[64:67], v[148:151]
    buffer_store_dwordx4 a[196:199], v11, s[32:35], s65 offen offset:1024 sc1
    v_cvt_pk_bf16_f32 v88, v40, v41
    v_smfmac_f32_16x16x64_bf16 a[64:67], a[80:83], v[64:71], v6
    ds_read_b128 a[12:15], v2 offset:44032
    v_cndmask_b32 v118, v96, v5, s[48:49]
    v_mfma_f32_16x16x32_bf16 v[152:155], a[56:59], v[64:67], v[152:155]
    v_exp_f32 v45, v45
    v_mfma_f32_16x16x32_bf16 v[184:187], a[56:59], v[68:71], v[184:187]
    v_exp_f32 v46, v46
    v_mfma_f32_16x16x32_bf16 v[216:219], a[56:59], v[72:75], v[216:219]
    v_cvt_pk_bf16_f32 v89, v42, v43
    v_cvt_pk_bf16_f32 v92, v44, v45
    v_mfma_f32_16x16x32_bf16 v[248:251], a[56:59], v[76:79], v[248:251]
    ds_read_b128 a[16:19], v2 offset:45056
    v_cvt_pk_bf16_f32 v84, v36, v37
    v_mfma_f32_16x16x32_bf16 v[252:255], a[60:63], v[76:79], v[252:255]
    buffer_store_dwordx4 a[200:203], v11, s[32:35], s65 offen offset:2048 sc1
    v_mfma_f32_16x16x32_bf16 v[220:223], a[60:63], v[72:75], v[220:223]
    s_add_u32 m0, s57, 36864
    v_cvt_pk_bf16_f32 v80, v32, v33
    v_cndmask_b32 v119, v96, v5, s[50:51]
    v_mfma_f32_16x16x32_bf16 v[188:191], a[60:63], v[68:71], v[188:191]
    v_exp_f32 v47, v47
    v_mfma_f32_16x16x32_bf16 v[156:159], a[60:63], v[64:67], v[156:159]
    s_waitcnt lgkmcnt(1)
    v_exp_f32 v16, v16
    v_mfma_f32_16x16x32_bf16 v[32:35], a[0:3], a[128:131], v[112:115]
    v_exp_f32 v17, v17
    v_mfma_f32_16x16x32_bf16 v[32:35], a[4:7], a[132:135], v[32:35]
    ds_read_b128 a[20:23], v2 offset:46080
    v_cvt_pk_bf16_f32 v85, v38, v39
    v_mfma_f32_16x16x32_bf16 v[32:35], a[8:11], a[136:139], v[32:35]
    v_exp_f32 v18, v18
    v_mfma_f32_16x16x32_bf16 v[32:35], a[12:15], a[140:143], v[32:35]
    buffer_store_dwordx4 a[204:207], v11, s[32:35], s65 offen offset:3072 sc1
    v_mfma_f32_16x16x32_bf16 v[36:39], a[12:15], a[156:159], v[100:103]
    v_exp_f32 v19, v19
    v_mfma_f32_16x16x32_bf16 v[36:39], a[8:11], a[152:155], v[36:39]
    ds_read_b128 a[24:27], v2 offset:47104
    ds_read_b128 a[28:31], v2 offset:48128
    v_mfma_f32_16x16x32_bf16 v[36:39], a[4:7], a[148:151], v[36:39]
    ds_read_b128 a[32:35], v2 offset:49152
    v_cvt_pk_bf16_f32 v93, v46, v47
    v_mfma_f32_16x16x32_bf16 v[36:39], a[0:3], a[144:147], v[36:39]
    buffer_store_dwordx4 a[208:211], v11, s[32:35], s62 offen offset:0 sc1
    v_mfma_f32_16x16x32_bf16 v[40:43], a[0:3], a[160:163], v[104:107]
    ds_read_b128 a[36:39], v2 offset:50176
    ds_read_b128 a[40:43], v2 offset:51200
    v_mfma_f32_16x16x32_bf16 v[40:43], a[4:7], a[164:167], v[40:43]
    v_exp_f32 v20, v20
    v_mfma_f32_16x16x32_bf16 v[40:43], a[8:11], a[168:171], v[40:43]
    buffer_store_dwordx4 a[212:215], v11, s[32:35], s62 offen offset:1024 sc1
    v_mfma_f32_16x16x32_bf16 v[40:43], a[12:15], a[172:175], v[40:43]
    v_exp_f32 v21, v21
    v_mfma_f32_16x16x32_bf16 v[44:47], a[12:15], a[188:191], v[108:111]
    v_exp_f32 v22, v22
    v_mfma_f32_16x16x32_bf16 v[44:47], a[8:11], a[184:187], v[44:47]
    v_exp_f32 v23, v23
    v_mfma_f32_16x16x32_bf16 v[44:47], a[4:7], a[180:183], v[44:47]
    buffer_store_dwordx4 a[216:219], v11, s[32:35], s62 offen offset:2048 sc1
    v_mfma_f32_16x16x32_bf16 v[44:47], a[0:3], a[176:179], v[44:47]
    s_waitcnt lgkmcnt(3)
    v_exp_f32 v24, v24
    v_mfma_f32_16x16x32_bf16 v[48:51], a[16:19], a[128:131], v[116:119]
    buffer_store_dwordx4 a[220:223], v11, s[32:35], s62 offen offset:3072 sc1
    v_mfma_f32_16x16x32_bf16 v[48:51], a[20:23], a[132:135], v[48:51]
    v_exp_f32 v25, v25
    v_mfma_f32_16x16x32_bf16 v[48:51], a[24:27], a[136:139], v[48:51]
    v_exp_f32 v26, v26
    v_mfma_f32_16x16x32_bf16 v[48:51], a[28:31], a[140:143], v[48:51]
    ds_read_b128 a[44:47], v2 offset:52224
    v_cvt_pk_bf16_f32 v83, v18, v19
    v_mfma_f32_16x16x32_bf16 v[52:55], a[28:31], a[156:159], v[100:103]
    ds_read_b128 a[48:51], v2 offset:53248
    v_cvt_pk_bf16_f32 v86, v20, v21
    v_mfma_f32_16x16x32_bf16 v[52:55], a[24:27], a[152:155], v[52:55]
L_ws_6790:
    s_cbranch_execz L_wr_a
    v_exp_f32 v27, v27
    v_mfma_f32_16x16x32_bf16 v[52:55], a[20:23], a[148:151], v[52:55]
    v_exp_f32 v28, v28
    v_mfma_f32_16x16x32_bf16 v[52:55], a[16:19], a[144:147], v[52:55]
    buffer_load_dwordx4 v11, s[4:7], s56 offen offset:0 sc1 lds
    v_mfma_f32_16x16x32_bf16 v[56:59], a[16:19], a[160:163], v[104:107]
    v_exp_f32 v29, v29
    v_mfma_f32_16x16x32_bf16 v[56:59], a[20:23], a[164:167], v[56:59]
    v_exp_f32 v30, v30
    v_mfma_f32_16x16x32_bf16 v[56:59], a[24:27], a[168:171], v[56:59]
    v_exp_f32 v31, v31
    v_mfma_f32_16x16x32_bf16 v[56:59], a[28:31], a[172:175], v[56:59]
    buffer_load_dwordx4 v11, s[4:7], s56 offen offset:1024 sc1 lds
    v_mfma_f32_16x16x32_bf16 v[60:63], a[28:31], a[188:191], v[108:111]
    v_cvt_pk_bf16_f32 v82, v16, v17
    v_cvt_pk_bf16_f32 v91, v26, v27
    v_mfma_f32_16x16x32_bf16 v[60:63], a[24:27], a[184:187], v[60:63]
    v_cvt_pk_bf16_f32 v87, v22, v23
    v_cvt_pk_bf16_f32 v95, v30, v31
    v_mfma_f32_16x16x32_bf16 v[60:63], a[20:23], a[180:183], v[60:63]
    v_cvt_pk_bf16_f32 v90, v24, v25
    v_cvt_pk_bf16_f32 v94, v28, v29
    v_mfma_f32_16x16x32_bf16 v[60:63], a[16:19], a[176:179], v[60:63]
    s_waitcnt lgkmcnt(1)
    ds_read_b128 a[52:55], v2 offset:54272
    v_mfma_f32_16x16x32_bf16 v[128:131], a[32:35], v[80:83], v[128:131]
    v_exp_f32 v32, v32
    v_mfma_f32_16x16x32_bf16 v[160:163], a[32:35], v[84:87], v[160:163]
    v_exp_f32 v33, v33
    v_mfma_f32_16x16x32_bf16 v[192:195], a[32:35], v[88:91], v[192:195]
    buffer_load_dwordx4 v11, s[4:7], s56 offen offset:2048 sc1 lds
    v_mfma_f32_16x16x32_bf16 v[224:227], a[32:35], v[92:95], v[224:227]
    v_exp_f32 v34, v34
    v_mfma_f32_16x16x32_bf16 v[228:231], a[36:39], v[92:95], v[228:231]
    ds_read_b128 a[56:59], v2 offset:55296
    v_mfma_f32_16x16x32_bf16 v[196:199], a[36:39], v[88:91], v[196:199]
    v_exp_f32 v35, v35
    v_mfma_f32_16x16x32_bf16 v[164:167], a[36:39], v[84:87], v[164:167]
    ds_read_b128 a[60:63], v2 offset:56320
    ds_read_b128 a[0:3], v2 offset:57344
    v_mfma_f32_16x16x32_bf16 v[132:135], a[36:39], v[80:83], v[132:135]
    v_mfma_f32_16x16x32_bf16 v[136:139], a[40:43], v[80:83], v[136:139]
    v_mfma_f32_16x16x32_bf16 v[168:171], a[40:43], v[84:87], v[168:171]
    ds_read_b128 a[4:7], v2 offset:58368
    ds_read_b128 a[8:11], v2 offset:59392
    v_mfma_f32_16x16x32_bf16 v[200:203], a[40:43], v[88:91], v[200:203]
    v_exp_f32 v36, v36
    v_mfma_f32_16x16x32_bf16 v[232:235], a[40:43], v[92:95], v[232:235]
    v_exp_f32 v37, v37
    v_smfmac_f32_16x16x64_bf16 a[68:71], a[80:83], v[88:95], v6
    buffer_load_dwordx4 v11, s[4:7], s56 offen offset:3072 sc1 lds
    v_mfma_f32_16x16x32_bf16 v[236:239], a[44:47], v[92:95], v[236:239]
    s_add_u32 s56, s56, 28672
    v_exp_f32 v38, v38
    v_mfma_f32_16x16x32_bf16 v[204:207], a[44:47], v[88:91], v[204:207]
    ds_read_b128 a[12:15], v2 offset:60416
    ds_read_b128 a[16:19], v2 offset:61440
    v_mfma_f32_16x16x32_bf16 v[172:175], a[44:47], v[84:87], v[172:175]
    v_exp_f32 v39, v39
    v_mfma_f32_16x16x32_bf16 v[140:143], a[44:47], v[80:83], v[140:143]
    s_waitcnt lgkmcnt(5)
    ds_read_b128 a[20:23], v2 offset:62464
    v_mfma_f32_16x16x32_bf16 v[144:147], a[48:51], v[80:83], v[144:147]
    v_exp_f32 v40, v40
    v_mfma_f32_16x16x32_bf16 v[176:179], a[48:51], v[84:87], v[176:179]
    s_add_u32 s57, s57, 32768
    v_exp_f32 v41, v41
    v_mfma_f32_16x16x32_bf16 v[208:211], a[48:51], v[88:91], v[208:211]
    v_exp_f32 v42, v42
    v_mfma_f32_16x16x32_bf16 v[240:243], a[48:51], v[92:95], v[240:243]
    s_and_b32 s57, s57, 0x1ffff
    v_exp_f32 v43, v43
    v_mfma_f32_16x16x32_bf16 v[244:247], a[52:55], v[92:95], v[244:247]
    v_exp_f32 v44, v44
    v_mfma_f32_16x16x32_bf16 v[212:215], a[52:55], v[88:91], v[212:215]
    v_exp_f32 v45, v45
    v_mfma_f32_16x16x32_bf16 v[180:183], a[52:55], v[84:87], v[180:183]
    s_sub_u32 s39, s39, 1
    v_exp_f32 v46, v46
    v_mfma_f32_16x16x32_bf16 v[148:151], a[52:55], v[80:83], v[148:151]
    ds_read_b128 a[24:27], v2 offset:63488
    ds_read_b128 a[28:31], v2 offset:64512
    v_smfmac_f32_16x16x64_bf16 a[64:67], a[80:83], v[80:87], v6
    v_add_u32 v2, s58, v11
    v_mfma_f32_16x16x32_bf16 v[152:155], a[56:59], v[80:83], v[152:155]
    s_mov_b32 s60, 0
    v_cvt_pk_bf16_f32 v69, v38, v39
    v_cvt_pk_bf16_f32 v73, v42, v43
    v_mfma_f32_16x16x32_bf16 v[184:187], a[56:59], v[84:87], v[184:187]
    v_exp_f32 v47, v47
    v_mfma_f32_16x16x32_bf16 v[216:219], a[56:59], v[88:91], v[216:219]
    v_exp_f32 v48, v48
    v_mfma_f32_16x16x32_bf16 v[248:251], a[56:59], v[92:95], v[248:251]
    v_cvt_pk_bf16_f32 v64, v32, v33
    v_cvt_pk_bf16_f32 v68, v36, v37
    v_mfma_f32_16x16x32_bf16 v[252:255], a[60:63], v[92:95], v[252:255]
    v_cvt_pk_bf16_f32 v65, v34, v35
    v_cvt_pk_bf16_f32 v72, v40, v41
    v_mfma_f32_16x16x32_bf16 v[220:223], a[60:63], v[88:91], v[220:223]
    s_waitcnt vmcnt(4) lgkmcnt(0)
    s_barrier
    v_mfma_f32_16x16x32_bf16 v[188:191], a[60:63], v[84:87], v[188:191]
    v_cvt_pk_bf16_f32 v76, v44, v45
    v_cvt_pk_bf16_f32 v77, v46, v47
    v_mfma_f32_16x16x32_bf16 v[156:159], a[60:63], v[80:83], v[156:159]
    v_cmp_ne_u32 vcc, 1, v13
    s_nop 0
    s_cmp_eq_u64 vcc, 0
    s_cbranch_scc1 L_k2a_ok
L_k2a_no:
    s_mov_b32 s0, 0x40000
L_k2a_spin:
    v_accvgpr_read_b32 v13, a86
    buffer_load_dword v13, v13, s[28:31], s88 offen offset:32 sc0 sc1
    s_waitcnt vmcnt(0)
    v_cmp_ne_u32 vcc, 1, v13
    s_nop 0
    s_cmp_eq_u64 vcc, 0
    s_cbranch_scc1 L_k2a_ok
L_k2a_again:
    s_sleep 4
    s_sub_u32 s0, s0, 1
    s_cmp_lg_u32 s0, 0
    s_cbranch_scc1 L_k2a_spin
L_k2a_ok:
    s_cmp_lg_u32 s85, 0
    s_cbranch_scc1 L_more
    buffer_store_dword v7, v0, s[28:31], s89 offen sc1
    s_mov_b32 s89, 0x40000000
    s_cmp_lg_u32 s39, 0
    s_cbranch_scc1 L_loopA
L_blkB:
    s_lshl_b32 s40, s38, 8
    s_sub_u32 s40, 1792, s40
    s_lshl_b32 s39, s38, 2
    s_sub_u32 s39, 28, s39
    v_mfma_f32_16x16x32_bf16 v[32:35], a[0:3], a[128:131], v[120:123]
    v_exp_f32 v49, v49
    v_mfma_f32_16x16x32_bf16 v[32:35], a[4:7], a[132:135], v[32:35]
    s_add_u32 s8, s90, 36700160
    s_addc_u32 s9, s91, 0
    v_cvt_pk_bf16_f32 v66, v48, v49
    v_mfma_f32_16x16x32_bf16 v[32:35], a[8:11], a[136:139], v[32:35]
    s_add_u32 s58, s58, 32768
    v_exp_f32 v50, v50
    v_mfma_f32_16x16x32_bf16 v[32:35], a[12:15], a[140:143], v[32:35]
    s_and_b32 s58, s58, 0x1ffff
    v_exp_f32 v51, v51
    v_subrev_u32 v15, 64, v4
    v_mfma_f32_16x16x32_bf16 v[36:39], a[12:15], a[156:159], v[100:103]
    ds_read_b128 a[32:35], v2 offset:32768
    v_exp_f32 v52, v52
    v_mfma_f32_16x16x32_bf16 v[36:39], a[8:11], a[152:155], v[36:39]
    s_mov_b32 s10, 23855104
    v_exp_f32 v53, v53
    v_mfma_f32_16x16x32_bf16 v[36:39], a[4:7], a[148:151], v[36:39]
    ds_read_b128 a[36:39], v2 offset:33792
    v_cmp_gt_i32 s[44:45], 0, v15
    v_mfma_f32_16x16x32_bf16 v[36:39], a[0:3], a[144:147], v[36:39]
    ds_read_b128 a[40:43], v2 offset:34816
    v_cmp_gt_i32 s[46:47], 1, v15
    v_mfma_f32_16x16x32_bf16 v[40:43], a[0:3], a[160:163], v[104:107]
    v_exp_f32 v54, v54
    v_mfma_f32_16x16x32_bf16 v[40:43], a[4:7], a[164:167], v[40:43]
    s_mov_b32 s11, 0x00020000
    v_exp_f32 v55, v55
    v_mfma_f32_16x16x32_bf16 v[40:43], a[8:11], a[168:171], v[40:43]
    s_add_u32 s12, s90, 60817408
    s_addc_u32 s13, s91, 0
    v_cmp_gt_i32 s[48:49], 2, v15
    v_mfma_f32_16x16x32_bf16 v[40:43], a[12:15], a[172:175], v[40:43]
    v_exp_f32 v56, v56
    v_mfma_f32_16x16x32_bf16 v[44:47], a[12:15], a[188:191], v[108:111]
    s_mov_b32 s14, 7454720
    v_exp_f32 v57, v57
    v_mov_b32 v96, -1
    v_mfma_f32_16x16x32_bf16 v[44:47], a[8:11], a[184:187], v[44:47]
    v_exp_f32 v58, v58
    v_mfma_f32_16x16x32_bf16 v[44:47], a[4:7], a[180:183], v[44:47]
    ds_read_b128 a[44:47], v2 offset:35840
    ds_read_b128 a[48:51], v2 offset:36864
    v_cmp_gt_i32 s[50:51], 3, v15
    v_mfma_f32_16x16x32_bf16 v[44:47], a[0:3], a[176:179], v[44:47]
    ds_read_b128 a[52:55], v2 offset:37888
    v_mov_b32 v97, -1
    v_mfma_f32_16x16x32_bf16 v[16:19], a[16:19], a[128:131], v[124:127]
    v_cndmask_b32 v112, v100, v5, s[44:45]
    v_cndmask_b32 v113, v100, v5, s[46:47]
    v_mfma_f32_16x16x32_bf16 v[16:19], a[20:23], a[132:135], v[16:19]
    ds_read_b128 a[56:59], v2 offset:38912
    v_cvt_pk_bf16_f32 v71, v54, v55
    v_mfma_f32_16x16x32_bf16 v[16:19], a[24:27], a[136:139], v[16:19]
    s_mov_b32 s15, 0x00020000
    v_cvt_pk_bf16_f32 v74, v56, v57
    v_mov_b32 v98, -1
    v_mfma_f32_16x16x32_bf16 v[16:19], a[28:31], a[140:143], v[16:19]
    s_and_b32 s0, s36, 1
    v_exp_f32 v59, v59
    v_mfma_f32_16x16x32_bf16 v[20:23], a[28:31], a[156:159], v[100:103]
    s_add_u32 m0, s57, 32768
    v_cvt_pk_bf16_f32 v70, v52, v53
    v_cndmask_b32 v114, v100, v5, s[48:49]
    v_mfma_f32_16x16x32_bf16 v[20:23], a[24:27], a[152:155], v[20:23]
    s_lshr_b32 s1, s36, 1
    v_exp_f32 v60, v60
    v_mfma_f32_16x16x32_bf16 v[20:23], a[20:23], a[148:151], v[20:23]
    s_lshl_b32 s16, s77, 1
    v_exp_f32 v61, v61
    v_mfma_f32_16x16x32_bf16 v[20:23], a[16:19], a[144:147], v[20:23]
    ds_read_b128 a[60:63], v2 offset:39936
    v_cvt_pk_bf16_f32 v75, v58, v59
    v_mfma_f32_16x16x32_bf16 v[24:27], a[16:19], a[160:163], v[104:107]
    v_exp_f32 v62, v62
    v_mfma_f32_16x16x32_bf16 v[24:27], a[20:23], a[164:167], v[24:27]
    v_cndmask_b32 v115, v100, v5, s[50:51]
    v_mov_b32 v99, -1
    v_mfma_f32_16x16x32_bf16 v[24:27], a[24:27], a[168:171], v[24:27]
    s_add_u32 s3, s79, 0
    v_exp_f32 v63, v63
    v_mfma_f32_16x16x32_bf16 v[24:27], a[28:31], a[172:175], v[24:27]
    ds_read_b128 a[0:3], v2 offset:40960
    v_cvt_pk_bf16_f32 v79, v62, v63
    v_mfma_f32_16x16x32_bf16 v[28:31], a[28:31], a[188:191], v[108:111]
    buffer_load_dwordx4 v11, s[4:7], s56 offen offset:0 sc1 lds
    v_mfma_f32_16x16x32_bf16 v[28:31], a[24:27], a[184:187], v[28:31]
    s_add_u32 s16, s16, s0
    v_cvt_pk_bf16_f32 v67, v50, v51
    v_cvt_pk_bf16_f32 v78, v60, v61
    v_mfma_f32_16x16x32_bf16 v[28:31], a[20:23], a[180:183], v[28:31]
    ds_read_b128 a[4:7], v2 offset:41984
    ds_read_b128 a[8:11], v2 offset:43008
    v_mfma_f32_16x16x32_bf16 v[28:31], a[16:19], a[176:179], v[28:31]
    s_waitcnt lgkmcnt(7)
    v_cmp_gt_i32 s[44:45], 16, v15
    v_cmp_gt_i32 s[46:47], 17, v15
    v_mfma_f32_16x16x32_bf16 v[128:131], a[32:35], v[64:67], v[128:131]
    v_exp_f32 v32, v32
    v_mfma_f32_16x16x32_bf16 v[160:163], a[32:35], v[68:71], v[160:163]
    buffer_store_dwordx4 v[96:99], v11, s[28:31], s3 offen sc1
    v_mfma_f32_16x16x32_bf16 v[192:195], a[32:35], v[72:75], v[192:195]
    s_lshl_b32 s16, s16, 12
    v_cmp_gt_i32 s[48:49], 18, v15
    v_cmp_gt_i32 s[50:51], 19, v15
    v_mfma_f32_16x16x32_bf16 v[224:227], a[32:35], v[76:79], v[224:227]
    s_lshl_b32 s17, s78, 1
    v_cndmask_b32 v116, v100, v5, s[44:45]
    v_cndmask_b32 v117, v100, v5, s[46:47]
    v_mfma_f32_16x16x32_bf16 v[228:231], a[36:39], v[76:79], v[228:231]
    v_exp_f32 v33, v33
    v_mfma_f32_16x16x32_bf16 v[196:199], a[36:39], v[72:75], v[196:199]
    s_add_u32 s17, s17, s0
    v_exp_f32 v34, v34
    v_mfma_f32_16x16x32_bf16 v[164:167], a[36:39], v[68:71], v[164:167]
    buffer_load_dwordx4 v11, s[4:7], s56 offen offset:1024 sc1 lds
    v_mfma_f32_16x16x32_bf16 v[132:135], a[36:39], v[64:67], v[132:135]
    s_add_u32 s3, s79, 1024
    v_exp_f32 v35, v35
    v_mfma_f32_16x16x32_bf16 v[136:139], a[40:43], v[64:67], v[136:139]
    v_exp_f32 v36, v36
    v_mfma_f32_16x16x32_bf16 v[168:171], a[40:43], v[68:71], v[168:171]
    ds_read_b128 a[12:15], v2 offset:44032
    ds_read_b128 a[16:19], v2 offset:45056
    v_mfma_f32_16x16x32_bf16 v[200:203], a[40:43], v[72:75], v[200:203]
    s_mul_i32 s17, s17, 5120
    v_exp_f32 v37, v37
    v_mfma_f32_16x16x32_bf16 v[232:235], a[40:43], v[76:79], v[232:235]
    s_lshr_b32 s18, s76, 1
    v_exp_f32 v38, v38
    v_smfmac_f32_16x16x64_bf16 a[68:71], a[80:83], v[72:79], v6
    buffer_load_dwordx4 v11, s[4:7], s56 offen offset:2048 sc1 lds
    v_mfma_f32_16x16x32_bf16 v[236:239], a[44:47], v[76:79], v[236:239]
    s_mul_i32 s18, s18, 24
    v_exp_f32 v39, v39
    v_mfma_f32_16x16x32_bf16 v[204:207], a[44:47], v[72:75], v[204:207]
    s_add_u32 s18, s18, s1
    v_cvt_pk_bf16_f32 v85, v38, v39
    v_cndmask_b32 v118, v100, v5, s[48:49]
    v_mfma_f32_16x16x32_bf16 v[172:175], a[44:47], v[68:71], v[172:175]
    ds_read_b128 a[20:23], v2 offset:46080
    v_cndmask_b32 v119, v100, v5, s[50:51]
    v_mfma_f32_16x16x32_bf16 v[140:143], a[44:47], v[64:67], v[140:143]
    s_waitcnt lgkmcnt(6)
    v_exp_f32 v40, v40
    v_mfma_f32_16x16x32_bf16 v[144:147], a[48:51], v[64:67], v[144:147]
    buffer_load_dwordx4 v11, s[4:7], s56 offen offset:3072 sc1 lds
    v_mfma_f32_16x16x32_bf16 v[176:179], a[48:51], v[68:71], v[176:179]
    s_bitcmp1_b32 s2, 0
    s_cselect_b32 s0, 16, 0
    s_cselect_b32 s42, 1, 4
    s_cselect_b32 s43, 0, 0x40000000
    v_mfma_f32_16x16x32_bf16 v[208:211], a[48:51], v[72:75], v[208:211]
    ds_read_b128 a[24:27], v2 offset:47104
    ds_read_b128 a[28:31], v2 offset:48128
    v_subrev_u32 v15, 0x60, v4
    v_mfma_f32_16x16x32_bf16 v[240:243], a[48:51], v[76:79], v[240:243]
    v_exp_f32 v41, v41
    v_mfma_f32_16x16x32_bf16 v[244:247], a[52:55], v[76:79], v[244:247]
    buffer_store_dwordx4 v[96:99], v11, s[28:31], s3 offen sc1
    v_exp_f32 v42, v42
    v_mfma_f32_16x16x32_bf16 v[212:215], a[52:55], v[72:75], v[212:215]
    s_add_u32 s56, s56, 4096
    v_exp_f32 v43, v43
    v_mfma_f32_16x16x32_bf16 v[180:183], a[52:55], v[68:71], v[180:183]
    s_add_u32 s3, s79, 2048
    v_cvt_pk_bf16_f32 v84, v36, v37
    v_cmp_gt_i32 s[44:45], 0, v15
    v_mfma_f32_16x16x32_bf16 v[148:151], a[52:55], v[64:67], v[148:151]
    s_add_u32 s18, s18, s0
    v_exp_f32 v44, v44
    v_smfmac_f32_16x16x64_bf16 a[64:67], a[80:83], v[64:71], v6
    buffer_store_dwordx4 v[96:99], v11, s[28:31], s3 offen sc1
    v_exp_f32 v45, v45
    v_mfma_f32_16x16x32_bf16 v[152:155], a[56:59], v[64:67], v[152:155]
    s_add_u32 s18, s18, 136
    v_exp_f32 v46, v46
    v_mfma_f32_16x16x32_bf16 v[184:187], a[56:59], v[68:71], v[184:187]
    s_add_u32 s3, s79, 3072
    v_exp_f32 v47, v47
    v_mfma_f32_16x16x32_bf16 v[216:219], a[56:59], v[72:75], v[216:219]
    v_exp_f32 v16, v16
    v_cvt_pk_bf16_f32 v89, v42, v43
    v_mfma_f32_16x16x32_bf16 v[248:251], a[56:59], v[76:79], v[248:251]
    ds_read_b128 a[32:35], v2 offset:49152
    v_cvt_pk_bf16_f32 v88, v40, v41
    v_mfma_f32_16x16x32_bf16 v[252:255], a[60:63], v[76:79], v[252:255]
    s_add_u32 m0, s57, 36864
    v_exp_f32 v17, v17
    v_mfma_f32_16x16x32_bf16 v[220:223], a[60:63], v[72:75], v[220:223]
    ds_read_b128 a[36:39], v2 offset:50176
    v_exp_f32 v18, v18
    v_mfma_f32_16x16x32_bf16 v[188:191], a[60:63], v[68:71], v[188:191]
    s_and_b32 s19, s2, 7
    v_exp_f32 v19, v19
    v_mfma_f32_16x16x32_bf16 v[156:159], a[60:63], v[64:67], v[156:159]
    s_waitcnt lgkmcnt(6)
    v_exp_f32 v20, v20
    v_mfma_f32_16x16x32_bf16 v[36:39], a[0:3], a[144:147], v[112:115]
    ds_read_b128 a[40:43], v2 offset:51200
    buffer_load_dwordx4 v11, s[4:7], s56 offen offset:0 sc1 lds
    v_mfma_f32_16x16x32_bf16 v[36:39], a[4:7], a[148:151], v[36:39]
    s_xor_b32 s19, s19, s42
    v_exp_f32 v21, v21
    v_mfma_f32_16x16x32_bf16 v[36:39], a[8:11], a[152:155], v[36:39]
    ds_read_b128 a[44:47], v2 offset:52224
    ds_read_b128 a[48:51], v2 offset:53248
    v_mfma_f32_16x16x32_bf16 v[36:39], a[12:15], a[156:159], v[36:39]
    s_lshl_b32 s42, s19, 7
    v_cvt_pk_bf16_f32 v92, v44, v45
    v_cvt_pk_bf16_f32 v83, v18, v19
    v_mfma_f32_16x16x32_bf16 v[40:43], a[12:15], a[172:175], v[104:107]
    v_exp_f32 v22, v22
    v_mfma_f32_16x16x32_bf16 v[40:43], a[8:11], a[168:171], v[40:43]
    buffer_store_dwordx4 v[96:99], v11, s[28:31], s3 offen sc1
    v_cvt_pk_bf16_f32 v82, v16, v17
    v_mfma_f32_16x16x32_bf16 v[40:43], a[4:7], a[164:167], v[40:43]
    ds_read_b128 a[52:55], v2 offset:54272
    v_cvt_pk_bf16_f32 v93, v46, v47
    v_mfma_f32_16x16x32_bf16 v[40:43], a[0:3], a[160:163], v[40:43]
    s_lshl_b32 s19, s19, 4
    v_exp_f32 v23, v23
    v_mfma_f32_16x16x32_bf16 v[44:47], a[0:3], a[176:179], v[108:111]
    s_add_u32 s19, s19, s1
    v_exp_f32 v24, v24
    v_mfma_f32_16x16x32_bf16 v[44:47], a[4:7], a[180:183], v[44:47]
    s_add_u32 s3, s79, 4096
    v_exp_f32 v25, v25
    v_mfma_f32_16x16x32_bf16 v[44:47], a[8:11], a[184:187], v[44:47]
    buffer_load_dwordx4 v11, s[4:7], s56 offen offset:1024 sc1 lds
    v_cvt_pk_bf16_f32 v81, v34, v35
    v_mfma_f32_16x16x32_bf16 v[44:47], a[12:15], a[188:191], v[44:47]
    s_waitcnt lgkmcnt(6)
    v_exp_f32 v26, v26
    v_cvt_pk_bf16_f32 v86, v20, v21
    v_mfma_f32_16x16x32_bf16 v[52:55], a[16:19], a[144:147], v[116:119]
    ds_read_b128 a[56:59], v2 offset:55296
    ds_read_b128 a[60:63], v2 offset:56320
    v_mfma_f32_16x16x32_bf16 v[52:55], a[20:23], a[148:151], v[52:55]
    s_add_u32 s0, s77, s78
    v_exp_f32 v27, v27
    v_mfma_f32_16x16x32_bf16 v[52:55], a[24:27], a[152:155], v[52:55]
    buffer_store_dwordx4 v[96:99], v11, s[28:31], s3 offen sc1
    v_mfma_f32_16x16x32_bf16 v[52:55], a[28:31], a[156:159], v[52:55]
    s_and_b32 s0, s0, 3
    v_exp_f32 v28, v28
    v_mfma_f32_16x16x32_bf16 v[56:59], a[28:31], a[172:175], v[104:107]
    s_lshl_b32 s0, s0, 1
    v_exp_f32 v29, v29
    v_mfma_f32_16x16x32_bf16 v[56:59], a[24:27], a[168:171], v[56:59]
    s_xor_b32 s19, s19, s0
    v_exp_f32 v30, v30
    v_cvt_pk_bf16_f32 v80, v32, v33
    v_mfma_f32_16x16x32_bf16 v[56:59], a[20:23], a[164:167], v[56:59]
    s_and_b32 s0, s0, 2
    v_cvt_pk_bf16_f32 v91, v26, v27
    v_cvt_pk_bf16_f32 v94, v28, v29
    v_mfma_f32_16x16x32_bf16 v[56:59], a[16:19], a[160:163], v[56:59]
    s_add_u32 s3, s79, 5120
    v_exp_f32 v31, v31
    v_mfma_f32_16x16x32_bf16 v[60:63], a[16:19], a[176:179], v[108:111]
    v_cvt_pk_bf16_f32 v87, v22, v23
    v_cmp_gt_i32 s[46:47], 1, v15
    v_mfma_f32_16x16x32_bf16 v[60:63], a[20:23], a[180:183], v[60:63]
    v_cvt_pk_bf16_f32 v95, v30, v31
    v_cmp_gt_i32 s[48:49], 2, v15
    v_mfma_f32_16x16x32_bf16 v[60:63], a[24:27], a[184:187], v[60:63]
    buffer_store_dwordx4 v[96:99], v11, s[28:31], s3 offen sc1
    v_cvt_pk_bf16_f32 v90, v24, v25
    v_mfma_f32_16x16x32_bf16 v[60:63], a[28:31], a[188:191], v[60:63]
    s_waitcnt lgkmcnt(4)
    v_cmp_gt_i32 s[50:51], 3, v15
    v_cndmask_b32 v120, v100, v5, s[44:45]
    v_mfma_f32_16x16x32_bf16 v[128:131], a[32:35], v[80:83], v[128:131]
    s_sub_u32 s25, s18, s0
    v_exp_f32 v36, v36
    v_mfma_f32_16x16x32_bf16 v[160:163], a[32:35], v[84:87], v[160:163]
    ds_read_b128 a[0:3], v2 offset:57344
    v_cndmask_b32 v121, v100, v5, s[46:47]
    v_mfma_f32_16x16x32_bf16 v[192:195], a[32:35], v[88:91], v[192:195]
    s_add_u32 s3, s79, 6144
    v_exp_f32 v37, v37
    v_mfma_f32_16x16x32_bf16 v[224:227], a[32:35], v[92:95], v[224:227]
    buffer_store_dwordx4 v[96:99], v11, s[28:31], s3 offen sc1
    v_mfma_f32_16x16x32_bf16 v[228:231], a[36:39], v[92:95], v[228:231]
    ds_read_b128 a[4:7], v2 offset:58368
    ds_read_b128 a[8:11], v2 offset:59392
    v_mfma_f32_16x16x32_bf16 v[196:199], a[36:39], v[88:91], v[196:199]
    buffer_load_dwordx4 v11, s[4:7], s56 offen offset:2048 sc1 lds
    v_mfma_f32_16x16x32_bf16 v[164:167], a[36:39], v[84:87], v[164:167]
    ds_read_b128 a[12:15], v2 offset:60416
    ds_read_b128 a[16:19], v2 offset:61440
    v_mfma_f32_16x16x32_bf16 v[132:135], a[36:39], v[80:83], v[132:135]
    s_add_u32 s18, s18, s0
    v_exp_f32 v38, v38
    v_mfma_f32_16x16x32_bf16 v[136:139], a[40:43], v[80:83], v[136:139]
    s_add_u32 s3, s79, 7168
    v_exp_f32 v39, v39
    v_mfma_f32_16x16x32_bf16 v[168:171], a[40:43], v[84:87], v[168:171]
    buffer_store_dwordx4 v[96:99], v11, s[28:31], s3 offen sc1
    v_mfma_f32_16x16x32_bf16 v[200:203], a[40:43], v[88:91], v[200:203]
    s_sub_u32 s0, 15, s77
    v_exp_f32 v40, v40
    v_mfma_f32_16x16x32_bf16 v[232:235], a[40:43], v[92:95], v[232:235]
    ds_read_b128 a[20:23], v2 offset:62464
    v_cndmask_b32 v122, v100, v5, s[48:49]
    v_smfmac_f32_16x16x64_bf16 a[68:71], a[80:83], v[88:95], v6
    buffer_load_dwordx4 v11, s[4:7], s56 offen offset:3072 sc1 lds
    v_mfma_f32_16x16x32_bf16 v[236:239], a[44:47], v[92:95], v[236:239]
    s_add_u32 s3, s79, 8192
    v_exp_f32 v41, v41
    v_mfma_f32_16x16x32_bf16 v[204:207], a[44:47], v[88:91], v[204:207]
    s_min_u32 s0, s0, s77
    v_cndmask_b32 v123, v100, v5, s[50:51]
    v_cmp_gt_i32 s[44:45], 16, v15
    v_mfma_f32_16x16x32_bf16 v[172:175], a[44:47], v[84:87], v[172:175]
    s_lshl_b32 s0, s0, 10
    v_exp_f32 v42, v42
    v_mfma_f32_16x16x32_bf16 v[140:143], a[44:47], v[80:83], v[140:143]
    s_waitcnt lgkmcnt(6)
    v_cmp_gt_i32 s[46:47], 17, v15
    v_cmp_gt_i32 s[48:49], 18, v15
    v_mfma_f32_16x16x32_bf16 v[144:147], a[48:51], v[80:83], v[144:147]
    s_add_u32 s0, s0, 83894272
    v_exp_f32 v43, v43
    v_mfma_f32_16x16x32_bf16 v[176:179], a[48:51], v[84:87], v[176:179]
    buffer_store_dwordx4 v[96:99], v11, s[28:31], s3 offen sc1
    v_mfma_f32_16x16x32_bf16 v[208:211], a[48:51], v[88:91], v[208:211]
    s_add_u32 s3, s79, 9216
    v_exp_f32 v44, v44
    v_mfma_f32_16x16x32_bf16 v[240:243], a[48:51], v[92:95], v[240:243]
    v_exp_f32 v45, v45
    v_mfma_f32_16x16x32_bf16 v[244:247], a[52:55], v[92:95], v[244:247]
    ds_read_b128 a[24:27], v2 offset:63488
    v_cmp_gt_i32 s[50:51], 19, v15
    v_mfma_f32_16x16x32_bf16 v[212:215], a[52:55], v[88:91], v[212:215]
    s_add_u32 s21, s0, s42
    v_cvt_pk_bf16_f32 v69, v38, v39
    v_cndmask_b32 v124, v100, v5, s[44:45]
    v_mfma_f32_16x16x32_bf16 v[180:183], a[52:55], v[84:87], v[180:183]
    s_xor_b32 s26, s21, 128
    v_cvt_pk_bf16_f32 v68, v36, v37
    v_cndmask_b32 v125, v100, v5, s[46:47]
    v_mfma_f32_16x16x32_bf16 v[148:151], a[52:55], v[80:83], v[148:151]
    s_add_u32 s56, s56, 28672
    v_exp_f32 v46, v46
    v_smfmac_f32_16x16x64_bf16 a[64:67], a[80:83], v[80:87], v6
    ds_read_b128 a[28:31], v2 offset:64512
    v_cndmask_b32 v126, v100, v5, s[48:49]
    v_mfma_f32_16x16x32_bf16 v[152:155], a[56:59], v[80:83], v[152:155]
    buffer_store_dwordx4 v[96:99], v11, s[28:31], s3 offen sc1
    v_mfma_f32_16x16x32_bf16 v[184:187], a[56:59], v[84:87], v[184:187]
    s_or_b32 s27, s21, s43
    v_cvt_pk_bf16_f32 v73, v42, v43
    v_and_b32 v13, 3, v1
    v_mfma_f32_16x16x32_bf16 v[216:219], a[56:59], v[88:91], v[216:219]
    v_exp_f32 v47, v47
    v_mfma_f32_16x16x32_bf16 v[248:251], a[56:59], v[92:95], v[248:251]
    s_add_u32 s57, s57, 32768
    v_cvt_pk_bf16_f32 v76, v44, v45
    v_cvt_pk_bf16_f32 v77, v46, v47
    v_mfma_f32_16x16x32_bf16 v[252:255], a[60:63], v[92:95], v[252:255]
    v_cndmask_b32 v127, v100, v5, s[50:51]
    v_lshlrev_b32 v13, 2, v13
    v_mfma_f32_16x16x32_bf16 v[220:223], a[60:63], v[88:91], v[220:223]
    s_waitcnt vmcnt(26) lgkmcnt(0)
    s_barrier
    v_mfma_f32_16x16x32_bf16 v[188:191], a[60:63], v[84:87], v[188:191]
    s_mul_i32 s20, s36, 9216
    v_cvt_pk_bf16_f32 v72, v40, v41
    v_add_u32 v2, s58, v11
    v_mfma_f32_16x16x32_bf16 v[156:159], a[60:63], v[80:83], v[156:159]
    s_and_b32 s57, s57, 0x1ffff
    v_exp_f32 v52, v52
    s_cmp_eq_u32 s39, 0
    s_cselect_b32 s59, s59, 0x40000000
    s_cselect_b32 s57, 0x20000, s57
    v_mfma_f32_16x16x32_bf16 v[36:39], a[0:3], a[144:147], v[120:123]
    buffer_load_dwordx4 v[96:99], v11, s[28:31], s59 offen sc0 sc1
    v_mfma_f32_16x16x32_bf16 v[36:39], a[4:7], a[148:151], v[36:39]
    s_lshl_b32 s42, s37, 19
    v_exp_f32 v53, v53
    v_accvgpr_read_b32 v102, a86
    v_mfma_f32_16x16x32_bf16 v[36:39], a[8:11], a[152:155], v[36:39]
    buffer_load_dword v102, v102, s[28:31], s88 offen offset:32 sc0 sc1
    v_mfma_f32_16x16x32_bf16 v[36:39], a[12:15], a[156:159], v[36:39]
    v_exp_f32 v54, v54
    v_mfma_f32_16x16x32_bf16 v[40:43], a[12:15], a[172:175], v[104:107]
    v_exp_f32 v55, v55
    v_mfma_f32_16x16x32_bf16 v[40:43], a[8:11], a[168:171], v[40:43]
    s_add_u32 s42, s42, 36700160
    v_exp_f32 v56, v56
    v_cvt_pk_bf16_f32 v71, v54, v55
    v_mfma_f32_16x16x32_bf16 v[40:43], a[4:7], a[164:167], v[40:43]
    s_add_u32 s58, s58, 32768
    v_add_u32 v15, s40, v3
    v_accvgpr_read_b32 v100, a64
    v_mfma_f32_16x16x32_bf16 v[40:43], a[0:3], a[160:163], v[40:43]
    ds_read_b128 a[32:35], v2 offset:32768
    v_exp_f32 v57, v57
    v_mfma_f32_16x16x32_bf16 v[44:47], a[0:3], a[176:179], v[108:111]
    s_and_b32 s58, s58, 0x1ffff
    v_exp_f32 v58, v58
    v_mfma_f32_16x16x32_bf16 v[44:47], a[4:7], a[180:183], v[44:47]
    ds_read_b128 a[36:39], v2 offset:33792
    v_exp_f32 v59, v59
    v_mfma_f32_16x16x32_bf16 v[44:47], a[8:11], a[184:187], v[44:47]
    s_add_u32 m0, s57, 32768
    v_exp_f32 v60, v60
    v_cmp_gt_i32 s[44:45], 0, v15
    v_mfma_f32_16x16x32_bf16 v[44:47], a[12:15], a[188:191], v[44:47]
    v_cmp_gt_i32 s[46:47], 1, v15
    v_accvgpr_read_b32 v101, a65
    v_add_f32 v100, v100, v101
    v_rcp_f32 v100, v100
    v_mfma_f32_16x16x32_bf16 v[20:23], a[16:19], a[144:147], v[124:127]
    s_nop 0
    v_exp_f32 v61, v61
    v_mul_f32 v100, v100, v8
    v_mfma_f32_16x16x32_bf16 v[20:23], a[20:23], a[148:151], v[20:23]
    s_lshl_b32 s43, s52, 10
    v_exp_f32 v62, v62
    v_cvt_pk_bf16_f32 v78, v60, v61
    v_mfma_f32_16x16x32_bf16 v[20:23], a[24:27], a[152:155], v[20:23]
    ds_read_b128 a[40:43], v2 offset:34816
    v_cvt_pk_bf16_f32 v75, v58, v59
    v_mfma_f32_16x16x32_bf16 v[20:23], a[28:31], a[156:159], v[20:23]
    s_add_u32 s43, s43, s42
    v_mul_f32 v128, v128, v100
    v_mul_f32 v129, v129, v100
    v_mul_f32 v130, v130, v100
    v_mfma_f32_16x16x32_bf16 v[24:27], a[28:31], a[172:175], v[104:107]
    buffer_load_dwordx4 v11, s[4:7], s56 offen offset:0 sc1 lds
    v_mfma_f32_16x16x32_bf16 v[24:27], a[24:27], a[168:171], v[24:27]
    v_exp_f32 v63, v63
    v_cvt_pk_bf16_f32 v70, v52, v53
    v_mfma_f32_16x16x32_bf16 v[24:27], a[20:23], a[164:167], v[24:27]
    ds_read_b128 a[44:47], v2 offset:35840
    v_mul_f32 v131, v131, v100
    v_mfma_f32_16x16x32_bf16 v[24:27], a[16:19], a[160:163], v[24:27]
    ds_read_b128 a[48:51], v2 offset:36864
    ds_read_b128 a[52:55], v2 offset:37888
    v_cmp_gt_i32 s[48:49], 2, v15
    v_mfma_f32_16x16x32_bf16 v[28:31], a[16:19], a[176:179], v[108:111]
    v_cmp_gt_i32 s[50:51], 3, v15
    v_cndmask_b32 v112, v104, v5, s[44:45]
    v_mfma_f32_16x16x32_bf16 v[28:31], a[20:23], a[180:183], v[28:31]
    buffer_load_dwordx4 v11, s[4:7], s56 offen offset:1024 sc1 lds
    v_mfma_f32_16x16x32_bf16 v[28:31], a[24:27], a[184:187], v[28:31]
    v_cvt_pk_bf16_f32 v74, v56, v57
    v_cvt_pk_bf16_f32 v79, v62, v63
    v_mul_f32 v132, v132, v100
    v_mul_f32 v133, v133, v100
    v_mfma_f32_16x16x32_bf16 v[28:31], a[28:31], a[188:191], v[28:31]
    s_waitcnt lgkmcnt(2)
    v_mul_f32 v134, v134, v100
    v_mul_f32 v135, v135, v100
    v_cvt_pk_bf16_f32 v128, v128, v129
    v_cvt_pk_bf16_f32 v129, v130, v131
    v_mfma_f32_16x16x32_bf16 v[160:163], a[32:35], v[68:71], v[160:163]
    ds_read_b128 a[56:59], v2 offset:38912
    v_exp_f32 v36, v36
    v_cvt_pk_bf16_f32 v130, v132, v133
    v_cvt_pk_bf16_f32 v131, v134, v135
    v_mfma_f32_16x16x32_bf16 v[192:195], a[32:35], v[72:75], v[192:195]
    ds_read_b128 a[60:63], v2 offset:39936
    ds_read_b128 a[0:3], v2 offset:40960
    buffer_store_dwordx4 v[128:131], v11, s[28:31], s43 offen sc1
    v_exp_f32 v37, v37
    v_mfma_f32_16x16x32_bf16 v[224:227], a[32:35], v[76:79], v[224:227]
    v_exp_f32 v38, v38
    v_cndmask_b32 v113, v104, v5, s[46:47]
    v_mfma_f32_16x16x32_bf16 v[228:231], a[36:39], v[76:79], v[228:231]
    s_add_u32 s43, s43, 131072
    v_mul_f32 v136, v136, v100
    v_mul_f32 v137, v137, v100
    v_mfma_f32_16x16x32_bf16 v[196:199], a[36:39], v[72:75], v[196:199]
    v_exp_f32 v39, v39
    v_cndmask_b32 v114, v104, v5, s[48:49]
    v_cndmask_b32 v115, v104, v5, s[50:51]
    v_mfma_f32_16x16x32_bf16 v[164:167], a[36:39], v[68:71], v[164:167]
    buffer_load_dwordx4 v11, s[4:7], s56 offen offset:2048 sc1 lds
    v_cmp_gt_i32 s[44:45], 16, v15
    v_mfma_f32_16x16x32_bf16 v[168:171], a[40:43], v[68:71], v[168:171]
    v_exp_f32 v40, v40
    v_mul_f32 v138, v138, v100
    v_mfma_f32_16x16x32_bf16 v[200:203], a[40:43], v[72:75], v[200:203]
    v_cmp_gt_i32 s[46:47], 17, v15
    v_cmp_gt_i32 s[48:49], 18, v15
    v_cmp_gt_i32 s[50:51], 19, v15
    v_mfma_f32_16x16x32_bf16 v[232:235], a[40:43], v[76:79], v[232:235]
    ds_read_b128 a[4:7], v2 offset:41984
    ds_read_b128 a[8:11], v2 offset:43008
    v_cndmask_b32 v116, v104, v5, s[44:45]
    v_smfmac_f32_16x16x64_bf16 a[68:71], a[80:83], v[72:79], v6
    buffer_load_dwordx4 v11, s[4:7], s56 offen offset:3072 sc1 lds
    v_mul_f32 v139, v139, v100
    v_mfma_f32_16x16x32_bf16 v[236:239], a[44:47], v[76:79], v[236:239]
    v_exp_f32 v41, v41
    v_cndmask_b32 v117, v104, v5, s[46:47]
    v_mfma_f32_16x16x32_bf16 v[204:207], a[44:47], v[72:75], v[204:207]
    v_exp_f32 v42, v42
    v_mul_f32 v140, v140, v100
    v_mul_f32 v141, v141, v100
    v_mul_f32 v142, v142, v100
    v_mfma_f32_16x16x32_bf16 v[172:175], a[44:47], v[68:71], v[172:175]
    s_waitcnt lgkmcnt(3)
    v_exp_f32 v43, v43
    v_mfma_f32_16x16x32_bf16 v[176:179], a[48:51], v[68:71], v[176:179]
    ds_read_b128 a[12:15], v2 offset:44032
    v_exp_f32 v44, v44
    v_cndmask_b32 v118, v104, v5, s[48:49]
    v_mfma_f32_16x16x32_bf16 v[208:211], a[48:51], v[72:75], v[208:211]
    v_mul_f32 v143, v143, v100
    v_cvt_pk_bf16_f32 v136, v136, v137
    v_mfma_f32_16x16x32_bf16 v[240:243], a[48:51], v[76:79], v[240:243]
    v_cndmask_b32 v119, v104, v5, s[50:51]
    v_subrev_u32 v15, 32, v3
    v_mfma_f32_16x16x32_bf16 v[244:247], a[52:55], v[76:79], v[244:247]
    ds_read_b128 a[16:19], v2 offset:45056
    v_exp_f32 v45, v45
    v_mfma_f32_16x16x32_bf16 v[212:215], a[52:55], v[72:75], v[212:215]
    v_cmp_gt_i32 s[44:45], 0, v15
    v_cvt_pk_bf16_f32 v137, v138, v139
    v_cvt_pk_bf16_f32 v138, v140, v141
    v_cvt_pk_bf16_f32 v139, v142, v143
    v_mfma_f32_16x16x32_bf16 v[180:183], a[52:55], v[68:71], v[180:183]
    ds_read_b128 a[20:23], v2 offset:46080
    v_exp_f32 v46, v46
    v_smfmac_f32_16x16x64_bf16 a[64:67], a[72:75], v[64:71], v6
    ds_read_b128 a[24:27], v2 offset:47104
    ds_read_b128 a[28:31], v2 offset:48128
    v_cvt_pk_bf16_f32 v89, v42, v43
    v_cmp_gt_i32 s[46:47], 1, v15
    v_mfma_f32_16x16x32_bf16 v[184:187], a[56:59], v[68:71], v[184:187]
    ds_read_b128 a[32:35], v2 offset:49152
    ds_read_b128 a[36:39], v2 offset:50176
    v_exp_f32 v47, v47
    v_cvt_pk_bf16_f32 v84, v36, v37
    v_mfma_f32_16x16x32_bf16 v[216:219], a[56:59], v[72:75], v[216:219]
    ds_read_b128 a[40:43], v2 offset:51200
    ds_read_b128 a[44:47], v2 offset:52224
    v_mfma_f32_16x16x32_bf16 v[248:251], a[56:59], v[76:79], v[248:251]
    buffer_store_dwordx4 v[136:139], v11, s[28:31], s43 offen sc1
    v_exp_f32 v20, v20
    v_mfma_f32_16x16x32_bf16 v[252:255], a[60:63], v[76:79], v[252:255]
    s_add_u32 s43, s43, 131072
    v_exp_f32 v21, v21
    v_cmp_gt_i32 s[48:49], 2, v15
    v_mul_f32 v144, v144, v100
    v_mfma_f32_16x16x32_bf16 v[220:223], a[60:63], v[72:75], v[220:223]
    v_exp_f32 v22, v22
    v_mfma_f32_16x16x32_bf16 v[188:191], a[60:63], v[68:71], v[188:191]
    s_waitcnt lgkmcnt(8)
    v_exp_f32 v23, v23
    v_cvt_pk_bf16_f32 v88, v40, v41
    v_cvt_pk_bf16_f32 v93, v46, v47
    v_mfma_f32_16x16x32_bf16 v[40:43], a[0:3], a[160:163], v[112:115]
    v_exp_f32 v24, v24
    v_cvt_pk_bf16_f32 v86, v20, v21
    v_cmp_gt_i32 s[50:51], 3, v15
    v_mfma_f32_16x16x32_bf16 v[40:43], a[4:7], a[164:167], v[40:43]
    v_cvt_pk_bf16_f32 v92, v44, v45
    v_cndmask_b32 v120, v104, v5, s[44:45]
    v_mfma_f32_16x16x32_bf16 v[40:43], a[8:11], a[168:171], v[40:43]
    v_exp_f32 v25, v25
    v_mfma_f32_16x16x32_bf16 v[40:43], a[12:15], a[172:175], v[40:43]
    ds_read_b128 a[48:51], v2 offset:53248
    v_exp_f32 v26, v26
    v_mfma_f32_16x16x32_bf16 v[44:47], a[12:15], a[188:191], v[108:111]
    v_exp_f32 v27, v27
    v_mfma_f32_16x16x32_bf16 v[44:47], a[8:11], a[184:187], v[44:47]
    ds_read_b128 a[52:55], v2 offset:54272
    v_cvt_pk_bf16_f32 v85, v38, v39
    v_mfma_f32_16x16x32_bf16 v[44:47], a[4:7], a[180:183], v[44:47]
    v_exp_f32 v28, v28
    v_cvt_pk_bf16_f32 v87, v22, v23
    v_mfma_f32_16x16x32_bf16 v[44:47], a[0:3], a[176:179], v[44:47]
    s_waitcnt lgkmcnt(6)
    v_exp_f32 v29, v29
    v_mfma_f32_16x16x32_bf16 v[56:59], a[16:19], a[160:163], v[116:119]
    s_add_u32 s56, s56, 4096
    v_exp_f32 v30, v30
    v_cvt_pk_bf16_f32 v90, v24, v25
    v_cvt_pk_bf16_f32 v94, v28, v29
    v_mfma_f32_16x16x32_bf16 v[56:59], a[20:23], a[164:167], v[56:59]
    v_cndmask_b32 v121, v104, v5, s[46:47]
    v_mul_f32 v145, v145, v100
    v_mfma_f32_16x16x32_bf16 v[56:59], a[24:27], a[168:171], v[56:59]
    ds_read_b128 a[56:59], v2 offset:55296
    v_mul_f32 v146, v146, v100
    v_mfma_f32_16x16x32_bf16 v[56:59], a[28:31], a[172:175], v[56:59]
    s_add_u32 m0, s57, 36864
    v_exp_f32 v31, v31
    v_mfma_f32_16x16x32_bf16 v[60:63], a[28:31], a[188:191], v[108:111]
    buffer_load_dwordx4 v11, s[4:7], s56 offen offset:0 sc1 lds
    v_cndmask_b32 v122, v104, v5, s[48:49]
    v_mul_f32 v147, v147, v100
    v_mul_f32 v148, v148, v100
    v_mfma_f32_16x16x32_bf16 v[60:63], a[24:27], a[184:187], v[60:63]
    v_cvt_pk_bf16_f32 v91, v26, v27
    v_cvt_pk_bf16_f32 v95, v30, v31
    v_mfma_f32_16x16x32_bf16 v[60:63], a[20:23], a[180:183], v[60:63]
    v_cndmask_b32 v123, v104, v5, s[50:51]
    v_cmp_gt_i32 s[44:45], 16, v15
    v_mfma_f32_16x16x32_bf16 v[60:63], a[16:19], a[176:179], v[60:63]
    s_waitcnt lgkmcnt(3)
    v_cmp_gt_i32 s[46:47], 17, v15
    v_mul_f32 v149, v149, v100
    v_mfma_f32_16x16x32_bf16 v[160:163], a[32:35], v[84:87], v[160:163]
    ds_read_b128 a[60:63], v2 offset:56320
    ds_read_b128 a[0:3], v2 offset:57344
    v_mfma_f32_16x16x32_bf16 v[192:195], a[32:35], v[88:91], v[192:195]
    ds_read_b128 a[4:7], v2 offset:58368
    buffer_load_dwordx4 v11, s[4:7], s56 offen offset:1024 sc1 lds
    v_mfma_f32_16x16x32_bf16 v[224:227], a[32:35], v[92:95], v[224:227]
    v_exp_f32 v40, v40
    v_mfma_f32_16x16x32_bf16 v[228:231], a[36:39], v[92:95], v[228:231]
    ds_read_b128 a[8:11], v2 offset:59392
    v_exp_f32 v41, v41
    v_mfma_f32_16x16x32_bf16 v[196:199], a[36:39], v[88:91], v[196:199]
    ds_read_b128 a[12:15], v2 offset:60416
    v_cmp_gt_i32 s[48:49], 18, v15
    v_mul_f32 v150, v150, v100
    v_mul_f32 v151, v151, v100
    v_mfma_f32_16x16x32_bf16 v[164:167], a[36:39], v[84:87], v[164:167]
    v_exp_f32 v42, v42
    v_cmp_gt_i32 s[50:51], 19, v15
    v_mfma_f32_16x16x32_bf16 v[168:171], a[40:43], v[84:87], v[168:171]
    v_exp_f32 v43, v43
    v_cvt_pk_bf16_f32 v144, v144, v145
    v_mfma_f32_16x16x32_bf16 v[200:203], a[40:43], v[88:91], v[200:203]
    ds_read_b128 a[16:19], v2 offset:61440
    v_cvt_pk_bf16_f32 v145, v146, v147
    v_mfma_f32_16x16x32_bf16 v[232:235], a[40:43], v[92:95], v[232:235]
    v_exp_f32 v44, v44
    v_cvt_pk_bf16_f32 v146, v148, v149
    v_smfmac_f32_16x16x64_bf16 a[68:71], a[80:83], v[88:95], v6
    buffer_load_dwordx4 v11, s[4:7], s56 offen offset:2048 sc1 lds
    v_cndmask_b32 v124, v104, v5, s[44:45]
    v_mfma_f32_16x16x32_bf16 v[236:239], a[44:47], v[92:95], v[236:239]
    v_exp_f32 v45, v45
    v_cvt_pk_bf16_f32 v147, v150, v151
    v_mfma_f32_16x16x32_bf16 v[204:207], a[44:47], v[88:91], v[204:207]
    buffer_store_dwordx4 v[144:147], v11, s[28:31], s43 offen sc1
    v_mfma_f32_16x16x32_bf16 v[172:175], a[44:47], v[84:87], v[172:175]
    s_waitcnt lgkmcnt(5)
    v_exp_f32 v46, v46
    v_mfma_f32_16x16x32_bf16 v[176:179], a[48:51], v[84:87], v[176:179]
    s_add_u32 s43, s43, 131072
    v_cvt_pk_bf16_f32 v72, v40, v41
    v_mul_f32 v152, v152, v100
    v_mul_f32 v153, v153, v100
    v_mfma_f32_16x16x32_bf16 v[208:211], a[48:51], v[88:91], v[208:211]
    v_cndmask_b32 v125, v104, v5, s[46:47]
    v_mul_f32 v154, v154, v100
    v_mfma_f32_16x16x32_bf16 v[240:243], a[48:51], v[92:95], v[240:243]
    v_cndmask_b32 v126, v104, v5, s[48:49]
    v_cndmask_b32 v127, v104, v5, s[50:51]
    v_mfma_f32_16x16x32_bf16 v[244:247], a[52:55], v[92:95], v[244:247]
    ds_read_b128 a[20:23], v2 offset:62464
    ds_read_b128 a[24:27], v2 offset:63488
    v_mfma_f32_16x16x32_bf16 v[212:215], a[52:55], v[88:91], v[212:215]
    v_mul_f32 v155, v155, v100
    v_mul_f32 v156, v156, v100
    v_mul_f32 v157, v157, v100
    v_mul_f32 v158, v158, v100
    v_mfma_f32_16x16x32_bf16 v[180:183], a[52:55], v[84:87], v[180:183]
    ds_read_b128 a[28:31], v2 offset:64512
    v_cvt_pk_bf16_f32 v76, v44, v45
    v_smfmac_f32_16x16x64_bf16 a[64:67], a[72:75], v[80:87], v6
    buffer_load_dwordx4 v11, s[4:7], s56 offen offset:3072 sc1 lds
    v_mfma_f32_16x16x32_bf16 v[184:187], a[56:59], v[84:87], v[184:187]
    s_add_u32 s56, s56, 28672
    v_mul_f32 v159, v159, v100
    v_cvt_pk_bf16_f32 v152, v152, v153
    v_mfma_f32_16x16x32_bf16 v[216:219], a[56:59], v[88:91], v[216:219]
    s_add_u32 s57, s57, 32768
    v_cvt_pk_bf16_f32 v153, v154, v155
    v_cvt_pk_bf16_f32 v154, v156, v157
    v_mfma_f32_16x16x32_bf16 v[248:251], a[56:59], v[92:95], v[248:251]
    v_exp_f32 v47, v47
    v_add_u32 v2, s58, v11
    v_mfma_f32_16x16x32_bf16 v[252:255], a[60:63], v[92:95], v[252:255]
    s_waitcnt vmcnt(16) lgkmcnt(0)
    s_barrier
    v_mfma_f32_16x16x32_bf16 v[220:223], a[60:63], v[88:91], v[220:223]
    s_and_b32 s57, s57, 0x1ffff
    v_cvt_pk_bf16_f32 v73, v42, v43
    v_cvt_pk_bf16_f32 v155, v158, v159
    v_mfma_f32_16x16x32_bf16 v[188:191], a[60:63], v[84:87], v[188:191]
    buffer_store_dwordx4 v[152:155], v11, s[28:31], s43 offen sc1
    s_waitcnt vmcnt(12)
    v_cmp_ne_u32 vcc, 1, v102
    s_nop 0
    s_cmp_eq_u64 vcc, 0
    s_cbranch_scc1 L_k2b_ok
L_k2b_no:
    s_mov_b32 s0, 0x40000
L_k2b_spin:
    v_accvgpr_read_b32 v102, a86
    buffer_load_dword v102, v102, s[28:31], s88 offen offset:32 sc0 sc1
    s_waitcnt vmcnt(0)
    v_cmp_ne_u32 vcc, 1, v102
    s_nop 0
    s_cmp_eq_u64 vcc, 0
    s_cbranch_scc1 L_k2b_ok
L_k2b_again:
    s_sleep 4
    s_sub_u32 s0, s0, 1
    s_cmp_lg_u32 s0, 0
    s_cbranch_scc1 L_k2b_spin
L_k2b_ok:
    buffer_store_dword v7, v0, s[28:31], s89 offen sc1
    s_lshl_b32 s42, s37, 19
    s_add_u32 s42, s42, 36700160
    v_accvgpr_read_b32 v100, a66
    v_accvgpr_read_b32 v101, a67
    v_add_f32 v100, v100, v101
    v_rcp_f32 v100, v100
    s_nop 0
    v_mul_f32 v100, v100, v9
    s_lshl_b32 s43, s53, 10
    s_add_u32 s43, s43, s42
    v_pk_mul_f32 v[160:161], v[160:161], v[100:101] op_sel_hi:[1,0]
    v_pk_mul_f32 v[162:163], v[162:163], v[100:101] op_sel_hi:[1,0]
    v_pk_mul_f32 v[164:165], v[164:165], v[100:101] op_sel_hi:[1,0]
    v_pk_mul_f32 v[166:167], v[166:167], v[100:101] op_sel_hi:[1,0]
    v_cvt_pk_bf16_f32 v160, v160, v161
    v_cvt_pk_bf16_f32 v161, v162, v163
    v_cvt_pk_bf16_f32 v162, v164, v165
    v_cvt_pk_bf16_f32 v163, v166, v167
    buffer_store_dwordx4 v[160:163], v11, s[28:31], s43 offen sc1
    s_add_u32 s43, s43, 131072
    v_pk_mul_f32 v[168:169], v[168:169], v[100:101] op_sel_hi:[1,0]
    v_pk_mul_f32 v[170:171], v[170:171], v[100:101] op_sel_hi:[1,0]
    v_pk_mul_f32 v[172:173], v[172:173], v[100:101] op_sel_hi:[1,0]
    v_pk_mul_f32 v[174:175], v[174:175], v[100:101] op_sel_hi:[1,0]
    v_cvt_pk_bf16_f32 v168, v168, v169
    v_cvt_pk_bf16_f32 v169, v170, v171
    v_cvt_pk_bf16_f32 v170, v172, v173
    v_cvt_pk_bf16_f32 v171, v174, v175
    buffer_store_dwordx4 v[168:171], v11, s[28:31], s43 offen sc1
    s_add_u32 s43, s43, 131072
    v_pk_mul_f32 v[176:177], v[176:177], v[100:101] op_sel_hi:[1,0]
    v_pk_mul_f32 v[178:179], v[178:179], v[100:101] op_sel_hi:[1,0]
    v_pk_mul_f32 v[180:181], v[180:181], v[100:101] op_sel_hi:[1,0]
    v_pk_mul_f32 v[182:183], v[182:183], v[100:101] op_sel_hi:[1,0]
    v_cvt_pk_bf16_f32 v176, v176, v177
    v_cvt_pk_bf16_f32 v177, v178, v179
    v_cvt_pk_bf16_f32 v178, v180, v181
    v_cvt_pk_bf16_f32 v179, v182, v183
    buffer_store_dwordx4 v[176:179], v11, s[28:31], s43 offen sc1
    s_add_u32 s43, s43, 131072
    v_pk_mul_f32 v[184:185], v[184:185], v[100:101] op_sel_hi:[1,0]
    v_pk_mul_f32 v[186:187], v[186:187], v[100:101] op_sel_hi:[1,0]
    v_pk_mul_f32 v[188:189], v[188:189], v[100:101] op_sel_hi:[1,0]
    v_pk_mul_f32 v[190:191], v[190:191], v[100:101] op_sel_hi:[1,0]
    v_cvt_pk_bf16_f32 v184, v184, v185
    v_cvt_pk_bf16_f32 v185, v186, v187
    v_cvt_pk_bf16_f32 v186, v188, v189
    v_cvt_pk_bf16_f32 v187, v190, v191
    buffer_store_dwordx4 v[184:187], v11, s[28:31], s43 offen sc1
    s_cmp_eq_u32 s39, 0
    s_cbranch_scc1 L_blkD
    .p2align 5
L_loopC:
    v_mfma_f32_16x16x32_bf16 v[40:43], a[0:3], a[160:163], v[104:107]
    v_exp_f32 v56, v56
    v_mfma_f32_16x16x32_bf16 v[40:43], a[4:7], a[164:167], v[40:43]
    ds_read_b128 a[32:35], v2 offset:32768
    v_cvt_pk_bf16_f32 v77, v46, v47
    v_mfma_f32_16x16x32_bf16 v[40:43], a[8:11], a[168:171], v[40:43]
    s_add_u32 s58, s58, 32768
    v_exp_f32 v57, v57
    v_mfma_f32_16x16x32_bf16 v[40:43], a[12:15], a[172:175], v[40:43]
    s_and_b32 s58, s58, 0x1ffff
    v_exp_f32 v58, v58
    v_mfma_f32_16x16x32_bf16 v[44:47], a[12:15], a[188:191], v[108:111]
    v_exp_f32 v59, v59
    v_mfma_f32_16x16x32_bf16 v[44:47], a[8:11], a[184:187], v[44:47]
    s_add_u32 m0, s57, 32768
    v_exp_f32 v60, v60
    v_mfma_f32_16x16x32_bf16 v[44:47], a[4:7], a[180:183], v[44:47]
    v_exp_f32 v61, v61
    v_mfma_f32_16x16x32_bf16 v[44:47], a[0:3], a[176:179], v[44:47]
    v_exp_f32 v62, v62
    v_mfma_f32_16x16x32_bf16 v[24:27], a[16:19], a[160:163], v[104:107]
    ds_read_b128 a[36:39], v2 offset:33792
    ds_read_b128 a[40:43], v2 offset:34816
    v_mfma_f32_16x16x32_bf16 v[24:27], a[20:23], a[164:167], v[24:27]
    buffer_load_dwordx4 v11, s[4:7], s56 offen offset:0 sc1 lds
    v_mfma_f32_16x16x32_bf16 v[24:27], a[24:27], a[168:171], v[24:27]
    ds_read_b128 a[44:47], v2 offset:35840
    v_cvt_pk_bf16_f32 v74, v56, v57
    v_mfma_f32_16x16x32_bf16 v[24:27], a[28:31], a[172:175], v[24:27]
    v_exp_f32 v63, v63
    v_mfma_f32_16x16x32_bf16 v[28:31], a[28:31], a[188:191], v[108:111]
    ds_read_b128 a[48:51], v2 offset:36864
    ds_read_b128 a[52:55], v2 offset:37888
    v_cvt_pk_bf16_f32 v75, v58, v59
    v_mfma_f32_16x16x32_bf16 v[28:31], a[24:27], a[184:187], v[28:31]
    ds_read_b128 a[56:59], v2 offset:38912
    v_cvt_pk_bf16_f32 v78, v60, v61
    v_mfma_f32_16x16x32_bf16 v[28:31], a[20:23], a[180:183], v[28:31]
    buffer_load_dwordx4 v11, s[4:7], s56 offen offset:1024 sc1 lds
    v_cvt_pk_bf16_f32 v79, v62, v63
    v_mfma_f32_16x16x32_bf16 v[28:31], a[16:19], a[176:179], v[28:31]
    s_waitcnt lgkmcnt(3)
    ds_read_b128 a[60:63], v2 offset:39936
    v_mfma_f32_16x16x32_bf16 v[192:195], a[32:35], v[72:75], v[192:195]
    v_exp_f32 v40, v40
    v_mfma_f32_16x16x32_bf16 v[224:227], a[32:35], v[76:79], v[224:227]
    ds_read_b128 a[0:3], v2 offset:40960
    ds_read_b128 a[4:7], v2 offset:41984
    v_mfma_f32_16x16x32_bf16 v[228:231], a[36:39], v[76:79], v[228:231]
    v_exp_f32 v41, v41
    v_mfma_f32_16x16x32_bf16 v[196:199], a[36:39], v[72:75], v[196:199]
    v_exp_f32 v42, v42
    v_mfma_f32_16x16x32_bf16 v[200:203], a[40:43], v[72:75], v[200:203]
    ds_read_b128 a[8:11], v2 offset:43008
    ds_read_b128 a[12:15], v2 offset:44032
    v_mfma_f32_16x16x32_bf16 v[232:235], a[40:43], v[76:79], v[232:235]
    buffer_load_dwordx4 v11, s[4:7], s56 offen offset:2048 sc1 lds
    v_smfmac_f32_16x16x64_bf16 a[68:71], a[80:83], v[72:79], v6
    ds_read_b128 a[16:19], v2 offset:45056
    ds_read_b128 a[20:23], v2 offset:46080
    v_mfma_f32_16x16x32_bf16 v[236:239], a[44:47], v[76:79], v[236:239]
    v_exp_f32 v43, v43
    v_mfma_f32_16x16x32_bf16 v[204:207], a[44:47], v[72:75], v[204:207]
    s_waitcnt lgkmcnt(6)
    v_exp_f32 v44, v44
    v_mfma_f32_16x16x32_bf16 v[208:211], a[48:51], v[72:75], v[208:211]
    v_exp_f32 v45, v45
    v_mfma_f32_16x16x32_bf16 v[240:243], a[48:51], v[76:79], v[240:243]
    v_exp_f32 v46, v46
    v_mfma_f32_16x16x32_bf16 v[244:247], a[52:55], v[76:79], v[244:247]
    buffer_load_dwordx4 v11, s[4:7], s56 offen offset:3072 sc1 lds
    v_mfma_f32_16x16x32_bf16 v[212:215], a[52:55], v[72:75], v[212:215]
    v_exp_f32 v47, v47
    v_mfma_f32_16x16x32_bf16 v[216:219], a[56:59], v[72:75], v[216:219]
    v_exp_f32 v24, v24
    v_mfma_f32_16x16x32_bf16 v[248:251], a[56:59], v[76:79], v[248:251]
    ds_read_b128 a[24:27], v2 offset:47104
    v_cvt_pk_bf16_f32 v92, v44, v45
    v_mfma_f32_16x16x32_bf16 v[252:255], a[60:63], v[76:79], v[252:255]
    ds_read_b128 a[28:31], v2 offset:48128
    v_cvt_pk_bf16_f32 v89, v42, v43
    v_mfma_f32_16x16x32_bf16 v[220:223], a[60:63], v[72:75], v[220:223]
    s_waitcnt lgkmcnt(4)
    v_cvt_pk_bf16_f32 v88, v40, v41
    v_cvt_pk_bf16_f32 v93, v46, v47
    v_mfma_f32_16x16x32_bf16 v[40:43], a[0:3], a[160:163], v[112:115]
    s_add_u32 s56, s56, 4096
    v_exp_f32 v25, v25
    v_mfma_f32_16x16x32_bf16 v[40:43], a[4:7], a[164:167], v[40:43]
    v_exp_f32 v26, v26
    v_mfma_f32_16x16x32_bf16 v[40:43], a[8:11], a[168:171], v[40:43]
    s_add_u32 m0, s57, 36864
    v_exp_f32 v27, v27
    v_mfma_f32_16x16x32_bf16 v[40:43], a[12:15], a[172:175], v[40:43]
    ds_read_b128 a[32:35], v2 offset:49152
    v_exp_f32 v28, v28
    v_mfma_f32_16x16x32_bf16 v[44:47], a[12:15], a[188:191], v[108:111]
    ds_read_b128 a[36:39], v2 offset:50176
    ds_read_b128 a[40:43], v2 offset:51200
    v_mfma_f32_16x16x32_bf16 v[44:47], a[8:11], a[184:187], v[44:47]
    v_exp_f32 v29, v29
    v_mfma_f32_16x16x32_bf16 v[44:47], a[4:7], a[180:183], v[44:47]
    v_cvt_pk_bf16_f32 v90, v24, v25
    v_cvt_pk_bf16_f32 v91, v26, v27
    v_mfma_f32_16x16x32_bf16 v[44:47], a[0:3], a[176:179], v[44:47]
    s_waitcnt lgkmcnt(3)
    v_exp_f32 v30, v30
    v_mfma_f32_16x16x32_bf16 v[56:59], a[16:19], a[160:163], v[116:119]
    ds_read_b128 a[44:47], v2 offset:52224
    ds_read_b128 a[48:51], v2 offset:53248
    v_mfma_f32_16x16x32_bf16 v[56:59], a[20:23], a[164:167], v[56:59]
    buffer_load_dwordx4 v11, s[4:7], s56 offen offset:0 sc1 lds
    v_mfma_f32_16x16x32_bf16 v[56:59], a[24:27], a[168:171], v[56:59]
    ds_read_b128 a[52:55], v2 offset:54272
    ds_read_b128 a[56:59], v2 offset:55296
    v_mfma_f32_16x16x32_bf16 v[56:59], a[28:31], a[172:175], v[56:59]
    v_exp_f32 v31, v31
    v_mfma_f32_16x16x32_bf16 v[60:63], a[28:31], a[188:191], v[108:111]
    ds_read_b128 a[60:63], v2 offset:56320
    ds_read_b128 a[0:3], v2 offset:57344
    v_mfma_f32_16x16x32_bf16 v[60:63], a[24:27], a[184:187], v[60:63]
    ds_read_b128 a[4:7], v2 offset:58368
    ds_read_b128 a[8:11], v2 offset:59392
    v_mfma_f32_16x16x32_bf16 v[60:63], a[20:23], a[180:183], v[60:63]
    v_cvt_pk_bf16_f32 v94, v28, v29
    v_cvt_pk_bf16_f32 v95, v30, v31
    v_mfma_f32_16x16x32_bf16 v[60:63], a[16:19], a[176:179], v[60:63]
    s_waitcnt lgkmcnt(7)
    ds_read_b128 a[12:15], v2 offset:60416
    v_mfma_f32_16x16x32_bf16 v[192:195], a[32:35], v[88:91], v[192:195]
    v_exp_f32 v40, v40
    v_mfma_f32_16x16x32_bf16 v[224:227], a[32:35], v[92:95], v[224:227]
    ds_read_b128 a[16:19], v2 offset:61440
    ds_read_b128 a[20:23], v2 offset:62464
    v_mfma_f32_16x16x32_bf16 v[228:231], a[36:39], v[92:95], v[228:231]
    buffer_load_dwordx4 v11, s[4:7], s56 offen offset:1024 sc1 lds
    v_mfma_f32_16x16x32_bf16 v[196:199], a[36:39], v[88:91], v[196:199]
    v_exp_f32 v41, v41
    v_mfma_f32_16x16x32_bf16 v[200:203], a[40:43], v[88:91], v[200:203]
    v_exp_f32 v42, v42
    v_mfma_f32_16x16x32_bf16 v[232:235], a[40:43], v[92:95], v[232:235]
    buffer_load_dwordx4 v11, s[4:7], s56 offen offset:2048 sc1 lds
    v_smfmac_f32_16x16x64_bf16 a[68:71], a[80:83], v[88:95], v6
    ds_read_b128 a[24:27], v2 offset:63488
    ds_read_b128 a[28:31], v2 offset:64512
    v_mfma_f32_16x16x32_bf16 v[236:239], a[44:47], v[92:95], v[236:239]
    v_exp_f32 v43, v43
    v_mfma_f32_16x16x32_bf16 v[204:207], a[44:47], v[88:91], v[204:207]
    s_waitcnt lgkmcnt(8)
    v_exp_f32 v44, v44
    v_mfma_f32_16x16x32_bf16 v[208:211], a[48:51], v[88:91], v[208:211]
    buffer_load_dwordx4 v11, s[4:7], s56 offen offset:3072 sc1 lds
    v_mfma_f32_16x16x32_bf16 v[240:243], a[48:51], v[92:95], v[240:243]
    s_add_u32 s56, s56, 28672
    v_exp_f32 v45, v45
    v_mfma_f32_16x16x32_bf16 v[244:247], a[52:55], v[92:95], v[244:247]
    s_add_u32 s57, s57, 32768
    v_cvt_pk_bf16_f32 v72, v40, v41
    v_cvt_pk_bf16_f32 v76, v44, v45
    v_mfma_f32_16x16x32_bf16 v[212:215], a[52:55], v[88:91], v[212:215]
    s_and_b32 s57, s57, 0x1ffff
    v_exp_f32 v46, v46
    v_mfma_f32_16x16x32_bf16 v[216:219], a[56:59], v[88:91], v[216:219]
    s_sub_u32 s39, s39, 1
    v_exp_f32 v47, v47
    v_mfma_f32_16x16x32_bf16 v[248:251], a[56:59], v[92:95], v[248:251]
    s_waitcnt vmcnt(16) lgkmcnt(0)
    s_barrier
    v_mfma_f32_16x16x32_bf16 v[252:255], a[60:63], v[92:95], v[252:255]
    s_cmp_gt_u32 s39, 1
    v_cvt_pk_bf16_f32 v73, v42, v43
    v_add_u32 v2, s58, v11
    v_mfma_f32_16x16x32_bf16 v[220:223], a[60:63], v[88:91], v[220:223]
    s_cbranch_scc1 L_loopC
    s_cmp_eq_u32 s39, 0
    s_cbranch_scc1 L_blkD
    s_mov_b32 s59, 83906560
    buffer_load_dwordx4 v[96:99], v11, s[28:31], s59 offen sc0 sc1
    s_mov_b32 s57, 0x20000
    v_mov_b32 v15, v3
    v_cmp_gt_i32 s[44:45], 0, v15
    v_cmp_gt_i32 s[46:47], 1, v15
    v_cmp_gt_i32 s[48:49], 2, v15
    v_cmp_gt_i32 s[50:51], 3, v15
    v_cndmask_b32 v112, v104, v5, s[44:45]
    v_cndmask_b32 v113, v104, v5, s[46:47]
    v_cndmask_b32 v114, v104, v5, s[48:49]
    v_cndmask_b32 v115, v104, v5, s[50:51]
    v_cmp_gt_i32 s[44:45], 16, v15
    v_cmp_gt_i32 s[46:47], 17, v15
    v_cmp_gt_i32 s[48:49], 18, v15
    v_cmp_gt_i32 s[50:51], 19, v15
    v_cndmask_b32 v116, v104, v5, s[44:45]
    v_cndmask_b32 v117, v104, v5, s[46:47]
    v_cndmask_b32 v118, v104, v5, s[48:49]
    v_cndmask_b32 v119, v104, v5, s[50:51]
    s_branch L_loopC
L_blkD:
    s_waitcnt vmcnt(8)
    v_max3_u32 v96, v96, v97, v98
    v_max_u32 v96, v96, v99
    v_cmp_ne_u32 vcc, 1, v96
    s_nop 0
    s_cmp_eq_u64 vcc, 0
    s_cbranch_scc1 L_ew_ok
L_ew_no:
    s_mov_b32 s39, 0x40000
L_ew_spin:
    buffer_load_dwordx4 v[96:99], v11, s[28:31], s59 offen sc0 sc1
    s_waitcnt vmcnt(0)
    v_max3_u32 v96, v96, v97, v98
    v_max_u32 v96, v96, v99
    v_cmp_ne_u32 vcc, 1, v96
    s_nop 0
    s_cmp_eq_u64 vcc, 0
    s_cbranch_scc1 L_ew_ok
L_ew_again:
    s_sleep 4
    s_sub_u32 s39, s39, 1
    s_cmp_lg_u32 s39, 0
    s_cbranch_scc1 L_ew_spin
L_ew_ok:
    v_mfma_f32_16x16x32_bf16 v[40:43], a[0:3], a[160:163], v[120:123]
    s_add_u32 s40, s18, 0
    s_mul_i32 s41, s40, 40960
    s_add_u32 s41, s41, s17
    s_add_u32 m0, s20, 4096
    v_mfma_f32_16x16x32_bf16 v[40:43], a[4:7], a[164:167], v[40:43]
    ds_read_b128 a[32:35], v2 offset:32768
    buffer_load_dwordx4 v11, s[12:15], s41 offen offset:0 sc1 lds
    v_mfma_f32_16x16x32_bf16 v[40:43], a[8:11], a[168:171], v[40:43]
    s_getpc_b64 s[0:1]
L_t4:
    v_exp_f32 v56, v56
    v_cvt_pk_bf16_f32 v77, v46, v47
    v_subrev_u32 v15, 64, v4
    v_mfma_f32_16x16x32_bf16 v[40:43], a[12:15], a[172:175], v[40:43]
    s_lshr_b32 s39, s2, 3
    v_exp_f32 v57, v57
    v_mfma_f32_16x16x32_bf16 v[44:47], a[12:15], a[188:191], v[108:111]
    s_lshl_b32 s39, s39, 2
    v_exp_f32 v58, v58
    v_mfma_f32_16x16x32_bf16 v[44:47], a[8:11], a[184:187], v[44:47]
    ds_read_b128 a[36:39], v2 offset:33792
    buffer_load_dwordx4 v11, s[12:15], s41 offen offset:1024 sc1 lds
    v_mfma_f32_16x16x32_bf16 v[44:47], a[4:7], a[180:183], v[44:47]
    s_add_u32 s39, s39, s36
    v_exp_f32 v59, v59
    v_cmp_gt_i32 s[44:45], 0, v15
    v_mfma_f32_16x16x32_bf16 v[44:47], a[0:3], a[176:179], v[44:47]
    ds_read_b128 a[40:43], v2 offset:34816
    v_exp_f32 v60, v60
    v_mfma_f32_16x16x32_bf16 v[24:27], a[16:19], a[160:163], v[124:127]
    ds_read_b128 a[44:47], v2 offset:35840
    buffer_load_dwordx4 v11, s[12:15], s41 offen offset:2048 sc1 lds
    v_cvt_pk_bf16_f32 v75, v58, v59
    v_mfma_f32_16x16x32_bf16 v[24:27], a[20:23], a[164:167], v[24:27]
    ds_read_b128 a[48:51], v2 offset:36864
    v_exp_f32 v61, v61
    v_mfma_f32_16x16x32_bf16 v[24:27], a[24:27], a[168:171], v[24:27]
    s_lshl_b32 s39, s39, 7
    v_exp_f32 v62, v62
    v_cvt_pk_bf16_f32 v78, v60, v61
    v_and_b32 v96, 3, v1
    v_lshl_add_u32 v96, v96, 14, s39
    v_add_u32 v96, L_attn_fin-L_t4, v96
    v_min_u32 v96, L_code_end-L_t4-4, v96
    v_mov_b32 v97, 0
    v_mfma_f32_16x16x32_bf16 v[24:27], a[28:31], a[172:175], v[24:27]
    ds_read_b128 a[52:55], v2 offset:37888
    v_lshl_add_u64 v[96:97], v[96:97], 0, s[0:1]
    v_mfma_f32_16x16x32_bf16 v[28:31], a[28:31], a[188:191], v[108:111]
    ds_read_b128 a[56:59], v2 offset:38912
    global_load_dword v96, v[96:97], off
    v_cvt_pk_bf16_f32 v74, v56, v57
    v_mfma_f32_16x16x32_bf16 v[28:31], a[24:27], a[184:187], v[28:31]
    ds_read_b128 a[60:63], v2 offset:39936
    v_exp_f32 v63, v63
    v_mfma_f32_16x16x32_bf16 v[28:31], a[20:23], a[180:183], v[28:31]
    ds_read_b128 a[0:3], v2 offset:40960
    v_cvt_pk_bf16_f32 v79, v62, v63
    v_mfma_f32_16x16x32_bf16 v[28:31], a[16:19], a[176:179], v[28:31]
    s_waitcnt lgkmcnt(5)
    v_cmp_gt_i32 s[46:47], 1, v15
    v_cmp_gt_i32 s[48:49], 2, v15
    v_mfma_f32_16x16x32_bf16 v[192:195], a[32:35], v[72:75], v[192:195]
    ds_read_b128 a[4:7], v2 offset:41984
    buffer_load_dwordx4 v11, s[12:15], s41 offen offset:3072 sc1 lds
    v_exp_f32 v40, v40
    v_cmp_gt_i32 s[50:51], 3, v15
    v_cndmask_b32 v112, v108, v5, s[44:45]
    v_mfma_f32_16x16x32_bf16 v[224:227], a[32:35], v[76:79], v[224:227]
    ds_read_b128 a[8:11], v2 offset:43008
    v_exp_f32 v41, v41
    v_mfma_f32_16x16x32_bf16 v[228:231], a[36:39], v[76:79], v[228:231]
    s_add_u32 m0, s20, 8192
    v_exp_f32 v42, v42
    v_mfma_f32_16x16x32_bf16 v[196:199], a[36:39], v[72:75], v[196:199]
    s_add_u32 s41, s41, 4096
    v_cndmask_b32 v113, v108, v5, s[46:47]
    v_cndmask_b32 v114, v108, v5, s[48:49]
    v_cndmask_b32 v115, v108, v5, s[50:51]
    v_mfma_f32_16x16x32_bf16 v[200:203], a[40:43], v[72:75], v[200:203]
    ds_read_b128 a[12:15], v2 offset:44032
    ds_read_b128 a[16:19], v2 offset:45056
    buffer_load_dwordx4 v11, s[12:15], s41 offen sc1 lds
    v_exp_f32 v43, v43
    v_mfma_f32_16x16x32_bf16 v[232:235], a[40:43], v[76:79], v[232:235]
    s_lshl_b32 s40, s40, 17
    s_add_u32 s40, s40, s16
    v_exp_f32 v44, v44
    v_smfmac_f32_16x16x64_bf16 a[68:71], a[80:83], v[72:79], v6
    ds_read_b128 a[20:23], v2 offset:46080
    v_exp_f32 v45, v45
    v_cvt_pk_bf16_f32 v89, v42, v43
    v_cmp_gt_i32 s[44:45], 16, v15
    v_mfma_f32_16x16x32_bf16 v[236:239], a[44:47], v[76:79], v[236:239]
    s_add_u32 m0, s20, 0
    v_exp_f32 v46, v46
    v_cmp_gt_i32 s[46:47], 17, v15
    v_mfma_f32_16x16x32_bf16 v[204:207], a[44:47], v[72:75], v[204:207]
    s_waitcnt lgkmcnt(6)
    v_exp_f32 v47, v47
    v_mfma_f32_16x16x32_bf16 v[208:211], a[48:51], v[72:75], v[208:211]
    ds_read_b128 a[24:27], v2 offset:47104
    buffer_load_dwordx4 v11, s[8:11], s40 offen offset:0 sc1 lds
    v_mfma_f32_16x16x32_bf16 v[240:243], a[48:51], v[76:79], v[240:243]
    ds_read_b128 a[28:31], v2 offset:48128
    v_exp_f32 v24, v24
    v_mfma_f32_16x16x32_bf16 v[244:247], a[52:55], v[76:79], v[244:247]
    s_add_u32 s58, s58, 32768
    v_exp_f32 v25, v25
    v_cmp_gt_i32 s[48:49], 18, v15
    v_mfma_f32_16x16x32_bf16 v[212:215], a[52:55], v[72:75], v[212:215]
    ds_read_b128 a[32:35], v2 offset:49152
    v_exp_f32 v26, v26
    v_cvt_pk_bf16_f32 v93, v46, v47
    v_cmp_gt_i32 s[50:51], 19, v15
    v_cndmask_b32 v116, v108, v5, s[44:45]
    v_mfma_f32_16x16x32_bf16 v[216:219], a[56:59], v[72:75], v[216:219]
    ds_read_b128 a[36:39], v2 offset:50176
    buffer_load_dwordx4 v11, s[8:11], s40 offen offset:1024 sc1 lds
    v_cvt_pk_bf16_f32 v92, v44, v45
    v_cndmask_b32 v117, v108, v5, s[46:47]
    v_cndmask_b32 v118, v108, v5, s[48:49]
    v_mfma_f32_16x16x32_bf16 v[248:251], a[56:59], v[76:79], v[248:251]
    s_and_b32 s58, s58, 0x1ffff
    v_exp_f32 v27, v27
    v_mfma_f32_16x16x32_bf16 v[252:255], a[60:63], v[76:79], v[252:255]
    ds_read_b128 a[40:43], v2 offset:51200
    v_cvt_pk_bf16_f32 v91, v26, v27
    v_cndmask_b32 v119, v108, v5, s[50:51]
    v_mfma_f32_16x16x32_bf16 v[220:223], a[60:63], v[72:75], v[220:223]
    s_waitcnt lgkmcnt(7)
    v_exp_f32 v28, v28
    v_mfma_f32_16x16x32_bf16 v[44:47], a[0:3], a[176:179], v[112:115]
    ds_read_b128 a[44:47], v2 offset:52224
    buffer_load_dwordx4 v11, s[8:11], s40 offen offset:2048 sc1 lds
    v_mfma_f32_16x16x32_bf16 v[44:47], a[4:7], a[180:183], v[44:47]
    ds_read_b128 a[48:51], v2 offset:53248
    v_exp_f32 v29, v29
    v_cvt_pk_bf16_f32 v88, v40, v41
    v_mfma_f32_16x16x32_bf16 v[44:47], a[8:11], a[184:187], v[44:47]
    ds_read_b128 a[52:55], v2 offset:54272
    v_exp_f32 v30, v30
    v_subrev_u32 v15, 0x60, v4
    v_mfma_f32_16x16x32_bf16 v[44:47], a[12:15], a[188:191], v[44:47]
    s_waitcnt lgkmcnt(6)
    v_exp_f32 v31, v31
    v_cvt_pk_bf16_f32 v94, v28, v29
    v_mfma_f32_16x16x32_bf16 v[60:63], a[16:19], a[176:179], v[116:119]
    ds_read_b128 a[56:59], v2 offset:55296
    ds_read_b128 a[60:63], v2 offset:56320
    buffer_load_dwordx4 v11, s[8:11], s40 offen offset:3072 sc1 lds
    v_cmp_gt_i32 s[44:45], 0, v15
    v_cmp_gt_i32 s[46:47], 1, v15
    v_mfma_f32_16x16x32_bf16 v[60:63], a[20:23], a[180:183], v[60:63]
    s_add_u32 s40, s25, 2
    s_mul_i32 s41, s40, 40960
    s_add_u32 s41, s41, s17
    v_mfma_f32_16x16x32_bf16 v[60:63], a[24:27], a[184:187], v[60:63]
    s_add_u32 m0, s20, 40960
    v_cvt_pk_bf16_f32 v90, v24, v25
    v_cvt_pk_bf16_f32 v95, v30, v31
    v_cmp_gt_i32 s[48:49], 2, v15
    v_mfma_f32_16x16x32_bf16 v[60:63], a[28:31], a[188:191], v[60:63]
    s_waitcnt lgkmcnt(4)
    v_cmp_gt_i32 s[50:51], 3, v15
    v_cndmask_b32 v120, v108, v5, s[44:45]
    v_mfma_f32_16x16x32_bf16 v[192:195], a[32:35], v[88:91], v[192:195]
    ds_read_b128 a[0:3], v2 offset:57344
    buffer_load_dwordx4 v11, s[12:15], s41 offen offset:0 sc1 lds
    buffer_load_dwordx4 v11, s[12:15], s41 offen offset:1024 sc1 lds
    v_cndmask_b32 v121, v108, v5, s[46:47]
    v_mfma_f32_16x16x32_bf16 v[224:227], a[32:35], v[92:95], v[224:227]
    ds_read_b128 a[4:7], v2 offset:58368
    buffer_load_dwordx4 v11, s[12:15], s41 offen offset:2048 sc1 lds
    v_mfma_f32_16x16x32_bf16 v[228:231], a[36:39], v[92:95], v[228:231]
    ds_read_b128 a[8:11], v2 offset:59392
    v_exp_f32 v44, v44
    v_mfma_f32_16x16x32_bf16 v[196:199], a[36:39], v[88:91], v[196:199]
    v_cndmask_b32 v122, v108, v5, s[48:49]
    v_cndmask_b32 v123, v108, v5, s[50:51]
    v_cmp_gt_i32 s[44:45], 16, v15
    v_cmp_gt_i32 s[46:47], 17, v15
    v_mfma_f32_16x16x32_bf16 v[200:203], a[40:43], v[88:91], v[200:203]
    ds_read_b128 a[12:15], v2 offset:60416
    v_cmp_gt_i32 s[48:49], 18, v15
    v_mfma_f32_16x16x32_bf16 v[232:235], a[40:43], v[92:95], v[232:235]
    ds_read_b128 a[16:19], v2 offset:61440
    buffer_load_dwordx4 v11, s[12:15], s41 offen offset:3072 sc1 lds
    v_smfmac_f32_16x16x64_bf16 a[68:71], a[80:83], v[88:95], v6
    ds_read_b128 a[20:23], v2 offset:62464
    v_exp_f32 v45, v45
    v_mfma_f32_16x16x32_bf16 v[236:239], a[44:47], v[92:95], v[236:239]
    s_add_u32 m0, s20, 45056
    v_cvt_pk_bf16_f32 v76, v44, v45
    v_cmp_gt_i32 s[50:51], 19, v15
    v_mfma_f32_16x16x32_bf16 v[204:207], a[44:47], v[88:91], v[204:207]
    s_waitcnt lgkmcnt(6)
    v_cndmask_b32 v124, v108, v5, s[44:45]
    v_cndmask_b32 v125, v108, v5, s[46:47]
    v_mfma_f32_16x16x32_bf16 v[208:211], a[48:51], v[88:91], v[208:211]
    s_add_u32 s41, s41, 4096
    ds_read_b128 a[24:27], v2 offset:63488
    ds_read_b128 a[28:31], v2 offset:64512
    buffer_load_dwordx4 v11, s[12:15], s41 offen sc1 lds
    v_mfma_f32_16x16x32_bf16 v[240:243], a[48:51], v[92:95], v[240:243]
    s_lshl_b32 s40, s40, 17
    s_add_u32 s40, s40, s16
    v_add_u32 v2, s58, v11
    v_cndmask_b32 v126, v108, v5, s[48:49]
    v_mfma_f32_16x16x32_bf16 v[244:247], a[52:55], v[92:95], v[244:247]
    s_add_u32 m0, s20, 36864
    v_exp_f32 v46, v46
    v_mfma_f32_16x16x32_bf16 v[212:215], a[52:55], v[88:91], v[212:215]
    v_exp_f32 v47, v47
    v_mfma_f32_16x16x32_bf16 v[216:219], a[56:59], v[88:91], v[216:219]
    buffer_load_dwordx4 v11, s[8:11], s40 offen offset:0 sc1 lds
    buffer_load_dwordx4 v11, s[8:11], s40 offen offset:1024 sc1 lds
    v_cvt_pk_bf16_f32 v77, v46, v47
    v_mfma_f32_16x16x32_bf16 v[248:251], a[56:59], v[92:95], v[248:251]
    s_waitcnt lgkmcnt(0)
    s_barrier
    v_mfma_f32_16x16x32_bf16 v[252:255], a[60:63], v[92:95], v[252:255]
    buffer_load_dwordx4 v11, s[8:11], s40 offen offset:2048 sc1 lds
    v_cndmask_b32 v127, v108, v5, s[50:51]
    v_mfma_f32_16x16x32_bf16 v[220:223], a[60:63], v[88:91], v[220:223]
    buffer_load_dwordx4 v11, s[8:11], s40 offen offset:3072 sc1 lds
    v_mfma_f32_16x16x32_bf16 v[44:47], a[0:3], a[176:179], v[120:123]
    s_add_u32 s40, s18, 4
    v_exp_f32 v60, v60
    v_mfma_f32_16x16x32_bf16 v[44:47], a[4:7], a[180:183], v[44:47]
    v_exp_f32 v61, v61
    v_mfma_f32_16x16x32_bf16 v[44:47], a[8:11], a[184:187], v[44:47]
    ds_read_b128 a[32:35], v2 offset:32768
    ds_read_b128 a[36:39], v2 offset:33792
    ds_read_b128 a[40:43], v2 offset:34816
    ds_read_b128 a[44:47], v2 offset:35840
    ds_read_b128 a[48:51], v2 offset:36864
    v_mfma_f32_16x16x32_bf16 v[44:47], a[12:15], a[188:191], v[44:47]
    s_mul_i32 s41, s40, 40960
    s_add_u32 s41, s41, s17
    v_cvt_pk_bf16_f32 v78, v60, v61
    v_mfma_f32_16x16x32_bf16 v[28:31], a[16:19], a[176:179], v[124:127]
    s_add_u32 m0, s20, 77824
    v_exp_f32 v62, v62
    v_mfma_f32_16x16x32_bf16 v[28:31], a[20:23], a[180:183], v[28:31]
    v_exp_f32 v63, v63
    v_mfma_f32_16x16x32_bf16 v[28:31], a[24:27], a[184:187], v[28:31]
    ds_read_b128 a[52:55], v2 offset:37888
    v_cvt_pk_bf16_f32 v79, v62, v63
    v_mfma_f32_16x16x32_bf16 v[28:31], a[28:31], a[188:191], v[28:31]
    s_waitcnt lgkmcnt(2)
    ds_read_b128 a[56:59], v2 offset:38912
    ds_read_b128 a[60:63], v2 offset:39936
    v_mfma_f32_16x16x32_bf16 v[224:227], a[32:35], v[76:79], v[224:227]
    buffer_load_dwordx4 v11, s[12:15], s41 offen offset:0 sc1 lds
    v_mfma_f32_16x16x32_bf16 v[228:231], a[36:39], v[76:79], v[228:231]
    buffer_load_dwordx4 v11, s[12:15], s41 offen offset:1024 sc1 lds
    v_mfma_f32_16x16x32_bf16 v[232:235], a[40:43], v[76:79], v[232:235]
    v_exp_f32 v44, v44
    v_smfmac_f32_16x16x64_bf16 a[68:71], a[72:75], v[72:79], v6
    buffer_load_dwordx4 v11, s[12:15], s41 offen offset:2048 sc1 lds
    v_exp_f32 v45, v45
    v_mfma_f32_16x16x32_bf16 v[236:239], a[44:47], v[76:79], v[236:239]
    s_waitcnt lgkmcnt(0)
    v_exp_f32 v46, v46
    v_mfma_f32_16x16x32_bf16 v[240:243], a[48:51], v[76:79], v[240:243]
    v_exp_f32 v47, v47
    v_mfma_f32_16x16x32_bf16 v[244:247], a[52:55], v[76:79], v[244:247]
    ds_read_b128 a[32:35], v2 offset:49152
    ds_read_b128 a[36:39], v2 offset:50176
    v_exp_f32 v28, v28
    v_mfma_f32_16x16x32_bf16 v[248:251], a[56:59], v[76:79], v[248:251]
    buffer_load_dwordx4 v11, s[12:15], s41 offen offset:3072 sc1 lds
    v_cvt_pk_bf16_f32 v92, v44, v45
    v_mfma_f32_16x16x32_bf16 v[252:255], a[60:63], v[76:79], v[252:255]
    s_add_u32 m0, s20, 81920
    v_exp_f32 v29, v29
    v_cvt_pk_bf16_f32 v93, v46, v47
    s_nop 0
    ds_read_b128 a[40:43], v2 offset:51200
    ds_read_b128 a[44:47], v2 offset:52224
    ds_read_b128 a[48:51], v2 offset:53248
    s_nop 0
    s_add_u32 s41, s41, 4096
    v_exp_f32 v30, v30
    s_nop 0
    v_exp_f32 v31, v31
    s_nop 0
    v_cvt_pk_bf16_f32 v94, v28, v29
    v_cvt_pk_bf16_f32 v95, v30, v31
    s_nop 0
    ds_read_b128 a[52:55], v2 offset:54272
    ds_read_b128 a[56:59], v2 offset:55296
    s_nop 0
    s_waitcnt lgkmcnt(3)
    ds_read_b128 a[60:63], v2 offset:56320
    v_mfma_f32_16x16x32_bf16 v[224:227], a[32:35], v[92:95], v[224:227]
    buffer_load_dwordx4 v11, s[12:15], s41 offen sc1 lds
    v_mfma_f32_16x16x32_bf16 v[228:231], a[36:39], v[92:95], v[228:231]
    s_lshl_b32 s40, s40, 17
    s_add_u32 s40, s40, s16
    v_mfma_f32_16x16x32_bf16 v[232:235], a[40:43], v[92:95], v[232:235]
    s_add_u32 m0, s20, 73728
    v_smfmac_f32_16x16x64_bf16 a[68:71], a[72:75], v[88:95], v6
    buffer_load_dwordx4 v11, s[8:11], s40 offen offset:0 sc1 lds
    v_mfma_f32_16x16x32_bf16 v[236:239], a[44:47], v[92:95], v[236:239]
    s_waitcnt lgkmcnt(0)
    v_mfma_f32_16x16x32_bf16 v[240:243], a[48:51], v[92:95], v[240:243]
    v_mfma_f32_16x16x32_bf16 v[244:247], a[52:55], v[92:95], v[244:247]
    buffer_load_dwordx4 v11, s[8:11], s40 offen offset:1024 sc1 lds
    v_mfma_f32_16x16x32_bf16 v[248:251], a[56:59], v[92:95], v[248:251]
    buffer_load_dwordx4 v11, s[8:11], s40 offen offset:2048 sc1 lds
    v_mfma_f32_16x16x32_bf16 v[252:255], a[60:63], v[92:95], v[252:255]
    buffer_load_dwordx4 v11, s[8:11], s40 offen offset:3072 sc1 lds
    s_waitcnt vmcnt(18)
    s_barrier
    v_accvgpr_read_b32 v32, a64
    v_accvgpr_read_b32 v33, a65
    v_accvgpr_read_b32 v34, a66
    v_accvgpr_read_b32 v35, a67
    v_accvgpr_read_b32 v36, a68
    v_accvgpr_read_b32 v37, a69
    v_accvgpr_read_b32 v38, a70
    v_accvgpr_read_b32 v39, a71
    v_add_f32 v32, v32, v33
    v_add_f32 v32, v32, v34
    v_add_f32 v32, v32, v35
    v_add_f32 v32, v32, v36
    v_add_f32 v32, v32, v37
    v_add_f32 v32, v32, v38
    v_add_f32 v32, v32, v39
    v_cmp_ngt_f32 vcc, 0x67800000, v32
    s_nop 1
    s_cbranch_vccnz L_slow
L_attn_fin:
    s_lshl_b32 s42, s37, 19
    s_add_u32 s42, s42, 36700160
    v_accvgpr_read_b32 v100, a68
    v_accvgpr_read_b32 v101, a69
    v_accvgpr_read_b32 v102, a70
    v_accvgpr_read_b32 v103, a71
    v_add_f32 v100, v100, v101
    v_add_f32 v102, v102, v103
    v_rcp_f32 v100, v100
    v_rcp_f32 v102, v102
    s_lshr_b32 s41, s36, 1
    s_mul_i32 s40, s41, 9216
    v_add_u32 v2, s40, v11
    s_and_b32 s40, s36, 1
    s_mul_i32 s40, s40, 9216
    s_add_u32 s40, s40, 4096
    v_add_u32 v3, s40, v11
    v_add_u32 v6, 0, v2
    v_add_u32 v9, 0, v3
    ds_read_b128 a[96:99], v6 offset:0
    ds_read_b128 a[132:135], v6 offset:18432
    ds_read_b128 a[100:103], v6 offset:1024
    ds_read_b128 a[136:139], v6 offset:19456
    ds_read_b128 a[104:107], v6 offset:2048
    ds_read_b128 a[140:143], v6 offset:20480
    ds_read_b128 a[108:111], v6 offset:3072
    ds_read_b128 a[144:147], v6 offset:21504
    ds_read_b128 a[112:115], v9 offset:0
    ds_read_b128 a[148:151], v9 offset:18432
    ds_read_b128 a[116:119], v9 offset:1024
    ds_read_b128 a[152:155], v9 offset:19456
    ds_read_b128 a[120:123], v9 offset:2048
    ds_read_b128 a[156:159], v9 offset:20480
    ds_read_b128 a[124:127], v9 offset:3072
    ds_read_b128 a[160:163], v9 offset:21504
    ds_read_b128 a[128:131], v9 offset:4096
    ds_read_b128 a[164:167], v9 offset:22528
    s_nop 0
    v_mul_f32 v100, v100, v10
    v_mul_f32 v102, v102, v12
    s_lshl_b32 s43, s54, 10
    s_add_u32 s43, s43, s42
    v_pk_mul_f32 v[192:193], v[192:193], v[100:101] op_sel_hi:[1,0]
    v_pk_mul_f32 v[194:195], v[194:195], v[100:101] op_sel_hi:[1,0]
    v_pk_mul_f32 v[196:197], v[196:197], v[100:101] op_sel_hi:[1,0]
    v_pk_mul_f32 v[198:199], v[198:199], v[100:101] op_sel_hi:[1,0]
    v_cvt_pk_bf16_f32 v192, v192, v193
    v_cvt_pk_bf16_f32 v193, v194, v195
    v_cvt_pk_bf16_f32 v194, v196, v197
    v_cvt_pk_bf16_f32 v195, v198, v199
    buffer_store_dwordx4 v[192:195], v11, s[28:31], s43 offen sc1
    s_add_u32 s43, s43, 131072
    v_pk_mul_f32 v[200:201], v[200:201], v[100:101] op_sel_hi:[1,0]
    v_pk_mul_f32 v[202:203], v[202:203], v[100:101] op_sel_hi:[1,0]
    v_pk_mul_f32 v[204:205], v[204:205], v[100:101] op_sel_hi:[1,0]
    v_pk_mul_f32 v[206:207], v[206:207], v[100:101] op_sel_hi:[1,0]
    v_cvt_pk_bf16_f32 v200, v200, v201
    v_cvt_pk_bf16_f32 v201, v202, v203
    v_cvt_pk_bf16_f32 v202, v204, v205
    v_cvt_pk_bf16_f32 v203, v206, v207
    buffer_store_dwordx4 v[200:203], v11, s[28:31], s43 offen sc1
    s_add_u32 s43, s43, 131072
    v_pk_mul_f32 v[208:209], v[208:209], v[100:101] op_sel_hi:[1,0]
    v_pk_mul_f32 v[210:211], v[210:211], v[100:101] op_sel_hi:[1,0]
    v_pk_mul_f32 v[212:213], v[212:213], v[100:101] op_sel_hi:[1,0]
    v_pk_mul_f32 v[214:215], v[214:215], v[100:101] op_sel_hi:[1,0]
    v_cvt_pk_bf16_f32 v208, v208, v209
    v_cvt_pk_bf16_f32 v209, v210, v211
    v_cvt_pk_bf16_f32 v210, v212, v213
    v_cvt_pk_bf16_f32 v211, v214, v215
    buffer_store_dwordx4 v[208:211], v11, s[28:31], s43 offen sc1
    s_add_u32 s43, s43, 131072
    v_pk_mul_f32 v[216:217], v[216:217], v[100:101] op_sel_hi:[1,0]
    v_pk_mul_f32 v[218:219], v[218:219], v[100:101] op_sel_hi:[1,0]
    v_pk_mul_f32 v[220:221], v[220:221], v[100:101] op_sel_hi:[1,0]
    v_pk_mul_f32 v[222:223], v[222:223], v[100:101] op_sel_hi:[1,0]
    v_cvt_pk_bf16_f32 v216, v216, v217
    v_cvt_pk_bf16_f32 v217, v218, v219
    v_cvt_pk_bf16_f32 v218, v220, v221
    v_cvt_pk_bf16_f32 v219, v222, v223
    buffer_store_dwordx4 v[216:219], v11, s[28:31], s43 offen sc1
    s_lshl_b32 s43, s55, 10
    s_add_u32 s43, s43, s42
    v_pk_mul_f32 v[224:225], v[224:225], v[102:103] op_sel_hi:[1,0]
    v_pk_mul_f32 v[226:227], v[226:227], v[102:103] op_sel_hi:[1,0]
    v_pk_mul_f32 v[228:229], v[228:229], v[102:103] op_sel_hi:[1,0]
    v_pk_mul_f32 v[230:231], v[230:231], v[102:103] op_sel_hi:[1,0]
    v_cvt_pk_bf16_f32 v224, v224, v225
    v_cvt_pk_bf16_f32 v225, v226, v227
    v_cvt_pk_bf16_f32 v226, v228, v229
    v_cvt_pk_bf16_f32 v227, v230, v231
    buffer_store_dwordx4 v[224:227], v11, s[28:31], s43 offen sc1
    s_add_u32 s43, s43, 131072
    v_pk_mul_f32 v[232:233], v[232:233], v[102:103] op_sel_hi:[1,0]
    v_pk_mul_f32 v[234:235], v[234:235], v[102:103] op_sel_hi:[1,0]
    v_pk_mul_f32 v[236:237], v[236:237], v[102:103] op_sel_hi:[1,0]
    v_pk_mul_f32 v[238:239], v[238:239], v[102:103] op_sel_hi:[1,0]
    v_cvt_pk_bf16_f32 v232, v232, v233
    v_cvt_pk_bf16_f32 v233, v234, v235
    v_cvt_pk_bf16_f32 v234, v236, v237
    v_cvt_pk_bf16_f32 v235, v238, v239
    buffer_store_dwordx4 v[232:235], v11, s[28:31], s43 offen sc1
    s_add_u32 s43, s43, 131072
    v_pk_mul_f32 v[240:241], v[240:241], v[102:103] op_sel_hi:[1,0]
    v_pk_mul_f32 v[242:243], v[242:243], v[102:103] op_sel_hi:[1,0]
    v_pk_mul_f32 v[244:245], v[244:245], v[102:103] op_sel_hi:[1,0]
    v_pk_mul_f32 v[246:247], v[246:247], v[102:103] op_sel_hi:[1,0]
    v_cvt_pk_bf16_f32 v240, v240, v241
    v_cvt_pk_bf16_f32 v241, v242, v243
    v_cvt_pk_bf16_f32 v242, v244, v245
    v_cvt_pk_bf16_f32 v243, v246, v247
    buffer_store_dwordx4 v[240:243], v11, s[28:31], s43 offen sc1
    s_add_u32 s43, s43, 131072
    v_pk_mul_f32 v[248:249], v[248:249], v[102:103] op_sel_hi:[1,0]
    v_pk_mul_f32 v[250:251], v[250:251], v[102:103] op_sel_hi:[1,0]
    v_pk_mul_f32 v[252:253], v[252:253], v[102:103] op_sel_hi:[1,0]
    v_pk_mul_f32 v[254:255], v[254:255], v[102:103] op_sel_hi:[1,0]
    v_cvt_pk_bf16_f32 v248, v248, v249
    v_cvt_pk_bf16_f32 v249, v250, v251
    v_cvt_pk_bf16_f32 v250, v252, v253
    v_cvt_pk_bf16_f32 v251, v254, v255
    buffer_store_dwordx4 v[248:251], v11, s[28:31], s43 offen sc1
    s_bitcmp1_b32 s2, 0
    s_cbranch_scc1 L_outO
L_outE:
    s_waitcnt lgkmcnt(8)
    v_mfma_f32_16x16x32_bf16 v[32:35], a[112:115], a[96:99], 0
    s_add_u32 s40, s25, 6
    s_mul_i32 s41, s40, 40960
    s_add_u32 s41, s41, s17
    v_mfma_f32_16x16x32_bf16 v[32:35], a[148:151], a[132:135], v[32:35]
    s_add_u32 m0, s20, 114688
    v_mfma_f32_16x16x32_bf16 v[36:39], a[148:151], a[136:139], 0
    buffer_load_dwordx4 v11, s[12:15], s41 offen offset:0 sc1 lds
    v_mfma_f32_16x16x32_bf16 v[36:39], a[112:115], a[100:103], v[36:39]
    v_mfma_f32_16x16x32_bf16 v[40:43], a[112:115], a[104:107], 0
    v_mfma_f32_16x16x32_bf16 v[40:43], a[148:151], a[140:143], v[40:43]
    v_mfma_f32_16x16x32_bf16 v[44:47], a[148:151], a[144:147], 0
    buffer_load_dwordx4 v11, s[12:15], s41 offen offset:1024 sc1 lds
    v_mfma_f32_16x16x32_bf16 v[44:47], a[112:115], a[108:111], v[44:47]
    s_waitcnt lgkmcnt(6)
    v_mfma_f32_16x16x32_bf16 v[60:63], a[116:119], a[108:111], 0
    v_mfma_f32_16x16x32_bf16 v[60:63], a[152:155], a[144:147], v[60:63]
    v_mfma_f32_16x16x32_bf16 v[56:59], a[152:155], a[140:143], 0
    buffer_load_dwordx4 v11, s[12:15], s41 offen offset:2048 sc1 lds
    v_mfma_f32_16x16x32_bf16 v[56:59], a[116:119], a[104:107], v[56:59]
    v_mfma_f32_16x16x32_bf16 v[52:55], a[116:119], a[100:103], 0
    v_mfma_f32_16x16x32_bf16 v[52:55], a[152:155], a[136:139], v[52:55]
    v_mfma_f32_16x16x32_bf16 v[48:51], a[152:155], a[132:135], 0
    buffer_load_dwordx4 v11, s[12:15], s41 offen offset:3072 sc1 lds
    v_mfma_f32_16x16x32_bf16 v[48:51], a[116:119], a[96:99], v[48:51]
    s_waitcnt vmcnt(21) lgkmcnt(0)
    s_barrier
    v_mfma_f32_16x16x32_bf16 v[64:67], a[120:123], a[96:99], 0
    s_add_u32 m0, s20, 118784
    v_add_u32 v6, 36864, v2
    v_add_u32 v9, 36864, v3
    v_mfma_f32_16x16x32_bf16 v[64:67], a[156:159], a[132:135], v[64:67]
    ds_read_b128 a[0:3], v6 offset:0
    v_mfma_f32_16x16x32_bf16 v[68:71], a[156:159], a[136:139], 0
    s_add_u32 s41, s41, 4096
    v_mfma_f32_16x16x32_bf16 v[68:71], a[120:123], a[100:103], v[68:71]
    v_mfma_f32_16x16x32_bf16 v[72:75], a[120:123], a[104:107], 0
    buffer_load_dwordx4 v11, s[12:15], s41 offen sc1 lds
    v_mfma_f32_16x16x32_bf16 v[72:75], a[156:159], a[140:143], v[72:75]
    s_lshl_b32 s40, s40, 17
    s_add_u32 s40, s40, s16
    s_add_u32 m0, s20, 110592
    v_mfma_f32_16x16x32_bf16 v[76:79], a[156:159], a[144:147], 0
    ds_read_b128 a[36:39], v6 offset:18432
    v_mfma_f32_16x16x32_bf16 v[76:79], a[120:123], a[108:111], v[76:79]
    v_mfma_f32_16x16x32_bf16 v[92:95], a[124:127], a[108:111], 0
    buffer_load_dwordx4 v11, s[8:11], s40 offen offset:0 sc1 lds
    v_mfma_f32_16x16x32_bf16 v[92:95], a[160:163], a[144:147], v[92:95]
    v_mfma_f32_16x16x32_bf16 v[88:91], a[160:163], a[140:143], 0
    ds_read_b128 a[4:7], v6 offset:1024
    v_mfma_f32_16x16x32_bf16 v[88:91], a[124:127], a[104:107], v[88:91]
    v_mfma_f32_16x16x32_bf16 v[84:87], a[124:127], a[100:103], 0
    ds_read_b128 a[40:43], v6 offset:19456
    v_mfma_f32_16x16x32_bf16 v[84:87], a[160:163], a[136:139], v[84:87]
    buffer_load_dwordx4 v11, s[8:11], s40 offen offset:1024 sc1 lds
    v_mfma_f32_16x16x32_bf16 v[80:83], a[160:163], a[132:135], 0
    ds_read_b128 a[8:11], v6 offset:2048
    v_mfma_f32_16x16x32_bf16 v[80:83], a[124:127], a[96:99], v[80:83]
    ds_read_b128 a[44:47], v6 offset:20480
    v_mfma_f32_16x16x32_bf16 v[96:99], a[128:131], a[96:99], 0
    v_mfma_f32_16x16x32_bf16 v[96:99], a[164:167], a[132:135], v[96:99]
    buffer_load_dwordx4 v11, s[8:11], s40 offen offset:2048 sc1 lds
    v_mfma_f32_16x16x32_bf16 v[100:103], a[164:167], a[136:139], 0
    ds_read_b128 a[12:15], v6 offset:3072
    v_mfma_f32_16x16x32_bf16 v[100:103], a[128:131], a[100:103], v[100:103]
    ds_read_b128 a[48:51], v6 offset:21504
    v_mfma_f32_16x16x32_bf16 v[104:107], a[128:131], a[104:107], 0
    ds_read_b128 a[16:19], v9 offset:0
    ds_read_b128 a[52:55], v9 offset:18432
    v_mfma_f32_16x16x32_bf16 v[104:107], a[164:167], a[140:143], v[104:107]
    ds_read_b128 a[20:23], v9 offset:1024
    ds_read_b128 a[56:59], v9 offset:19456
    v_mfma_f32_16x16x32_bf16 v[108:111], a[164:167], a[144:147], 0
    buffer_load_dwordx4 v11, s[8:11], s40 offen offset:3072 sc1 lds
    v_mfma_f32_16x16x32_bf16 v[108:111], a[128:131], a[108:111], v[108:111]
    s_waitcnt lgkmcnt(2)
    v_mfma_f32_16x16x32_bf16 v[32:35], a[16:19], a[0:3], v[32:35]
    s_add_u32 s40, s18, 8
    v_mfma_f32_16x16x32_bf16 v[32:35], a[52:55], a[36:39], v[32:35]
    ds_read_b128 a[24:27], v9 offset:2048
    ds_read_b128 a[60:63], v9 offset:20480
    v_mfma_f32_16x16x32_bf16 v[36:39], a[52:55], a[40:43], v[36:39]
    s_mul_i32 s41, s40, 40960
    s_add_u32 s41, s41, s17
    s_add_u32 m0, s20, 4096
    v_mfma_f32_16x16x32_bf16 v[36:39], a[16:19], a[4:7], v[36:39]
    buffer_load_dwordx4 v11, s[12:15], s41 offen offset:0 sc1 lds
    v_mfma_f32_16x16x32_bf16 v[40:43], a[16:19], a[8:11], v[40:43]
    ds_read_b128 a[28:31], v9 offset:3072
    v_mfma_f32_16x16x32_bf16 v[40:43], a[52:55], a[44:47], v[40:43]
    ds_read_b128 a[64:67], v9 offset:21504
    ds_read_b128 a[32:35], v9 offset:4096
    v_mfma_f32_16x16x32_bf16 v[44:47], a[52:55], a[48:51], v[44:47]
    buffer_load_dwordx4 v11, s[12:15], s41 offen offset:1024 sc1 lds
    v_mfma_f32_16x16x32_bf16 v[44:47], a[16:19], a[12:15], v[44:47]
    s_waitcnt lgkmcnt(5)
    v_mfma_f32_16x16x32_bf16 v[60:63], a[20:23], a[12:15], v[60:63]
    ds_read_b128 a[68:71], v9 offset:22528
    v_mfma_f32_16x16x32_bf16 v[60:63], a[56:59], a[48:51], v[60:63]
    buffer_load_dwordx4 v11, s[12:15], s41 offen offset:2048 sc1 lds
    v_mfma_f32_16x16x32_bf16 v[56:59], a[56:59], a[44:47], v[56:59]
    v_mfma_f32_16x16x32_bf16 v[56:59], a[20:23], a[8:11], v[56:59]
    v_mfma_f32_16x16x32_bf16 v[52:55], a[20:23], a[4:7], v[52:55]
    v_mfma_f32_16x16x32_bf16 v[52:55], a[56:59], a[40:43], v[52:55]
    buffer_load_dwordx4 v11, s[12:15], s41 offen offset:3072 sc1 lds
    v_mfma_f32_16x16x32_bf16 v[48:51], a[56:59], a[36:39], v[48:51]
    s_add_u32 m0, s20, 8192
    v_mfma_f32_16x16x32_bf16 v[48:51], a[20:23], a[0:3], v[48:51]
    s_waitcnt vmcnt(13) lgkmcnt(0)
    s_barrier
    v_mfma_f32_16x16x32_bf16 v[64:67], a[24:27], a[0:3], v[64:67]
    buffer_store_dword v7, v0, s[28:31], s67 offen sc1
    v_mfma_f32_16x16x32_bf16 v[64:67], a[60:63], a[36:39], v[64:67]
    s_add_u32 s41, s41, 4096
    v_mfma_f32_16x16x32_bf16 v[68:71], a[60:63], a[40:43], v[68:71]
    v_add_u32 v6, 73728, v2
    v_mfma_f32_16x16x32_bf16 v[68:71], a[24:27], a[4:7], v[68:71]
    v_add_u32 v9, 73728, v3
    v_mfma_f32_16x16x32_bf16 v[72:75], a[24:27], a[8:11], v[72:75]
    buffer_load_dwordx4 v11, s[12:15], s41 offen sc1 lds
    v_mfma_f32_16x16x32_bf16 v[72:75], a[60:63], a[44:47], v[72:75]
    v_mfma_f32_16x16x32_bf16 v[76:79], a[60:63], a[48:51], v[76:79]
    s_lshl_b32 s40, s40, 17
    s_add_u32 s40, s40, s16
    v_mfma_f32_16x16x32_bf16 v[76:79], a[24:27], a[12:15], v[76:79]
    s_add_u32 m0, s20, 0
    v_mfma_f32_16x16x32_bf16 v[92:95], a[28:31], a[12:15], v[92:95]
    ds_read_b128 a[96:99], v6 offset:0
    ds_read_b128 a[132:135], v6 offset:18432
    v_mfma_f32_16x16x32_bf16 v[92:95], a[64:67], a[48:51], v[92:95]
    buffer_load_dwordx4 v11, s[8:11], s40 offen offset:0 sc1 lds
    v_mfma_f32_16x16x32_bf16 v[88:91], a[64:67], a[44:47], v[88:91]
    v_mfma_f32_16x16x32_bf16 v[88:91], a[28:31], a[8:11], v[88:91]
    ds_read_b128 a[100:103], v6 offset:1024
    ds_read_b128 a[136:139], v6 offset:19456
    v_mfma_f32_16x16x32_bf16 v[84:87], a[28:31], a[4:7], v[84:87]
    ds_read_b128 a[104:107], v6 offset:2048
    v_mfma_f32_16x16x32_bf16 v[84:87], a[64:67], a[40:43], v[84:87]
    buffer_load_dwordx4 v11, s[8:11], s40 offen offset:1024 sc1 lds
    v_mfma_f32_16x16x32_bf16 v[80:83], a[64:67], a[36:39], v[80:83]
    ds_read_b128 a[140:143], v6 offset:20480
    ds_read_b128 a[108:111], v6 offset:3072
    v_mfma_f32_16x16x32_bf16 v[80:83], a[28:31], a[0:3], v[80:83]
    v_mfma_f32_16x16x32_bf16 v[96:99], a[32:35], a[0:3], v[96:99]
    v_mfma_f32_16x16x32_bf16 v[96:99], a[68:71], a[36:39], v[96:99]
    ds_read_b128 a[144:147], v6 offset:21504
    ds_read_b128 a[112:115], v9 offset:0
    v_mfma_f32_16x16x32_bf16 v[100:103], a[68:71], a[40:43], v[100:103]
    buffer_load_dwordx4 v11, s[8:11], s40 offen offset:2048 sc1 lds
    v_mfma_f32_16x16x32_bf16 v[100:103], a[32:35], a[4:7], v[100:103]
    ds_read_b128 a[148:151], v9 offset:18432
    v_mfma_f32_16x16x32_bf16 v[104:107], a[32:35], a[8:11], v[104:107]
    ds_read_b128 a[116:119], v9 offset:1024
    v_mfma_f32_16x16x32_bf16 v[104:107], a[68:71], a[44:47], v[104:107]
    ds_read_b128 a[152:155], v9 offset:19456
    v_mfma_f32_16x16x32_bf16 v[108:111], a[68:71], a[48:51], v[108:111]
    buffer_load_dwordx4 v11, s[8:11], s40 offen offset:3072 sc1 lds
    v_mfma_f32_16x16x32_bf16 v[108:111], a[32:35], a[12:15], v[108:111]
    s_waitcnt lgkmcnt(2)
    v_mfma_f32_16x16x32_bf16 v[32:35], a[112:115], a[96:99], v[32:35]
    ds_read_b128 a[120:123], v9 offset:2048
    ds_read_b128 a[156:159], v9 offset:20480
    v_mfma_f32_16x16x32_bf16 v[32:35], a[148:151], a[132:135], v[32:35]
    s_add_u32 s40, s25, 10
    ds_read_b128 a[124:127], v9 offset:3072
    v_mfma_f32_16x16x32_bf16 v[36:39], a[148:151], a[136:139], v[36:39]
    v_mfma_f32_16x16x32_bf16 v[36:39], a[112:115], a[100:103], v[36:39]
    s_mul_i32 s41, s40, 40960
    s_add_u32 s41, s41, s17
    s_add_u32 m0, s20, 40960
    v_mfma_f32_16x16x32_bf16 v[40:43], a[112:115], a[104:107], v[40:43]
    buffer_load_dwordx4 v11, s[12:15], s41 offen offset:0 sc1 lds
    v_mfma_f32_16x16x32_bf16 v[40:43], a[148:151], a[140:143], v[40:43]
    v_mfma_f32_16x16x32_bf16 v[44:47], a[148:151], a[144:147], v[44:47]
    v_mfma_f32_16x16x32_bf16 v[44:47], a[112:115], a[108:111], v[44:47]
    s_waitcnt lgkmcnt(3)
    v_mfma_f32_16x16x32_bf16 v[60:63], a[116:119], a[108:111], v[60:63]
    buffer_load_dwordx4 v11, s[12:15], s41 offen offset:1024 sc1 lds
    v_mfma_f32_16x16x32_bf16 v[60:63], a[152:155], a[144:147], v[60:63]
    ds_read_b128 a[160:163], v9 offset:21504
    v_mfma_f32_16x16x32_bf16 v[56:59], a[152:155], a[140:143], v[56:59]
    ds_read_b128 a[128:131], v9 offset:4096
    v_mfma_f32_16x16x32_bf16 v[56:59], a[116:119], a[104:107], v[56:59]
    ds_read_b128 a[164:167], v9 offset:22528
    v_mfma_f32_16x16x32_bf16 v[52:55], a[116:119], a[100:103], v[52:55]
    v_mfma_f32_16x16x32_bf16 v[52:55], a[152:155], a[136:139], v[52:55]
    buffer_load_dwordx4 v11, s[12:15], s41 offen offset:2048 sc1 lds
    v_mfma_f32_16x16x32_bf16 v[48:51], a[152:155], a[132:135], v[48:51]
    v_mfma_f32_16x16x32_bf16 v[48:51], a[116:119], a[96:99], v[48:51]
    s_waitcnt vmcnt(13) lgkmcnt(0)
    s_barrier
    v_mfma_f32_16x16x32_bf16 v[64:67], a[120:123], a[96:99], v[64:67]
    v_add_u32 v6, 110592, v2
    v_add_u32 v9, 110592, v3
    v_mfma_f32_16x16x32_bf16 v[64:67], a[156:159], a[132:135], v[64:67]
    buffer_load_dwordx4 v11, s[12:15], s41 offen offset:3072 sc1 lds
    v_mfma_f32_16x16x32_bf16 v[68:71], a[156:159], a[136:139], v[68:71]
    v_mfma_f32_16x16x32_bf16 v[68:71], a[120:123], a[100:103], v[68:71]
    s_add_u32 m0, s20, 45056
    ds_read_b128 a[0:3], v6 offset:0
    v_mfma_f32_16x16x32_bf16 v[72:75], a[120:123], a[104:107], v[72:75]
    s_add_u32 s41, s41, 4096
    v_mfma_f32_16x16x32_bf16 v[72:75], a[156:159], a[140:143], v[72:75]
    v_mfma_f32_16x16x32_bf16 v[76:79], a[156:159], a[144:147], v[76:79]
    buffer_load_dwordx4 v11, s[12:15], s41 offen sc1 lds
    v_mfma_f32_16x16x32_bf16 v[76:79], a[120:123], a[108:111], v[76:79]
    s_lshl_b32 s40, s40, 17
    s_add_u32 s40, s40, s16
    v_mfma_f32_16x16x32_bf16 v[92:95], a[124:127], a[108:111], v[92:95]
    ds_read_b128 a[36:39], v6 offset:18432
    ds_read_b128 a[4:7], v6 offset:1024
    v_mfma_f32_16x16x32_bf16 v[92:95], a[160:163], a[144:147], v[92:95]
    s_add_u32 m0, s20, 36864
    v_mfma_f32_16x16x32_bf16 v[88:91], a[160:163], a[140:143], v[88:91]
    buffer_load_dwordx4 v11, s[8:11], s40 offen offset:0 sc1 lds
    v_mfma_f32_16x16x32_bf16 v[88:91], a[124:127], a[104:107], v[88:91]
    ds_read_b128 a[40:43], v6 offset:19456
    ds_read_b128 a[8:11], v6 offset:2048
    v_mfma_f32_16x16x32_bf16 v[84:87], a[124:127], a[100:103], v[84:87]
    ds_read_b128 a[44:47], v6 offset:20480
    ds_read_b128 a[12:15], v6 offset:3072
    v_mfma_f32_16x16x32_bf16 v[84:87], a[160:163], a[136:139], v[84:87]
    v_mfma_f32_16x16x32_bf16 v[80:83], a[160:163], a[132:135], v[80:83]
    buffer_load_dwordx4 v11, s[8:11], s40 offen offset:1024 sc1 lds
    v_mfma_f32_16x16x32_bf16 v[80:83], a[124:127], a[96:99], v[80:83]
    v_mfma_f32_16x16x32_bf16 v[96:99], a[128:131], a[96:99], v[96:99]
    ds_read_b128 a[48:51], v6 offset:21504
    ds_read_b128 a[16:19], v9 offset:0
    v_mfma_f32_16x16x32_bf16 v[96:99], a[164:167], a[132:135], v[96:99]
    ds_read_b128 a[52:55], v9 offset:18432
    ds_read_b128 a[20:23], v9 offset:1024
    v_mfma_f32_16x16x32_bf16 v[100:103], a[164:167], a[136:139], v[100:103]
    buffer_load_dwordx4 v11, s[8:11], s40 offen offset:2048 sc1 lds
    v_mfma_f32_16x16x32_bf16 v[100:103], a[128:131], a[100:103], v[100:103]
    v_mfma_f32_16x16x32_bf16 v[104:107], a[128:131], a[104:107], v[104:107]
    v_mfma_f32_16x16x32_bf16 v[104:107], a[164:167], a[140:143], v[104:107]
    v_mfma_f32_16x16x32_bf16 v[108:111], a[164:167], a[144:147], v[108:111]
    buffer_load_dwordx4 v11, s[8:11], s40 offen offset:3072 sc1 lds
    v_mfma_f32_16x16x32_bf16 v[108:111], a[128:131], a[108:111], v[108:111]
    ds_read_b128 a[56:59], v9 offset:19456
    s_waitcnt lgkmcnt(2)
    v_mfma_f32_16x16x32_bf16 v[32:35], a[16:19], a[0:3], v[32:35]
    v_mfma_f32_16x16x32_bf16 v[32:35], a[52:55], a[36:39], v[32:35]
    s_add_u32 s40, s18, 12
    s_mul_i32 s41, s40, 40960
    s_add_u32 s41, s41, s17
    v_mfma_f32_16x16x32_bf16 v[36:39], a[52:55], a[40:43], v[36:39]
    s_lshl_b32 s0, s77, 2
    ds_read_b128 a[24:27], v9 offset:2048
    v_mfma_f32_16x16x32_bf16 v[36:39], a[16:19], a[4:7], v[36:39]
    s_add_u32 m0, s20, 77824
    s_add_u32 s0, s0, s78
    s_lshl_b32 s0, s0, 2
    v_mfma_f32_16x16x32_bf16 v[40:43], a[16:19], a[8:11], v[40:43]
    ds_read_b128 a[60:63], v9 offset:20480
    ds_read_b128 a[28:31], v9 offset:3072
    v_mfma_f32_16x16x32_bf16 v[40:43], a[52:55], a[44:47], v[40:43]
    s_add_u32 s0, s0, s76
    s_mul_i32 s0, s0, 40960
    s_add_u32 s22, s0, 69206016
    v_mfma_f32_16x16x32_bf16 v[44:47], a[52:55], a[48:51], v[44:47]
    buffer_load_dwordx4 v11, s[12:15], s41 offen offset:0 sc1 lds
    v_mfma_f32_16x16x32_bf16 v[44:47], a[16:19], a[12:15], v[44:47]
    s_lshl_b32 s39, s36, 11
    s_lshr_b32 s101, s36, 1
    s_waitcnt lgkmcnt(3)
    v_mfma_f32_16x16x32_bf16 v[60:63], a[20:23], a[12:15], v[60:63]
    ds_read_b128 a[64:67], v9 offset:21504
    ds_read_b128 a[32:35], v9 offset:4096
    v_mfma_f32_16x16x32_bf16 v[60:63], a[56:59], a[48:51], v[60:63]
    s_lshl_b32 s101, s101, 10
    ds_read_b128 a[68:71], v9 offset:22528
    v_mfma_f32_16x16x32_bf16 v[56:59], a[56:59], a[44:47], v[56:59]
    buffer_load_dwordx4 v11, s[12:15], s41 offen offset:1024 sc1 lds
    v_mfma_f32_16x16x32_bf16 v[56:59], a[20:23], a[8:11], v[56:59]
    s_add_u32 s101, s101, 8192
    v_add_u32 v19, 147456, v11
    v_add_u32 v22, s39, v19
    v_mfma_f32_16x16x32_bf16 v[52:55], a[20:23], a[4:7], v[52:55]
    v_add_u32 v23, s101, v19
    v_mfma_f32_16x16x32_bf16 v[52:55], a[56:59], a[40:43], v[52:55]
    s_add_u32 s0, s76, 1
    s_and_b32 s0, s0, 3
    v_mfma_f32_16x16x32_bf16 v[48:51], a[56:59], a[36:39], v[48:51]
    buffer_load_dwordx4 v11, s[12:15], s41 offen offset:2048 sc1 lds
    v_mfma_f32_16x16x32_bf16 v[48:51], a[20:23], a[0:3], v[48:51]
    s_waitcnt vmcnt(12) lgkmcnt(0)
    s_barrier
    v_mfma_f32_16x16x32_bf16 v[64:67], a[24:27], a[0:3], v[64:67]
    s_mul_i32 s0, s0, 10240
    v_add_u32 v6, 0, v2
    v_add_u32 v9, 0, v3
    v_mfma_f32_16x16x32_bf16 v[64:67], a[60:63], a[36:39], v[64:67]
    s_add_u32 s0, s0, s22
    s_add_u32 s44, s0, s39
    v_mfma_f32_16x16x32_bf16 v[68:71], a[60:63], a[40:43], v[68:71]
    buffer_load_dwordx4 v11, s[12:15], s41 offen offset:3072 sc1 lds
    v_mfma_f32_16x16x32_bf16 v[68:71], a[24:27], a[4:7], v[68:71]
    s_add_u32 m0, s20, 81920
    ds_read_b128 a[96:99], v6 offset:0
    v_mfma_f32_16x16x32_bf16 v[72:75], a[24:27], a[8:11], v[72:75]
    s_add_u32 s47, s0, s101
    ds_read_b128 a[132:135], v6 offset:18432
    v_mfma_f32_16x16x32_bf16 v[72:75], a[60:63], a[44:47], v[72:75]
    s_add_u32 s41, s41, 4096
    s_add_u32 s0, s76, 2
    s_and_b32 s0, s0, 3
    v_mfma_f32_16x16x32_bf16 v[76:79], a[60:63], a[48:51], v[76:79]
    buffer_load_dwordx4 v11, s[12:15], s41 offen sc1 lds
    v_mfma_f32_16x16x32_bf16 v[76:79], a[24:27], a[12:15], v[76:79]
    s_lshl_b32 s40, s40, 17
    s_add_u32 s40, s40, s16
    v_mfma_f32_16x16x32_bf16 v[92:95], a[28:31], a[12:15], v[92:95]
    s_add_u32 m0, s20, 73728
    s_mul_i32 s0, s0, 10240
    v_mfma_f32_16x16x32_bf16 v[92:95], a[64:67], a[48:51], v[92:95]
    s_add_u32 s0, s0, s22
    s_add_u32 s45, s0, s39
    s_add_u32 s48, s0, s101
    v_mfma_f32_16x16x32_bf16 v[88:91], a[64:67], a[44:47], v[88:91]
    s_add_u32 s0, s76, 3
    ds_read_b128 a[100:103], v6 offset:1024
    v_mfma_f32_16x16x32_bf16 v[88:91], a[28:31], a[8:11], v[88:91]
    buffer_load_dwordx4 v11, s[8:11], s40 offen offset:0 sc1 lds
    v_mfma_f32_16x16x32_bf16 v[84:87], a[28:31], a[4:7], v[84:87]
    s_and_b32 s0, s0, 3
    s_mul_i32 s0, s0, 10240
    s_add_u32 s0, s0, s22
    v_mfma_f32_16x16x32_bf16 v[84:87], a[64:67], a[40:43], v[84:87]
    s_add_u32 s46, s0, s39
    ds_read_b128 a[136:139], v6 offset:19456
    v_mfma_f32_16x16x32_bf16 v[80:83], a[64:67], a[36:39], v[80:83]
    v_mfma_f32_16x16x32_bf16 v[80:83], a[28:31], a[0:3], v[80:83]
    s_add_u32 s49, s0, s101
    v_mfma_f32_16x16x32_bf16 v[96:99], a[32:35], a[0:3], v[96:99]
    buffer_load_dwordx4 v11, s[8:11], s40 offen offset:1024 sc1 lds
    v_mfma_f32_16x16x32_bf16 v[96:99], a[68:71], a[36:39], v[96:99]
    ds_read_b128 a[104:107], v6 offset:2048
    ds_read_b128 a[140:143], v6 offset:20480
    v_mfma_f32_16x16x32_bf16 v[100:103], a[68:71], a[40:43], v[100:103]
    ds_read_b128 a[108:111], v6 offset:3072
    ds_read_b128 a[144:147], v6 offset:21504
    v_mfma_f32_16x16x32_bf16 v[100:103], a[32:35], a[4:7], v[100:103]
    buffer_load_dwordx4 v11, s[8:11], s40 offen offset:2048 sc1 lds
    v_mfma_f32_16x16x32_bf16 v[104:107], a[32:35], a[8:11], v[104:107]
    ds_read_b128 a[112:115], v9 offset:0
    ds_read_b128 a[148:151], v9 offset:18432
    v_mfma_f32_16x16x32_bf16 v[104:107], a[68:71], a[44:47], v[104:107]
    ds_read_b128 a[116:119], v9 offset:1024
    ds_read_b128 a[152:155], v9 offset:19456
    v_mfma_f32_16x16x32_bf16 v[108:111], a[68:71], a[48:51], v[108:111]
    buffer_load_dwordx4 v11, s[8:11], s40 offen offset:3072 sc1 lds
    v_mfma_f32_16x16x32_bf16 v[108:111], a[32:35], a[12:15], v[108:111]
    s_waitcnt lgkmcnt(2)
    v_mfma_f32_16x16x32_bf16 v[32:35], a[112:115], a[96:99], v[32:35]
    s_add_u32 s40, s25, 14
    ds_read_b128 a[120:123], v9 offset:2048
    v_mfma_f32_16x16x32_bf16 v[32:35], a[148:151], a[132:135], v[32:35]
    s_mul_i32 s41, s40, 40960
    s_add_u32 s41, s41, s17
    s_add_u32 m0, s20, 114688
    v_mfma_f32_16x16x32_bf16 v[36:39], a[148:151], a[136:139], v[36:39]
    buffer_load_dwordx4 v11, s[12:15], s41 offen offset:0 sc1 lds
    v_mfma_f32_16x16x32_bf16 v[36:39], a[112:115], a[100:103], v[36:39]
    v_mfma_f32_16x16x32_bf16 v[40:43], a[112:115], a[104:107], v[40:43]
    v_mfma_f32_16x16x32_bf16 v[40:43], a[148:151], a[140:143], v[40:43]
    buffer_load_dwordx4 v11, s[12:15], s41 offen offset:1024 sc1 lds
    v_mfma_f32_16x16x32_bf16 v[44:47], a[148:151], a[144:147], v[44:47]
    ds_read_b128 a[156:159], v9 offset:20480
    v_mfma_f32_16x16x32_bf16 v[44:47], a[112:115], a[108:111], v[44:47]
    s_waitcnt lgkmcnt(2)
    v_mfma_f32_16x16x32_bf16 v[60:63], a[116:119], a[108:111], v[60:63]
    ds_read_b128 a[124:127], v9 offset:3072
    ds_read_b128 a[160:163], v9 offset:21504
    v_mfma_f32_16x16x32_bf16 v[60:63], a[152:155], a[144:147], v[60:63]
    buffer_load_dwordx4 v11, s[12:15], s41 offen offset:2048 sc1 lds
    v_mfma_f32_16x16x32_bf16 v[56:59], a[152:155], a[140:143], v[56:59]
    v_mfma_f32_16x16x32_bf16 v[56:59], a[116:119], a[104:107], v[56:59]
    ds_read_b128 a[128:131], v9 offset:4096
    ds_read_b128 a[164:167], v9 offset:22528
    v_mfma_f32_16x16x32_bf16 v[52:55], a[116:119], a[100:103], v[52:55]
    v_mfma_f32_16x16x32_bf16 v[52:55], a[152:155], a[136:139], v[52:55]
    buffer_load_dwordx4 v11, s[12:15], s41 offen offset:3072 sc1 lds
    v_mfma_f32_16x16x32_bf16 v[48:51], a[152:155], a[132:135], v[48:51]
    v_mfma_f32_16x16x32_bf16 v[48:51], a[116:119], a[96:99], v[48:51]
    s_waitcnt vmcnt(13) lgkmcnt(0)
    s_barrier
    v_mfma_f32_16x16x32_bf16 v[64:67], a[120:123], a[96:99], v[64:67]
    s_add_u32 m0, s20, 118784
    v_add_u32 v6, 36864, v2
    v_mfma_f32_16x16x32_bf16 v[64:67], a[156:159], a[132:135], v[64:67]
    s_add_u32 s41, s41, 4096
    v_add_u32 v9, 36864, v3
    v_mfma_f32_16x16x32_bf16 v[68:71], a[156:159], a[136:139], v[68:71]
    buffer_load_dword v4, v13, s[28:31], s21 offen sc0 sc1
    v_mfma_f32_16x16x32_bf16 v[68:71], a[120:123], a[100:103], v[68:71]
    v_mfma_f32_16x16x32_bf16 v[72:75], a[120:123], a[104:107], v[72:75]
    ds_read_b128 a[0:3], v6 offset:0
    ds_read_b128 a[36:39], v6 offset:18432
    v_mfma_f32_16x16x32_bf16 v[72:75], a[156:159], a[140:143], v[72:75]
    ds_read_b128 a[4:7], v6 offset:1024
    v_mfma_f32_16x16x32_bf16 v[76:79], a[156:159], a[144:147], v[76:79]
    buffer_load_dwordx4 v11, s[12:15], s41 offen sc1 lds
    v_mfma_f32_16x16x32_bf16 v[76:79], a[120:123], a[108:111], v[76:79]
    ds_read_b128 a[40:43], v6 offset:19456
    v_mfma_f32_16x16x32_bf16 v[92:95], a[124:127], a[108:111], v[92:95]
    ds_read_b128 a[8:11], v6 offset:2048
    v_mfma_f32_16x16x32_bf16 v[92:95], a[160:163], a[144:147], v[92:95]
    ds_read_b128 a[44:47], v6 offset:20480
    v_mfma_f32_16x16x32_bf16 v[88:91], a[160:163], a[140:143], v[88:91]
    s_lshl_b32 s40, s40, 17
    s_add_u32 s40, s40, s16
    s_add_u32 m0, s20, 110592
    v_mfma_f32_16x16x32_bf16 v[88:91], a[124:127], a[104:107], v[88:91]
    buffer_load_dwordx4 v11, s[8:11], s40 offen offset:0 sc1 lds
    v_mfma_f32_16x16x32_bf16 v[84:87], a[124:127], a[100:103], v[84:87]
    ds_read_b128 a[12:15], v6 offset:3072
    ds_read_b128 a[48:51], v6 offset:21504
    v_mfma_f32_16x16x32_bf16 v[84:87], a[160:163], a[136:139], v[84:87]
    buffer_load_dwordx4 v11, s[8:11], s40 offen offset:1024 sc1 lds
    v_mfma_f32_16x16x32_bf16 v[80:83], a[160:163], a[132:135], v[80:83]
    ds_read_b128 a[16:19], v9 offset:0
    ds_read_b128 a[52:55], v9 offset:18432
    v_mfma_f32_16x16x32_bf16 v[80:83], a[124:127], a[96:99], v[80:83]
    v_mfma_f32_16x16x32_bf16 v[96:99], a[128:131], a[96:99], v[96:99]
    v_mfma_f32_16x16x32_bf16 v[96:99], a[164:167], a[132:135], v[96:99]
    buffer_load_dwordx4 v11, s[8:11], s40 offen offset:2048 sc1 lds
    v_mfma_f32_16x16x32_bf16 v[100:103], a[164:167], a[136:139], v[100:103]
    v_mfma_f32_16x16x32_bf16 v[100:103], a[128:131], a[100:103], v[100:103]
    v_mfma_f32_16x16x32_bf16 v[104:107], a[128:131], a[104:107], v[104:107]
    v_mfma_f32_16x16x32_bf16 v[104:107], a[164:167], a[140:143], v[104:107]
    buffer_load_dwordx4 v11, s[8:11], s40 offen offset:3072 sc1 lds
    v_mfma_f32_16x16x32_bf16 v[108:111], a[164:167], a[144:147], v[108:111]
    ds_read_b128 a[20:23], v9 offset:1024
    ds_read_b128 a[56:59], v9 offset:19456
    v_mfma_f32_16x16x32_bf16 v[108:111], a[128:131], a[108:111], v[108:111]
    s_waitcnt lgkmcnt(2)
    v_mfma_f32_16x16x32_bf16 v[32:35], a[16:19], a[0:3], v[32:35]
    ds_read_b128 a[24:27], v9 offset:2048
    v_mfma_f32_16x16x32_bf16 v[32:35], a[52:55], a[36:39], v[32:35]
    ds_read_b128 a[60:63], v9 offset:20480
    ds_read_b128 a[28:31], v9 offset:3072
    v_mfma_f32_16x16x32_bf16 v[36:39], a[52:55], a[40:43], v[36:39]
    ds_read_b128 a[64:67], v9 offset:21504
    ds_read_b128 a[32:35], v9 offset:4096
    v_mfma_f32_16x16x32_bf16 v[36:39], a[16:19], a[4:7], v[36:39]
    s_xor_b32 s40, s19, 0
    s_mov_b32 s32, s86
    s_mov_b32 s33, s87
    v_mfma_f32_16x16x32_bf16 v[40:43], a[16:19], a[8:11], v[40:43]
    s_mov_b32 s34, 2621440
    v_mfma_f32_16x16x32_bf16 v[40:43], a[52:55], a[44:47], v[40:43]
    s_mul_i32 s41, s40, 40960
    s_add_u32 s41, s41, s17
    s_add_u32 m0, s20, 4096
    v_mfma_f32_16x16x32_bf16 v[44:47], a[52:55], a[48:51], v[44:47]
    buffer_load_dwordx4 v11, s[12:15], s41 offen offset:0 sc1 lds
    v_mfma_f32_16x16x32_bf16 v[44:47], a[16:19], a[12:15], v[44:47]
    s_mov_b32 s35, 0x00020000
    v_lshrrev_b32 v26, 2, v1
    s_waitcnt lgkmcnt(5)
    v_mfma_f32_16x16x32_bf16 v[60:63], a[20:23], a[12:15], v[60:63]
    v_mfma_f32_16x16x32_bf16 v[60:63], a[56:59], a[48:51], v[60:63]
    buffer_load_dwordx4 v11, s[12:15], s41 offen offset:1024 sc1 lds
    v_mfma_f32_16x16x32_bf16 v[56:59], a[56:59], a[44:47], v[56:59]
    ds_read_b128 a[68:71], v9 offset:22528
    v_and_b32 v27, 3, v1
    v_mfma_f32_16x16x32_bf16 v[56:59], a[20:23], a[8:11], v[56:59]
    v_mul_u32_u24 v24, 1280, v26
    v_mfma_f32_16x16x32_bf16 v[52:55], a[20:23], a[4:7], v[52:55]
    v_lshl_add_u32 v25, v27, 3, v24
    v_lshl_add_u32 v24, v27, 4, v24
    v_mfma_f32_16x16x32_bf16 v[52:55], a[56:59], a[40:43], v[52:55]
    buffer_load_dwordx4 v11, s[12:15], s41 offen offset:2048 sc1 lds
    v_mfma_f32_16x16x32_bf16 v[48:51], a[56:59], a[36:39], v[48:51]
    buffer_load_dwordx4 v11, s[12:15], s41 offen offset:3072 sc1 lds
    v_mfma_f32_16x16x32_bf16 v[48:51], a[20:23], a[0:3], v[48:51]
    s_waitcnt vmcnt(9) lgkmcnt(0)
    s_barrier
    v_mfma_f32_16x16x32_bf16 v[64:67], a[24:27], a[0:3], v[64:67]
    v_cmp_ne_u32 vcc, 1, v4
    s_nop 0
    s_cmp_eq_u64 vcc, 0
    s_cbranch_scc1 L_cwE5_ok
L_cwE5_no:
    s_mov_b32 s51, 0x40000
L_cwE5_spin:
    buffer_load_dword v4, v13, s[28:31], s21 offen sc0 sc1
    s_waitcnt vmcnt(0)
    v_cmp_ne_u32 vcc, 1, v4
    s_nop 0
    s_cmp_eq_u64 vcc, 0
    s_cbranch_scc1 L_cwE5_ok
L_cwE5_again:
    s_sleep 4
    s_sub_u32 s51, s51, 1
    s_cmp_lg_u32 s51, 0
    s_cbranch_scc1 L_cwE5_spin
L_cwE5_ok:
    v_mfma_f32_16x16x32_bf16 v[64:67], a[60:63], a[36:39], v[64:67]
    s_add_u32 m0, s20, 8192
    v_lshl_add_u32 v29, v27, 4, v26
    v_lshlrev_b32 v29, 2, v29
    v_mfma_f32_16x16x32_bf16 v[68:71], a[60:63], a[40:43], v[68:71]
    s_add_u32 s41, s41, 4096
    v_mfma_f32_16x16x32_bf16 v[68:71], a[24:27], a[4:7], v[68:71]
    buffer_load_dwordx4 v11, s[12:15], s41 offen sc1 lds
    v_mfma_f32_16x16x32_bf16 v[72:75], a[24:27], a[8:11], v[72:75]
    s_lshl_b32 s40, s40, 17
    s_add_u32 s40, s40, s16
    v_bfrev_b32 v27, v27
    v_mfma_f32_16x16x32_bf16 v[72:75], a[60:63], a[44:47], v[72:75]
    s_add_u32 m0, s20, 0
    v_lshrrev_b32 v27, 30, v27
    v_lshl_add_u32 v28, v27, 4, v26
    v_mfma_f32_16x16x32_bf16 v[76:79], a[60:63], a[48:51], v[76:79]
    buffer_load_dwordx4 v11, s[8:11], s40 offen offset:0 sc1 lds
    v_mfma_f32_16x16x32_bf16 v[76:79], a[24:27], a[12:15], v[76:79]
    v_add_u32 v6, 73728, v2
    v_mfma_f32_16x16x32_bf16 v[92:95], a[28:31], a[12:15], v[92:95]
    v_add_u32 v9, 73728, v3
    v_lshlrev_b32 v28, 2, v28
    v_mfma_f32_16x16x32_bf16 v[92:95], a[64:67], a[48:51], v[92:95]
    s_lshr_b32 s0, s76, 1
    s_lshl_b32 s1, s77, 1
    s_add_u32 s0, s0, s1
    v_mfma_f32_16x16x32_bf16 v[88:91], a[64:67], a[44:47], v[88:91]
    buffer_load_dwordx4 v11, s[8:11], s40 offen offset:1024 sc1 lds
    v_mfma_f32_16x16x32_bf16 v[88:91], a[28:31], a[8:11], v[88:91]
    s_lshl_b32 s0, s0, 2
    s_add_u32 s0, s0, s36
    s_mul_i32 s0, s0, 20480
    v_mfma_f32_16x16x32_bf16 v[84:87], a[28:31], a[4:7], v[84:87]
    ds_read_b128 a[96:99], v6 offset:0
    v_mfma_f32_16x16x32_bf16 v[84:87], a[64:67], a[40:43], v[84:87]
    s_and_b32 s1, s76, 1
    s_lshl_b32 s39, s78, 1
    s_add_u32 s1, s1, s39
    v_mfma_f32_16x16x32_bf16 v[80:83], a[64:67], a[36:39], v[80:83]
    ds_read_b128 a[132:135], v6 offset:18432
    ds_read_b128 a[100:103], v6 offset:1024
    v_mfma_f32_16x16x32_bf16 v[80:83], a[28:31], a[0:3], v[80:83]
    ds_read_b128 a[136:139], v6 offset:19456
    v_mfma_f32_16x16x32_bf16 v[96:99], a[32:35], a[0:3], v[96:99]
    ds_read_b128 a[104:107], v6 offset:2048
    ds_read_b128 a[140:143], v6 offset:20480
    v_mfma_f32_16x16x32_bf16 v[96:99], a[68:71], a[36:39], v[96:99]
    buffer_load_dwordx4 v11, s[8:11], s40 offen offset:2048 sc1 lds
    v_mfma_f32_16x16x32_bf16 v[100:103], a[68:71], a[40:43], v[100:103]
    ds_read_b128 a[108:111], v6 offset:3072
    v_mfma_f32_16x16x32_bf16 v[100:103], a[32:35], a[4:7], v[100:103]
    ds_read_b128 a[144:147], v6 offset:21504
    ds_read_b128 a[112:115], v9 offset:0
    v_mfma_f32_16x16x32_bf16 v[104:107], a[32:35], a[8:11], v[104:107]
    ds_read_b128 a[148:151], v9 offset:18432
    ds_read_b128 a[116:119], v9 offset:1024
    v_mfma_f32_16x16x32_bf16 v[104:107], a[68:71], a[44:47], v[104:107]
    buffer_load_dwordx4 v11, s[8:11], s40 offen offset:3072 sc1 lds
    v_mfma_f32_16x16x32_bf16 v[108:111], a[68:71], a[48:51], v[108:111]
    s_mul_i32 s1, s1, 160
    ds_read_b128 a[152:155], v9 offset:19456
    v_mfma_f32_16x16x32_bf16 v[108:111], a[32:35], a[12:15], v[108:111]
    s_add_u32 s24, s0, s1
    s_waitcnt lgkmcnt(2)
    v_mfma_f32_16x16x32_bf16 v[32:35], a[112:115], a[96:99], v[32:35]
    ds_read_b128 a[120:123], v9 offset:2048
    v_bfe_u32 v16, v1, 2, 2
    v_mfma_f32_16x16x32_bf16 v[32:35], a[148:151], a[132:135], v[32:35]
    s_xor_b32 s40, s19, 2
    s_mul_i32 s41, s40, 40960
    s_add_u32 s41, s41, s17
    v_mfma_f32_16x16x32_bf16 v[36:39], a[148:151], a[136:139], v[36:39]
    v_lshrrev_b32 v17, 4, v1
    v_cmp_eq_u32 vcc, v16, v17
    v_mfma_f32_16x16x32_bf16 v[36:39], a[112:115], a[100:103], v[36:39]
    s_add_u32 m0, s20, 40960
    v_and_b32 v16, 1, v1
    v_lshlrev_b32 v16, 4, v16
    v_mfma_f32_16x16x32_bf16 v[40:43], a[112:115], a[104:107], v[40:43]
    buffer_load_dwordx4 v11, s[12:15], s41 offen offset:0 sc1 lds
    v_mfma_f32_16x16x32_bf16 v[40:43], a[148:151], a[140:143], v[40:43]
    ds_read_b128 a[156:159], v9 offset:20480
    v_mov_b32 v17, 0x3f80
    v_mfma_f32_16x16x32_bf16 v[44:47], a[148:151], a[144:147], v[44:47]
    ds_read_b128 a[124:127], v9 offset:3072
    ds_read_b128 a[160:163], v9 offset:21504
    v_mfma_f32_16x16x32_bf16 v[44:47], a[112:115], a[108:111], v[44:47]
    ds_read_b128 a[128:131], v9 offset:4096
    s_waitcnt lgkmcnt(5)
    v_mfma_f32_16x16x32_bf16 v[60:63], a[116:119], a[108:111], v[60:63]
    ds_read_b128 a[164:167], v9 offset:22528
    v_lshlrev_b32 v16, v16, v17
    v_mfma_f32_16x16x32_bf16 v[60:63], a[152:155], a[144:147], v[60:63]
    v_cndmask_b32 v16, 0, v16, vcc
    v_and_b32 v17, 2, v1
    v_mfma_f32_16x16x32_bf16 v[56:59], a[152:155], a[140:143], v[56:59]
    buffer_load_dwordx4 v11, s[12:15], s41 offen offset:1024 sc1 lds
    v_mfma_f32_16x16x32_bf16 v[56:59], a[116:119], a[104:107], v[56:59]
    v_mfma_f32_16x16x32_bf16 v[52:55], a[116:119], a[100:103], v[52:55]
    v_mfma_f32_16x16x32_bf16 v[52:55], a[152:155], a[136:139], v[52:55]
    v_cmp_eq_u32 vcc, 0, v17
    v_mov_b32 v200, 0
    v_mfma_f32_16x16x32_bf16 v[48:51], a[152:155], a[132:135], v[48:51]
    buffer_load_dwordx4 v11, s[12:15], s41 offen offset:2048 sc1 lds
    v_mfma_f32_16x16x32_bf16 v[48:51], a[116:119], a[96:99], v[48:51]
    s_waitcnt vmcnt(12) lgkmcnt(0)
    s_barrier
    v_mfma_f32_16x16x32_bf16 v[64:67], a[120:123], a[96:99], v[64:67]
    v_add_u32 v6, 110592, v2
    v_add_u32 v9, 110592, v3
    v_mfma_f32_16x16x32_bf16 v[64:67], a[156:159], a[132:135], v[64:67]
    v_mov_b32 v201, 0
    v_mfma_f32_16x16x32_bf16 v[68:71], a[156:159], a[136:139], v[68:71]
    buffer_load_dwordx4 v11, s[12:15], s41 offen offset:3072 sc1 lds
    v_mfma_f32_16x16x32_bf16 v[68:71], a[120:123], a[100:103], v[68:71]
    s_add_u32 m0, s20, 45056
    v_mov_b32 v204, 0
    v_mov_b32 v205, 0
    v_mfma_f32_16x16x32_bf16 v[72:75], a[120:123], a[104:107], v[72:75]
    s_add_u32 s41, s41, 4096
    ds_read_b128 a[0:3], v6 offset:0
    v_mfma_f32_16x16x32_bf16 v[72:75], a[156:159], a[140:143], v[72:75]
    ds_read_b128 a[36:39], v6 offset:18432
    ds_read_b128 a[4:7], v6 offset:1024
    v_mfma_f32_16x16x32_bf16 v[76:79], a[156:159], a[144:147], v[76:79]
    buffer_load_dwordx4 v11, s[12:15], s41 offen sc1 lds
    v_mfma_f32_16x16x32_bf16 v[76:79], a[120:123], a[108:111], v[76:79]
    s_lshl_b32 s40, s40, 17
    s_add_u32 s40, s40, s16
    v_mfma_f32_16x16x32_bf16 v[92:95], a[124:127], a[108:111], v[92:95]
    ds_read_b128 a[40:43], v6 offset:19456
    v_mfma_f32_16x16x32_bf16 v[92:95], a[160:163], a[144:147], v[92:95]
    s_add_u32 m0, s20, 36864
    v_cndmask_b32 v202, 0, v16, vcc
    v_sub_u32 v203, v16, v202
    v_mfma_f32_16x16x32_bf16 v[88:91], a[160:163], a[140:143], v[88:91]
    buffer_load_dwordx4 v11, s[8:11], s40 offen offset:0 sc1 lds
    v_mfma_f32_16x16x32_bf16 v[88:91], a[124:127], a[104:107], v[88:91]
    ds_read_b128 a[8:11], v6 offset:2048
    v_mfma_f32_16x16x32_bf16 v[84:87], a[124:127], a[100:103], v[84:87]
    s_and_b32 s0, s36, 1
    ds_read_b128 a[44:47], v6 offset:20480
    v_mfma_f32_16x16x32_bf16 v[84:87], a[160:163], a[136:139], v[84:87]
    ds_read_b128 a[12:15], v6 offset:3072
    ds_read_b128 a[48:51], v6 offset:21504
    v_mfma_f32_16x16x32_bf16 v[80:83], a[160:163], a[132:135], v[80:83]
    buffer_load_dwordx4 v11, s[8:11], s40 offen offset:1024 sc1 lds
    v_mfma_f32_16x16x32_bf16 v[80:83], a[124:127], a[96:99], v[80:83]
    ds_read_b128 a[16:19], v9 offset:0
    v_mfma_f32_16x16x32_bf16 v[96:99], a[128:131], a[96:99], v[96:99]
    s_sub_u32 s0, 0, s0
    v_mfma_f32_16x16x32_bf16 v[96:99], a[164:167], a[132:135], v[96:99]
    ds_read_b128 a[52:55], v9 offset:18432
    ds_read_b128 a[20:23], v9 offset:1024
    v_mfma_f32_16x16x32_bf16 v[100:103], a[164:167], a[136:139], v[100:103]
    buffer_load_dwordx4 v11, s[8:11], s40 offen offset:2048 sc1 lds
    v_mfma_f32_16x16x32_bf16 v[100:103], a[128:131], a[100:103], v[100:103]
    v_and_b32 v208, s0, v202
    v_and_b32 v209, s0, v203
    v_mfma_f32_16x16x32_bf16 v[104:107], a[128:131], a[104:107], v[104:107]
    ds_read_b128 a[56:59], v9 offset:19456
    v_sub_u32 v206, v202, v208
    v_mfma_f32_16x16x32_bf16 v[104:107], a[164:167], a[140:143], v[104:107]
    v_sub_u32 v207, v203, v209
    v_mfma_f32_16x16x32_bf16 v[108:111], a[164:167], a[144:147], v[108:111]
    buffer_load_dwordx4 v11, s[8:11], s40 offen offset:3072 sc1 lds
    v_mfma_f32_16x16x32_bf16 v[108:111], a[128:131], a[108:111], v[108:111]
    s_waitcnt lgkmcnt(2)
    v_mfma_f32_16x16x32_bf16 v[32:35], a[16:19], a[0:3], v[32:35]
    v_and_b32 v18, 3, v1
    v_min_u32 v18, 2, v18
    v_mfma_f32_16x16x32_bf16 v[32:35], a[52:55], a[36:39], v[32:35]
    ds_read_b128 a[24:27], v9 offset:2048
    v_mfma_f32_16x16x32_bf16 v[36:39], a[52:55], a[40:43], v[36:39]
    s_xor_b32 s40, s19, 4
    s_mul_i32 s41, s40, 40960
    s_add_u32 s41, s41, s17
    v_mfma_f32_16x16x32_bf16 v[36:39], a[16:19], a[4:7], v[36:39]
    s_add_u32 m0, s20, 77824
    v_mfma_f32_16x16x32_bf16 v[40:43], a[16:19], a[8:11], v[40:43]
    buffer_load_dwordx4 v11, s[12:15], s41 offen offset:0 sc1 lds
    v_mfma_f32_16x16x32_bf16 v[40:43], a[52:55], a[44:47], v[40:43]
    s_add_u32 s0, s76, 1
    ds_read_b128 a[60:63], v9 offset:20480
    v_mfma_f32_16x16x32_bf16 v[44:47], a[52:55], a[48:51], v[44:47]
    v_mfma_f32_16x16x32_bf16 v[44:47], a[16:19], a[12:15], v[44:47]
    ds_read_b128 a[28:31], v9 offset:3072
    s_waitcnt lgkmcnt(3)
    v_mfma_f32_16x16x32_bf16 v[60:63], a[20:23], a[12:15], v[60:63]
    buffer_load_dwordx4 v11, s[12:15], s41 offen offset:1024 sc1 lds
    v_mfma_f32_16x16x32_bf16 v[60:63], a[56:59], a[48:51], v[60:63]
    ds_read_b128 a[64:67], v9 offset:21504
    v_add_u32 v18, s0, v18
    v_mfma_f32_16x16x32_bf16 v[56:59], a[56:59], a[44:47], v[56:59]
    ds_read_b128 a[32:35], v9 offset:4096
    ds_read_b128 a[68:71], v9 offset:22528
    v_mfma_f32_16x16x32_bf16 v[56:59], a[20:23], a[8:11], v[56:59]
    v_mfma_f32_16x16x32_bf16 v[52:55], a[20:23], a[4:7], v[52:55]
    buffer_load_dwordx4 v11, s[12:15], s41 offen offset:2048 sc1 lds
    v_mfma_f32_16x16x32_bf16 v[52:55], a[56:59], a[40:43], v[52:55]
    v_and_b32 v18, 3, v18
    v_mfma_f32_16x16x32_bf16 v[48:51], a[56:59], a[36:39], v[48:51]
    v_lshlrev_b32 v30, 2, v18
    v_mul_u32_u24 v18, 10240, v18
    v_mfma_f32_16x16x32_bf16 v[48:51], a[20:23], a[0:3], v[48:51]
    s_waitcnt vmcnt(12) lgkmcnt(0)
    s_barrier
    v_mfma_f32_16x16x32_bf16 v[64:67], a[24:27], a[0:3], v[64:67]
    buffer_load_dwordx4 v11, s[12:15], s41 offen offset:3072 sc1 lds
    v_mfma_f32_16x16x32_bf16 v[64:67], a[60:63], a[36:39], v[64:67]
    v_lshlrev_b32 v31, 5, v30
    v_mfma_f32_16x16x32_bf16 v[68:71], a[60:63], a[40:43], v[68:71]
    s_add_u32 m0, s20, 81920
    v_mfma_f32_16x16x32_bf16 v[68:71], a[24:27], a[4:7], v[68:71]
    s_add_u32 s41, s41, 4096
    v_add_u32 v6, 0, v2
    v_add_u32 v9, 0, v3
    v_mfma_f32_16x16x32_bf16 v[72:75], a[24:27], a[8:11], v[72:75]
    buffer_load_dwordx4 v11, s[12:15], s41 offen sc1 lds
    v_mfma_f32_16x16x32_bf16 v[72:75], a[60:63], a[44:47], v[72:75]
    s_and_b32 s50, s67, 0xfffffe7f
    v_add_u32 v21, 10236, v18
    v_mfma_f32_16x16x32_bf16 v[76:79], a[60:63], a[48:51], v[76:79]
    ds_read_b128 a[96:99], v6 offset:0
    ds_read_b128 a[132:135], v6 offset:18432
    v_mfma_f32_16x16x32_bf16 v[76:79], a[24:27], a[12:15], v[76:79]
    s_lshl_b32 s40, s40, 17
    s_add_u32 s40, s40, s16
    v_mfma_f32_16x16x32_bf16 v[92:95], a[28:31], a[12:15], v[92:95]
    s_add_u32 m0, s20, 73728
    v_mfma_f32_16x16x32_bf16 v[92:95], a[64:67], a[48:51], v[92:95]
    buffer_load_dwordx4 v11, s[8:11], s40 offen offset:0 sc1 lds
    v_mfma_f32_16x16x32_bf16 v[88:91], a[64:67], a[44:47], v[88:91]
    ds_read_b128 a[100:103], v6 offset:1024
    v_mfma_f32_16x16x32_bf16 v[88:91], a[28:31], a[8:11], v[88:91]
    ds_read_b128 a[136:139], v6 offset:19456
    ds_read_b128 a[104:107], v6 offset:2048
    v_mfma_f32_16x16x32_bf16 v[84:87], a[28:31], a[4:7], v[84:87]
    v_mfma_f32_16x16x32_bf16 v[84:87], a[64:67], a[40:43], v[84:87]
    buffer_load_dwordx4 v11, s[8:11], s40 offen offset:1024 sc1 lds
    v_mfma_f32_16x16x32_bf16 v[80:83], a[64:67], a[36:39], v[80:83]
    ds_read_b128 a[140:143], v6 offset:20480
    v_mfma_f32_16x16x32_bf16 v[80:83], a[28:31], a[0:3], v[80:83]
    v_mfma_f32_16x16x32_bf16 v[96:99], a[32:35], a[0:3], v[96:99]
    ds_read_b128 a[108:111], v6 offset:3072
    v_mfma_f32_16x16x32_bf16 v[96:99], a[68:71], a[36:39], v[96:99]
    buffer_load_dwordx4 v11, s[8:11], s40 offen offset:2048 sc1 lds
    v_mfma_f32_16x16x32_bf16 v[100:103], a[68:71], a[40:43], v[100:103]
    ds_read_b128 a[144:147], v6 offset:21504
    v_mfma_f32_16x16x32_bf16 v[100:103], a[32:35], a[4:7], v[100:103]
    ds_read_b128 a[112:115], v9 offset:0
    v_mfma_f32_16x16x32_bf16 v[104:107], a[32:35], a[8:11], v[104:107]
    ds_read_b128 a[148:151], v9 offset:18432
    ds_read_b128 a[116:119], v9 offset:1024
    v_mfma_f32_16x16x32_bf16 v[104:107], a[68:71], a[44:47], v[104:107]
    buffer_load_dwordx4 v11, s[8:11], s40 offen offset:3072 sc1 lds
    v_mfma_f32_16x16x32_bf16 v[108:111], a[68:71], a[48:51], v[108:111]
    v_add_u32 v18, 3068, v18
    v_mfma_f32_16x16x32_bf16 v[108:111], a[32:35], a[12:15], v[108:111]
    ds_read_b128 a[152:155], v9 offset:19456
    s_waitcnt lgkmcnt(2)
    v_mfma_f32_16x16x32_bf16 v[32:35], a[112:115], a[96:99], v[32:35]
    ds_read_b128 a[120:123], v9 offset:2048
    ds_read_b128 a[156:159], v9 offset:20480
    v_mfma_f32_16x16x32_bf16 v[32:35], a[148:151], a[132:135], v[32:35]
    s_xor_b32 s40, s19, 6
    ds_read_b128 a[124:127], v9 offset:3072
    v_mfma_f32_16x16x32_bf16 v[36:39], a[148:151], a[136:139], v[36:39]
    v_mfma_f32_16x16x32_bf16 v[36:39], a[112:115], a[100:103], v[36:39]
    s_mul_i32 s41, s40, 40960
    s_add_u32 s41, s41, s17
    s_add_u32 m0, s20, 114688
    v_mfma_f32_16x16x32_bf16 v[40:43], a[112:115], a[104:107], v[40:43]
    buffer_load_dwordx4 v11, s[12:15], s41 offen offset:0 sc1 lds
    v_mfma_f32_16x16x32_bf16 v[40:43], a[148:151], a[140:143], v[40:43]
    v_mfma_f32_16x16x32_bf16 v[44:47], a[148:151], a[144:147], v[44:47]
    v_mfma_f32_16x16x32_bf16 v[44:47], a[112:115], a[108:111], v[44:47]
    s_waitcnt lgkmcnt(3)
    v_mfma_f32_16x16x32_bf16 v[60:63], a[116:119], a[108:111], v[60:63]
    buffer_load_dwordx4 v11, s[12:15], s41 offen offset:1024 sc1 lds
    v_mfma_f32_16x16x32_bf16 v[60:63], a[152:155], a[144:147], v[60:63]
    ds_read_b128 a[160:163], v9 offset:21504
    v_mfma_f32_16x16x32_bf16 v[56:59], a[152:155], a[140:143], v[56:59]
    ds_read_b128 a[128:131], v9 offset:4096
    v_mfma_f32_16x16x32_bf16 v[56:59], a[116:119], a[104:107], v[56:59]
    ds_read_b128 a[164:167], v9 offset:22528
    v_mfma_f32_16x16x32_bf16 v[52:55], a[116:119], a[100:103], v[52:55]
    v_mfma_f32_16x16x32_bf16 v[52:55], a[152:155], a[136:139], v[52:55]
    buffer_load_dwordx4 v11, s[12:15], s41 offen offset:2048 sc1 lds
    v_mfma_f32_16x16x32_bf16 v[48:51], a[152:155], a[132:135], v[48:51]
    v_mfma_f32_16x16x32_bf16 v[48:51], a[116:119], a[96:99], v[48:51]
    s_waitcnt vmcnt(12) lgkmcnt(0)
    s_barrier
    v_mfma_f32_16x16x32_bf16 v[64:67], a[120:123], a[96:99], v[64:67]
    v_add_u32 v6, 36864, v2
    v_add_u32 v9, 36864, v3
    v_mfma_f32_16x16x32_bf16 v[64:67], a[156:159], a[132:135], v[64:67]
    buffer_load_dwordx4 v11, s[12:15], s41 offen offset:3072 sc1 lds
    v_mfma_f32_16x16x32_bf16 v[68:71], a[156:159], a[136:139], v[68:71]
    v_mfma_f32_16x16x32_bf16 v[68:71], a[120:123], a[100:103], v[68:71]
    s_add_u32 m0, s20, 118784
    ds_read_b128 a[0:3], v6 offset:0
    v_mfma_f32_16x16x32_bf16 v[72:75], a[120:123], a[104:107], v[72:75]
    s_add_u32 s41, s41, 4096
    v_mfma_f32_16x16x32_bf16 v[72:75], a[156:159], a[140:143], v[72:75]
    v_mfma_f32_16x16x32_bf16 v[76:79], a[156:159], a[144:147], v[76:79]
    buffer_load_dwordx4 v11, s[12:15], s41 offen sc1 lds
    v_mfma_f32_16x16x32_bf16 v[76:79], a[120:123], a[108:111], v[76:79]
    s_lshl_b32 s40, s40, 17
    s_add_u32 s40, s40, s16
    v_mfma_f32_16x16x32_bf16 v[92:95], a[124:127], a[108:111], v[92:95]
    ds_read_b128 a[36:39], v6 offset:18432
    ds_read_b128 a[4:7], v6 offset:1024
    v_mfma_f32_16x16x32_bf16 v[92:95], a[160:163], a[144:147], v[92:95]
    s_add_u32 m0, s20, 110592
    v_mfma_f32_16x16x32_bf16 v[88:91], a[160:163], a[140:143], v[88:91]
    buffer_load_dwordx4 v11, s[8:11], s40 offen offset:0 sc1 lds
    v_mfma_f32_16x16x32_bf16 v[88:91], a[124:127], a[104:107], v[88:91]
    ds_read_b128 a[40:43], v6 offset:19456
    ds_read_b128 a[8:11], v6 offset:2048
    v_mfma_f32_16x16x32_bf16 v[84:87], a[124:127], a[100:103], v[84:87]
    ds_read_b128 a[44:47], v6 offset:20480
    ds_read_b128 a[12:15], v6 offset:3072
    v_mfma_f32_16x16x32_bf16 v[84:87], a[160:163], a[136:139], v[84:87]
    v_mfma_f32_16x16x32_bf16 v[80:83], a[160:163], a[132:135], v[80:83]
    buffer_load_dwordx4 v11, s[8:11], s40 offen offset:1024 sc1 lds
    v_mfma_f32_16x16x32_bf16 v[80:83], a[124:127], a[96:99], v[80:83]
    v_mfma_f32_16x16x32_bf16 v[96:99], a[128:131], a[96:99], v[96:99]
    ds_read_b128 a[48:51], v6 offset:21504
    ds_read_b128 a[16:19], v9 offset:0
    v_mfma_f32_16x16x32_bf16 v[96:99], a[164:167], a[132:135], v[96:99]
    ds_read_b128 a[52:55], v9 offset:18432
    ds_read_b128 a[20:23], v9 offset:1024
    v_mfma_f32_16x16x32_bf16 v[100:103], a[164:167], a[136:139], v[100:103]
    buffer_load_dwordx4 v11, s[8:11], s40 offen offset:2048 sc1 lds
    v_mfma_f32_16x16x32_bf16 v[100:103], a[128:131], a[100:103], v[100:103]
    v_mfma_f32_16x16x32_bf16 v[104:107], a[128:131], a[104:107], v[104:107]
    v_mfma_f32_16x16x32_bf16 v[104:107], a[164:167], a[140:143], v[104:107]
    v_mfma_f32_16x16x32_bf16 v[108:111], a[164:167], a[144:147], v[108:111]
    buffer_load_dwordx4 v11, s[8:11], s40 offen offset:3072 sc1 lds
    v_mfma_f32_16x16x32_bf16 v[108:111], a[128:131], a[108:111], v[108:111]
    ds_read_b128 a[56:59], v9 offset:19456
    s_waitcnt lgkmcnt(2)
    v_mfma_f32_16x16x32_bf16 v[32:35], a[16:19], a[0:3], v[32:35]
    ds_read_b128 a[24:27], v9 offset:2048
    ds_read_b128 a[60:63], v9 offset:20480
    v_mfma_f32_16x16x32_bf16 v[32:35], a[52:55], a[36:39], v[32:35]
    s_xor_b32 s40, s19, 8
    ds_read_b128 a[28:31], v9 offset:3072
    v_mfma_f32_16x16x32_bf16 v[36:39], a[52:55], a[40:43], v[36:39]
    v_mfma_f32_16x16x32_bf16 v[36:39], a[16:19], a[4:7], v[36:39]
    s_mul_i32 s41, s40, 40960
    s_add_u32 s41, s41, s17
    s_add_u32 m0, s20, 4096
    v_mfma_f32_16x16x32_bf16 v[40:43], a[16:19], a[8:11], v[40:43]
    buffer_load_dwordx4 v11, s[12:15], s41 offen offset:0 sc1 lds
    v_mfma_f32_16x16x32_bf16 v[40:43], a[52:55], a[44:47], v[40:43]
    v_mfma_f32_16x16x32_bf16 v[44:47], a[52:55], a[48:51], v[44:47]
    v_mfma_f32_16x16x32_bf16 v[44:47], a[16:19], a[12:15], v[44:47]
    s_waitcnt lgkmcnt(3)
    v_mfma_f32_16x16x32_bf16 v[60:63], a[20:23], a[12:15], v[60:63]
    buffer_load_dwordx4 v11, s[12:15], s41 offen offset:1024 sc1 lds
    v_mfma_f32_16x16x32_bf16 v[60:63], a[56:59], a[48:51], v[60:63]
    ds_read_b128 a[64:67], v9 offset:21504
    v_mfma_f32_16x16x32_bf16 v[56:59], a[56:59], a[44:47], v[56:59]
    ds_read_b128 a[32:35], v9 offset:4096
    v_mfma_f32_16x16x32_bf16 v[56:59], a[20:23], a[8:11], v[56:59]
    ds_read_b128 a[68:71], v9 offset:22528
    v_mfma_f32_16x16x32_bf16 v[52:55], a[20:23], a[4:7], v[52:55]
    v_mfma_f32_16x16x32_bf16 v[52:55], a[56:59], a[40:43], v[52:55]
    buffer_load_dwordx4 v11, s[12:15], s41 offen offset:2048 sc1 lds
    v_mfma_f32_16x16x32_bf16 v[48:51], a[56:59], a[36:39], v[48:51]
    v_mfma_f32_16x16x32_bf16 v[48:51], a[20:23], a[0:3], v[48:51]
    s_waitcnt vmcnt(12) lgkmcnt(0)
    s_barrier
    v_mfma_f32_16x16x32_bf16 v[64:67], a[24:27], a[0:3], v[64:67]
    v_add_u32 v6, 73728, v2
    v_add_u32 v9, 73728, v3
    v_mfma_f32_16x16x32_bf16 v[64:67], a[60:63], a[36:39], v[64:67]
    buffer_load_dwordx4 v11, s[12:15], s41 offen offset:3072 sc1 lds
    v_mfma_f32_16x16x32_bf16 v[68:71], a[60:63], a[40:43], v[68:71]
    v_mfma_f32_16x16x32_bf16 v[68:71], a[24:27], a[4:7], v[68:71]
    s_add_u32 m0, s20, 8192
    ds_read_b128 a[96:99], v6 offset:0
    v_mfma_f32_16x16x32_bf16 v[72:75], a[24:27], a[8:11], v[72:75]
    s_add_u32 s41, s41, 4096
    v_mfma_f32_16x16x32_bf16 v[72:75], a[60:63], a[44:47], v[72:75]
    v_mfma_f32_16x16x32_bf16 v[76:79], a[60:63], a[48:51], v[76:79]
    buffer_load_dwordx4 v11, s[12:15], s41 offen sc1 lds
    v_mfma_f32_16x16x32_bf16 v[76:79], a[24:27], a[12:15], v[76:79]
    s_lshl_b32 s40, s40, 17
    s_add_u32 s40, s40, s16
    v_mfma_f32_16x16x32_bf16 v[92:95], a[28:31], a[12:15], v[92:95]
    ds_read_b128 a[132:135], v6 offset:18432
    ds_read_b128 a[100:103], v6 offset:1024
    v_mfma_f32_16x16x32_bf16 v[92:95], a[64:67], a[48:51], v[92:95]
    s_add_u32 m0, s20, 0
    v_mfma_f32_16x16x32_bf16 v[88:91], a[64:67], a[44:47], v[88:91]
    buffer_load_dwordx4 v11, s[8:11], s40 offen offset:0 sc1 lds
    v_mfma_f32_16x16x32_bf16 v[88:91], a[28:31], a[8:11], v[88:91]
    ds_read_b128 a[136:139], v6 offset:19456
    ds_read_b128 a[104:107], v6 offset:2048
    v_mfma_f32_16x16x32_bf16 v[84:87], a[28:31], a[4:7], v[84:87]
    ds_read_b128 a[140:143], v6 offset:20480
    ds_read_b128 a[108:111], v6 offset:3072
    v_mfma_f32_16x16x32_bf16 v[84:87], a[64:67], a[40:43], v[84:87]
    v_mfma_f32_16x16x32_bf16 v[80:83], a[64:67], a[36:39], v[80:83]
    buffer_load_dwordx4 v11, s[8:11], s40 offen offset:1024 sc1 lds
    v_mfma_f32_16x16x32_bf16 v[80:83], a[28:31], a[0:3], v[80:83]
    v_mfma_f32_16x16x32_bf16 v[96:99], a[32:35], a[0:3], v[96:99]
    ds_read_b128 a[144:147], v6 offset:21504
    ds_read_b128 a[112:115], v9 offset:0
    v_mfma_f32_16x16x32_bf16 v[96:99], a[68:71], a[36:39], v[96:99]
    ds_read_b128 a[148:151], v9 offset:18432
    ds_read_b128 a[116:119], v9 offset:1024
    v_mfma_f32_16x16x32_bf16 v[100:103], a[68:71], a[40:43], v[100:103]
    buffer_load_dwordx4 v11, s[8:11], s40 offen offset:2048 sc1 lds
    v_mfma_f32_16x16x32_bf16 v[100:103], a[32:35], a[4:7], v[100:103]
    v_mfma_f32_16x16x32_bf16 v[104:107], a[32:35], a[8:11], v[104:107]
    v_mfma_f32_16x16x32_bf16 v[104:107], a[68:71], a[44:47], v[104:107]
    v_mfma_f32_16x16x32_bf16 v[108:111], a[68:71], a[48:51], v[108:111]
    buffer_load_dwordx4 v11, s[8:11], s40 offen offset:3072 sc1 lds
    v_mfma_f32_16x16x32_bf16 v[108:111], a[32:35], a[12:15], v[108:111]
    ds_read_b128 a[152:155], v9 offset:19456
    s_waitcnt lgkmcnt(2)
    v_mfma_f32_16x16x32_bf16 v[32:35], a[112:115], a[96:99], v[32:35]
    s_xor_b32 s40, s19, 10
    ds_read_b128 a[120:123], v9 offset:2048
    v_mfma_f32_16x16x32_bf16 v[32:35], a[148:151], a[132:135], v[32:35]
    s_mul_i32 s41, s40, 40960
    s_add_u32 s41, s41, s17
    s_getpc_b64 s[0:1]
L_t5:
    v_mfma_f32_16x16x32_bf16 v[36:39], a[148:151], a[136:139], v[36:39]
    s_add_u32 m0, s20, 40960
    v_mfma_f32_16x16x32_bf16 v[36:39], a[112:115], a[100:103], v[36:39]
    buffer_load_dwordx4 v11, s[12:15], s41 offen offset:0 sc1 lds
    v_mfma_f32_16x16x32_bf16 v[40:43], a[112:115], a[104:107], v[40:43]
    s_lshr_b32 s39, s2, 3
    s_lshl_b32 s39, s39, 2
    s_add_u32 s39, s39, s36
    v_mfma_f32_16x16x32_bf16 v[40:43], a[148:151], a[140:143], v[40:43]
    ds_read_b128 a[156:159], v9 offset:20480
    ds_read_b128 a[124:127], v9 offset:3072
    v_mfma_f32_16x16x32_bf16 v[44:47], a[148:151], a[144:147], v[44:47]
    ds_read_b128 a[160:163], v9 offset:21504
    v_mfma_f32_16x16x32_bf16 v[44:47], a[112:115], a[108:111], v[44:47]
    ds_read_b128 a[128:131], v9 offset:4096
    s_waitcnt lgkmcnt(5)
    v_mfma_f32_16x16x32_bf16 v[60:63], a[116:119], a[108:111], v[60:63]
    buffer_load_dwordx4 v11, s[12:15], s41 offen offset:1024 sc1 lds
    v_mfma_f32_16x16x32_bf16 v[60:63], a[152:155], a[144:147], v[60:63]
    v_mfma_f32_16x16x32_bf16 v[56:59], a[152:155], a[140:143], v[56:59]
    s_lshl_b32 s39, s39, 7
    v_and_b32 v20, 0, v1
    v_mfma_f32_16x16x32_bf16 v[56:59], a[116:119], a[104:107], v[56:59]
    ds_read_b128 a[164:167], v9 offset:22528
    v_mfma_f32_16x16x32_bf16 v[52:55], a[116:119], a[100:103], v[52:55]
    buffer_load_dwordx4 v11, s[12:15], s41 offen offset:2048 sc1 lds
    v_mfma_f32_16x16x32_bf16 v[52:55], a[152:155], a[136:139], v[52:55]
    v_mfma_f32_16x16x32_bf16 v[48:51], a[152:155], a[132:135], v[48:51]
    v_lshl_add_u32 v20, v20, 14, s39
    v_add_u32 v20, L_joined-L_t5, v20
    v_mfma_f32_16x16x32_bf16 v[48:51], a[116:119], a[96:99], v[48:51]
    s_waitcnt vmcnt(12) lgkmcnt(0)
    s_barrier
    v_mfma_f32_16x16x32_bf16 v[64:67], a[120:123], a[96:99], v[64:67]
    buffer_load_dwordx4 v11, s[12:15], s41 offen offset:3072 sc1 lds
    v_mfma_f32_16x16x32_bf16 v[64:67], a[156:159], a[132:135], v[64:67]
    s_add_u32 m0, s20, 45056
    v_mfma_f32_16x16x32_bf16 v[68:71], a[156:159], a[136:139], v[68:71]
    s_add_u32 s41, s41, 4096
    v_add_u32 v6, 110592, v2
    v_min_u32 v20, L_code_end-L_t5-4, v20
    v_mfma_f32_16x16x32_bf16 v[68:71], a[120:123], a[100:103], v[68:71]
    buffer_load_dwordx4 v11, s[12:15], s41 offen sc1 lds
    v_mfma_f32_16x16x32_bf16 v[72:75], a[120:123], a[104:107], v[72:75]
    s_lshl_b32 s40, s40, 17
    s_add_u32 s40, s40, s16
    v_add_u32 v9, 110592, v3
    v_mfma_f32_16x16x32_bf16 v[72:75], a[156:159], a[140:143], v[72:75]
    s_add_u32 m0, s20, 36864
    ds_read_b128 a[0:3], v6 offset:0
    v_mfma_f32_16x16x32_bf16 v[76:79], a[156:159], a[144:147], v[76:79]
    ds_read_b128 a[36:39], v6 offset:18432
    ds_read_b128 a[4:7], v6 offset:1024
    v_mfma_f32_16x16x32_bf16 v[76:79], a[120:123], a[108:111], v[76:79]
    v_mov_b32 v21, 0
    v_mfma_f32_16x16x32_bf16 v[92:95], a[124:127], a[108:111], v[92:95]
    buffer_load_dwordx4 v11, s[8:11], s40 offen offset:0 sc1 lds
    v_mfma_f32_16x16x32_bf16 v[92:95], a[160:163], a[144:147], v[92:95]
    v_mfma_f32_16x16x32_bf16 v[88:91], a[160:163], a[140:143], v[88:91]
    ds_read_b128 a[40:43], v6 offset:19456
    ds_read_b128 a[8:11], v6 offset:2048
    v_mfma_f32_16x16x32_bf16 v[88:91], a[124:127], a[104:107], v[88:91]
    v_mfma_f32_16x16x32_bf16 v[84:87], a[124:127], a[100:103], v[84:87]
    v_mfma_f32_16x16x32_bf16 v[84:87], a[160:163], a[136:139], v[84:87]
    buffer_load_dwordx4 v11, s[8:11], s40 offen offset:1024 sc1 lds
    v_mfma_f32_16x16x32_bf16 v[80:83], a[160:163], a[132:135], v[80:83]
    ds_read_b128 a[44:47], v6 offset:20480
    v_lshl_add_u64 v[20:21], v[20:21], 0, s[0:1]
    v_mfma_f32_16x16x32_bf16 v[80:83], a[124:127], a[96:99], v[80:83]
    v_mfma_f32_16x16x32_bf16 v[96:99], a[128:131], a[96:99], v[96:99]
    ds_read_b128 a[12:15], v6 offset:3072
    ds_read_b128 a[48:51], v6 offset:21504
    v_mfma_f32_16x16x32_bf16 v[96:99], a[164:167], a[132:135], v[96:99]
    buffer_load_dwordx4 v11, s[8:11], s40 offen offset:2048 sc1 lds
    v_mfma_f32_16x16x32_bf16 v[100:103], a[164:167], a[136:139], v[100:103]
    global_load_dword v20, v[20:21], off
    v_mfma_f32_16x16x32_bf16 v[100:103], a[128:131], a[100:103], v[100:103]
    ds_read_b128 a[16:19], v9 offset:0
    ds_read_b128 a[52:55], v9 offset:18432
    v_mfma_f32_16x16x32_bf16 v[104:107], a[128:131], a[104:107], v[104:107]
    ds_read_b128 a[20:23], v9 offset:1024
    ds_read_b128 a[56:59], v9 offset:19456
    v_mfma_f32_16x16x32_bf16 v[104:107], a[164:167], a[140:143], v[104:107]
    v_mfma_f32_16x16x32_bf16 v[108:111], a[164:167], a[144:147], v[108:111]
    buffer_load_dwordx4 v11, s[8:11], s40 offen offset:3072 sc1 lds
    v_mfma_f32_16x16x32_bf16 v[108:111], a[128:131], a[108:111], v[108:111]
    s_waitcnt lgkmcnt(2)
    v_mfma_f32_16x16x32_bf16 v[32:35], a[16:19], a[0:3], v[32:35]
    s_lshl_b32 s0, s77, 1
    s_lshr_b32 s1, s76, 1
    v_mfma_f32_16x16x32_bf16 v[32:35], a[52:55], a[36:39], v[32:35]
    ds_read_b128 a[24:27], v9 offset:2048
    ds_read_b128 a[60:63], v9 offset:20480
    v_mfma_f32_16x16x32_bf16 v[36:39], a[52:55], a[40:43], v[36:39]
    s_xor_b32 s40, s19, 12
    s_mul_i32 s41, s40, 40960
    s_add_u32 s41, s41, s17
    v_mfma_f32_16x16x32_bf16 v[36:39], a[16:19], a[4:7], v[36:39]
    s_add_u32 m0, s20, 77824
    v_mfma_f32_16x16x32_bf16 v[40:43], a[16:19], a[8:11], v[40:43]
    buffer_load_dwordx4 v11, s[12:15], s41 offen offset:0 sc1 lds
    v_mfma_f32_16x16x32_bf16 v[40:43], a[52:55], a[44:47], v[40:43]
    v_mfma_f32_16x16x32_bf16 v[44:47], a[52:55], a[48:51], v[44:47]
    s_add_u32 s0, s0, s1
    s_lshl_b32 s60, s0, 12
    v_mfma_f32_16x16x32_bf16 v[44:47], a[16:19], a[12:15], v[44:47]
    ds_read_b128 a[28:31], v9 offset:3072
    s_waitcnt lgkmcnt(3)
    v_mfma_f32_16x16x32_bf16 v[60:63], a[20:23], a[12:15], v[60:63]
    buffer_load_dwordx4 v11, s[12:15], s41 offen offset:1024 sc1 lds
    v_mfma_f32_16x16x32_bf16 v[60:63], a[56:59], a[48:51], v[60:63]
    ds_read_b128 a[64:67], v9 offset:21504
    ds_read_b128 a[32:35], v9 offset:4096
    v_mfma_f32_16x16x32_bf16 v[56:59], a[56:59], a[44:47], v[56:59]
    s_lshl_b32 s0, s78, 1
    v_mfma_f32_16x16x32_bf16 v[56:59], a[20:23], a[8:11], v[56:59]
    ds_read_b128 a[68:71], v9 offset:22528
    v_mfma_f32_16x16x32_bf16 v[52:55], a[20:23], a[4:7], v[52:55]
    v_mfma_f32_16x16x32_bf16 v[52:55], a[56:59], a[40:43], v[52:55]
    buffer_load_dwordx4 v11, s[12:15], s41 offen offset:2048 sc1 lds
    v_mfma_f32_16x16x32_bf16 v[48:51], a[56:59], a[36:39], v[48:51]
    s_and_b32 s1, s76, 1
    v_mfma_f32_16x16x32_bf16 v[48:51], a[20:23], a[0:3], v[48:51]
    s_waitcnt vmcnt(13) lgkmcnt(0)
    s_barrier
    v_mfma_f32_16x16x32_bf16 v[64:67], a[24:27], a[0:3], v[64:67]
    s_add_u32 s0, s0, s1
    v_add_u32 v6, 0, v2
    v_add_u32 v9, 0, v3
    v_mfma_f32_16x16x32_bf16 v[64:67], a[60:63], a[36:39], v[64:67]
    buffer_load_dwordx4 v11, s[12:15], s41 offen offset:3072 sc1 lds
    v_mfma_f32_16x16x32_bf16 v[68:71], a[60:63], a[40:43], v[68:71]
    s_add_u32 m0, s20, 81920
    v_mfma_f32_16x16x32_bf16 v[68:71], a[24:27], a[4:7], v[68:71]
    s_mul_i32 s62, s0, 5120
    v_mfma_f32_16x16x32_bf16 v[72:75], a[24:27], a[8:11], v[72:75]
    s_add_u32 s41, s41, 4096
    s_lshl_b32 s0, s36, 10
    v_mfma_f32_16x16x32_bf16 v[72:75], a[60:63], a[44:47], v[72:75]
    buffer_load_dwordx4 v11, s[12:15], s41 offen sc1 lds
    v_mfma_f32_16x16x32_bf16 v[76:79], a[60:63], a[48:51], v[76:79]
    s_lshl_b32 s40, s40, 17
    s_add_u32 s40, s40, s16
    v_mfma_f32_16x16x32_bf16 v[76:79], a[24:27], a[12:15], v[76:79]
    s_add_u32 m0, s20, 73728
    v_mfma_f32_16x16x32_bf16 v[92:95], a[28:31], a[12:15], v[92:95]
    buffer_load_dwordx4 v11, s[8:11], s40 offen offset:0 sc1 lds
    v_mfma_f32_16x16x32_bf16 v[92:95], a[64:67], a[48:51], v[92:95]
    ds_read_b128 a[96:99], v6 offset:0
    v_mfma_f32_16x16x32_bf16 v[88:91], a[64:67], a[44:47], v[88:91]
    ds_read_b128 a[132:135], v6 offset:18432
    v_mfma_f32_16x16x32_bf16 v[88:91], a[28:31], a[8:11], v[88:91]
    ds_read_b128 a[100:103], v6 offset:1024
    ds_read_b128 a[136:139], v6 offset:19456
    v_mfma_f32_16x16x32_bf16 v[84:87], a[28:31], a[4:7], v[84:87]
    buffer_load_dwordx4 v11, s[8:11], s40 offen offset:1024 sc1 lds
    v_mfma_f32_16x16x32_bf16 v[84:87], a[64:67], a[40:43], v[84:87]
    ds_read_b128 a[104:107], v6 offset:2048
    v_mfma_f32_16x16x32_bf16 v[80:83], a[64:67], a[36:39], v[80:83]
    ds_read_b128 a[140:143], v6 offset:20480
    v_add_u32 v212, 0, v11
    v_mfma_f32_16x16x32_bf16 v[80:83], a[28:31], a[0:3], v[80:83]
    ds_read_b128 a[108:111], v6 offset:3072
    v_mfma_f32_16x16x32_bf16 v[96:99], a[32:35], a[0:3], v[96:99]
    buffer_load_dwordx4 v11, s[8:11], s40 offen offset:2048 sc1 lds
    v_mfma_f32_16x16x32_bf16 v[96:99], a[68:71], a[36:39], v[96:99]
    ds_read_b128 a[144:147], v6 offset:21504
    ds_read_b128 a[112:115], v9 offset:0
    v_mfma_f32_16x16x32_bf16 v[100:103], a[68:71], a[40:43], v[100:103]
    v_add_u32 v213, s0, v212
    v_mfma_f32_16x16x32_bf16 v[100:103], a[32:35], a[4:7], v[100:103]
    ds_read_b128 a[148:151], v9 offset:18432
    v_mfma_f32_16x16x32_bf16 v[104:107], a[32:35], a[8:11], v[104:107]
    ds_read_b128 a[116:119], v9 offset:1024
    ds_read_b128 a[152:155], v9 offset:19456
    v_mfma_f32_16x16x32_bf16 v[104:107], a[68:71], a[44:47], v[104:107]
    v_add_u32 v214, 36864, v11
    v_add_u32 v215, s0, v214
    v_mfma_f32_16x16x32_bf16 v[108:111], a[68:71], a[48:51], v[108:111]
    buffer_load_dwordx4 v11, s[8:11], s40 offen offset:3072 sc1 lds
    v_mfma_f32_16x16x32_bf16 v[108:111], a[32:35], a[12:15], v[108:111]
    s_waitcnt lgkmcnt(2)
    v_mfma_f32_16x16x32_bf16 v[32:35], a[112:115], a[96:99], v[32:35]
    s_xor_b32 s40, s19, 14
    ds_read_b128 a[120:123], v9 offset:2048
    v_mfma_f32_16x16x32_bf16 v[32:35], a[148:151], a[132:135], v[32:35]
    s_mul_i32 s41, s40, 40960
    s_add_u32 s41, s41, s17
    s_add_u32 m0, s20, 114688
    v_mfma_f32_16x16x32_bf16 v[36:39], a[148:151], a[136:139], v[36:39]
    buffer_load_dwordx4 v11, s[12:15], s41 offen offset:0 sc1 lds
    v_mfma_f32_16x16x32_bf16 v[36:39], a[112:115], a[100:103], v[36:39]
    v_mfma_f32_16x16x32_bf16 v[40:43], a[112:115], a[104:107], v[40:43]
    v_mfma_f32_16x16x32_bf16 v[40:43], a[148:151], a[140:143], v[40:43]
    buffer_load_dwordx4 v11, s[12:15], s41 offen offset:1024 sc1 lds
    v_mfma_f32_16x16x32_bf16 v[44:47], a[148:151], a[144:147], v[44:47]
    ds_read_b128 a[156:159], v9 offset:20480
    v_mfma_f32_16x16x32_bf16 v[44:47], a[112:115], a[108:111], v[44:47]
    s_waitcnt lgkmcnt(2)
    v_mfma_f32_16x16x32_bf16 v[60:63], a[116:119], a[108:111], v[60:63]
    ds_read_b128 a[124:127], v9 offset:3072
    ds_read_b128 a[160:163], v9 offset:21504
    v_mfma_f32_16x16x32_bf16 v[60:63], a[152:155], a[144:147], v[60:63]
    buffer_load_dwordx4 v11, s[12:15], s41 offen offset:2048 sc1 lds
    v_mfma_f32_16x16x32_bf16 v[56:59], a[152:155], a[140:143], v[56:59]
    v_mfma_f32_16x16x32_bf16 v[56:59], a[116:119], a[104:107], v[56:59]
    ds_read_b128 a[128:131], v9 offset:4096
    ds_read_b128 a[164:167], v9 offset:22528
    v_mfma_f32_16x16x32_bf16 v[52:55], a[116:119], a[100:103], v[52:55]
    v_mfma_f32_16x16x32_bf16 v[52:55], a[152:155], a[136:139], v[52:55]
    buffer_load_dwordx4 v11, s[12:15], s41 offen offset:3072 sc1 lds
    v_mfma_f32_16x16x32_bf16 v[48:51], a[152:155], a[132:135], v[48:51]
    v_mfma_f32_16x16x32_bf16 v[48:51], a[116:119], a[96:99], v[48:51]
    s_waitcnt vmcnt(13) lgkmcnt(0)
    s_barrier
    v_mfma_f32_16x16x32_bf16 v[64:67], a[120:123], a[96:99], v[64:67]
    s_add_u32 m0, s20, 118784
    v_add_u32 v6, 36864, v2
    v_mfma_f32_16x16x32_bf16 v[64:67], a[156:159], a[132:135], v[64:67]
    s_add_u32 s41, s41, 4096
    v_add_u32 v9, 36864, v3
    v_mfma_f32_16x16x32_bf16 v[68:71], a[156:159], a[136:139], v[68:71]
    buffer_load_dword v4, v13, s[28:31], s26 offen sc0 sc1
    v_mfma_f32_16x16x32_bf16 v[68:71], a[120:123], a[100:103], v[68:71]
    v_mfma_f32_16x16x32_bf16 v[72:75], a[120:123], a[104:107], v[72:75]
    ds_read_b128 a[0:3], v6 offset:0
    ds_read_b128 a[36:39], v6 offset:18432
    v_mfma_f32_16x16x32_bf16 v[72:75], a[156:159], a[140:143], v[72:75]
    ds_read_b128 a[4:7], v6 offset:1024
    v_mfma_f32_16x16x32_bf16 v[76:79], a[156:159], a[144:147], v[76:79]
    buffer_load_dwordx4 v11, s[12:15], s41 offen sc1 lds
    v_mfma_f32_16x16x32_bf16 v[76:79], a[120:123], a[108:111], v[76:79]
    ds_read_b128 a[40:43], v6 offset:19456
    v_mfma_f32_16x16x32_bf16 v[92:95], a[124:127], a[108:111], v[92:95]
    ds_read_b128 a[8:11], v6 offset:2048
    v_mfma_f32_16x16x32_bf16 v[92:95], a[160:163], a[144:147], v[92:95]
    ds_read_b128 a[44:47], v6 offset:20480
    v_mfma_f32_16x16x32_bf16 v[88:91], a[160:163], a[140:143], v[88:91]
    s_lshl_b32 s40, s40, 17
    s_add_u32 s40, s40, s16
    s_add_u32 m0, s20, 110592
    v_mfma_f32_16x16x32_bf16 v[88:91], a[124:127], a[104:107], v[88:91]
    buffer_load_dwordx4 v11, s[8:11], s40 offen offset:0 sc1 lds
    v_mfma_f32_16x16x32_bf16 v[84:87], a[124:127], a[100:103], v[84:87]
    ds_read_b128 a[12:15], v6 offset:3072
    ds_read_b128 a[48:51], v6 offset:21504
    v_mfma_f32_16x16x32_bf16 v[84:87], a[160:163], a[136:139], v[84:87]
    buffer_load_dwordx4 v11, s[8:11], s40 offen offset:1024 sc1 lds
    v_mfma_f32_16x16x32_bf16 v[80:83], a[160:163], a[132:135], v[80:83]
    ds_read_b128 a[16:19], v9 offset:0
    ds_read_b128 a[52:55], v9 offset:18432
    v_mfma_f32_16x16x32_bf16 v[80:83], a[124:127], a[96:99], v[80:83]
    v_mfma_f32_16x16x32_bf16 v[96:99], a[128:131], a[96:99], v[96:99]
    v_mfma_f32_16x16x32_bf16 v[96:99], a[164:167], a[132:135], v[96:99]
    buffer_load_dwordx4 v11, s[8:11], s40 offen offset:2048 sc1 lds
    v_mfma_f32_16x16x32_bf16 v[100:103], a[164:167], a[136:139], v[100:103]
    v_mfma_f32_16x16x32_bf16 v[100:103], a[128:131], a[100:103], v[100:103]
    v_mfma_f32_16x16x32_bf16 v[104:107], a[128:131], a[104:107], v[104:107]
    v_mfma_f32_16x16x32_bf16 v[104:107], a[164:167], a[140:143], v[104:107]
    buffer_load_dwordx4 v11, s[8:11], s40 offen offset:3072 sc1 lds
    v_mfma_f32_16x16x32_bf16 v[108:111], a[164:167], a[144:147], v[108:111]
    ds_read_b128 a[20:23], v9 offset:1024
    ds_read_b128 a[56:59], v9 offset:19456
    v_mfma_f32_16x16x32_bf16 v[108:111], a[128:131], a[108:111], v[108:111]
    s_waitcnt lgkmcnt(2)
    v_mfma_f32_16x16x32_bf16 v[32:35], a[16:19], a[0:3], v[32:35]
    s_xor_b32 s40, s19, 16
    s_mul_i32 s41, s40, 40960
    s_add_u32 s41, s41, s17
    v_mfma_f32_16x16x32_bf16 v[32:35], a[52:55], a[36:39], v[32:35]
    s_add_u32 m0, s20, 4096
    v_mfma_f32_16x16x32_bf16 v[36:39], a[52:55], a[40:43], v[36:39]
    buffer_load_dwordx4 v11, s[12:15], s41 offen offset:0 sc1 lds
    v_mfma_f32_16x16x32_bf16 v[36:39], a[16:19], a[4:7], v[36:39]
    v_mfma_f32_16x16x32_bf16 v[40:43], a[16:19], a[8:11], v[40:43]
    v_mfma_f32_16x16x32_bf16 v[40:43], a[52:55], a[44:47], v[40:43]
    v_mfma_f32_16x16x32_bf16 v[44:47], a[52:55], a[48:51], v[44:47]
    buffer_load_dwordx4 v11, s[12:15], s41 offen offset:1024 sc1 lds
    v_mfma_f32_16x16x32_bf16 v[44:47], a[16:19], a[12:15], v[44:47]
    ds_read_b128 a[24:27], v9 offset:2048
    s_waitcnt lgkmcnt(1)
    v_mfma_f32_16x16x32_bf16 v[60:63], a[20:23], a[12:15], v[60:63]
    ds_read_b128 a[60:63], v9 offset:20480
    ds_read_b128 a[28:31], v9 offset:3072
    v_mfma_f32_16x16x32_bf16 v[60:63], a[56:59], a[48:51], v[60:63]
    buffer_load_dwordx4 v11, s[12:15], s41 offen offset:2048 sc1 lds
    v_mfma_f32_16x16x32_bf16 v[56:59], a[56:59], a[44:47], v[56:59]
    ds_read_b128 a[64:67], v9 offset:21504
    ds_read_b128 a[32:35], v9 offset:4096
    v_mfma_f32_16x16x32_bf16 v[56:59], a[20:23], a[8:11], v[56:59]
    ds_read_b128 a[68:71], v9 offset:22528
    v_mfma_f32_16x16x32_bf16 v[52:55], a[20:23], a[4:7], v[52:55]
    v_mfma_f32_16x16x32_bf16 v[52:55], a[56:59], a[40:43], v[52:55]
    buffer_load_dwordx4 v11, s[12:15], s41 offen offset:3072 sc1 lds
    v_mfma_f32_16x16x32_bf16 v[48:51], a[56:59], a[36:39], v[48:51]
    s_add_u32 m0, s20, 8192
    v_mfma_f32_16x16x32_bf16 v[48:51], a[20:23], a[0:3], v[48:51]
    s_waitcnt vmcnt(9) lgkmcnt(0)
    s_barrier
    v_mfma_f32_16x16x32_bf16 v[64:67], a[24:27], a[0:3], v[64:67]
    v_cmp_ne_u32 vcc, 1, v4
    s_nop 0
    s_cmp_eq_u64 vcc, 0
    s_cbranch_scc1 L_cwE13_ok
L_cwE13_no:
    s_mov_b32 s51, 0x40000
L_cwE13_spin:
    buffer_load_dword v4, v13, s[28:31], s26 offen sc0 sc1
    s_waitcnt vmcnt(0)
    v_cmp_ne_u32 vcc, 1, v4
    s_nop 0
    s_cmp_eq_u64 vcc, 0
    s_cbranch_scc1 L_cwE13_ok
L_cwE13_again:
    s_sleep 4
    s_sub_u32 s51, s51, 1
    s_cmp_lg_u32 s51, 0
    s_cbranch_scc1 L_cwE13_spin
L_cwE13_ok:
    v_mfma_f32_16x16x32_bf16 v[64:67], a[60:63], a[36:39], v[64:67]
    s_add_u32 s41, s41, 4096
    v_mfma_f32_16x16x32_bf16 v[68:71], a[60:63], a[40:43], v[68:71]
    buffer_load_dwordx4 v11, s[12:15], s41 offen sc1 lds
    v_mfma_f32_16x16x32_bf16 v[68:71], a[24:27], a[4:7], v[68:71]
    s_lshl_b32 s40, s40, 17
    s_add_u32 s40, s40, s16
    v_mfma_f32_16x16x32_bf16 v[72:75], a[24:27], a[8:11], v[72:75]
    v_add_u32 v6, 73728, v2
    v_add_u32 v9, 73728, v3
    v_mfma_f32_16x16x32_bf16 v[72:75], a[60:63], a[44:47], v[72:75]
    ds_read_b128 a[96:99], v6 offset:0
    v_mfma_f32_16x16x32_bf16 v[76:79], a[60:63], a[48:51], v[76:79]
    s_add_u32 m0, s20, 0
    ds_read_b128 a[132:135], v6 offset:18432
    v_mfma_f32_16x16x32_bf16 v[76:79], a[24:27], a[12:15], v[76:79]
    ds_read_b128 a[100:103], v6 offset:1024
    v_mfma_f32_16x16x32_bf16 v[92:95], a[28:31], a[12:15], v[92:95]
    v_mfma_f32_16x16x32_bf16 v[92:95], a[64:67], a[48:51], v[92:95]
    buffer_load_dwordx4 v11, s[8:11], s40 offen offset:0 sc1 lds
    v_mfma_f32_16x16x32_bf16 v[88:91], a[64:67], a[44:47], v[88:91]
    ds_read_b128 a[136:139], v6 offset:19456
    v_mfma_f32_16x16x32_bf16 v[88:91], a[28:31], a[8:11], v[88:91]
    ds_read_b128 a[104:107], v6 offset:2048
    ds_read_b128 a[140:143], v6 offset:20480
    v_mfma_f32_16x16x32_bf16 v[84:87], a[28:31], a[4:7], v[84:87]
    v_mfma_f32_16x16x32_bf16 v[84:87], a[64:67], a[40:43], v[84:87]
    buffer_load_dwordx4 v11, s[8:11], s40 offen offset:1024 sc1 lds
    v_mfma_f32_16x16x32_bf16 v[80:83], a[64:67], a[36:39], v[80:83]
    ds_read_b128 a[108:111], v6 offset:3072
    ds_read_b128 a[144:147], v6 offset:21504
    v_mfma_f32_16x16x32_bf16 v[80:83], a[28:31], a[0:3], v[80:83]
    ds_read_b128 a[112:115], v9 offset:0
    v_mfma_f32_16x16x32_bf16 v[96:99], a[32:35], a[0:3], v[96:99]
    v_mfma_f32_16x16x32_bf16 v[96:99], a[68:71], a[36:39], v[96:99]
    buffer_load_dwordx4 v11, s[8:11], s40 offen offset:2048 sc1 lds
    v_mfma_f32_16x16x32_bf16 v[100:103], a[68:71], a[40:43], v[100:103]
    ds_read_b128 a[148:151], v9 offset:18432
    v_mfma_f32_16x16x32_bf16 v[100:103], a[32:35], a[4:7], v[100:103]
    ds_read_b128 a[116:119], v9 offset:1024
    ds_read_b128 a[152:155], v9 offset:19456
    v_mfma_f32_16x16x32_bf16 v[104:107], a[32:35], a[8:11], v[104:107]
    v_mfma_f32_16x16x32_bf16 v[104:107], a[68:71], a[44:47], v[104:107]
    v_mfma_f32_16x16x32_bf16 v[108:111], a[68:71], a[48:51], v[108:111]
    buffer_load_dwordx4 v11, s[8:11], s40 offen offset:3072 sc1 lds
    v_mfma_f32_16x16x32_bf16 v[108:111], a[32:35], a[12:15], v[108:111]
    s_waitcnt lgkmcnt(2)
    v_mfma_f32_16x16x32_bf16 v[32:35], a[112:115], a[96:99], v[32:35]
    ds_read_b128 a[120:123], v9 offset:2048
    ds_read_b128 a[156:159], v9 offset:20480
    v_mfma_f32_16x16x32_bf16 v[32:35], a[148:151], a[132:135], v[32:35]
    s_xor_b32 s40, s19, 18
    ds_read_b128 a[124:127], v9 offset:3072
    v_mfma_f32_16x16x32_bf16 v[36:39], a[148:151], a[136:139], v[36:39]
    v_mfma_f32_16x16x32_bf16 v[36:39], a[112:115], a[100:103], v[36:39]
    s_mul_i32 s41, s40, 40960
    s_add_u32 s41, s41, s17
    s_add_u32 m0, s20, 40960
    v_mfma_f32_16x16x32_bf16 v[40:43], a[112:115], a[104:107], v[40:43]
    buffer_load_dwordx4 v11, s[12:15], s41 offen offset:0 sc1 lds
    v_mfma_f32_16x16x32_bf16 v[40:43], a[148:151], a[140:143], v[40:43]
    v_mfma_f32_16x16x32_bf16 v[44:47], a[148:151], a[144:147], v[44:47]
    v_mfma_f32_16x16x32_bf16 v[44:47], a[112:115], a[108:111], v[44:47]
    s_waitcnt lgkmcnt(3)
    v_mfma_f32_16x16x32_bf16 v[60:63], a[116:119], a[108:111], v[60:63]
    buffer_load_dwordx4 v11, s[12:15], s41 offen offset:1024 sc1 lds
    v_mfma_f32_16x16x32_bf16 v[60:63], a[152:155], a[144:147], v[60:63]
    ds_read_b128 a[160:163], v9 offset:21504
    v_mfma_f32_16x16x32_bf16 v[56:59], a[152:155], a[140:143], v[56:59]
    ds_read_b128 a[128:131], v9 offset:4096
    v_mfma_f32_16x16x32_bf16 v[56:59], a[116:119], a[104:107], v[56:59]
    ds_read_b128 a[164:167], v9 offset:22528
    v_mfma_f32_16x16x32_bf16 v[52:55], a[116:119], a[100:103], v[52:55]
    v_mfma_f32_16x16x32_bf16 v[52:55], a[152:155], a[136:139], v[52:55]
    buffer_load_dwordx4 v11, s[12:15], s41 offen offset:2048 sc1 lds
    v_mfma_f32_16x16x32_bf16 v[48:51], a[152:155], a[132:135], v[48:51]
    v_mfma_f32_16x16x32_bf16 v[48:51], a[116:119], a[96:99], v[48:51]
    s_waitcnt vmcnt(12) lgkmcnt(0)
    s_barrier
    v_mfma_f32_16x16x32_bf16 v[64:67], a[120:123], a[96:99], v[64:67]
    v_add_u32 v6, 110592, v2
    v_add_u32 v9, 110592, v3
    v_mfma_f32_16x16x32_bf16 v[64:67], a[156:159], a[132:135], v[64:67]
    buffer_load_dwordx4 v11, s[12:15], s41 offen offset:3072 sc1 lds
    v_mfma_f32_16x16x32_bf16 v[68:71], a[156:159], a[136:139], v[68:71]
    v_mfma_f32_16x16x32_bf16 v[68:71], a[120:123], a[100:103], v[68:71]
    s_add_u32 m0, s20, 45056
    ds_read_b128 a[0:3], v6 offset:0
    v_mfma_f32_16x16x32_bf16 v[72:75], a[120:123], a[104:107], v[72:75]
    s_add_u32 s41, s41, 4096
    v_mfma_f32_16x16x32_bf16 v[72:75], a[156:159], a[140:143], v[72:75]
    v_mfma_f32_16x16x32_bf16 v[76:79], a[156:159], a[144:147], v[76:79]
    buffer_load_dwordx4 v11, s[12:15], s41 offen sc1 lds
    v_mfma_f32_16x16x32_bf16 v[76:79], a[120:123], a[108:111], v[76:79]
    s_lshl_b32 s40, s40, 17
    s_add_u32 s40, s40, s16
    v_mfma_f32_16x16x32_bf16 v[92:95], a[124:127], a[108:111], v[92:95]
    ds_read_b128 a[36:39], v6 offset:18432
    ds_read_b128 a[4:7], v6 offset:1024
    v_mfma_f32_16x16x32_bf16 v[92:95], a[160:163], a[144:147], v[92:95]
    s_add_u32 m0, s20, 36864
    v_mfma_f32_16x16x32_bf16 v[88:91], a[160:163], a[140:143], v[88:91]
    buffer_load_dwordx4 v11, s[8:11], s40 offen offset:0 sc1 lds
    v_mfma_f32_16x16x32_bf16 v[88:91], a[124:127], a[104:107], v[88:91]
    ds_read_b128 a[40:43], v6 offset:19456
    ds_read_b128 a[8:11], v6 offset:2048
    v_mfma_f32_16x16x32_bf16 v[84:87], a[124:127], a[100:103], v[84:87]
    ds_read_b128 a[44:47], v6 offset:20480
    ds_read_b128 a[12:15], v6 offset:3072
    v_mfma_f32_16x16x32_bf16 v[84:87], a[160:163], a[136:139], v[84:87]
    v_mfma_f32_16x16x32_bf16 v[80:83], a[160:163], a[132:135], v[80:83]
    buffer_load_dwordx4 v11, s[8:11], s40 offen offset:1024 sc1 lds
    v_mfma_f32_16x16x32_bf16 v[80:83], a[124:127], a[96:99], v[80:83]
    v_mfma_f32_16x16x32_bf16 v[96:99], a[128:131], a[96:99], v[96:99]
    ds_read_b128 a[48:51], v6 offset:21504
    ds_read_b128 a[16:19], v9 offset:0
    v_mfma_f32_16x16x32_bf16 v[96:99], a[164:167], a[132:135], v[96:99]
    ds_read_b128 a[52:55], v9 offset:18432
    ds_read_b128 a[20:23], v9 offset:1024
    v_mfma_f32_16x16x32_bf16 v[100:103], a[164:167], a[136:139], v[100:103]
    buffer_load_dwordx4 v11, s[8:11], s40 offen offset:2048 sc1 lds
    v_mfma_f32_16x16x32_bf16 v[100:103], a[128:131], a[100:103], v[100:103]
    v_mfma_f32_16x16x32_bf16 v[104:107], a[128:131], a[104:107], v[104:107]
    v_mfma_f32_16x16x32_bf16 v[104:107], a[164:167], a[140:143], v[104:107]
    v_mfma_f32_16x16x32_bf16 v[108:111], a[164:167], a[144:147], v[108:111]
    buffer_load_dwordx4 v11, s[8:11], s40 offen offset:3072 sc1 lds
    v_mfma_f32_16x16x32_bf16 v[108:111], a[128:131], a[108:111], v[108:111]
    ds_read_b128 a[56:59], v9 offset:19456
    s_waitcnt lgkmcnt(2)
    v_mfma_f32_16x16x32_bf16 v[32:35], a[16:19], a[0:3], v[32:35]
    ds_read_b128 a[24:27], v9 offset:2048
    ds_read_b128 a[60:63], v9 offset:20480
    v_mfma_f32_16x16x32_bf16 v[32:35], a[52:55], a[36:39], v[32:35]
    s_xor_b32 s40, s19, 20
    ds_read_b128 a[28:31], v9 offset:3072
    v_mfma_f32_16x16x32_bf16 v[36:39], a[52:55], a[40:43], v[36:39]
    v_mfma_f32_16x16x32_bf16 v[36:39], a[16:19], a[4:7], v[36:39]
    s_mul_i32 s41, s40, 40960
    s_add_u32 s41, s41, s17
    s_add_u32 m0, s20, 77824
    v_mfma_f32_16x16x32_bf16 v[40:43], a[16:19], a[8:11], v[40:43]
    buffer_load_dwordx4 v11, s[12:15], s41 offen offset:0 sc1 lds
    v_mfma_f32_16x16x32_bf16 v[40:43], a[52:55], a[44:47], v[40:43]
    v_mfma_f32_16x16x32_bf16 v[44:47], a[52:55], a[48:51], v[44:47]
    v_mfma_f32_16x16x32_bf16 v[44:47], a[16:19], a[12:15], v[44:47]
    s_waitcnt lgkmcnt(3)
    v_mfma_f32_16x16x32_bf16 v[60:63], a[20:23], a[12:15], v[60:63]
    buffer_load_dwordx4 v11, s[12:15], s41 offen offset:1024 sc1 lds
    v_mfma_f32_16x16x32_bf16 v[60:63], a[56:59], a[48:51], v[60:63]
    ds_read_b128 a[64:67], v9 offset:21504
    v_mfma_f32_16x16x32_bf16 v[56:59], a[56:59], a[44:47], v[56:59]
    ds_read_b128 a[32:35], v9 offset:4096
    v_mfma_f32_16x16x32_bf16 v[56:59], a[20:23], a[8:11], v[56:59]
    ds_read_b128 a[68:71], v9 offset:22528
    v_mfma_f32_16x16x32_bf16 v[52:55], a[20:23], a[4:7], v[52:55]
    v_mfma_f32_16x16x32_bf16 v[52:55], a[56:59], a[40:43], v[52:55]
    buffer_load_dwordx4 v11, s[12:15], s41 offen offset:2048 sc1 lds
    v_mfma_f32_16x16x32_bf16 v[48:51], a[56:59], a[36:39], v[48:51]
    v_mfma_f32_16x16x32_bf16 v[48:51], a[20:23], a[0:3], v[48:51]
    s_waitcnt vmcnt(12) lgkmcnt(0)
    s_barrier
    v_mfma_f32_16x16x32_bf16 v[64:67], a[24:27], a[0:3], v[64:67]
    v_add_u32 v6, 0, v2
    v_add_u32 v9, 0, v3
    v_mfma_f32_16x16x32_bf16 v[64:67], a[60:63], a[36:39], v[64:67]
    buffer_load_dwordx4 v11, s[12:15], s41 offen offset:3072 sc1 lds
    v_mfma_f32_16x16x32_bf16 v[68:71], a[60:63], a[40:43], v[68:71]
    v_mfma_f32_16x16x32_bf16 v[68:71], a[24:27], a[4:7], v[68:71]
    s_add_u32 m0, s20, 81920
    ds_read_b128 a[96:99], v6 offset:0
    v_mfma_f32_16x16x32_bf16 v[72:75], a[24:27], a[8:11], v[72:75]
    s_add_u32 s41, s41, 4096
    v_mfma_f32_16x16x32_bf16 v[72:75], a[60:63], a[44:47], v[72:75]
    v_mfma_f32_16x16x32_bf16 v[76:79], a[60:63], a[48:51], v[76:79]
    buffer_load_dwordx4 v11, s[12:15], s41 offen sc1 lds
    v_mfma_f32_16x16x32_bf16 v[76:79], a[24:27], a[12:15], v[76:79]
    s_lshl_b32 s40, s40, 17
    s_add_u32 s40, s40, s16
    v_mfma_f32_16x16x32_bf16 v[92:95], a[28:31], a[12:15], v[92:95]
    ds_read_b128 a[132:135], v6 offset:18432
    ds_read_b128 a[100:103], v6 offset:1024
    v_mfma_f32_16x16x32_bf16 v[92:95], a[64:67], a[48:51], v[92:95]
    s_add_u32 m0, s20, 73728
    v_mfma_f32_16x16x32_bf16 v[88:91], a[64:67], a[44:47], v[88:91]
    buffer_load_dwordx4 v11, s[8:11], s40 offen offset:0 sc1 lds
    v_mfma_f32_16x16x32_bf16 v[88:91], a[28:31], a[8:11], v[88:91]
    ds_read_b128 a[136:139], v6 offset:19456
    ds_read_b128 a[104:107], v6 offset:2048
    v_mfma_f32_16x16x32_bf16 v[84:87], a[28:31], a[4:7], v[84:87]
    ds_read_b128 a[140:143], v6 offset:20480
    ds_read_b128 a[108:111], v6 offset:3072
    v_mfma_f32_16x16x32_bf16 v[84:87], a[64:67], a[40:43], v[84:87]
    v_mfma_f32_16x16x32_bf16 v[80:83], a[64:67], a[36:39], v[80:83]
    buffer_load_dwordx4 v11, s[8:11], s40 offen offset:1024 sc1 lds
    v_mfma_f32_16x16x32_bf16 v[80:83], a[28:31], a[0:3], v[80:83]
    v_mfma_f32_16x16x32_bf16 v[96:99], a[32:35], a[0:3], v[96:99]
    ds_read_b128 a[144:147], v6 offset:21504
    ds_read_b128 a[112:115], v9 offset:0
    v_mfma_f32_16x16x32_bf16 v[96:99], a[68:71], a[36:39], v[96:99]
    ds_read_b128 a[148:151], v9 offset:18432
    ds_read_b128 a[116:119], v9 offset:1024
    v_mfma_f32_16x16x32_bf16 v[100:103], a[68:71], a[40:43], v[100:103]
    buffer_load_dwordx4 v11, s[8:11], s40 offen offset:2048 sc1 lds
    v_mfma_f32_16x16x32_bf16 v[100:103], a[32:35], a[4:7], v[100:103]
    v_mfma_f32_16x16x32_bf16 v[104:107], a[32:35], a[8:11], v[104:107]
    v_mfma_f32_16x16x32_bf16 v[104:107], a[68:71], a[44:47], v[104:107]
    v_mfma_f32_16x16x32_bf16 v[108:111], a[68:71], a[48:51], v[108:111]
    buffer_load_dwordx4 v11, s[8:11], s40 offen offset:3072 sc1 lds
    v_mfma_f32_16x16x32_bf16 v[108:111], a[32:35], a[12:15], v[108:111]
    ds_read_b128 a[152:155], v9 offset:19456
    s_waitcnt lgkmcnt(2)
    v_mfma_f32_16x16x32_bf16 v[32:35], a[112:115], a[96:99], v[32:35]
    ds_read_b128 a[120:123], v9 offset:2048
    ds_read_b128 a[156:159], v9 offset:20480
    v_mfma_f32_16x16x32_bf16 v[32:35], a[148:151], a[132:135], v[32:35]
    s_xor_b32 s40, s19, 22
    ds_read_b128 a[124:127], v9 offset:3072
    v_mfma_f32_16x16x32_bf16 v[36:39], a[148:151], a[136:139], v[36:39]
    v_mfma_f32_16x16x32_bf16 v[36:39], a[112:115], a[100:103], v[36:39]
    s_mul_i32 s41, s40, 40960
    s_add_u32 s41, s41, s17
    s_add_u32 m0, s20, 114688
    v_mfma_f32_16x16x32_bf16 v[40:43], a[112:115], a[104:107], v[40:43]
    buffer_load_dwordx4 v11, s[12:15], s41 offen offset:0 sc1 lds
    v_mfma_f32_16x16x32_bf16 v[40:43], a[148:151], a[140:143], v[40:43]
    v_mfma_f32_16x16x32_bf16 v[44:47], a[148:151], a[144:147], v[44:47]
    v_mfma_f32_16x16x32_bf16 v[44:47], a[112:115], a[108:111], v[44:47]
    s_waitcnt lgkmcnt(3)
    v_mfma_f32_16x16x32_bf16 v[60:63], a[116:119], a[108:111], v[60:63]
    buffer_load_dwordx4 v11, s[12:15], s41 offen offset:1024 sc1 lds
    v_mfma_f32_16x16x32_bf16 v[60:63], a[152:155], a[144:147], v[60:63]
    ds_read_b128 a[160:163], v9 offset:21504
    v_mfma_f32_16x16x32_bf16 v[56:59], a[152:155], a[140:143], v[56:59]
    ds_read_b128 a[128:131], v9 offset:4096
    v_mfma_f32_16x16x32_bf16 v[56:59], a[116:119], a[104:107], v[56:59]
    ds_read_b128 a[164:167], v9 offset:22528
    v_mfma_f32_16x16x32_bf16 v[52:55], a[116:119], a[100:103], v[52:55]
    v_mfma_f32_16x16x32_bf16 v[52:55], a[152:155], a[136:139], v[52:55]
    buffer_load_dwordx4 v11, s[12:15], s41 offen offset:2048 sc1 lds
    v_mfma_f32_16x16x32_bf16 v[48:51], a[152:155], a[132:135], v[48:51]
    v_mfma_f32_16x16x32_bf16 v[48:51], a[116:119], a[96:99], v[48:51]
    s_waitcnt vmcnt(12) lgkmcnt(0)
    s_barrier
    v_mfma_f32_16x16x32_bf16 v[64:67], a[120:123], a[96:99], v[64:67]
    v_add_u32 v6, 36864, v2
    v_add_u32 v9, 36864, v3
    v_mfma_f32_16x16x32_bf16 v[64:67], a[156:159], a[132:135], v[64:67]
    buffer_load_dwordx4 v11, s[12:15], s41 offen offset:3072 sc1 lds
    v_mfma_f32_16x16x32_bf16 v[68:71], a[156:159], a[136:139], v[68:71]
    v_mfma_f32_16x16x32_bf16 v[68:71], a[120:123], a[100:103], v[68:71]
    s_add_u32 m0, s20, 118784
    ds_read_b128 a[0:3], v6 offset:0
    v_mfma_f32_16x16x32_bf16 v[72:75], a[120:123], a[104:107], v[72:75]
    s_add_u32 s41, s41, 4096
    v_mfma_f32_16x16x32_bf16 v[72:75], a[156:159], a[140:143], v[72:75]
    v_mfma_f32_16x16x32_bf16 v[76:79], a[156:159], a[144:147], v[76:79]
    buffer_load_dwordx4 v11, s[12:15], s41 offen sc1 lds
    v_mfma_f32_16x16x32_bf16 v[76:79], a[120:123], a[108:111], v[76:79]
    s_lshl_b32 s40, s40, 17
    s_add_u32 s40, s40, s16
    v_mfma_f32_16x16x32_bf16 v[92:95], a[124:127], a[108:111], v[92:95]
    ds_read_b128 a[36:39], v6 offset:18432
    ds_read_b128 a[4:7], v6 offset:1024
    v_mfma_f32_16x16x32_bf16 v[92:95], a[160:163], a[144:147], v[92:95]
    s_add_u32 m0, s20, 110592
    v_mfma_f32_16x16x32_bf16 v[88:91], a[160:163], a[140:143], v[88:91]
    buffer_load_dwordx4 v11, s[8:11], s40 offen offset:0 sc1 lds
    v_mfma_f32_16x16x32_bf16 v[88:91], a[124:127], a[104:107], v[88:91]
    ds_read_b128 a[40:43], v6 offset:19456
    ds_read_b128 a[8:11], v6 offset:2048
    v_mfma_f32_16x16x32_bf16 v[84:87], a[124:127], a[100:103], v[84:87]
    ds_read_b128 a[44:47], v6 offset:20480
    ds_read_b128 a[12:15], v6 offset:3072
    v_mfma_f32_16x16x32_bf16 v[84:87], a[160:163], a[136:139], v[84:87]
    v_mfma_f32_16x16x32_bf16 v[80:83], a[160:163], a[132:135], v[80:83]
    buffer_load_dwordx4 v11, s[8:11], s40 offen offset:1024 sc1 lds
    v_mfma_f32_16x16x32_bf16 v[80:83], a[124:127], a[96:99], v[80:83]
    v_mfma_f32_16x16x32_bf16 v[96:99], a[128:131], a[96:99], v[96:99]
    ds_read_b128 a[48:51], v6 offset:21504
    ds_read_b128 a[16:19], v9 offset:0
    v_mfma_f32_16x16x32_bf16 v[96:99], a[164:167], a[132:135], v[96:99]
    ds_read_b128 a[52:55], v9 offset:18432
    ds_read_b128 a[20:23], v9 offset:1024
    v_mfma_f32_16x16x32_bf16 v[100:103], a[164:167], a[136:139], v[100:103]
    buffer_load_dwordx4 v11, s[8:11], s40 offen offset:2048 sc1 lds
    v_mfma_f32_16x16x32_bf16 v[100:103], a[128:131], a[100:103], v[100:103]
    v_mfma_f32_16x16x32_bf16 v[104:107], a[128:131], a[104:107], v[104:107]
    v_mfma_f32_16x16x32_bf16 v[104:107], a[164:167], a[140:143], v[104:107]
    v_mfma_f32_16x16x32_bf16 v[108:111], a[164:167], a[144:147], v[108:111]
    buffer_load_dwordx4 v11, s[8:11], s40 offen offset:3072 sc1 lds
    v_mfma_f32_16x16x32_bf16 v[108:111], a[128:131], a[108:111], v[108:111]
    ds_read_b128 a[56:59], v9 offset:19456
    s_waitcnt lgkmcnt(2)
    v_mfma_f32_16x16x32_bf16 v[32:35], a[16:19], a[0:3], v[32:35]
    ds_read_b128 a[24:27], v9 offset:2048
    ds_read_b128 a[60:63], v9 offset:20480
    v_mfma_f32_16x16x32_bf16 v[32:35], a[52:55], a[36:39], v[32:35]
    s_xor_b32 s40, s19, 24
    ds_read_b128 a[28:31], v9 offset:3072
    v_mfma_f32_16x16x32_bf16 v[36:39], a[52:55], a[40:43], v[36:39]
    v_mfma_f32_16x16x32_bf16 v[36:39], a[16:19], a[4:7], v[36:39]
    s_mul_i32 s41, s40, 40960
    s_add_u32 s41, s41, s17
    s_add_u32 m0, s20, 4096
    v_mfma_f32_16x16x32_bf16 v[40:43], a[16:19], a[8:11], v[40:43]
    buffer_load_dwordx4 v11, s[12:15], s41 offen offset:0 sc1 lds
    v_mfma_f32_16x16x32_bf16 v[40:43], a[52:55], a[44:47], v[40:43]
    v_mfma_f32_16x16x32_bf16 v[44:47], a[52:55], a[48:51], v[44:47]
    v_mfma_f32_16x16x32_bf16 v[44:47], a[16:19], a[12:15], v[44:47]
    s_waitcnt lgkmcnt(3)
    v_mfma_f32_16x16x32_bf16 v[60:63], a[20:23], a[12:15], v[60:63]
    buffer_load_dwordx4 v11, s[12:15], s41 offen offset:1024 sc1 lds
    v_mfma_f32_16x16x32_bf16 v[60:63], a[56:59], a[48:51], v[60:63]
    ds_read_b128 a[64:67], v9 offset:21504
    v_mfma_f32_16x16x32_bf16 v[56:59], a[56:59], a[44:47], v[56:59]
    ds_read_b128 a[32:35], v9 offset:4096
    v_mfma_f32_16x16x32_bf16 v[56:59], a[20:23], a[8:11], v[56:59]
    ds_read_b128 a[68:71], v9 offset:22528
    v_mfma_f32_16x16x32_bf16 v[52:55], a[20:23], a[4:7], v[52:55]
    v_mfma_f32_16x16x32_bf16 v[52:55], a[56:59], a[40:43], v[52:55]
    buffer_load_dwordx4 v11, s[12:15], s41 offen offset:2048 sc1 lds
    v_mfma_f32_16x16x32_bf16 v[48:51], a[56:59], a[36:39], v[48:51]
    v_mfma_f32_16x16x32_bf16 v[48:51], a[20:23], a[0:3], v[48:51]
    s_waitcnt vmcnt(12) lgkmcnt(0)
    s_barrier
    v_mfma_f32_16x16x32_bf16 v[64:67], a[24:27], a[0:3], v[64:67]
    v_add_u32 v6, 73728, v2
    v_add_u32 v9, 73728, v3
    v_mfma_f32_16x16x32_bf16 v[64:67], a[60:63], a[36:39], v[64:67]
    buffer_load_dwordx4 v11, s[12:15], s41 offen offset:3072 sc1 lds
    v_mfma_f32_16x16x32_bf16 v[68:71], a[60:63], a[40:43], v[68:71]
    v_mfma_f32_16x16x32_bf16 v[68:71], a[24:27], a[4:7], v[68:71]
    s_add_u32 m0, s20, 8192
    ds_read_b128 a[96:99], v6 offset:0
    v_mfma_f32_16x16x32_bf16 v[72:75], a[24:27], a[8:11], v[72:75]
    s_add_u32 s41, s41, 4096
    v_mfma_f32_16x16x32_bf16 v[72:75], a[60:63], a[44:47], v[72:75]
    v_mfma_f32_16x16x32_bf16 v[76:79], a[60:63], a[48:51], v[76:79]
    buffer_load_dwordx4 v11, s[12:15], s41 offen sc1 lds
    v_mfma_f32_16x16x32_bf16 v[76:79], a[24:27], a[12:15], v[76:79]
    s_lshl_b32 s40, s40, 17
    s_add_u32 s40, s40, s16
    v_mfma_f32_16x16x32_bf16 v[92:95], a[28:31], a[12:15], v[92:95]
    ds_read_b128 a[132:135], v6 offset:18432
    ds_read_b128 a[100:103], v6 offset:1024
    v_mfma_f32_16x16x32_bf16 v[92:95], a[64:67], a[48:51], v[92:95]
    s_add_u32 m0, s20, 0
    v_mfma_f32_16x16x32_bf16 v[88:91], a[64:67], a[44:47], v[88:91]
    buffer_load_dwordx4 v11, s[8:11], s40 offen offset:0 sc1 lds
    v_mfma_f32_16x16x32_bf16 v[88:91], a[28:31], a[8:11], v[88:91]
    ds_read_b128 a[136:139], v6 offset:19456
    ds_read_b128 a[104:107], v6 offset:2048
    v_mfma_f32_16x16x32_bf16 v[84:87], a[28:31], a[4:7], v[84:87]
    ds_read_b128 a[140:143], v6 offset:20480
    ds_read_b128 a[108:111], v6 offset:3072
    v_mfma_f32_16x16x32_bf16 v[84:87], a[64:67], a[40:43], v[84:87]
    v_mfma_f32_16x16x32_bf16 v[80:83], a[64:67], a[36:39], v[80:83]
    buffer_load_dwordx4 v11, s[8:11], s40 offen offset:1024 sc1 lds
    v_mfma_f32_16x16x32_bf16 v[80:83], a[28:31], a[0:3], v[80:83]
    v_mfma_f32_16x16x32_bf16 v[96:99], a[32:35], a[0:3], v[96:99]
    ds_read_b128 a[144:147], v6 offset:21504
    ds_read_b128 a[112:115], v9 offset:0
    v_mfma_f32_16x16x32_bf16 v[96:99], a[68:71], a[36:39], v[96:99]
    ds_read_b128 a[148:151], v9 offset:18432
    ds_read_b128 a[116:119], v9 offset:1024
    v_mfma_f32_16x16x32_bf16 v[100:103], a[68:71], a[40:43], v[100:103]
    buffer_load_dwordx4 v11, s[8:11], s40 offen offset:2048 sc1 lds
    v_mfma_f32_16x16x32_bf16 v[100:103], a[32:35], a[4:7], v[100:103]
    v_mfma_f32_16x16x32_bf16 v[104:107], a[32:35], a[8:11], v[104:107]
    v_mfma_f32_16x16x32_bf16 v[104:107], a[68:71], a[44:47], v[104:107]
    v_mfma_f32_16x16x32_bf16 v[108:111], a[68:71], a[48:51], v[108:111]
    buffer_load_dwordx4 v11, s[8:11], s40 offen offset:3072 sc1 lds
    v_mfma_f32_16x16x32_bf16 v[108:111], a[32:35], a[12:15], v[108:111]
    ds_read_b128 a[152:155], v9 offset:19456
    s_waitcnt lgkmcnt(2)
    v_mfma_f32_16x16x32_bf16 v[32:35], a[112:115], a[96:99], v[32:35]
    ds_read_b128 a[120:123], v9 offset:2048
    ds_read_b128 a[156:159], v9 offset:20480
    v_mfma_f32_16x16x32_bf16 v[32:35], a[148:151], a[132:135], v[32:35]
    s_xor_b32 s40, s19, 26
    ds_read_b128 a[124:127], v9 offset:3072
    v_mfma_f32_16x16x32_bf16 v[36:39], a[148:151], a[136:139], v[36:39]
    v_mfma_f32_16x16x32_bf16 v[36:39], a[112:115], a[100:103], v[36:39]
    s_mul_i32 s41, s40, 40960
    s_add_u32 s41, s41, s17
    s_add_u32 m0, s20, 40960
    v_mfma_f32_16x16x32_bf16 v[40:43], a[112:115], a[104:107], v[40:43]
    buffer_load_dwordx4 v11, s[12:15], s41 offen offset:0 sc1 lds
    v_mfma_f32_16x16x32_bf16 v[40:43], a[148:151], a[140:143], v[40:43]
    v_mfma_f32_16x16x32_bf16 v[44:47], a[148:151], a[144:147], v[44:47]
    v_mfma_f32_16x16x32_bf16 v[44:47], a[112:115], a[108:111], v[44:47]
    s_waitcnt lgkmcnt(3)
    v_mfma_f32_16x16x32_bf16 v[60:63], a[116:119], a[108:111], v[60:63]
    buffer_load_dwordx4 v11, s[12:15], s41 offen offset:1024 sc1 lds
    v_mfma_f32_16x16x32_bf16 v[60:63], a[152:155], a[144:147], v[60:63]
    ds_read_b128 a[160:163], v9 offset:21504
    v_mfma_f32_16x16x32_bf16 v[56:59], a[152:155], a[140:143], v[56:59]
    ds_read_b128 a[128:131], v9 offset:4096
    v_mfma_f32_16x16x32_bf16 v[56:59], a[116:119], a[104:107], v[56:59]
    ds_read_b128 a[164:167], v9 offset:22528
    v_mfma_f32_16x16x32_bf16 v[52:55], a[116:119], a[100:103], v[52:55]
    v_mfma_f32_16x16x32_bf16 v[52:55], a[152:155], a[136:139], v[52:55]
    buffer_load_dwordx4 v11, s[12:15], s41 offen offset:2048 sc1 lds
    v_mfma_f32_16x16x32_bf16 v[48:51], a[152:155], a[132:135], v[48:51]
    v_mfma_f32_16x16x32_bf16 v[48:51], a[116:119], a[96:99], v[48:51]
    s_waitcnt vmcnt(12) lgkmcnt(0)
    s_barrier
    v_mfma_f32_16x16x32_bf16 v[64:67], a[120:123], a[96:99], v[64:67]
    v_add_u32 v6, 110592, v2
    v_add_u32 v9, 110592, v3
    v_mfma_f32_16x16x32_bf16 v[64:67], a[156:159], a[132:135], v[64:67]
    buffer_load_dwordx4 v11, s[12:15], s41 offen offset:3072 sc1 lds
    v_mfma_f32_16x16x32_bf16 v[68:71], a[156:159], a[136:139], v[68:71]
    v_mfma_f32_16x16x32_bf16 v[68:71], a[120:123], a[100:103], v[68:71]
    s_add_u32 m0, s20, 45056
    ds_read_b128 a[0:3], v6 offset:0
    v_mfma_f32_16x16x32_bf16 v[72:75], a[120:123], a[104:107], v[72:75]
    s_add_u32 s41, s41, 4096
    v_mfma_f32_16x16x32_bf16 v[72:75], a[156:159], a[140:143], v[72:75]
    v_mfma_f32_16x16x32_bf16 v[76:79], a[156:159], a[144:147], v[76:79]
    buffer_load_dwordx4 v11, s[12:15], s41 offen sc1 lds
    v_mfma_f32_16x16x32_bf16 v[76:79], a[120:123], a[108:111], v[76:79]
    s_lshl_b32 s40, s40, 17
    s_add_u32 s40, s40, s16
    v_mfma_f32_16x16x32_bf16 v[92:95], a[124:127], a[108:111], v[92:95]
    ds_read_b128 a[36:39], v6 offset:18432
    ds_read_b128 a[4:7], v6 offset:1024
    v_mfma_f32_16x16x32_bf16 v[92:95], a[160:163], a[144:147], v[92:95]
    s_add_u32 m0, s20, 36864
    v_mfma_f32_16x16x32_bf16 v[88:91], a[160:163], a[140:143], v[88:91]
    buffer_load_dwordx4 v11, s[8:11], s40 offen offset:0 sc1 lds
    v_mfma_f32_16x16x32_bf16 v[88:91], a[124:127], a[104:107], v[88:91]
    ds_read_b128 a[40:43], v6 offset:19456
    ds_read_b128 a[8:11], v6 offset:2048
    v_mfma_f32_16x16x32_bf16 v[84:87], a[124:127], a[100:103], v[84:87]
    ds_read_b128 a[44:47], v6 offset:20480
    ds_read_b128 a[12:15], v6 offset:3072
    v_mfma_f32_16x16x32_bf16 v[84:87], a[160:163], a[136:139], v[84:87]
    v_mfma_f32_16x16x32_bf16 v[80:83], a[160:163], a[132:135], v[80:83]
    buffer_load_dwordx4 v11, s[8:11], s40 offen offset:1024 sc1 lds
    v_mfma_f32_16x16x32_bf16 v[80:83], a[124:127], a[96:99], v[80:83]
    v_mfma_f32_16x16x32_bf16 v[96:99], a[128:131], a[96:99], v[96:99]
    ds_read_b128 a[48:51], v6 offset:21504
    ds_read_b128 a[16:19], v9 offset:0
    v_mfma_f32_16x16x32_bf16 v[96:99], a[164:167], a[132:135], v[96:99]
    ds_read_b128 a[52:55], v9 offset:18432
    ds_read_b128 a[20:23], v9 offset:1024
    v_mfma_f32_16x16x32_bf16 v[100:103], a[164:167], a[136:139], v[100:103]
    buffer_load_dwordx4 v11, s[8:11], s40 offen offset:2048 sc1 lds
    v_mfma_f32_16x16x32_bf16 v[100:103], a[128:131], a[100:103], v[100:103]
    v_mfma_f32_16x16x32_bf16 v[104:107], a[128:131], a[104:107], v[104:107]
    v_mfma_f32_16x16x32_bf16 v[104:107], a[164:167], a[140:143], v[104:107]
    v_mfma_f32_16x16x32_bf16 v[108:111], a[164:167], a[144:147], v[108:111]
    buffer_load_dwordx4 v11, s[8:11], s40 offen offset:3072 sc1 lds
    v_mfma_f32_16x16x32_bf16 v[108:111], a[128:131], a[108:111], v[108:111]
    ds_read_b128 a[56:59], v9 offset:19456
    s_waitcnt lgkmcnt(2)
    v_mfma_f32_16x16x32_bf16 v[32:35], a[16:19], a[0:3], v[32:35]
    s_xor_b32 s40, s19, 28
    ds_read_b128 a[24:27], v9 offset:2048
    v_mfma_f32_16x16x32_bf16 v[32:35], a[52:55], a[36:39], v[32:35]
    s_mul_i32 s41, s40, 40960
    s_add_u32 s41, s41, s17
    s_add_u32 m0, s20, 77824
    v_mfma_f32_16x16x32_bf16 v[36:39], a[52:55], a[40:43], v[36:39]
    buffer_load_dwordx4 v11, s[12:15], s41 offen offset:0 sc1 lds
    v_mfma_f32_16x16x32_bf16 v[36:39], a[16:19], a[4:7], v[36:39]
    v_mfma_f32_16x16x32_bf16 v[40:43], a[16:19], a[8:11], v[40:43]
    v_mfma_f32_16x16x32_bf16 v[40:43], a[52:55], a[44:47], v[40:43]
    buffer_load_dwordx4 v11, s[12:15], s41 offen offset:1024 sc1 lds
    v_mfma_f32_16x16x32_bf16 v[44:47], a[52:55], a[48:51], v[44:47]
    ds_read_b128 a[60:63], v9 offset:20480
    v_mfma_f32_16x16x32_bf16 v[44:47], a[16:19], a[12:15], v[44:47]
    s_waitcnt lgkmcnt(2)
    v_mfma_f32_16x16x32_bf16 v[60:63], a[20:23], a[12:15], v[60:63]
    ds_read_b128 a[28:31], v9 offset:3072
    ds_read_b128 a[64:67], v9 offset:21504
    v_mfma_f32_16x16x32_bf16 v[60:63], a[56:59], a[48:51], v[60:63]
    buffer_load_dwordx4 v11, s[12:15], s41 offen offset:2048 sc1 lds
    v_mfma_f32_16x16x32_bf16 v[56:59], a[56:59], a[44:47], v[56:59]
    v_mfma_f32_16x16x32_bf16 v[56:59], a[20:23], a[8:11], v[56:59]
    ds_read_b128 a[32:35], v9 offset:4096
    ds_read_b128 a[68:71], v9 offset:22528
    v_mfma_f32_16x16x32_bf16 v[52:55], a[20:23], a[4:7], v[52:55]
    v_mfma_f32_16x16x32_bf16 v[52:55], a[56:59], a[40:43], v[52:55]
    buffer_load_dwordx4 v11, s[12:15], s41 offen offset:3072 sc1 lds
    v_mfma_f32_16x16x32_bf16 v[48:51], a[56:59], a[36:39], v[48:51]
    v_mfma_f32_16x16x32_bf16 v[48:51], a[20:23], a[0:3], v[48:51]
    s_waitcnt vmcnt(13) lgkmcnt(0)
    s_barrier
    v_mfma_f32_16x16x32_bf16 v[64:67], a[24:27], a[0:3], v[64:67]
    s_add_u32 m0, s20, 81920
    v_add_u32 v6, 0, v2
    v_mfma_f32_16x16x32_bf16 v[64:67], a[60:63], a[36:39], v[64:67]
    s_add_u32 s41, s41, 4096
    v_add_u32 v9, 0, v3
    v_mfma_f32_16x16x32_bf16 v[68:71], a[60:63], a[40:43], v[68:71]
    buffer_load_dword v4, v31, s[28:31], s50 offen sc0 sc1
    v_mfma_f32_16x16x32_bf16 v[68:71], a[24:27], a[4:7], v[68:71]
    v_mfma_f32_16x16x32_bf16 v[72:75], a[24:27], a[8:11], v[72:75]
    ds_read_b128 a[96:99], v6 offset:0
    ds_read_b128 a[132:135], v6 offset:18432
    v_mfma_f32_16x16x32_bf16 v[72:75], a[60:63], a[44:47], v[72:75]
    ds_read_b128 a[100:103], v6 offset:1024
    v_mfma_f32_16x16x32_bf16 v[76:79], a[60:63], a[48:51], v[76:79]
    buffer_load_dwordx4 v11, s[12:15], s41 offen sc1 lds
    v_mfma_f32_16x16x32_bf16 v[76:79], a[24:27], a[12:15], v[76:79]
    ds_read_b128 a[136:139], v6 offset:19456
    v_mfma_f32_16x16x32_bf16 v[92:95], a[28:31], a[12:15], v[92:95]
    ds_read_b128 a[104:107], v6 offset:2048
    v_mfma_f32_16x16x32_bf16 v[92:95], a[64:67], a[48:51], v[92:95]
    ds_read_b128 a[140:143], v6 offset:20480
    v_mfma_f32_16x16x32_bf16 v[88:91], a[64:67], a[44:47], v[88:91]
    s_lshl_b32 s40, s40, 17
    s_add_u32 s40, s40, s16
    s_add_u32 m0, s20, 73728
    v_mfma_f32_16x16x32_bf16 v[88:91], a[28:31], a[8:11], v[88:91]
    buffer_load_dwordx4 v11, s[8:11], s40 offen offset:0 sc1 lds
    v_mfma_f32_16x16x32_bf16 v[84:87], a[28:31], a[4:7], v[84:87]
    ds_read_b128 a[108:111], v6 offset:3072
    ds_read_b128 a[144:147], v6 offset:21504
    v_mfma_f32_16x16x32_bf16 v[84:87], a[64:67], a[40:43], v[84:87]
    buffer_load_dwordx4 v11, s[8:11], s40 offen offset:1024 sc1 lds
    v_mfma_f32_16x16x32_bf16 v[80:83], a[64:67], a[36:39], v[80:83]
    ds_read_b128 a[112:115], v9 offset:0
    ds_read_b128 a[148:151], v9 offset:18432
    v_mfma_f32_16x16x32_bf16 v[80:83], a[28:31], a[0:3], v[80:83]
    v_mfma_f32_16x16x32_bf16 v[96:99], a[32:35], a[0:3], v[96:99]
    v_mfma_f32_16x16x32_bf16 v[96:99], a[68:71], a[36:39], v[96:99]
    buffer_load_dwordx4 v11, s[8:11], s40 offen offset:2048 sc1 lds
    v_mfma_f32_16x16x32_bf16 v[100:103], a[68:71], a[40:43], v[100:103]
    v_mfma_f32_16x16x32_bf16 v[100:103], a[32:35], a[4:7], v[100:103]
    v_mfma_f32_16x16x32_bf16 v[104:107], a[32:35], a[8:11], v[104:107]
    v_mfma_f32_16x16x32_bf16 v[104:107], a[68:71], a[44:47], v[104:107]
    buffer_load_dwordx4 v11, s[8:11], s40 offen offset:3072 sc1 lds
    v_mfma_f32_16x16x32_bf16 v[108:111], a[68:71], a[48:51], v[108:111]
    ds_read_b128 a[116:119], v9 offset:1024
    ds_read_b128 a[152:155], v9 offset:19456
    v_mfma_f32_16x16x32_bf16 v[108:111], a[32:35], a[12:15], v[108:111]
    s_waitcnt lgkmcnt(2)
    v_mfma_f32_16x16x32_bf16 v[32:35], a[112:115], a[96:99], v[32:35]
    s_xor_b32 s40, s19, 30
    s_mul_i32 s41, s40, 40960
    s_add_u32 s41, s41, s17
    v_mfma_f32_16x16x32_bf16 v[32:35], a[148:151], a[132:135], v[32:35]
    s_add_u32 m0, s20, 114688
    v_mfma_f32_16x16x32_bf16 v[36:39], a[148:151], a[136:139], v[36:39]
    buffer_load_dwordx4 v11, s[12:15], s41 offen offset:0 sc1 lds
    v_mfma_f32_16x16x32_bf16 v[36:39], a[112:115], a[100:103], v[36:39]
    v_mfma_f32_16x16x32_bf16 v[40:43], a[112:115], a[104:107], v[40:43]
    v_mfma_f32_16x16x32_bf16 v[40:43], a[148:151], a[140:143], v[40:43]
    v_mfma_f32_16x16x32_bf16 v[44:47], a[148:151], a[144:147], v[44:47]
    buffer_load_dwordx4 v11, s[12:15], s41 offen offset:1024 sc1 lds
    v_mfma_f32_16x16x32_bf16 v[44:47], a[112:115], a[108:111], v[44:47]
    ds_read_b128 a[120:123], v9 offset:2048
    s_waitcnt lgkmcnt(1)
    v_mfma_f32_16x16x32_bf16 v[60:63], a[116:119], a[108:111], v[60:63]
    ds_read_b128 a[156:159], v9 offset:20480
    ds_read_b128 a[124:127], v9 offset:3072
    v_mfma_f32_16x16x32_bf16 v[60:63], a[152:155], a[144:147], v[60:63]
    buffer_load_dwordx4 v11, s[12:15], s41 offen offset:2048 sc1 lds
    v_mfma_f32_16x16x32_bf16 v[56:59], a[152:155], a[140:143], v[56:59]
    ds_read_b128 a[160:163], v9 offset:21504
    ds_read_b128 a[128:131], v9 offset:4096
    v_mfma_f32_16x16x32_bf16 v[56:59], a[116:119], a[104:107], v[56:59]
    ds_read_b128 a[164:167], v9 offset:22528
    v_mfma_f32_16x16x32_bf16 v[52:55], a[116:119], a[100:103], v[52:55]
    v_mfma_f32_16x16x32_bf16 v[52:55], a[152:155], a[136:139], v[52:55]
    buffer_load_dwordx4 v11, s[12:15], s41 offen offset:3072 sc1 lds
    v_mfma_f32_16x16x32_bf16 v[48:51], a[152:155], a[132:135], v[48:51]
    s_add_u32 m0, s20, 118784
    v_mfma_f32_16x16x32_bf16 v[48:51], a[116:119], a[96:99], v[48:51]
    s_waitcnt vmcnt(9) lgkmcnt(0)
    s_barrier
    v_mfma_f32_16x16x32_bf16 v[64:67], a[120:123], a[96:99], v[64:67]
    v_cmp_ne_u32 vcc, 1, v4
    s_nop 0
    s_cmp_eq_u64 vcc, 0
    s_cbranch_scc1 L_cwE20_ok
L_cwE20_no:
    s_mov_b32 s51, 0x40000
L_cwE20_spin:
    buffer_load_dword v4, v31, s[28:31], s50 offen sc0 sc1
    s_waitcnt vmcnt(0)
    v_cmp_ne_u32 vcc, 1, v4
    s_nop 0
    s_cmp_eq_u64 vcc, 0
    s_cbranch_scc1 L_cwE20_ok
L_cwE20_again:
    s_sleep 4
    s_sub_u32 s51, s51, 1
    s_cmp_lg_u32 s51, 0
    s_cbranch_scc1 L_cwE20_spin
L_cwE20_ok:
    v_mfma_f32_16x16x32_bf16 v[64:67], a[156:159], a[132:135], v[64:67]
    s_add_u32 s41, s41, 4096
    v_mfma_f32_16x16x32_bf16 v[68:71], a[156:159], a[136:139], v[68:71]
    buffer_load_dwordx4 v11, s[12:15], s41 offen sc1 lds
    v_mfma_f32_16x16x32_bf16 v[68:71], a[120:123], a[100:103], v[68:71]
    s_lshl_b32 s40, s40, 17
    s_add_u32 s40, s40, s16
    v_mfma_f32_16x16x32_bf16 v[72:75], a[120:123], a[104:107], v[72:75]
    v_add_u32 v6, 36864, v2
    v_add_u32 v9, 36864, v3
    v_mfma_f32_16x16x32_bf16 v[72:75], a[156:159], a[140:143], v[72:75]
    ds_read_b128 a[0:3], v6 offset:0
    v_mfma_f32_16x16x32_bf16 v[76:79], a[156:159], a[144:147], v[76:79]
    s_add_u32 m0, s20, 110592
    ds_read_b128 a[36:39], v6 offset:18432
    v_mfma_f32_16x16x32_bf16 v[76:79], a[120:123], a[108:111], v[76:79]
    ds_read_b128 a[4:7], v6 offset:1024
    v_mfma_f32_16x16x32_bf16 v[92:95], a[124:127], a[108:111], v[92:95]
    v_mfma_f32_16x16x32_bf16 v[92:95], a[160:163], a[144:147], v[92:95]
    buffer_load_dwordx4 v11, s[8:11], s40 offen offset:0 sc1 lds
    v_mfma_f32_16x16x32_bf16 v[88:91], a[160:163], a[140:143], v[88:91]
    ds_read_b128 a[40:43], v6 offset:19456
    v_mfma_f32_16x16x32_bf16 v[88:91], a[124:127], a[104:107], v[88:91]
    ds_read_b128 a[8:11], v6 offset:2048
    ds_read_b128 a[44:47], v6 offset:20480
    v_mfma_f32_16x16x32_bf16 v[84:87], a[124:127], a[100:103], v[84:87]
    v_mfma_f32_16x16x32_bf16 v[84:87], a[160:163], a[136:139], v[84:87]
    buffer_load_dwordx4 v11, s[8:11], s40 offen offset:1024 sc1 lds
    v_mfma_f32_16x16x32_bf16 v[80:83], a[160:163], a[132:135], v[80:83]
    ds_read_b128 a[12:15], v6 offset:3072
    ds_read_b128 a[48:51], v6 offset:21504
    v_mfma_f32_16x16x32_bf16 v[80:83], a[124:127], a[96:99], v[80:83]
    ds_read_b128 a[16:19], v9 offset:0
    v_mfma_f32_16x16x32_bf16 v[96:99], a[128:131], a[96:99], v[96:99]
    v_mfma_f32_16x16x32_bf16 v[96:99], a[164:167], a[132:135], v[96:99]
    buffer_load_dwordx4 v11, s[8:11], s40 offen offset:2048 sc1 lds
    v_mfma_f32_16x16x32_bf16 v[100:103], a[164:167], a[136:139], v[100:103]
    ds_read_b128 a[52:55], v9 offset:18432
    v_mfma_f32_16x16x32_bf16 v[100:103], a[128:131], a[100:103], v[100:103]
    ds_read_b128 a[20:23], v9 offset:1024
    ds_read_b128 a[56:59], v9 offset:19456
    v_mfma_f32_16x16x32_bf16 v[104:107], a[128:131], a[104:107], v[104:107]
    v_mfma_f32_16x16x32_bf16 v[104:107], a[164:167], a[140:143], v[104:107]
    v_mfma_f32_16x16x32_bf16 v[108:111], a[164:167], a[144:147], v[108:111]
    buffer_load_dwordx4 v11, s[8:11], s40 offen offset:3072 sc1 lds
    v_mfma_f32_16x16x32_bf16 v[108:111], a[128:131], a[108:111], v[108:111]
    s_waitcnt lgkmcnt(2)
    v_mfma_f32_16x16x32_bf16 v[32:35], a[16:19], a[0:3], v[32:35]
    ds_read_b128 a[24:27], v9 offset:2048
    ds_read_b128 a[60:63], v9 offset:20480
    v_mfma_f32_16x16x32_bf16 v[32:35], a[52:55], a[36:39], v[32:35]
    s_add_u32 s40, s36, 128
    ds_read_b128 a[28:31], v9 offset:3072
    v_mfma_f32_16x16x32_bf16 v[36:39], a[52:55], a[40:43], v[36:39]
    v_mfma_f32_16x16x32_bf16 v[36:39], a[16:19], a[4:7], v[36:39]
    s_mul_i32 s41, s40, 40960
    s_add_u32 s41, s41, s62
    s_add_u32 m0, s20, 4096
    v_mfma_f32_16x16x32_bf16 v[40:43], a[16:19], a[8:11], v[40:43]
    buffer_load_dwordx4 v11, s[12:15], s41 offen offset:0 sc1 lds
    v_mfma_f32_16x16x32_bf16 v[40:43], a[52:55], a[44:47], v[40:43]
    v_mfma_f32_16x16x32_bf16 v[44:47], a[52:55], a[48:51], v[44:47]
    v_mfma_f32_16x16x32_bf16 v[44:47], a[16:19], a[12:15], v[44:47]
    s_waitcnt lgkmcnt(3)
    v_mfma_f32_16x16x32_bf16 v[60:63], a[20:23], a[12:15], v[60:63]
    buffer_load_dwordx4 v11, s[12:15], s41 offen offset:1024 sc1 lds
    v_mfma_f32_16x16x32_bf16 v[60:63], a[56:59], a[48:51], v[60:63]
    ds_read_b128 a[64:67], v9 offset:21504
    v_mfma_f32_16x16x32_bf16 v[56:59], a[56:59], a[44:47], v[56:59]
    ds_read_b128 a[32:35], v9 offset:4096
    v_mfma_f32_16x16x32_bf16 v[56:59], a[20:23], a[8:11], v[56:59]
    ds_read_b128 a[68:71], v9 offset:22528
    v_mfma_f32_16x16x32_bf16 v[52:55], a[20:23], a[4:7], v[52:55]
    v_mfma_f32_16x16x32_bf16 v[52:55], a[56:59], a[40:43], v[52:55]
    buffer_load_dwordx4 v11, s[12:15], s41 offen offset:2048 sc1 lds
    v_mfma_f32_16x16x32_bf16 v[48:51], a[56:59], a[36:39], v[48:51]
    v_mfma_f32_16x16x32_bf16 v[48:51], a[20:23], a[0:3], v[48:51]
    s_waitcnt vmcnt(12) lgkmcnt(0)
    s_barrier
    v_mfma_f32_16x16x32_bf16 v[64:67], a[24:27], a[0:3], v[64:67]
    v_add_u32 v6, 73728, v2
    v_add_u32 v9, 73728, v3
    v_mfma_f32_16x16x32_bf16 v[64:67], a[60:63], a[36:39], v[64:67]
    buffer_load_dwordx4 v11, s[12:15], s41 offen offset:3072 sc1 lds
    v_mfma_f32_16x16x32_bf16 v[68:71], a[60:63], a[40:43], v[68:71]
    v_mfma_f32_16x16x32_bf16 v[68:71], a[24:27], a[4:7], v[68:71]
    s_add_u32 m0, s20, 8192
    ds_read_b128 a[96:99], v6 offset:0
    v_mfma_f32_16x16x32_bf16 v[72:75], a[24:27], a[8:11], v[72:75]
    s_add_u32 s41, s41, 4096
    v_mfma_f32_16x16x32_bf16 v[72:75], a[60:63], a[44:47], v[72:75]
    v_mfma_f32_16x16x32_bf16 v[76:79], a[60:63], a[48:51], v[76:79]
    buffer_load_dwordx4 v11, s[12:15], s41 offen sc1 lds
    v_mfma_f32_16x16x32_bf16 v[76:79], a[24:27], a[12:15], v[76:79]
    s_lshl_b32 s40, s40, 17
    s_add_u32 s40, s40, s60
    v_mfma_f32_16x16x32_bf16 v[92:95], a[28:31], a[12:15], v[92:95]
    ds_read_b128 a[132:135], v6 offset:18432
    ds_read_b128 a[100:103], v6 offset:1024
    v_mfma_f32_16x16x32_bf16 v[92:95], a[64:67], a[48:51], v[92:95]
    s_add_u32 m0, s20, 0
    v_mfma_f32_16x16x32_bf16 v[88:91], a[64:67], a[44:47], v[88:91]
    buffer_load_dwordx4 v11, s[8:11], s40 offen offset:0 sc1 lds
    v_mfma_f32_16x16x32_bf16 v[88:91], a[28:31], a[8:11], v[88:91]
    ds_read_b128 a[136:139], v6 offset:19456
    ds_read_b128 a[104:107], v6 offset:2048
    v_mfma_f32_16x16x32_bf16 v[84:87], a[28:31], a[4:7], v[84:87]
    ds_read_b128 a[140:143], v6 offset:20480
    ds_read_b128 a[108:111], v6 offset:3072
    v_mfma_f32_16x16x32_bf16 v[84:87], a[64:67], a[40:43], v[84:87]
    v_mfma_f32_16x16x32_bf16 v[80:83], a[64:67], a[36:39], v[80:83]
    buffer_load_dwordx4 v11, s[8:11], s40 offen offset:1024 sc1 lds
    v_mfma_f32_16x16x32_bf16 v[80:83], a[28:31], a[0:3], v[80:83]
    v_mfma_f32_16x16x32_bf16 v[96:99], a[32:35], a[0:3], v[96:99]
    ds_read_b128 a[144:147], v6 offset:21504
    ds_read_b128 a[112:115], v9 offset:0
    v_mfma_f32_16x16x32_bf16 v[96:99], a[68:71], a[36:39], v[96:99]
    ds_read_b128 a[148:151], v9 offset:18432
    ds_read_b128 a[116:119], v9 offset:1024
    v_mfma_f32_16x16x32_bf16 v[100:103], a[68:71], a[40:43], v[100:103]
    buffer_load_dwordx4 v11, s[8:11], s40 offen offset:2048 sc1 lds
    v_mfma_f32_16x16x32_bf16 v[100:103], a[32:35], a[4:7], v[100:103]
    v_mfma_f32_16x16x32_bf16 v[104:107], a[32:35], a[8:11], v[104:107]
    v_mfma_f32_16x16x32_bf16 v[104:107], a[68:71], a[44:47], v[104:107]
    v_mfma_f32_16x16x32_bf16 v[108:111], a[68:71], a[48:51], v[108:111]
    buffer_load_dwordx4 v11, s[8:11], s40 offen offset:3072 sc1 lds
    v_mfma_f32_16x16x32_bf16 v[108:111], a[32:35], a[12:15], v[108:111]
    ds_read_b128 a[152:155], v9 offset:19456
    s_waitcnt lgkmcnt(2)
    v_mfma_f32_16x16x32_bf16 v[32:35], a[112:115], a[96:99], v[32:35]
    ds_read_b128 a[120:123], v9 offset:2048
    ds_read_b128 a[156:159], v9 offset:20480
    v_mfma_f32_16x16x32_bf16 v[32:35], a[148:151], a[132:135], v[32:35]
    s_add_u32 s40, s36, 132
    ds_read_b128 a[124:127], v9 offset:3072
    v_mfma_f32_16x16x32_bf16 v[36:39], a[148:151], a[136:139], v[36:39]
    v_mfma_f32_16x16x32_bf16 v[36:39], a[112:115], a[100:103], v[36:39]
    s_mul_i32 s41, s40, 40960
    s_add_u32 s41, s41, s62
    s_add_u32 m0, s20, 40960
    v_mfma_f32_16x16x32_bf16 v[40:43], a[112:115], a[104:107], v[40:43]
    buffer_load_dwordx4 v11, s[12:15], s41 offen offset:0 sc1 lds
    v_mfma_f32_16x16x32_bf16 v[40:43], a[148:151], a[140:143], v[40:43]
    v_mfma_f32_16x16x32_bf16 v[44:47], a[148:151], a[144:147], v[44:47]
    v_mfma_f32_16x16x32_bf16 v[44:47], a[112:115], a[108:111], v[44:47]
    s_waitcnt lgkmcnt(3)
    v_mfma_f32_16x16x32_bf16 v[60:63], a[116:119], a[108:111], v[60:63]
    buffer_load_dwordx4 v11, s[12:15], s41 offen offset:1024 sc1 lds
    v_mfma_f32_16x16x32_bf16 v[60:63], a[152:155], a[144:147], v[60:63]
    ds_read_b128 a[160:163], v9 offset:21504
    v_mfma_f32_16x16x32_bf16 v[56:59], a[152:155], a[140:143], v[56:59]
    ds_read_b128 a[128:131], v9 offset:4096
    v_mfma_f32_16x16x32_bf16 v[56:59], a[116:119], a[104:107], v[56:59]
    ds_read_b128 a[164:167], v9 offset:22528
    v_mfma_f32_16x16x32_bf16 v[52:55], a[116:119], a[100:103], v[52:55]
    v_mfma_f32_16x16x32_bf16 v[52:55], a[152:155], a[136:139], v[52:55]
    buffer_load_dwordx4 v11, s[12:15], s41 offen offset:2048 sc1 lds
    v_mfma_f32_16x16x32_bf16 v[48:51], a[152:155], a[132:135], v[48:51]
    v_mfma_f32_16x16x32_bf16 v[48:51], a[116:119], a[96:99], v[48:51]
    s_waitcnt vmcnt(12) lgkmcnt(0)
    s_barrier
    v_mfma_f32_16x16x32_bf16 v[64:67], a[120:123], a[96:99], v[64:67]
    v_add_u32 v6, 110592, v2
    v_add_u32 v9, 110592, v3
    v_mfma_f32_16x16x32_bf16 v[64:67], a[156:159], a[132:135], v[64:67]
    buffer_load_dwordx4 v11, s[12:15], s41 offen offset:3072 sc1 lds
    v_mfma_f32_16x16x32_bf16 v[68:71], a[156:159], a[136:139], v[68:71]
    v_mfma_f32_16x16x32_bf16 v[68:71], a[120:123], a[100:103], v[68:71]
    s_add_u32 m0, s20, 45056
    ds_read_b128 a[0:3], v6 offset:0
    v_mfma_f32_16x16x32_bf16 v[72:75], a[120:123], a[104:107], v[72:75]
    s_add_u32 s41, s41, 4096
    v_mfma_f32_16x16x32_bf16 v[72:75], a[156:159], a[140:143], v[72:75]
    v_mfma_f32_16x16x32_bf16 v[76:79], a[156:159], a[144:147], v[76:79]
    buffer_load_dwordx4 v11, s[12:15], s41 offen sc1 lds
    v_mfma_f32_16x16x32_bf16 v[76:79], a[120:123], a[108:111], v[76:79]
    s_lshl_b32 s40, s40, 17
    s_add_u32 s40, s40, s60
    v_mfma_f32_16x16x32_bf16 v[92:95], a[124:127], a[108:111], v[92:95]
    ds_read_b128 a[36:39], v6 offset:18432
    ds_read_b128 a[4:7], v6 offset:1024
    v_mfma_f32_16x16x32_bf16 v[92:95], a[160:163], a[144:147], v[92:95]
    s_add_u32 m0, s20, 36864
    v_mfma_f32_16x16x32_bf16 v[88:91], a[160:163], a[140:143], v[88:91]
    buffer_load_dwordx4 v11, s[8:11], s40 offen offset:0 sc1 lds
    v_mfma_f32_16x16x32_bf16 v[88:91], a[124:127], a[104:107], v[88:91]
    ds_read_b128 a[40:43], v6 offset:19456
    ds_read_b128 a[8:11], v6 offset:2048
    v_mfma_f32_16x16x32_bf16 v[84:87], a[124:127], a[100:103], v[84:87]
    ds_read_b128 a[44:47], v6 offset:20480
    ds_read_b128 a[12:15], v6 offset:3072
    v_mfma_f32_16x16x32_bf16 v[84:87], a[160:163], a[136:139], v[84:87]
    v_mfma_f32_16x16x32_bf16 v[80:83], a[160:163], a[132:135], v[80:83]
    buffer_load_dwordx4 v11, s[8:11], s40 offen offset:1024 sc1 lds
    v_mfma_f32_16x16x32_bf16 v[80:83], a[124:127], a[96:99], v[80:83]
    v_mfma_f32_16x16x32_bf16 v[96:99], a[128:131], a[96:99], v[96:99]
    ds_read_b128 a[48:51], v6 offset:21504
    ds_read_b128 a[16:19], v9 offset:0
    v_mfma_f32_16x16x32_bf16 v[96:99], a[164:167], a[132:135], v[96:99]
    ds_read_b128 a[52:55], v9 offset:18432
    ds_read_b128 a[20:23], v9 offset:1024
    v_mfma_f32_16x16x32_bf16 v[100:103], a[164:167], a[136:139], v[100:103]
    buffer_load_dwordx4 v11, s[8:11], s40 offen offset:2048 sc1 lds
    v_mfma_f32_16x16x32_bf16 v[100:103], a[128:131], a[100:103], v[100:103]
    v_mfma_f32_16x16x32_bf16 v[104:107], a[128:131], a[104:107], v[104:107]
    v_mfma_f32_16x16x32_bf16 v[104:107], a[164:167], a[140:143], v[104:107]
    v_mfma_f32_16x16x32_bf16 v[108:111], a[164:167], a[144:147], v[108:111]
    buffer_load_dwordx4 v11, s[8:11], s40 offen offset:3072 sc1 lds
    v_mfma_f32_16x16x32_bf16 v[108:111], a[128:131], a[108:111], v[108:111]
    ds_read_b128 a[56:59], v9 offset:19456
    s_cmp_eq_u32 s36, s76
    s_cbranch_scc1 L_ownE
    s_waitcnt lgkmcnt(2)
    v_mfma_f32_16x16x32_bf16 v[32:35], a[16:19], a[0:3], v[32:35]
    v_mfma_f32_16x16x32_bf16 v[32:35], a[52:55], a[36:39], v[32:35]
    s_mov_b32 s23, 7
    v_mfma_f32_16x16x32_bf16 v[36:39], a[52:55], a[40:43], v[36:39]
    v_mfma_f32_16x16x32_bf16 v[36:39], a[16:19], a[4:7], v[36:39]
    v_mfma_f32_16x16x32_bf16 v[40:43], a[16:19], a[8:11], v[40:43]
    v_mfma_f32_16x16x32_bf16 v[40:43], a[52:55], a[44:47], v[40:43]
    ds_read_b128 a[24:27], v9 offset:2048
    ds_read_b128 a[60:63], v9 offset:20480
    v_mfma_f32_16x16x32_bf16 v[44:47], a[52:55], a[48:51], v[44:47]
    ds_read_b128 a[28:31], v9 offset:3072
    v_mfma_f32_16x16x32_bf16 v[44:47], a[16:19], a[12:15], v[44:47]
    s_waitcnt lgkmcnt(3)
    v_mfma_f32_16x16x32_bf16 v[48:51], a[20:23], a[0:3], v[48:51]
    ds_read_b128 a[64:67], v9 offset:21504
    ds_read_b128 a[32:35], v9 offset:4096
    v_mfma_f32_16x16x32_bf16 v[48:51], a[56:59], a[36:39], v[48:51]
    ds_read_b128 a[68:71], v9 offset:22528
    v_mfma_f32_16x16x32_bf16 v[52:55], a[56:59], a[40:43], v[52:55]
    v_mfma_f32_16x16x32_bf16 v[52:55], a[20:23], a[4:7], v[52:55]
    v_mfma_f32_16x16x32_bf16 v[56:59], a[20:23], a[8:11], v[56:59]
    v_mfma_f32_16x16x32_bf16 v[56:59], a[56:59], a[44:47], v[56:59]
    v_mfma_f32_16x16x32_bf16 v[60:63], a[56:59], a[48:51], v[60:63]
    buffer_load_dword v8, v18, s[28:31], s22 offen sc0 sc1
    v_mfma_f32_16x16x32_bf16 v[60:63], a[20:23], a[12:15], v[60:63]
    s_waitcnt lgkmcnt(4)
    v_mfma_f32_16x16x32_bf16 v[64:67], a[24:27], a[0:3], v[64:67]
    v_mfma_f32_16x16x32_bf16 v[64:67], a[60:63], a[36:39], v[64:67]
    v_cvt_pk_bf16_f32 v32, v32, v33
    v_cvt_pk_bf16_f32 v33, v34, v35
    v_mfma_f32_16x16x32_bf16 v[68:71], a[60:63], a[40:43], v[68:71]
    v_cvt_pk_bf16_f32 v34, v48, v49
    v_cvt_pk_bf16_f32 v35, v50, v51
    v_mfma_f32_16x16x32_bf16 v[68:71], a[24:27], a[4:7], v[68:71]
    s_add_u32 s3, s79, 0
    buffer_store_dwordx4 v[32:35], v11, s[28:31], s3 offen sc1
    v_mfma_f32_16x16x32_bf16 v[72:75], a[24:27], a[8:11], v[72:75]
    v_cvt_pk_bf16_f32 v36, v36, v37
    v_mfma_f32_16x16x32_bf16 v[72:75], a[60:63], a[44:47], v[72:75]
    v_cvt_pk_bf16_f32 v37, v38, v39
    v_cvt_pk_bf16_f32 v38, v52, v53
    v_mfma_f32_16x16x32_bf16 v[76:79], a[60:63], a[48:51], v[76:79]
    v_cvt_pk_bf16_f32 v39, v54, v55
    v_mfma_f32_16x16x32_bf16 v[76:79], a[24:27], a[12:15], v[76:79]
    s_add_u32 s3, s79, 2048
    s_waitcnt lgkmcnt(2)
    v_mfma_f32_16x16x32_bf16 v[80:83], a[28:31], a[0:3], v[80:83]
    buffer_store_dwordx4 v[36:39], v11, s[28:31], s3 offen sc1
    v_mfma_f32_16x16x32_bf16 v[80:83], a[64:67], a[36:39], v[80:83]
    v_cvt_pk_bf16_f32 v40, v40, v41
    v_cvt_pk_bf16_f32 v41, v42, v43
    v_mfma_f32_16x16x32_bf16 v[84:87], a[64:67], a[40:43], v[84:87]
    v_cvt_pk_bf16_f32 v42, v56, v57
    v_cvt_pk_bf16_f32 v43, v58, v59
    v_mfma_f32_16x16x32_bf16 v[84:87], a[28:31], a[4:7], v[84:87]
    s_add_u32 s3, s79, 4096
    v_mfma_f32_16x16x32_bf16 v[88:91], a[28:31], a[8:11], v[88:91]
    buffer_store_dwordx4 v[40:43], v11, s[28:31], s3 offen sc1
    v_mfma_f32_16x16x32_bf16 v[88:91], a[64:67], a[44:47], v[88:91]
    v_cvt_pk_bf16_f32 v44, v44, v45
    v_cvt_pk_bf16_f32 v45, v46, v47
    v_mfma_f32_16x16x32_bf16 v[92:95], a[64:67], a[48:51], v[92:95]
    v_cvt_pk_bf16_f32 v46, v60, v61
    v_cvt_pk_bf16_f32 v47, v62, v63
    v_mfma_f32_16x16x32_bf16 v[92:95], a[28:31], a[12:15], v[92:95]
    s_add_u32 s3, s79, 6144
    s_waitcnt lgkmcnt(0)
    v_mfma_f32_16x16x32_bf16 v[96:99], a[32:35], a[0:3], v[96:99]
    buffer_store_dwordx4 v[44:47], v11, s[28:31], s3 offen sc1
    v_mfma_f32_16x16x32_bf16 v[96:99], a[68:71], a[36:39], v[96:99]
    v_cvt_pk_bf16_f32 v64, v64, v65
    v_cvt_pk_bf16_f32 v65, v66, v67
    v_mfma_f32_16x16x32_bf16 v[100:103], a[68:71], a[40:43], v[100:103]
    v_cvt_pk_bf16_f32 v66, v80, v81
    v_cvt_pk_bf16_f32 v67, v82, v83
    v_mfma_f32_16x16x32_bf16 v[100:103], a[32:35], a[4:7], v[100:103]
    s_add_u32 s3, s79, 1024
    buffer_store_dwordx4 v[64:67], v11, s[28:31], s3 offen sc1
    v_cvt_pk_bf16_f32 v68, v68, v69
    v_cvt_pk_bf16_f32 v69, v70, v71
    v_mfma_f32_16x16x32_bf16 v[104:107], a[32:35], a[8:11], v[104:107]
    v_cvt_pk_bf16_f32 v70, v84, v85
    v_cvt_pk_bf16_f32 v71, v86, v87
    v_mfma_f32_16x16x32_bf16 v[104:107], a[68:71], a[44:47], v[104:107]
    s_add_u32 s3, s79, 3072
    buffer_store_dwordx4 v[68:71], v11, s[28:31], s3 offen sc1
    v_cvt_pk_bf16_f32 v72, v72, v73
    v_cvt_pk_bf16_f32 v73, v74, v75
    v_cvt_pk_bf16_f32 v74, v88, v89
    v_cvt_pk_bf16_f32 v75, v90, v91
    v_mfma_f32_16x16x32_bf16 v[108:111], a[68:71], a[48:51], v[108:111]
    s_add_u32 s3, s79, 5120
    v_mfma_f32_16x16x32_bf16 v[108:111], a[32:35], a[12:15], v[108:111]
    buffer_store_dwordx4 v[72:75], v11, s[28:31], s3 offen sc1
    s_nop 1
    v_cvt_pk_bf16_f32 v76, v76, v77
    v_cvt_pk_bf16_f32 v77, v78, v79
    v_cvt_pk_bf16_f32 v78, v92, v93
    v_cvt_pk_bf16_f32 v79, v94, v95
    s_add_u32 s3, s79, 7168
    buffer_store_dwordx4 v[76:79], v11, s[28:31], s3 offen sc1
    v_cvt_pk_bf16_f32 v96, v96, v97
    v_cvt_pk_bf16_f32 v97, v98, v99
    v_cvt_pk_bf16_f32 v98, v100, v101
    v_cvt_pk_bf16_f32 v99, v102, v103
    s_add_u32 s3, s79, 8192
    buffer_store_dwordx4 v[96:99], v11, s[28:31], s3 offen sc1
    v_cvt_pk_bf16_f32 v104, v104, v105
    v_cvt_pk_bf16_f32 v105, v106, v107
    v_cvt_pk_bf16_f32 v106, v108, v109
    v_cvt_pk_bf16_f32 v107, v110, v111
    s_add_u32 s3, s79, 9216
    buffer_store_dwordx4 v[104:107], v11, s[28:31], s3 offen sc1
    s_waitcnt vmcnt(10) lgkmcnt(0)
    s_branch L_joined
L_ownE:
    s_waitcnt lgkmcnt(2)
    v_mfma_f32_16x16x32_bf16 v[32:35], a[16:19], a[0:3], v[32:35]
    v_mfma_f32_16x16x32_bf16 v[32:35], a[52:55], a[36:39], v[32:35]
    s_mov_b32 s23, 7
    v_mfma_f32_16x16x32_bf16 v[36:39], a[52:55], a[40:43], v[36:39]
    v_mfma_f32_16x16x32_bf16 v[36:39], a[16:19], a[4:7], v[36:39]
    v_mfma_f32_16x16x32_bf16 v[40:43], a[16:19], a[8:11], v[40:43]
    v_mfma_f32_16x16x32_bf16 v[40:43], a[52:55], a[44:47], v[40:43]
    ds_read_b128 a[24:27], v9 offset:2048
    ds_read_b128 a[60:63], v9 offset:20480
    v_mfma_f32_16x16x32_bf16 v[44:47], a[52:55], a[48:51], v[44:47]
    ds_read_b128 a[28:31], v9 offset:3072
    v_mfma_f32_16x16x32_bf16 v[44:47], a[16:19], a[12:15], v[44:47]
    s_waitcnt lgkmcnt(3)
    v_mfma_f32_16x16x32_bf16 v[48:51], a[20:23], a[0:3], v[48:51]
    ds_read_b128 a[64:67], v9 offset:21504
    ds_read_b128 a[32:35], v9 offset:4096
    v_mfma_f32_16x16x32_bf16 v[48:51], a[56:59], a[36:39], v[48:51]
    ds_read_b128 a[68:71], v9 offset:22528
    v_mfma_f32_16x16x32_bf16 v[52:55], a[56:59], a[40:43], v[52:55]
    v_mfma_f32_16x16x32_bf16 v[52:55], a[20:23], a[4:7], v[52:55]
    v_mfma_f32_16x16x32_bf16 v[56:59], a[20:23], a[8:11], v[56:59]
    v_mfma_f32_16x16x32_bf16 v[56:59], a[56:59], a[44:47], v[56:59]
    v_mfma_f32_16x16x32_bf16 v[60:63], a[56:59], a[48:51], v[60:63]
    buffer_load_dword v8, v18, s[28:31], s22 offen sc0 sc1
    v_mfma_f32_16x16x32_bf16 v[60:63], a[20:23], a[12:15], v[60:63]
    s_waitcnt lgkmcnt(4)
    v_mfma_f32_16x16x32_bf16 v[64:67], a[24:27], a[0:3], v[64:67]
    v_mfma_f32_16x16x32_bf16 v[64:67], a[60:63], a[36:39], v[64:67]
    v_cvt_pk_bf16_f32 v32, v32, v33
    v_cvt_pk_bf16_f32 v33, v34, v35
    v_mfma_f32_16x16x32_bf16 v[68:71], a[60:63], a[40:43], v[68:71]
    v_cvt_pk_bf16_f32 v34, v48, v49
    v_cvt_pk_bf16_f32 v35, v50, v51
    v_mfma_f32_16x16x32_bf16 v[68:71], a[24:27], a[4:7], v[68:71]
    s_add_u32 s3, s79, 0
    ds_write_b128 v19, v[32:35] offset:0
    v_mfma_f32_16x16x32_bf16 v[72:75], a[24:27], a[8:11], v[72:75]
    v_cvt_pk_bf16_f32 v36, v36, v37
    v_mfma_f32_16x16x32_bf16 v[72:75], a[60:63], a[44:47], v[72:75]
    v_cvt_pk_bf16_f32 v37, v38, v39
    v_cvt_pk_bf16_f32 v38, v52, v53
    v_mfma_f32_16x16x32_bf16 v[76:79], a[60:63], a[48:51], v[76:79]
    v_cvt_pk_bf16_f32 v39, v54, v55
    v_mfma_f32_16x16x32_bf16 v[76:79], a[24:27], a[12:15], v[76:79]
    s_add_u32 s3, s79, 2048
    s_waitcnt lgkmcnt(3)
    v_mfma_f32_16x16x32_bf16 v[80:83], a[28:31], a[0:3], v[80:83]
    ds_write_b128 v19, v[36:39] offset:2048
    v_mfma_f32_16x16x32_bf16 v[80:83], a[64:67], a[36:39], v[80:83]
    v_cvt_pk_bf16_f32 v40, v40, v41
    v_cvt_pk_bf16_f32 v41, v42, v43
    v_mfma_f32_16x16x32_bf16 v[84:87], a[64:67], a[40:43], v[84:87]
    v_cvt_pk_bf16_f32 v42, v56, v57
    v_cvt_pk_bf16_f32 v43, v58, v59
    v_mfma_f32_16x16x32_bf16 v[84:87], a[28:31], a[4:7], v[84:87]
    s_add_u32 s3, s79, 4096
    v_mfma_f32_16x16x32_bf16 v[88:91], a[28:31], a[8:11], v[88:91]
    ds_write_b128 v19, v[40:43] offset:4096
    v_mfma_f32_16x16x32_bf16 v[88:91], a[64:67], a[44:47], v[88:91]
    v_cvt_pk_bf16_f32 v44, v44, v45
    v_cvt_pk_bf16_f32 v45, v46, v47
    v_mfma_f32_16x16x32_bf16 v[92:95], a[64:67], a[48:51], v[92:95]
    v_cvt_pk_bf16_f32 v46, v60, v61
    v_cvt_pk_bf16_f32 v47, v62, v63
    v_mfma_f32_16x16x32_bf16 v[92:95], a[28:31], a[12:15], v[92:95]
    s_add_u32 s3, s79, 6144
    s_waitcnt lgkmcnt(3)
    v_mfma_f32_16x16x32_bf16 v[96:99], a[32:35], a[0:3], v[96:99]
    ds_write_b128 v19, v[44:47] offset:6144
    v_mfma_f32_16x16x32_bf16 v[96:99], a[68:71], a[36:39], v[96:99]
    v_cvt_pk_bf16_f32 v64, v64, v65
    v_cvt_pk_bf16_f32 v65, v66, v67
    v_mfma_f32_16x16x32_bf16 v[100:103], a[68:71], a[40:43], v[100:103]
    v_cvt_pk_bf16_f32 v66, v80, v81
    v_cvt_pk_bf16_f32 v67, v82, v83
    v_mfma_f32_16x16x32_bf16 v[100:103], a[32:35], a[4:7], v[100:103]
    s_add_u32 s3, s79, 1024
    ds_write_b128 v19, v[64:67] offset:1024
    v_cvt_pk_bf16_f32 v68, v68, v69
    v_cvt_pk_bf16_f32 v69, v70, v71
    v_mfma_f32_16x16x32_bf16 v[104:107], a[32:35], a[8:11], v[104:107]
    v_cvt_pk_bf16_f32 v70, v84, v85
    v_cvt_pk_bf16_f32 v71, v86, v87
    v_mfma_f32_16x16x32_bf16 v[104:107], a[68:71], a[44:47], v[104:107]
    s_add_u32 s3, s79, 3072
    ds_write_b128 v19, v[68:71] offset:3072
    v_cvt_pk_bf16_f32 v72, v72, v73
    v_cvt_pk_bf16_f32 v73, v74, v75
    v_cvt_pk_bf16_f32 v74, v88, v89
    v_cvt_pk_bf16_f32 v75, v90, v91
    v_mfma_f32_16x16x32_bf16 v[108:111], a[68:71], a[48:51], v[108:111]
    s_add_u32 s3, s79, 5120
    v_mfma_f32_16x16x32_bf16 v[108:111], a[32:35], a[12:15], v[108:111]
    ds_write_b128 v19, v[72:75] offset:5120
    s_nop 1
    v_cvt_pk_bf16_f32 v76, v76, v77
    v_cvt_pk_bf16_f32 v77, v78, v79
    v_cvt_pk_bf16_f32 v78, v92, v93
    v_cvt_pk_bf16_f32 v79, v94, v95
    ds_write_b128 v19, v[76:79] offset:7168
    v_cvt_pk_bf16_f32 v96, v96, v97
    v_cvt_pk_bf16_f32 v97, v98, v99
    v_cvt_pk_bf16_f32 v98, v100, v101
    v_cvt_pk_bf16_f32 v99, v102, v103
    ds_write_b128 v19, v[96:99] offset:8192
    v_cvt_pk_bf16_f32 v104, v104, v105
    v_cvt_pk_bf16_f32 v105, v106, v107
    v_cvt_pk_bf16_f32 v106, v108, v109
    v_cvt_pk_bf16_f32 v107, v110, v111
    ds_write_b128 v19, v[104:107] offset:9216
    s_waitcnt vmcnt(0) lgkmcnt(0)
    s_branch L_joined
L_outO:
    s_waitcnt lgkmcnt(8)
    v_mfma_f32_16x16x32_bf16 v[32:35], a[112:115], a[96:99], 0
    s_add_u32 s40, s25, 6
    v_mfma_f32_16x16x32_bf16 v[32:35], a[148:151], a[132:135], v[32:35]
    s_mul_i32 s41, s40, 40960
    s_add_u32 s41, s41, s17
    v_mfma_f32_16x16x32_bf16 v[36:39], a[148:151], a[136:139], 0
    s_add_u32 m0, s20, 114688
    v_mfma_f32_16x16x32_bf16 v[36:39], a[112:115], a[100:103], v[36:39]
    buffer_load_dwordx4 v11, s[12:15], s41 offen offset:0 sc1 lds
    v_mfma_f32_16x16x32_bf16 v[40:43], a[112:115], a[104:107], 0
    v_mfma_f32_16x16x32_bf16 v[40:43], a[148:151], a[140:143], v[40:43]
    v_mfma_f32_16x16x32_bf16 v[44:47], a[148:151], a[144:147], 0
    buffer_load_dwordx4 v11, s[12:15], s41 offen offset:1024 sc1 lds
    v_mfma_f32_16x16x32_bf16 v[44:47], a[112:115], a[108:111], v[44:47]
    s_waitcnt lgkmcnt(6)
    v_mfma_f32_16x16x32_bf16 v[60:63], a[116:119], a[108:111], 0
    v_mfma_f32_16x16x32_bf16 v[60:63], a[152:155], a[144:147], v[60:63]
    v_mfma_f32_16x16x32_bf16 v[56:59], a[152:155], a[140:143], 0
    buffer_load_dwordx4 v11, s[12:15], s41 offen offset:2048 sc1 lds
    v_mfma_f32_16x16x32_bf16 v[56:59], a[116:119], a[104:107], v[56:59]
    v_mfma_f32_16x16x32_bf16 v[52:55], a[116:119], a[100:103], 0
    v_mfma_f32_16x16x32_bf16 v[52:55], a[152:155], a[136:139], v[52:55]
    v_mfma_f32_16x16x32_bf16 v[48:51], a[152:155], a[132:135], 0
    buffer_load_dwordx4 v11, s[12:15], s41 offen offset:3072 sc1 lds
    v_mfma_f32_16x16x32_bf16 v[48:51], a[116:119], a[96:99], v[48:51]
    s_waitcnt vmcnt(21) lgkmcnt(0)
    s_barrier
    v_mfma_f32_16x16x32_bf16 v[64:67], a[120:123], a[96:99], 0
    s_add_u32 m0, s20, 118784
    v_add_u32 v6, 36864, v2
    v_mfma_f32_16x16x32_bf16 v[64:67], a[156:159], a[132:135], v[64:67]
    buffer_load_dword v4, v13, s[28:31], s21 offen sc0 sc1
    v_mfma_f32_16x16x32_bf16 v[68:71], a[156:159], a[136:139], 0
    s_add_u32 s41, s41, 4096
    v_add_u32 v9, 36864, v3
    v_mfma_f32_16x16x32_bf16 v[68:71], a[120:123], a[100:103], v[68:71]
    ds_read_b128 a[0:3], v6 offset:0
    v_mfma_f32_16x16x32_bf16 v[72:75], a[120:123], a[104:107], 0
    ds_read_b128 a[36:39], v6 offset:18432
    ds_read_b128 a[4:7], v6 offset:1024
    v_mfma_f32_16x16x32_bf16 v[72:75], a[156:159], a[140:143], v[72:75]
    buffer_load_dwordx4 v11, s[12:15], s41 offen sc1 lds
    v_mfma_f32_16x16x32_bf16 v[76:79], a[156:159], a[144:147], 0
    ds_read_b128 a[40:43], v6 offset:19456
    ds_read_b128 a[8:11], v6 offset:2048
    v_mfma_f32_16x16x32_bf16 v[76:79], a[120:123], a[108:111], v[76:79]
    v_mfma_f32_16x16x32_bf16 v[92:95], a[124:127], a[108:111], 0
    s_lshl_b32 s40, s40, 17
    s_add_u32 s40, s40, s16
    s_add_u32 m0, s20, 110592
    v_mfma_f32_16x16x32_bf16 v[92:95], a[160:163], a[144:147], v[92:95]
    ds_read_b128 a[44:47], v6 offset:20480
    v_mfma_f32_16x16x32_bf16 v[88:91], a[160:163], a[140:143], 0
    buffer_load_dwordx4 v11, s[8:11], s40 offen offset:0 sc1 lds
    v_mfma_f32_16x16x32_bf16 v[88:91], a[124:127], a[104:107], v[88:91]
    ds_read_b128 a[12:15], v6 offset:3072
    ds_read_b128 a[48:51], v6 offset:21504
    v_mfma_f32_16x16x32_bf16 v[84:87], a[124:127], a[100:103], 0
    v_mfma_f32_16x16x32_bf16 v[84:87], a[160:163], a[136:139], v[84:87]
    v_mfma_f32_16x16x32_bf16 v[80:83], a[160:163], a[132:135], 0
    buffer_load_dwordx4 v11, s[8:11], s40 offen offset:1024 sc1 lds
    v_mfma_f32_16x16x32_bf16 v[80:83], a[124:127], a[96:99], v[80:83]
    v_mfma_f32_16x16x32_bf16 v[96:99], a[128:131], a[96:99], 0
    v_mfma_f32_16x16x32_bf16 v[96:99], a[164:167], a[132:135], v[96:99]
    ds_read_b128 a[16:19], v9 offset:0
    ds_read_b128 a[52:55], v9 offset:18432
    v_mfma_f32_16x16x32_bf16 v[100:103], a[164:167], a[136:139], 0
    buffer_load_dwordx4 v11, s[8:11], s40 offen offset:2048 sc1 lds
    v_mfma_f32_16x16x32_bf16 v[100:103], a[128:131], a[100:103], v[100:103]
    v_mfma_f32_16x16x32_bf16 v[104:107], a[128:131], a[104:107], 0
    v_mfma_f32_16x16x32_bf16 v[104:107], a[164:167], a[140:143], v[104:107]
    ds_read_b128 a[20:23], v9 offset:1024
    ds_read_b128 a[56:59], v9 offset:19456
    v_mfma_f32_16x16x32_bf16 v[108:111], a[164:167], a[144:147], 0
    buffer_load_dwordx4 v11, s[8:11], s40 offen offset:3072 sc1 lds
    v_mfma_f32_16x16x32_bf16 v[108:111], a[128:131], a[108:111], v[108:111]
    s_waitcnt lgkmcnt(2)
    v_mfma_f32_16x16x32_bf16 v[32:35], a[16:19], a[0:3], v[32:35]
    s_xor_b32 s40, s19, 0
    ds_read_b128 a[24:27], v9 offset:2048
    v_mfma_f32_16x16x32_bf16 v[32:35], a[52:55], a[36:39], v[32:35]
    s_mul_i32 s41, s40, 40960
    s_add_u32 s41, s41, s17
    s_add_u32 m0, s20, 4096
    v_mfma_f32_16x16x32_bf16 v[36:39], a[52:55], a[40:43], v[36:39]
    ds_read_b128 a[60:63], v9 offset:20480
    v_mfma_f32_16x16x32_bf16 v[36:39], a[16:19], a[4:7], v[36:39]
    buffer_load_dwordx4 v11, s[12:15], s41 offen offset:0 sc1 lds
    v_mfma_f32_16x16x32_bf16 v[40:43], a[16:19], a[8:11], v[40:43]
    ds_read_b128 a[28:31], v9 offset:3072
    ds_read_b128 a[64:67], v9 offset:21504
    v_mfma_f32_16x16x32_bf16 v[40:43], a[52:55], a[44:47], v[40:43]
    buffer_load_dwordx4 v11, s[12:15], s41 offen offset:1024 sc1 lds
    v_mfma_f32_16x16x32_bf16 v[44:47], a[52:55], a[48:51], v[44:47]
    ds_read_b128 a[32:35], v9 offset:4096
    ds_read_b128 a[68:71], v9 offset:22528
    v_mfma_f32_16x16x32_bf16 v[44:47], a[16:19], a[12:15], v[44:47]
    s_waitcnt lgkmcnt(6)
    v_mfma_f32_16x16x32_bf16 v[60:63], a[20:23], a[12:15], v[60:63]
    v_mfma_f32_16x16x32_bf16 v[60:63], a[56:59], a[48:51], v[60:63]
    buffer_load_dwordx4 v11, s[12:15], s41 offen offset:2048 sc1 lds
    v_mfma_f32_16x16x32_bf16 v[56:59], a[56:59], a[44:47], v[56:59]
    v_mfma_f32_16x16x32_bf16 v[56:59], a[20:23], a[8:11], v[56:59]
    v_mfma_f32_16x16x32_bf16 v[52:55], a[20:23], a[4:7], v[52:55]
    v_mfma_f32_16x16x32_bf16 v[52:55], a[56:59], a[40:43], v[52:55]
    buffer_load_dwordx4 v11, s[12:15], s41 offen offset:3072 sc1 lds
    v_mfma_f32_16x16x32_bf16 v[48:51], a[56:59], a[36:39], v[48:51]
    s_add_u32 m0, s20, 8192
    v_mfma_f32_16x16x32_bf16 v[48:51], a[20:23], a[0:3], v[48:51]
    s_waitcnt vmcnt(9) lgkmcnt(0)
    s_barrier
    v_mfma_f32_16x16x32_bf16 v[64:67], a[24:27], a[0:3], v[64:67]
    buffer_store_dword v7, v0, s[28:31], s67 offen sc1
    v_cmp_ne_u32 vcc, 1, v4
    s_nop 0
    s_cmp_eq_u64 vcc, 0
    s_cbranch_scc1 L_cwO1_ok
L_cwO1_no:
    s_mov_b32 s51, 0x40000
L_cwO1_spin:
    buffer_load_dword v4, v13, s[28:31], s21 offen sc0 sc1
    s_waitcnt vmcnt(0)
    v_cmp_ne_u32 vcc, 1, v4
    s_nop 0
    s_cmp_eq_u64 vcc, 0
    s_cbranch_scc1 L_cwO1_ok
L_cwO1_again:
    s_sleep 4
    s_sub_u32 s51, s51, 1
    s_cmp_lg_u32 s51, 0
    s_cbranch_scc1 L_cwO1_spin
L_cwO1_ok:
    v_mfma_f32_16x16x32_bf16 v[64:67], a[60:63], a[36:39], v[64:67]
    v_add_u32 v6, 73728, v2
    v_mfma_f32_16x16x32_bf16 v[68:71], a[60:63], a[40:43], v[68:71]
    v_mfma_f32_16x16x32_bf16 v[68:71], a[24:27], a[4:7], v[68:71]
    s_add_u32 s41, s41, 4096
    v_add_u32 v9, 73728, v3
    v_mfma_f32_16x16x32_bf16 v[72:75], a[24:27], a[8:11], v[72:75]
    ds_read_b128 a[96:99], v6 offset:0
    v_mfma_f32_16x16x32_bf16 v[72:75], a[60:63], a[44:47], v[72:75]
    buffer_load_dwordx4 v11, s[12:15], s41 offen sc1 lds
    v_mfma_f32_16x16x32_bf16 v[76:79], a[60:63], a[48:51], v[76:79]
    s_lshl_b32 s40, s40, 17
    s_add_u32 s40, s40, s16
    s_add_u32 m0, s20, 0
    v_mfma_f32_16x16x32_bf16 v[76:79], a[24:27], a[12:15], v[76:79]
    ds_read_b128 a[132:135], v6 offset:18432
    v_mfma_f32_16x16x32_bf16 v[92:95], a[28:31], a[12:15], v[92:95]
    ds_read_b128 a[100:103], v6 offset:1024
    v_mfma_f32_16x16x32_bf16 v[92:95], a[64:67], a[48:51], v[92:95]
    buffer_load_dwordx4 v11, s[8:11], s40 offen offset:0 sc1 lds
    v_mfma_f32_16x16x32_bf16 v[88:91], a[64:67], a[44:47], v[88:91]
    v_mfma_f32_16x16x32_bf16 v[88:91], a[28:31], a[8:11], v[88:91]
    v_mfma_f32_16x16x32_bf16 v[84:87], a[28:31], a[4:7], v[84:87]
    v_mfma_f32_16x16x32_bf16 v[84:87], a[64:67], a[40:43], v[84:87]
    ds_read_b128 a[136:139], v6 offset:19456
    ds_read_b128 a[104:107], v6 offset:2048
    v_mfma_f32_16x16x32_bf16 v[80:83], a[64:67], a[36:39], v[80:83]
    buffer_load_dwordx4 v11, s[8:11], s40 offen offset:1024 sc1 lds
    v_mfma_f32_16x16x32_bf16 v[80:83], a[28:31], a[0:3], v[80:83]
    ds_read_b128 a[140:143], v6 offset:20480
    v_mfma_f32_16x16x32_bf16 v[96:99], a[32:35], a[0:3], v[96:99]
    ds_read_b128 a[108:111], v6 offset:3072
    v_mfma_f32_16x16x32_bf16 v[96:99], a[68:71], a[36:39], v[96:99]
    v_mfma_f32_16x16x32_bf16 v[100:103], a[68:71], a[40:43], v[100:103]
    buffer_load_dwordx4 v11, s[8:11], s40 offen offset:2048 sc1 lds
    v_mfma_f32_16x16x32_bf16 v[100:103], a[32:35], a[4:7], v[100:103]
    ds_read_b128 a[144:147], v6 offset:21504
    v_mfma_f32_16x16x32_bf16 v[104:107], a[32:35], a[8:11], v[104:107]
    ds_read_b128 a[112:115], v9 offset:0
    ds_read_b128 a[148:151], v9 offset:18432
    v_mfma_f32_16x16x32_bf16 v[104:107], a[68:71], a[44:47], v[104:107]
    ds_read_b128 a[116:119], v9 offset:1024
    ds_read_b128 a[152:155], v9 offset:19456
    v_mfma_f32_16x16x32_bf16 v[108:111], a[68:71], a[48:51], v[108:111]
    buffer_load_dwordx4 v11, s[8:11], s40 offen offset:3072 sc1 lds
    v_mfma_f32_16x16x32_bf16 v[108:111], a[32:35], a[12:15], v[108:111]
    s_waitcnt lgkmcnt(2)
    v_mfma_f32_16x16x32_bf16 v[32:35], a[112:115], a[96:99], v[32:35]
    ds_read_b128 a[120:123], v9 offset:2048
    ds_read_b128 a[156:159], v9 offset:20480
    v_mfma_f32_16x16x32_bf16 v[32:35], a[148:151], a[132:135], v[32:35]
    s_xor_b32 s40, s19, 2
    ds_read_b128 a[124:127], v9 offset:3072
    v_mfma_f32_16x16x32_bf16 v[36:39], a[148:151], a[136:139], v[36:39]
    v_mfma_f32_16x16x32_bf16 v[36:39], a[112:115], a[100:103], v[36:39]
    s_mul_i32 s41, s40, 40960
    s_add_u32 s41, s41, s17
    s_add_u32 m0, s20, 40960
    v_mfma_f32_16x16x32_bf16 v[40:43], a[112:115], a[104:107], v[40:43]
    buffer_load_dwordx4 v11, s[12:15], s41 offen offset:0 sc1 lds
    v_mfma_f32_16x16x32_bf16 v[40:43], a[148:151], a[140:143], v[40:43]
    v_mfma_f32_16x16x32_bf16 v[44:47], a[148:151], a[144:147], v[44:47]
    v_mfma_f32_16x16x32_bf16 v[44:47], a[112:115], a[108:111], v[44:47]
    s_waitcnt lgkmcnt(3)
    v_mfma_f32_16x16x32_bf16 v[60:63], a[116:119], a[108:111], v[60:63]
    buffer_load_dwordx4 v11, s[12:15], s41 offen offset:1024 sc1 lds
    v_mfma_f32_16x16x32_bf16 v[60:63], a[152:155], a[144:147], v[60:63]
    ds_read_b128 a[160:163], v9 offset:21504
    v_mfma_f32_16x16x32_bf16 v[56:59], a[152:155], a[140:143], v[56:59]
    ds_read_b128 a[128:131], v9 offset:4096
    v_mfma_f32_16x16x32_bf16 v[56:59], a[116:119], a[104:107], v[56:59]
    ds_read_b128 a[164:167], v9 offset:22528
    v_mfma_f32_16x16x32_bf16 v[52:55], a[116:119], a[100:103], v[52:55]
    v_mfma_f32_16x16x32_bf16 v[52:55], a[152:155], a[136:139], v[52:55]
    buffer_load_dwordx4 v11, s[12:15], s41 offen offset:2048 sc1 lds
    v_mfma_f32_16x16x32_bf16 v[48:51], a[152:155], a[132:135], v[48:51]
    v_mfma_f32_16x16x32_bf16 v[48:51], a[116:119], a[96:99], v[48:51]
    s_waitcnt vmcnt(13) lgkmcnt(0)
    s_barrier
    v_mfma_f32_16x16x32_bf16 v[64:67], a[120:123], a[96:99], v[64:67]
    v_add_u32 v6, 110592, v2
    v_add_u32 v9, 110592, v3
    v_mfma_f32_16x16x32_bf16 v[64:67], a[156:159], a[132:135], v[64:67]
    buffer_load_dwordx4 v11, s[12:15], s41 offen offset:3072 sc1 lds
    v_mfma_f32_16x16x32_bf16 v[68:71], a[156:159], a[136:139], v[68:71]
    v_mfma_f32_16x16x32_bf16 v[68:71], a[120:123], a[100:103], v[68:71]
    s_add_u32 m0, s20, 45056
    ds_read_b128 a[0:3], v6 offset:0
    v_mfma_f32_16x16x32_bf16 v[72:75], a[120:123], a[104:107], v[72:75]
    s_add_u32 s41, s41, 4096
    v_mfma_f32_16x16x32_bf16 v[72:75], a[156:159], a[140:143], v[72:75]
    v_mfma_f32_16x16x32_bf16 v[76:79], a[156:159], a[144:147], v[76:79]
    buffer_load_dwordx4 v11, s[12:15], s41 offen sc1 lds
    v_mfma_f32_16x16x32_bf16 v[76:79], a[120:123], a[108:111], v[76:79]
    s_lshl_b32 s40, s40, 17
    s_add_u32 s40, s40, s16
    v_mfma_f32_16x16x32_bf16 v[92:95], a[124:127], a[108:111], v[92:95]
    ds_read_b128 a[36:39], v6 offset:18432
    ds_read_b128 a[4:7], v6 offset:1024
    v_mfma_f32_16x16x32_bf16 v[92:95], a[160:163], a[144:147], v[92:95]
    s_add_u32 m0, s20, 36864
    v_mfma_f32_16x16x32_bf16 v[88:91], a[160:163], a[140:143], v[88:91]
    buffer_load_dwordx4 v11, s[8:11], s40 offen offset:0 sc1 lds
    v_mfma_f32_16x16x32_bf16 v[88:91], a[124:127], a[104:107], v[88:91]
    ds_read_b128 a[40:43], v6 offset:19456
    ds_read_b128 a[8:11], v6 offset:2048
    v_mfma_f32_16x16x32_bf16 v[84:87], a[124:127], a[100:103], v[84:87]
    ds_read_b128 a[44:47], v6 offset:20480
    ds_read_b128 a[12:15], v6 offset:3072
    v_mfma_f32_16x16x32_bf16 v[84:87], a[160:163], a[136:139], v[84:87]
    v_mfma_f32_16x16x32_bf16 v[80:83], a[160:163], a[132:135], v[80:83]
    buffer_load_dwordx4 v11, s[8:11], s40 offen offset:1024 sc1 lds
    v_mfma_f32_16x16x32_bf16 v[80:83], a[124:127], a[96:99], v[80:83]
    v_mfma_f32_16x16x32_bf16 v[96:99], a[128:131], a[96:99], v[96:99]
    ds_read_b128 a[48:51], v6 offset:21504
    ds_read_b128 a[16:19], v9 offset:0
    v_mfma_f32_16x16x32_bf16 v[96:99], a[164:167], a[132:135], v[96:99]
    ds_read_b128 a[52:55], v9 offset:18432
    ds_read_b128 a[20:23], v9 offset:1024
    v_mfma_f32_16x16x32_bf16 v[100:103], a[164:167], a[136:139], v[100:103]
    buffer_load_dwordx4 v11, s[8:11], s40 offen offset:2048 sc1 lds
    v_mfma_f32_16x16x32_bf16 v[100:103], a[128:131], a[100:103], v[100:103]
    v_mfma_f32_16x16x32_bf16 v[104:107], a[128:131], a[104:107], v[104:107]
    v_mfma_f32_16x16x32_bf16 v[104:107], a[164:167], a[140:143], v[104:107]
    v_mfma_f32_16x16x32_bf16 v[108:111], a[164:167], a[144:147], v[108:111]
    buffer_load_dwordx4 v11, s[8:11], s40 offen offset:3072 sc1 lds
    v_mfma_f32_16x16x32_bf16 v[108:111], a[128:131], a[108:111], v[108:111]
    ds_read_b128 a[56:59], v9 offset:19456
    s_waitcnt lgkmcnt(2)
    v_mfma_f32_16x16x32_bf16 v[32:35], a[16:19], a[0:3], v[32:35]
    v_mfma_f32_16x16x32_bf16 v[32:35], a[52:55], a[36:39], v[32:35]
    s_xor_b32 s40, s19, 4
    s_mul_i32 s41, s40, 40960
    s_add_u32 s41, s41, s17
    v_mfma_f32_16x16x32_bf16 v[36:39], a[52:55], a[40:43], v[36:39]
    s_lshl_b32 s0, s77, 2
    ds_read_b128 a[24:27], v9 offset:2048
    v_mfma_f32_16x16x32_bf16 v[36:39], a[16:19], a[4:7], v[36:39]
    s_add_u32 m0, s20, 77824
    s_add_u32 s0, s0, s78
    s_lshl_b32 s0, s0, 2
    v_mfma_f32_16x16x32_bf16 v[40:43], a[16:19], a[8:11], v[40:43]
    ds_read_b128 a[60:63], v9 offset:20480
    ds_read_b128 a[28:31], v9 offset:3072
    v_mfma_f32_16x16x32_bf16 v[40:43], a[52:55], a[44:47], v[40:43]
    s_add_u32 s0, s0, s76
    s_mul_i32 s0, s0, 40960
    s_add_u32 s22, s0, 69206016
    v_mfma_f32_16x16x32_bf16 v[44:47], a[52:55], a[48:51], v[44:47]
    buffer_load_dwordx4 v11, s[12:15], s41 offen offset:0 sc1 lds
    v_mfma_f32_16x16x32_bf16 v[44:47], a[16:19], a[12:15], v[44:47]
    s_lshl_b32 s39, s36, 11
    s_lshr_b32 s101, s36, 1
    s_waitcnt lgkmcnt(3)
    v_mfma_f32_16x16x32_bf16 v[60:63], a[20:23], a[12:15], v[60:63]
    ds_read_b128 a[64:67], v9 offset:21504
    ds_read_b128 a[32:35], v9 offset:4096
    v_mfma_f32_16x16x32_bf16 v[60:63], a[56:59], a[48:51], v[60:63]
    s_lshl_b32 s101, s101, 10
    ds_read_b128 a[68:71], v9 offset:22528
    v_mfma_f32_16x16x32_bf16 v[56:59], a[56:59], a[44:47], v[56:59]
    buffer_load_dwordx4 v11, s[12:15], s41 offen offset:1024 sc1 lds
    v_mfma_f32_16x16x32_bf16 v[56:59], a[20:23], a[8:11], v[56:59]
    s_add_u32 s101, s101, 8192
    v_add_u32 v19, 147456, v11
    v_add_u32 v22, s39, v19
    v_mfma_f32_16x16x32_bf16 v[52:55], a[20:23], a[4:7], v[52:55]
    v_add_u32 v23, s101, v19
    v_mfma_f32_16x16x32_bf16 v[52:55], a[56:59], a[40:43], v[52:55]
    s_add_u32 s0, s76, 1
    s_and_b32 s0, s0, 3
    v_mfma_f32_16x16x32_bf16 v[48:51], a[56:59], a[36:39], v[48:51]
    buffer_load_dwordx4 v11, s[12:15], s41 offen offset:2048 sc1 lds
    v_mfma_f32_16x16x32_bf16 v[48:51], a[20:23], a[0:3], v[48:51]
    s_waitcnt vmcnt(12) lgkmcnt(0)
    s_barrier
    v_mfma_f32_16x16x32_bf16 v[64:67], a[24:27], a[0:3], v[64:67]
    s_mul_i32 s0, s0, 10240
    v_add_u32 v6, 0, v2
    v_add_u32 v9, 0, v3
    v_mfma_f32_16x16x32_bf16 v[64:67], a[60:63], a[36:39], v[64:67]
    s_add_u32 s0, s0, s22
    s_add_u32 s44, s0, s39
    v_mfma_f32_16x16x32_bf16 v[68:71], a[60:63], a[40:43], v[68:71]
    buffer_load_dwordx4 v11, s[12:15], s41 offen offset:3072 sc1 lds
    v_mfma_f32_16x16x32_bf16 v[68:71], a[24:27], a[4:7], v[68:71]
    s_add_u32 m0, s20, 81920
    ds_read_b128 a[96:99], v6 offset:0
    v_mfma_f32_16x16x32_bf16 v[72:75], a[24:27], a[8:11], v[72:75]
    s_add_u32 s47, s0, s101
    ds_read_b128 a[132:135], v6 offset:18432
    v_mfma_f32_16x16x32_bf16 v[72:75], a[60:63], a[44:47], v[72:75]
    s_add_u32 s41, s41, 4096
    s_add_u32 s0, s76, 2
    s_and_b32 s0, s0, 3
    v_mfma_f32_16x16x32_bf16 v[76:79], a[60:63], a[48:51], v[76:79]
    buffer_load_dwordx4 v11, s[12:15], s41 offen sc1 lds
    v_mfma_f32_16x16x32_bf16 v[76:79], a[24:27], a[12:15], v[76:79]
    s_lshl_b32 s40, s40, 17
    s_add_u32 s40, s40, s16
    v_mfma_f32_16x16x32_bf16 v[92:95], a[28:31], a[12:15], v[92:95]
    s_add_u32 m0, s20, 73728
    s_mul_i32 s0, s0, 10240
    v_mfma_f32_16x16x32_bf16 v[92:95], a[64:67], a[48:51], v[92:95]
    s_add_u32 s0, s0, s22
    s_add_u32 s45, s0, s39
    s_add_u32 s48, s0, s101
    v_mfma_f32_16x16x32_bf16 v[88:91], a[64:67], a[44:47], v[88:91]
    s_add_u32 s0, s76, 3
    ds_read_b128 a[100:103], v6 offset:1024
    v_mfma_f32_16x16x32_bf16 v[88:91], a[28:31], a[8:11], v[88:91]
    buffer_load_dwordx4 v11, s[8:11], s40 offen offset:0 sc1 lds
    v_mfma_f32_16x16x32_bf16 v[84:87], a[28:31], a[4:7], v[84:87]
    s_and_b32 s0, s0, 3
    s_mul_i32 s0, s0, 10240
    s_add_u32 s0, s0, s22
    v_mfma_f32_16x16x32_bf16 v[84:87], a[64:67], a[40:43], v[84:87]
    s_add_u32 s46, s0, s39
    ds_read_b128 a[136:139], v6 offset:19456
    v_mfma_f32_16x16x32_bf16 v[80:83], a[64:67], a[36:39], v[80:83]
    v_mfma_f32_16x16x32_bf16 v[80:83], a[28:31], a[0:3], v[80:83]
    s_add_u32 s49, s0, s101
    v_mfma_f32_16x16x32_bf16 v[96:99], a[32:35], a[0:3], v[96:99]
    buffer_load_dwordx4 v11, s[8:11], s40 offen offset:1024 sc1 lds
    v_mfma_f32_16x16x32_bf16 v[96:99], a[68:71], a[36:39], v[96:99]
    ds_read_b128 a[104:107], v6 offset:2048
    ds_read_b128 a[140:143], v6 offset:20480
    v_mfma_f32_16x16x32_bf16 v[100:103], a[68:71], a[40:43], v[100:103]
    ds_read_b128 a[108:111], v6 offset:3072
    ds_read_b128 a[144:147], v6 offset:21504
    v_mfma_f32_16x16x32_bf16 v[100:103], a[32:35], a[4:7], v[100:103]
    buffer_load_dwordx4 v11, s[8:11], s40 offen offset:2048 sc1 lds
    v_mfma_f32_16x16x32_bf16 v[104:107], a[32:35], a[8:11], v[104:107]
    ds_read_b128 a[112:115], v9 offset:0
    ds_read_b128 a[148:151], v9 offset:18432
    v_mfma_f32_16x16x32_bf16 v[104:107], a[68:71], a[44:47], v[104:107]
    ds_read_b128 a[116:119], v9 offset:1024
    ds_read_b128 a[152:155], v9 offset:19456
    v_mfma_f32_16x16x32_bf16 v[108:111], a[68:71], a[48:51], v[108:111]
    buffer_load_dwordx4 v11, s[8:11], s40 offen offset:3072 sc1 lds
    v_mfma_f32_16x16x32_bf16 v[108:111], a[32:35], a[12:15], v[108:111]
    s_waitcnt lgkmcnt(2)
    v_mfma_f32_16x16x32_bf16 v[32:35], a[112:115], a[96:99], v[32:35]
    ds_read_b128 a[120:123], v9 offset:2048
    ds_read_b128 a[156:159], v9 offset:20480
    v_mfma_f32_16x16x32_bf16 v[32:35], a[148:151], a[132:135], v[32:35]
    s_xor_b32 s40, s19, 6
    ds_read_b128 a[124:127], v9 offset:3072
    v_mfma_f32_16x16x32_bf16 v[36:39], a[148:151], a[136:139], v[36:39]
    v_mfma_f32_16x16x32_bf16 v[36:39], a[112:115], a[100:103], v[36:39]
    s_mul_i32 s41, s40, 40960
    s_add_u32 s41, s41, s17
    s_add_u32 m0, s20, 114688
    v_mfma_f32_16x16x32_bf16 v[40:43], a[112:115], a[104:107], v[40:43]
    buffer_load_dwordx4 v11, s[12:15], s41 offen offset:0 sc1 lds
    v_mfma_f32_16x16x32_bf16 v[40:43], a[148:151], a[140:143], v[40:43]
    v_mfma_f32_16x16x32_bf16 v[44:47], a[148:151], a[144:147], v[44:47]
    v_mfma_f32_16x16x32_bf16 v[44:47], a[112:115], a[108:111], v[44:47]
    s_waitcnt lgkmcnt(3)
    v_mfma_f32_16x16x32_bf16 v[60:63], a[116:119], a[108:111], v[60:63]
    buffer_load_dwordx4 v11, s[12:15], s41 offen offset:1024 sc1 lds
    v_mfma_f32_16x16x32_bf16 v[60:63], a[152:155], a[144:147], v[60:63]
    ds_read_b128 a[160:163], v9 offset:21504
    v_mfma_f32_16x16x32_bf16 v[56:59], a[152:155], a[140:143], v[56:59]
    ds_read_b128 a[128:131], v9 offset:4096
    v_mfma_f32_16x16x32_bf16 v[56:59], a[116:119], a[104:107], v[56:59]
    ds_read_b128 a[164:167], v9 offset:22528
    v_mfma_f32_16x16x32_bf16 v[52:55], a[116:119], a[100:103], v[52:55]
    v_mfma_f32_16x16x32_bf16 v[52:55], a[152:155], a[136:139], v[52:55]
    buffer_load_dwordx4 v11, s[12:15], s41 offen offset:2048 sc1 lds
    v_mfma_f32_16x16x32_bf16 v[48:51], a[152:155], a[132:135], v[48:51]
    v_mfma_f32_16x16x32_bf16 v[48:51], a[116:119], a[96:99], v[48:51]
    s_waitcnt vmcnt(12) lgkmcnt(0)
    s_barrier
    v_mfma_f32_16x16x32_bf16 v[64:67], a[120:123], a[96:99], v[64:67]
    v_add_u32 v6, 36864, v2
    v_add_u32 v9, 36864, v3
    v_mfma_f32_16x16x32_bf16 v[64:67], a[156:159], a[132:135], v[64:67]
    buffer_load_dwordx4 v11, s[12:15], s41 offen offset:3072 sc1 lds
    v_mfma_f32_16x16x32_bf16 v[68:71], a[156:159], a[136:139], v[68:71]
    v_mfma_f32_16x16x32_bf16 v[68:71], a[120:123], a[100:103], v[68:71]
    s_add_u32 m0, s20, 118784
    ds_read_b128 a[0:3], v6 offset:0
    v_mfma_f32_16x16x32_bf16 v[72:75], a[120:123], a[104:107], v[72:75]
    s_add_u32 s41, s41, 4096
    v_mfma_f32_16x16x32_bf16 v[72:75], a[156:159], a[140:143], v[72:75]
    v_mfma_f32_16x16x32_bf16 v[76:79], a[156:159], a[144:147], v[76:79]
    buffer_load_dwordx4 v11, s[12:15], s41 offen sc1 lds
    v_mfma_f32_16x16x32_bf16 v[76:79], a[120:123], a[108:111], v[76:79]
    s_lshl_b32 s40, s40, 17
    s_add_u32 s40, s40, s16
    v_mfma_f32_16x16x32_bf16 v[92:95], a[124:127], a[108:111], v[92:95]
    ds_read_b128 a[36:39], v6 offset:18432
    ds_read_b128 a[4:7], v6 offset:1024
    v_mfma_f32_16x16x32_bf16 v[92:95], a[160:163], a[144:147], v[92:95]
    s_add_u32 m0, s20, 110592
    v_mfma_f32_16x16x32_bf16 v[88:91], a[160:163], a[140:143], v[88:91]
    buffer_load_dwordx4 v11, s[8:11], s40 offen offset:0 sc1 lds
    v_mfma_f32_16x16x32_bf16 v[88:91], a[124:127], a[104:107], v[88:91]
    ds_read_b128 a[40:43], v6 offset:19456
    ds_read_b128 a[8:11], v6 offset:2048
    v_mfma_f32_16x16x32_bf16 v[84:87], a[124:127], a[100:103], v[84:87]
    ds_read_b128 a[44:47], v6 offset:20480
    ds_read_b128 a[12:15], v6 offset:3072
    v_mfma_f32_16x16x32_bf16 v[84:87], a[160:163], a[136:139], v[84:87]
    v_mfma_f32_16x16x32_bf16 v[80:83], a[160:163], a[132:135], v[80:83]
    buffer_load_dwordx4 v11, s[8:11], s40 offen offset:1024 sc1 lds
    v_mfma_f32_16x16x32_bf16 v[80:83], a[124:127], a[96:99], v[80:83]
    v_mfma_f32_16x16x32_bf16 v[96:99], a[128:131], a[96:99], v[96:99]
    ds_read_b128 a[48:51], v6 offset:21504
    ds_read_b128 a[16:19], v9 offset:0
    v_mfma_f32_16x16x32_bf16 v[96:99], a[164:167], a[132:135], v[96:99]
    ds_read_b128 a[52:55], v9 offset:18432
    ds_read_b128 a[20:23], v9 offset:1024
    v_mfma_f32_16x16x32_bf16 v[100:103], a[164:167], a[136:139], v[100:103]
    buffer_load_dwordx4 v11, s[8:11], s40 offen offset:2048 sc1 lds
    v_mfma_f32_16x16x32_bf16 v[100:103], a[128:131], a[100:103], v[100:103]
    v_mfma_f32_16x16x32_bf16 v[104:107], a[128:131], a[104:107], v[104:107]
    v_mfma_f32_16x16x32_bf16 v[104:107], a[164:167], a[140:143], v[104:107]
    v_mfma_f32_16x16x32_bf16 v[108:111], a[164:167], a[144:147], v[108:111]
    buffer_load_dwordx4 v11, s[8:11], s40 offen offset:3072 sc1 lds
    v_mfma_f32_16x16x32_bf16 v[108:111], a[128:131], a[108:111], v[108:111]
    ds_read_b128 a[56:59], v9 offset:19456
    s_waitcnt lgkmcnt(2)
    v_mfma_f32_16x16x32_bf16 v[32:35], a[16:19], a[0:3], v[32:35]
    s_xor_b32 s40, s19, 8
    s_mov_b32 s32, s86
    s_mov_b32 s33, s87
    v_mfma_f32_16x16x32_bf16 v[32:35], a[52:55], a[36:39], v[32:35]
    s_mul_i32 s41, s40, 40960
    s_add_u32 s41, s41, s17
    s_add_u32 m0, s20, 4096
    v_mfma_f32_16x16x32_bf16 v[36:39], a[52:55], a[40:43], v[36:39]
    buffer_load_dwordx4 v11, s[12:15], s41 offen offset:0 sc1 lds
    v_mfma_f32_16x16x32_bf16 v[36:39], a[16:19], a[4:7], v[36:39]
    s_mov_b32 s34, 2621440
    ds_read_b128 a[24:27], v9 offset:2048
    v_mfma_f32_16x16x32_bf16 v[40:43], a[16:19], a[8:11], v[40:43]
    s_mov_b32 s35, 0x00020000
    ds_read_b128 a[60:63], v9 offset:20480
    v_mfma_f32_16x16x32_bf16 v[40:43], a[52:55], a[44:47], v[40:43]
    ds_read_b128 a[28:31], v9 offset:3072
    ds_read_b128 a[64:67], v9 offset:21504
    v_mfma_f32_16x16x32_bf16 v[44:47], a[52:55], a[48:51], v[44:47]
    v_lshrrev_b32 v26, 2, v1
    v_and_b32 v27, 3, v1
    v_mfma_f32_16x16x32_bf16 v[44:47], a[16:19], a[12:15], v[44:47]
    v_mul_u32_u24 v24, 1280, v26
    s_waitcnt lgkmcnt(4)
    v_mfma_f32_16x16x32_bf16 v[60:63], a[20:23], a[12:15], v[60:63]
    buffer_load_dwordx4 v11, s[12:15], s41 offen offset:1024 sc1 lds
    v_mfma_f32_16x16x32_bf16 v[60:63], a[56:59], a[48:51], v[60:63]
    ds_read_b128 a[32:35], v9 offset:4096
    v_lshl_add_u32 v25, v27, 3, v24
    v_mfma_f32_16x16x32_bf16 v[56:59], a[56:59], a[44:47], v[56:59]
    v_lshl_add_u32 v24, v27, 4, v24
    v_mfma_f32_16x16x32_bf16 v[56:59], a[20:23], a[8:11], v[56:59]
    ds_read_b128 a[68:71], v9 offset:22528
    v_mfma_f32_16x16x32_bf16 v[52:55], a[20:23], a[4:7], v[52:55]
    buffer_load_dwordx4 v11, s[12:15], s41 offen offset:2048 sc1 lds
    v_mfma_f32_16x16x32_bf16 v[52:55], a[56:59], a[40:43], v[52:55]
    v_lshl_add_u32 v29, v27, 4, v26
    v_lshlrev_b32 v29, 2, v29
    v_mfma_f32_16x16x32_bf16 v[48:51], a[56:59], a[36:39], v[48:51]
    v_bfrev_b32 v27, v27
    v_lshrrev_b32 v27, 30, v27
    v_mfma_f32_16x16x32_bf16 v[48:51], a[20:23], a[0:3], v[48:51]
    s_waitcnt vmcnt(12) lgkmcnt(0)
    s_barrier
    v_mfma_f32_16x16x32_bf16 v[64:67], a[24:27], a[0:3], v[64:67]
    v_lshl_add_u32 v28, v27, 4, v26
    v_lshlrev_b32 v28, 2, v28
    v_mfma_f32_16x16x32_bf16 v[64:67], a[60:63], a[36:39], v[64:67]
    buffer_load_dwordx4 v11, s[12:15], s41 offen offset:3072 sc1 lds
    v_mfma_f32_16x16x32_bf16 v[68:71], a[60:63], a[40:43], v[68:71]
    s_lshr_b32 s0, s76, 1
    s_lshl_b32 s1, s77, 1
    v_add_u32 v6, 73728, v2
    v_mfma_f32_16x16x32_bf16 v[68:71], a[24:27], a[4:7], v[68:71]
    v_mfma_f32_16x16x32_bf16 v[72:75], a[24:27], a[8:11], v[72:75]
    s_add_u32 m0, s20, 8192
    v_mfma_f32_16x16x32_bf16 v[72:75], a[60:63], a[44:47], v[72:75]
    s_add_u32 s41, s41, 4096
    v_add_u32 v9, 73728, v3
    v_mfma_f32_16x16x32_bf16 v[76:79], a[60:63], a[48:51], v[76:79]
    buffer_load_dwordx4 v11, s[12:15], s41 offen sc1 lds
    v_mfma_f32_16x16x32_bf16 v[76:79], a[24:27], a[12:15], v[76:79]
    ds_read_b128 a[96:99], v6 offset:0
    v_mfma_f32_16x16x32_bf16 v[92:95], a[28:31], a[12:15], v[92:95]
    ds_read_b128 a[132:135], v6 offset:18432
    ds_read_b128 a[100:103], v6 offset:1024
    v_mfma_f32_16x16x32_bf16 v[92:95], a[64:67], a[48:51], v[92:95]
    s_lshl_b32 s40, s40, 17
    s_add_u32 s40, s40, s16
    s_add_u32 m0, s20, 0
    v_mfma_f32_16x16x32_bf16 v[88:91], a[64:67], a[44:47], v[88:91]
    s_add_u32 s0, s0, s1
    v_mfma_f32_16x16x32_bf16 v[88:91], a[28:31], a[8:11], v[88:91]
    ds_read_b128 a[136:139], v6 offset:19456
    ds_read_b128 a[104:107], v6 offset:2048
    v_mfma_f32_16x16x32_bf16 v[84:87], a[28:31], a[4:7], v[84:87]
    buffer_load_dwordx4 v11, s[8:11], s40 offen offset:0 sc1 lds
    v_mfma_f32_16x16x32_bf16 v[84:87], a[64:67], a[40:43], v[84:87]
    ds_read_b128 a[140:143], v6 offset:20480
    ds_read_b128 a[108:111], v6 offset:3072
    v_mfma_f32_16x16x32_bf16 v[80:83], a[64:67], a[36:39], v[80:83]
    buffer_load_dwordx4 v11, s[8:11], s40 offen offset:1024 sc1 lds
    v_mfma_f32_16x16x32_bf16 v[80:83], a[28:31], a[0:3], v[80:83]
    s_lshl_b32 s0, s0, 2
    s_add_u32 s0, s0, s36
    v_mfma_f32_16x16x32_bf16 v[96:99], a[32:35], a[0:3], v[96:99]
    ds_read_b128 a[144:147], v6 offset:21504
    ds_read_b128 a[112:115], v9 offset:0
    v_mfma_f32_16x16x32_bf16 v[96:99], a[68:71], a[36:39], v[96:99]
    buffer_load_dwordx4 v11, s[8:11], s40 offen offset:2048 sc1 lds
    v_mfma_f32_16x16x32_bf16 v[100:103], a[68:71], a[40:43], v[100:103]
    ds_read_b128 a[148:151], v9 offset:18432
    v_mfma_f32_16x16x32_bf16 v[100:103], a[32:35], a[4:7], v[100:103]
    ds_read_b128 a[116:119], v9 offset:1024
    v_mfma_f32_16x16x32_bf16 v[104:107], a[32:35], a[8:11], v[104:107]
    s_mul_i32 s0, s0, 20480
    s_and_b32 s1, s76, 1
    s_lshl_b32 s39, s78, 1
    v_mfma_f32_16x16x32_bf16 v[104:107], a[68:71], a[44:47], v[104:107]
    buffer_load_dwordx4 v11, s[8:11], s40 offen offset:3072 sc1 lds
    v_mfma_f32_16x16x32_bf16 v[108:111], a[68:71], a[48:51], v[108:111]
    s_add_u32 s1, s1, s39
    s_mul_i32 s1, s1, 160
    s_add_u32 s24, s0, s1
    v_mfma_f32_16x16x32_bf16 v[108:111], a[32:35], a[12:15], v[108:111]
    ds_read_b128 a[152:155], v9 offset:19456
    s_waitcnt lgkmcnt(2)
    v_mfma_f32_16x16x32_bf16 v[32:35], a[112:115], a[96:99], v[32:35]
    ds_read_b128 a[120:123], v9 offset:2048
    v_bfe_u32 v16, v1, 2, 2
    v_mfma_f32_16x16x32_bf16 v[32:35], a[148:151], a[132:135], v[32:35]
    s_xor_b32 s40, s19, 10
    s_mul_i32 s41, s40, 40960
    s_add_u32 s41, s41, s17
    v_mfma_f32_16x16x32_bf16 v[36:39], a[148:151], a[136:139], v[36:39]
    v_lshrrev_b32 v17, 4, v1
    v_cmp_eq_u32 vcc, v16, v17
    v_mfma_f32_16x16x32_bf16 v[36:39], a[112:115], a[100:103], v[36:39]
    s_add_u32 m0, s20, 40960
    v_and_b32 v16, 1, v1
    v_lshlrev_b32 v16, 4, v16
    v_mfma_f32_16x16x32_bf16 v[40:43], a[112:115], a[104:107], v[40:43]
    buffer_load_dwordx4 v11, s[12:15], s41 offen offset:0 sc1 lds
    v_mfma_f32_16x16x32_bf16 v[40:43], a[148:151], a[140:143], v[40:43]
    ds_read_b128 a[156:159], v9 offset:20480
    v_mov_b32 v17, 0x3f80
    v_mfma_f32_16x16x32_bf16 v[44:47], a[148:151], a[144:147], v[44:47]
    ds_read_b128 a[124:127], v9 offset:3072
    ds_read_b128 a[160:163], v9 offset:21504
    v_mfma_f32_16x16x32_bf16 v[44:47], a[112:115], a[108:111], v[44:47]
    ds_read_b128 a[128:131], v9 offset:4096
    s_waitcnt lgkmcnt(5)
    v_mfma_f32_16x16x32_bf16 v[60:63], a[116:119], a[108:111], v[60:63]
    ds_read_b128 a[164:167], v9 offset:22528
    v_lshlrev_b32 v16, v16, v17
    v_mfma_f32_16x16x32_bf16 v[60:63], a[152:155], a[144:147], v[60:63]
    v_cndmask_b32 v16, 0, v16, vcc
    v_and_b32 v17, 2, v1
    v_mfma_f32_16x16x32_bf16 v[56:59], a[152:155], a[140:143], v[56:59]
    buffer_load_dwordx4 v11, s[12:15], s41 offen offset:1024 sc1 lds
    v_mfma_f32_16x16x32_bf16 v[56:59], a[116:119], a[104:107], v[56:59]
    v_mfma_f32_16x16x32_bf16 v[52:55], a[116:119], a[100:103], v[52:55]
    v_mfma_f32_16x16x32_bf16 v[52:55], a[152:155], a[136:139], v[52:55]
    v_cmp_eq_u32 vcc, 0, v17
    v_mov_b32 v200, 0
    v_mfma_f32_16x16x32_bf16 v[48:51], a[152:155], a[132:135], v[48:51]
    buffer_load_dwordx4 v11, s[12:15], s41 offen offset:2048 sc1 lds
    v_mfma_f32_16x16x32_bf16 v[48:51], a[116:119], a[96:99], v[48:51]
    s_waitcnt vmcnt(12) lgkmcnt(0)
    s_barrier
    v_mfma_f32_16x16x32_bf16 v[64:67], a[120:123], a[96:99], v[64:67]
    v_add_u32 v6, 110592, v2
    v_add_u32 v9, 110592, v3
    v_mfma_f32_16x16x32_bf16 v[64:67], a[156:159], a[132:135], v[64:67]
    v_mov_b32 v201, 0
    v_mfma_f32_16x16x32_bf16 v[68:71], a[156:159], a[136:139], v[68:71]
    buffer_load_dwordx4 v11, s[12:15], s41 offen offset:3072 sc1 lds
    v_mfma_f32_16x16x32_bf16 v[68:71], a[120:123], a[100:103], v[68:71]
    s_add_u32 m0, s20, 45056
    v_mov_b32 v204, 0
    v_mov_b32 v205, 0
    v_mfma_f32_16x16x32_bf16 v[72:75], a[120:123], a[104:107], v[72:75]
    s_add_u32 s41, s41, 4096
    ds_read_b128 a[0:3], v6 offset:0
    v_mfma_f32_16x16x32_bf16 v[72:75], a[156:159], a[140:143], v[72:75]
    ds_read_b128 a[36:39], v6 offset:18432
    ds_read_b128 a[4:7], v6 offset:1024
    v_mfma_f32_16x16x32_bf16 v[76:79], a[156:159], a[144:147], v[76:79]
    buffer_load_dwordx4 v11, s[12:15], s41 offen sc1 lds
    v_mfma_f32_16x16x32_bf16 v[76:79], a[120:123], a[108:111], v[76:79]
    s_lshl_b32 s40, s40, 17
    s_add_u32 s40, s40, s16
    v_mfma_f32_16x16x32_bf16 v[92:95], a[124:127], a[108:111], v[92:95]
    ds_read_b128 a[40:43], v6 offset:19456
    v_mfma_f32_16x16x32_bf16 v[92:95], a[160:163], a[144:147], v[92:95]
    s_add_u32 m0, s20, 36864
    v_cndmask_b32 v202, 0, v16, vcc
    v_sub_u32 v203, v16, v202
    v_mfma_f32_16x16x32_bf16 v[88:91], a[160:163], a[140:143], v[88:91]
    buffer_load_dwordx4 v11, s[8:11], s40 offen offset:0 sc1 lds
    v_mfma_f32_16x16x32_bf16 v[88:91], a[124:127], a[104:107], v[88:91]
    ds_read_b128 a[8:11], v6 offset:2048
    v_mfma_f32_16x16x32_bf16 v[84:87], a[124:127], a[100:103], v[84:87]
    s_and_b32 s0, s36, 1
    ds_read_b128 a[44:47], v6 offset:20480
    v_mfma_f32_16x16x32_bf16 v[84:87], a[160:163], a[136:139], v[84:87]
    ds_read_b128 a[12:15], v6 offset:3072
    ds_read_b128 a[48:51], v6 offset:21504
    v_mfma_f32_16x16x32_bf16 v[80:83], a[160:163], a[132:135], v[80:83]
    buffer_load_dwordx4 v11, s[8:11], s40 offen offset:1024 sc1 lds
    v_mfma_f32_16x16x32_bf16 v[80:83], a[124:127], a[96:99], v[80:83]
    ds_read_b128 a[16:19], v9 offset:0
    v_mfma_f32_16x16x32_bf16 v[96:99], a[128:131], a[96:99], v[96:99]
    s_sub_u32 s0, 0, s0
    v_mfma_f32_16x16x32_bf16 v[96:99], a[164:167], a[132:135], v[96:99]
    ds_read_b128 a[52:55], v9 offset:18432
    ds_read_b128 a[20:23], v9 offset:1024
    v_mfma_f32_16x16x32_bf16 v[100:103], a[164:167], a[136:139], v[100:103]
    buffer_load_dwordx4 v11, s[8:11], s40 offen offset:2048 sc1 lds
    v_mfma_f32_16x16x32_bf16 v[100:103], a[128:131], a[100:103], v[100:103]
    v_and_b32 v208, s0, v202
    v_and_b32 v209, s0, v203
    v_mfma_f32_16x16x32_bf16 v[104:107], a[128:131], a[104:107], v[104:107]
    ds_read_b128 a[56:59], v9 offset:19456
    v_sub_u32 v206, v202, v208
    v_mfma_f32_16x16x32_bf16 v[104:107], a[164:167], a[140:143], v[104:107]
    v_sub_u32 v207, v203, v209
    v_mfma_f32_16x16x32_bf16 v[108:111], a[164:167], a[144:147], v[108:111]
    buffer_load_dwordx4 v11, s[8:11], s40 offen offset:3072 sc1 lds
    v_mfma_f32_16x16x32_bf16 v[108:111], a[128:131], a[108:111], v[108:111]
    s_waitcnt lgkmcnt(2)
    v_mfma_f32_16x16x32_bf16 v[32:35], a[16:19], a[0:3], v[32:35]
    v_and_b32 v18, 3, v1
    v_min_u32 v18, 2, v18
    v_mfma_f32_16x16x32_bf16 v[32:35], a[52:55], a[36:39], v[32:35]
    ds_read_b128 a[24:27], v9 offset:2048
    v_mfma_f32_16x16x32_bf16 v[36:39], a[52:55], a[40:43], v[36:39]
    s_xor_b32 s40, s19, 12
    s_mul_i32 s41, s40, 40960
    s_add_u32 s41, s41, s17
    v_mfma_f32_16x16x32_bf16 v[36:39], a[16:19], a[4:7], v[36:39]
    s_add_u32 m0, s20, 77824
    v_mfma_f32_16x16x32_bf16 v[40:43], a[16:19], a[8:11], v[40:43]
    buffer_load_dwordx4 v11, s[12:15], s41 offen offset:0 sc1 lds
    v_mfma_f32_16x16x32_bf16 v[40:43], a[52:55], a[44:47], v[40:43]
    s_add_u32 s0, s76, 1
    ds_read_b128 a[60:63], v9 offset:20480
    v_mfma_f32_16x16x32_bf16 v[44:47], a[52:55], a[48:51], v[44:47]
    v_mfma_f32_16x16x32_bf16 v[44:47], a[16:19], a[12:15], v[44:47]
    ds_read_b128 a[28:31], v9 offset:3072
    s_waitcnt lgkmcnt(3)
    v_mfma_f32_16x16x32_bf16 v[60:63], a[20:23], a[12:15], v[60:63]
    buffer_load_dwordx4 v11, s[12:15], s41 offen offset:1024 sc1 lds
    v_mfma_f32_16x16x32_bf16 v[60:63], a[56:59], a[48:51], v[60:63]
    ds_read_b128 a[64:67], v9 offset:21504
    v_add_u32 v18, s0, v18
    v_mfma_f32_16x16x32_bf16 v[56:59], a[56:59], a[44:47], v[56:59]
    ds_read_b128 a[32:35], v9 offset:4096
    ds_read_b128 a[68:71], v9 offset:22528
    v_mfma_f32_16x16x32_bf16 v[56:59], a[20:23], a[8:11], v[56:59]
    v_mfma_f32_16x16x32_bf16 v[52:55], a[20:23], a[4:7], v[52:55]
    buffer_load_dwordx4 v11, s[12:15], s41 offen offset:2048 sc1 lds
    v_mfma_f32_16x16x32_bf16 v[52:55], a[56:59], a[40:43], v[52:55]
    v_and_b32 v18, 3, v18
    v_mfma_f32_16x16x32_bf16 v[48:51], a[56:59], a[36:39], v[48:51]
    v_lshlrev_b32 v30, 2, v18
    v_mul_u32_u24 v18, 10240, v18
    v_mfma_f32_16x16x32_bf16 v[48:51], a[20:23], a[0:3], v[48:51]
    s_waitcnt vmcnt(12) lgkmcnt(0)
    s_barrier
    v_mfma_f32_16x16x32_bf16 v[64:67], a[24:27], a[0:3], v[64:67]
    buffer_load_dwordx4 v11, s[12:15], s41 offen offset:3072 sc1 lds
    v_mfma_f32_16x16x32_bf16 v[64:67], a[60:63], a[36:39], v[64:67]
    v_lshlrev_b32 v31, 5, v30
    v_mfma_f32_16x16x32_bf16 v[68:71], a[60:63], a[40:43], v[68:71]
    s_add_u32 m0, s20, 81920
    v_mfma_f32_16x16x32_bf16 v[68:71], a[24:27], a[4:7], v[68:71]
    s_add_u32 s41, s41, 4096
    v_add_u32 v6, 0, v2
    v_add_u32 v9, 0, v3
    v_mfma_f32_16x16x32_bf16 v[72:75], a[24:27], a[8:11], v[72:75]
    buffer_load_dwordx4 v11, s[12:15], s41 offen sc1 lds
    v_mfma_f32_16x16x32_bf16 v[72:75], a[60:63], a[44:47], v[72:75]
    s_and_b32 s50, s67, 0xfffffe7f
    v_add_u32 v21, 10236, v18
    v_mfma_f32_16x16x32_bf16 v[76:79], a[60:63], a[48:51], v[76:79]
    ds_read_b128 a[96:99], v6 offset:0
    ds_read_b128 a[132:135], v6 offset:18432
    v_mfma_f32_16x16x32_bf16 v[76:79], a[24:27], a[12:15], v[76:79]
    s_lshl_b32 s40, s40, 17
    s_add_u32 s40, s40, s16
    v_mfma_f32_16x16x32_bf16 v[92:95], a[28:31], a[12:15], v[92:95]
    s_add_u32 m0, s20, 73728
    v_mfma_f32_16x16x32_bf16 v[92:95], a[64:67], a[48:51], v[92:95]
    buffer_load_dwordx4 v11, s[8:11], s40 offen offset:0 sc1 lds
    v_mfma_f32_16x16x32_bf16 v[88:91], a[64:67], a[44:47], v[88:91]
    ds_read_b128 a[100:103], v6 offset:1024
    v_mfma_f32_16x16x32_bf16 v[88:91], a[28:31], a[8:11], v[88:91]
    ds_read_b128 a[136:139], v6 offset:19456
    ds_read_b128 a[104:107], v6 offset:2048
    v_mfma_f32_16x16x32_bf16 v[84:87], a[28:31], a[4:7], v[84:87]
    v_mfma_f32_16x16x32_bf16 v[84:87], a[64:67], a[40:43], v[84:87]
    buffer_load_dwordx4 v11, s[8:11], s40 offen offset:1024 sc1 lds
    v_mfma_f32_16x16x32_bf16 v[80:83], a[64:67], a[36:39], v[80:83]
    ds_read_b128 a[140:143], v6 offset:20480
    v_mfma_f32_16x16x32_bf16 v[80:83], a[28:31], a[0:3], v[80:83]
    v_mfma_f32_16x16x32_bf16 v[96:99], a[32:35], a[0:3], v[96:99]
    ds_read_b128 a[108:111], v6 offset:3072
    v_mfma_f32_16x16x32_bf16 v[96:99], a[68:71], a[36:39], v[96:99]
    buffer_load_dwordx4 v11, s[8:11], s40 offen offset:2048 sc1 lds
    v_mfma_f32_16x16x32_bf16 v[100:103], a[68:71], a[40:43], v[100:103]
    ds_read_b128 a[144:147], v6 offset:21504
    v_mfma_f32_16x16x32_bf16 v[100:103], a[32:35], a[4:7], v[100:103]
    ds_read_b128 a[112:115], v9 offset:0
    v_mfma_f32_16x16x32_bf16 v[104:107], a[32:35], a[8:11], v[104:107]
    ds_read_b128 a[148:151], v9 offset:18432
    ds_read_b128 a[116:119], v9 offset:1024
    v_mfma_f32_16x16x32_bf16 v[104:107], a[68:71], a[44:47], v[104:107]
    buffer_load_dwordx4 v11, s[8:11], s40 offen offset:3072 sc1 lds
    v_mfma_f32_16x16x32_bf16 v[108:111], a[68:71], a[48:51], v[108:111]
    v_add_u32 v18, 3068, v18
    v_mfma_f32_16x16x32_bf16 v[108:111], a[32:35], a[12:15], v[108:111]
    ds_read_b128 a[152:155], v9 offset:19456
    s_waitcnt lgkmcnt(2)
    v_mfma_f32_16x16x32_bf16 v[32:35], a[112:115], a[96:99], v[32:35]
    s_xor_b32 s40, s19, 14
    ds_read_b128 a[120:123], v9 offset:2048
    v_mfma_f32_16x16x32_bf16 v[32:35], a[148:151], a[132:135], v[32:35]
    s_mul_i32 s41, s40, 40960
    s_add_u32 s41, s41, s17
    s_add_u32 m0, s20, 114688
    v_mfma_f32_16x16x32_bf16 v[36:39], a[148:151], a[136:139], v[36:39]
    buffer_load_dwordx4 v11, s[12:15], s41 offen offset:0 sc1 lds
    v_mfma_f32_16x16x32_bf16 v[36:39], a[112:115], a[100:103], v[36:39]
    v_mfma_f32_16x16x32_bf16 v[40:43], a[112:115], a[104:107], v[40:43]
    v_mfma_f32_16x16x32_bf16 v[40:43], a[148:151], a[140:143], v[40:43]
    buffer_load_dwordx4 v11, s[12:15], s41 offen offset:1024 sc1 lds
    v_mfma_f32_16x16x32_bf16 v[44:47], a[148:151], a[144:147], v[44:47]
    ds_read_b128 a[156:159], v9 offset:20480
    v_mfma_f32_16x16x32_bf16 v[44:47], a[112:115], a[108:111], v[44:47]
    s_waitcnt lgkmcnt(2)
    v_mfma_f32_16x16x32_bf16 v[60:63], a[116:119], a[108:111], v[60:63]
    ds_read_b128 a[124:127], v9 offset:3072
    ds_read_b128 a[160:163], v9 offset:21504
    v_mfma_f32_16x16x32_bf16 v[60:63], a[152:155], a[144:147], v[60:63]
    buffer_load_dwordx4 v11, s[12:15], s41 offen offset:2048 sc1 lds
    v_mfma_f32_16x16x32_bf16 v[56:59], a[152:155], a[140:143], v[56:59]
    v_mfma_f32_16x16x32_bf16 v[56:59], a[116:119], a[104:107], v[56:59]
    ds_read_b128 a[128:131], v9 offset:4096
    ds_read_b128 a[164:167], v9 offset:22528
    v_mfma_f32_16x16x32_bf16 v[52:55], a[116:119], a[100:103], v[52:55]
    v_mfma_f32_16x16x32_bf16 v[52:55], a[152:155], a[136:139], v[52:55]
    buffer_load_dwordx4 v11, s[12:15], s41 offen offset:3072 sc1 lds
    v_mfma_f32_16x16x32_bf16 v[48:51], a[152:155], a[132:135], v[48:51]
    v_mfma_f32_16x16x32_bf16 v[48:51], a[116:119], a[96:99], v[48:51]
    s_waitcnt vmcnt(13) lgkmcnt(0)
    s_barrier
    v_mfma_f32_16x16x32_bf16 v[64:67], a[120:123], a[96:99], v[64:67]
    s_add_u32 m0, s20, 118784
    v_add_u32 v6, 36864, v2
    v_mfma_f32_16x16x32_bf16 v[64:67], a[156:159], a[132:135], v[64:67]
    s_add_u32 s41, s41, 4096
    v_add_u32 v9, 36864, v3
    v_mfma_f32_16x16x32_bf16 v[68:71], a[156:159], a[136:139], v[68:71]
    buffer_load_dword v4, v13, s[28:31], s26 offen sc0 sc1
    v_mfma_f32_16x16x32_bf16 v[68:71], a[120:123], a[100:103], v[68:71]
    v_mfma_f32_16x16x32_bf16 v[72:75], a[120:123], a[104:107], v[72:75]
    ds_read_b128 a[0:3], v6 offset:0
    ds_read_b128 a[36:39], v6 offset:18432
    v_mfma_f32_16x16x32_bf16 v[72:75], a[156:159], a[140:143], v[72:75]
    ds_read_b128 a[4:7], v6 offset:1024
    v_mfma_f32_16x16x32_bf16 v[76:79], a[156:159], a[144:147], v[76:79]
    buffer_load_dwordx4 v11, s[12:15], s41 offen sc1 lds
    v_mfma_f32_16x16x32_bf16 v[76:79], a[120:123], a[108:111], v[76:79]
    ds_read_b128 a[40:43], v6 offset:19456
    v_mfma_f32_16x16x32_bf16 v[92:95], a[124:127], a[108:111], v[92:95]
    ds_read_b128 a[8:11], v6 offset:2048
    v_mfma_f32_16x16x32_bf16 v[92:95], a[160:163], a[144:147], v[92:95]
    ds_read_b128 a[44:47], v6 offset:20480
    v_mfma_f32_16x16x32_bf16 v[88:91], a[160:163], a[140:143], v[88:91]
    s_lshl_b32 s40, s40, 17
    s_add_u32 s40, s40, s16
    s_add_u32 m0, s20, 110592
    v_mfma_f32_16x16x32_bf16 v[88:91], a[124:127], a[104:107], v[88:91]
    buffer_load_dwordx4 v11, s[8:11], s40 offen offset:0 sc1 lds
    v_mfma_f32_16x16x32_bf16 v[84:87], a[124:127], a[100:103], v[84:87]
    ds_read_b128 a[12:15], v6 offset:3072
    ds_read_b128 a[48:51], v6 offset:21504
    v_mfma_f32_16x16x32_bf16 v[84:87], a[160:163], a[136:139], v[84:87]
    buffer_load_dwordx4 v11, s[8:11], s40 offen offset:1024 sc1 lds
    v_mfma_f32_16x16x32_bf16 v[80:83], a[160:163], a[132:135], v[80:83]
    ds_read_b128 a[16:19], v9 offset:0
    ds_read_b128 a[52:55], v9 offset:18432
    v_mfma_f32_16x16x32_bf16 v[80:83], a[124:127], a[96:99], v[80:83]
    v_mfma_f32_16x16x32_bf16 v[96:99], a[128:131], a[96:99], v[96:99]
    v_mfma_f32_16x16x32_bf16 v[96:99], a[164:167], a[132:135], v[96:99]
    buffer_load_dwordx4 v11, s[8:11], s40 offen offset:2048 sc1 lds
    v_mfma_f32_16x16x32_bf16 v[100:103], a[164:167], a[136:139], v[100:103]
    v_mfma_f32_16x16x32_bf16 v[100:103], a[128:131], a[100:103], v[100:103]
    v_mfma_f32_16x16x32_bf16 v[104:107], a[128:131], a[104:107], v[104:107]
    v_mfma_f32_16x16x32_bf16 v[104:107], a[164:167], a[140:143], v[104:107]
    buffer_load_dwordx4 v11, s[8:11], s40 offen offset:3072 sc1 lds
    v_mfma_f32_16x16x32_bf16 v[108:111], a[164:167], a[144:147], v[108:111]
    ds_read_b128 a[20:23], v9 offset:1024
    ds_read_b128 a[56:59], v9 offset:19456
    v_mfma_f32_16x16x32_bf16 v[108:111], a[128:131], a[108:111], v[108:111]
    s_waitcnt lgkmcnt(2)
    v_mfma_f32_16x16x32_bf16 v[32:35], a[16:19], a[0:3], v[32:35]
    s_xor_b32 s40, s19, 16
    s_mul_i32 s41, s40, 40960
    s_add_u32 s41, s41, s17
    v_mfma_f32_16x16x32_bf16 v[32:35], a[52:55], a[36:39], v[32:35]
    s_add_u32 m0, s20, 4096
    v_mfma_f32_16x16x32_bf16 v[36:39], a[52:55], a[40:43], v[36:39]
    buffer_load_dwordx4 v11, s[12:15], s41 offen offset:0 sc1 lds
    v_mfma_f32_16x16x32_bf16 v[36:39], a[16:19], a[4:7], v[36:39]
    v_mfma_f32_16x16x32_bf16 v[40:43], a[16:19], a[8:11], v[40:43]
    v_mfma_f32_16x16x32_bf16 v[40:43], a[52:55], a[44:47], v[40:43]
    v_mfma_f32_16x16x32_bf16 v[44:47], a[52:55], a[48:51], v[44:47]
    buffer_load_dwordx4 v11, s[12:15], s41 offen offset:1024 sc1 lds
    v_mfma_f32_16x16x32_bf16 v[44:47], a[16:19], a[12:15], v[44:47]
    ds_read_b128 a[24:27], v9 offset:2048
    s_waitcnt lgkmcnt(1)
    v_mfma_f32_16x16x32_bf16 v[60:63], a[20:23], a[12:15], v[60:63]
    ds_read_b128 a[60:63], v9 offset:20480
    ds_read_b128 a[28:31], v9 offset:3072
    v_mfma_f32_16x16x32_bf16 v[60:63], a[56:59], a[48:51], v[60:63]
    buffer_load_dwordx4 v11, s[12:15], s41 offen offset:2048 sc1 lds
    v_mfma_f32_16x16x32_bf16 v[56:59], a[56:59], a[44:47], v[56:59]
    ds_read_b128 a[64:67], v9 offset:21504
    ds_read_b128 a[32:35], v9 offset:4096
    v_mfma_f32_16x16x32_bf16 v[56:59], a[20:23], a[8:11], v[56:59]
    ds_read_b128 a[68:71], v9 offset:22528
    v_mfma_f32_16x16x32_bf16 v[52:55], a[20:23], a[4:7], v[52:55]
    v_mfma_f32_16x16x32_bf16 v[52:55], a[56:59], a[40:43], v[52:55]
    buffer_load_dwordx4 v11, s[12:15], s41 offen offset:3072 sc1 lds
    v_mfma_f32_16x16x32_bf16 v[48:51], a[56:59], a[36:39], v[48:51]
    s_add_u32 m0, s20, 8192
    v_mfma_f32_16x16x32_bf16 v[48:51], a[20:23], a[0:3], v[48:51]
    s_waitcnt vmcnt(9) lgkmcnt(0)
    s_barrier
    v_mfma_f32_16x16x32_bf16 v[64:67], a[24:27], a[0:3], v[64:67]
    v_cmp_ne_u32 vcc, 1, v4
    s_nop 0
    s_cmp_eq_u64 vcc, 0
    s_cbranch_scc1 L_cwO9_ok
L_cwO9_no:
    s_mov_b32 s51, 0x40000
L_cwO9_spin:
    buffer_load_dword v4, v13, s[28:31], s26 offen sc0 sc1
    s_waitcnt vmcnt(0)
    v_cmp_ne_u32 vcc, 1, v4
    s_nop 0
    s_cmp_eq_u64 vcc, 0
    s_cbranch_scc1 L_cwO9_ok
L_cwO9_again:
    s_sleep 4
    s_sub_u32 s51, s51, 1
    s_cmp_lg_u32 s51, 0
    s_cbranch_scc1 L_cwO9_spin
L_cwO9_ok:
    v_mfma_f32_16x16x32_bf16 v[64:67], a[60:63], a[36:39], v[64:67]
    s_add_u32 s41, s41, 4096
    v_mfma_f32_16x16x32_bf16 v[68:71], a[60:63], a[40:43], v[68:71]
    buffer_load_dwordx4 v11, s[12:15], s41 offen sc1 lds
    v_mfma_f32_16x16x32_bf16 v[68:71], a[24:27], a[4:7], v[68:71]
    s_lshl_b32 s40, s40, 17
    s_add_u32 s40, s40, s16
    v_mfma_f32_16x16x32_bf16 v[72:75], a[24:27], a[8:11], v[72:75]
    v_add_u32 v6, 73728, v2
    v_add_u32 v9, 73728, v3
    v_mfma_f32_16x16x32_bf16 v[72:75], a[60:63], a[44:47], v[72:75]
    ds_read_b128 a[96:99], v6 offset:0
    v_mfma_f32_16x16x32_bf16 v[76:79], a[60:63], a[48:51], v[76:79]
    s_add_u32 m0, s20, 0
    ds_read_b128 a[132:135], v6 offset:18432
    v_mfma_f32_16x16x32_bf16 v[76:79], a[24:27], a[12:15], v[76:79]
    ds_read_b128 a[100:103], v6 offset:1024
    v_mfma_f32_16x16x32_bf16 v[92:95], a[28:31], a[12:15], v[92:95]
    v_mfma_f32_16x16x32_bf16 v[92:95], a[64:67], a[48:51], v[92:95]
    buffer_load_dwordx4 v11, s[8:11], s40 offen offset:0 sc1 lds
    v_mfma_f32_16x16x32_bf16 v[88:91], a[64:67], a[44:47], v[88:91]
    ds_read_b128 a[136:139], v6 offset:19456
    v_mfma_f32_16x16x32_bf16 v[88:91], a[28:31], a[8:11], v[88:91]
    ds_read_b128 a[104:107], v6 offset:2048
    ds_read_b128 a[140:143], v6 offset:20480
    v_mfma_f32_16x16x32_bf16 v[84:87], a[28:31], a[4:7], v[84:87]
    v_mfma_f32_16x16x32_bf16 v[84:87], a[64:67], a[40:43], v[84:87]
    buffer_load_dwordx4 v11, s[8:11], s40 offen offset:1024 sc1 lds
    v_mfma_f32_16x16x32_bf16 v[80:83], a[64:67], a[36:39], v[80:83]
    ds_read_b128 a[108:111], v6 offset:3072
    ds_read_b128 a[144:147], v6 offset:21504
    v_mfma_f32_16x16x32_bf16 v[80:83], a[28:31], a[0:3], v[80:83]
    ds_read_b128 a[112:115], v9 offset:0
    v_mfma_f32_16x16x32_bf16 v[96:99], a[32:35], a[0:3], v[96:99]
    v_mfma_f32_16x16x32_bf16 v[96:99], a[68:71], a[36:39], v[96:99]
    buffer_load_dwordx4 v11, s[8:11], s40 offen offset:2048 sc1 lds
    v_mfma_f32_16x16x32_bf16 v[100:103], a[68:71], a[40:43], v[100:103]
    ds_read_b128 a[148:151], v9 offset:18432
    v_mfma_f32_16x16x32_bf16 v[100:103], a[32:35], a[4:7], v[100:103]
    ds_read_b128 a[116:119], v9 offset:1024
    ds_read_b128 a[152:155], v9 offset:19456
    v_mfma_f32_16x16x32_bf16 v[104:107], a[32:35], a[8:11], v[104:107]
    v_mfma_f32_16x16x32_bf16 v[104:107], a[68:71], a[44:47], v[104:107]
    v_mfma_f32_16x16x32_bf16 v[108:111], a[68:71], a[48:51], v[108:111]
    buffer_load_dwordx4 v11, s[8:11], s40 offen offset:3072 sc1 lds
    v_mfma_f32_16x16x32_bf16 v[108:111], a[32:35], a[12:15], v[108:111]
    s_waitcnt lgkmcnt(2)
    v_mfma_f32_16x16x32_bf16 v[32:35], a[112:115], a[96:99], v[32:35]
    s_xor_b32 s40, s19, 18
    ds_read_b128 a[120:123], v9 offset:2048
    v_mfma_f32_16x16x32_bf16 v[32:35], a[148:151], a[132:135], v[32:35]
    s_mul_i32 s41, s40, 40960
    s_add_u32 s41, s41, s17
    s_getpc_b64 s[0:1]
L_t6:
    v_mfma_f32_16x16x32_bf16 v[36:39], a[148:151], a[136:139], v[36:39]
    s_add_u32 m0, s20, 40960
    v_mfma_f32_16x16x32_bf16 v[36:39], a[112:115], a[100:103], v[36:39]
    buffer_load_dwordx4 v11, s[12:15], s41 offen offset:0 sc1 lds
    v_mfma_f32_16x16x32_bf16 v[40:43], a[112:115], a[104:107], v[40:43]
    s_lshr_b32 s39, s2, 3
    s_lshl_b32 s39, s39, 2
    s_add_u32 s39, s39, s36
    v_mfma_f32_16x16x32_bf16 v[40:43], a[148:151], a[140:143], v[40:43]
    ds_read_b128 a[156:159], v9 offset:20480
    ds_read_b128 a[124:127], v9 offset:3072
    v_mfma_f32_16x16x32_bf16 v[44:47], a[148:151], a[144:147], v[44:47]
    ds_read_b128 a[160:163], v9 offset:21504
    v_mfma_f32_16x16x32_bf16 v[44:47], a[112:115], a[108:111], v[44:47]
    ds_read_b128 a[128:131], v9 offset:4096
    s_waitcnt lgkmcnt(5)
    v_mfma_f32_16x16x32_bf16 v[60:63], a[116:119], a[108:111], v[60:63]
    buffer_load_dwordx4 v11, s[12:15], s41 offen offset:1024 sc1 lds
    v_mfma_f32_16x16x32_bf16 v[60:63], a[152:155], a[144:147], v[60:63]
    v_mfma_f32_16x16x32_bf16 v[56:59], a[152:155], a[140:143], v[56:59]
    s_lshl_b32 s39, s39, 7
    v_and_b32 v20, 0, v1
    v_mfma_f32_16x16x32_bf16 v[56:59], a[116:119], a[104:107], v[56:59]
    ds_read_b128 a[164:167], v9 offset:22528
    v_mfma_f32_16x16x32_bf16 v[52:55], a[116:119], a[100:103], v[52:55]
    buffer_load_dwordx4 v11, s[12:15], s41 offen offset:2048 sc1 lds
    v_mfma_f32_16x16x32_bf16 v[52:55], a[152:155], a[136:139], v[52:55]
    v_mfma_f32_16x16x32_bf16 v[48:51], a[152:155], a[132:135], v[48:51]
    v_lshl_add_u32 v20, v20, 14, s39
    v_add_u32 v20, L_joined-L_t6, v20
    v_mfma_f32_16x16x32_bf16 v[48:51], a[116:119], a[96:99], v[48:51]
    s_waitcnt vmcnt(12) lgkmcnt(0)
    s_barrier
    v_mfma_f32_16x16x32_bf16 v[64:67], a[120:123], a[96:99], v[64:67]
    buffer_load_dwordx4 v11, s[12:15], s41 offen offset:3072 sc1 lds
    v_mfma_f32_16x16x32_bf16 v[64:67], a[156:159], a[132:135], v[64:67]
    s_add_u32 m0, s20, 45056
    v_mfma_f32_16x16x32_bf16 v[68:71], a[156:159], a[136:139], v[68:71]
    s_add_u32 s41, s41, 4096
    v_add_u32 v6, 110592, v2
    v_min_u32 v20, L_code_end-L_t6-4, v20
    v_mfma_f32_16x16x32_bf16 v[68:71], a[120:123], a[100:103], v[68:71]
    buffer_load_dwordx4 v11, s[12:15], s41 offen sc1 lds
    v_mfma_f32_16x16x32_bf16 v[72:75], a[120:123], a[104:107], v[72:75]
    s_lshl_b32 s40, s40, 17
    s_add_u32 s40, s40, s16
    v_add_u32 v9, 110592, v3
    v_mfma_f32_16x16x32_bf16 v[72:75], a[156:159], a[140:143], v[72:75]
    s_add_u32 m0, s20, 36864
    ds_read_b128 a[0:3], v6 offset:0
    v_mfma_f32_16x16x32_bf16 v[76:79], a[156:159], a[144:147], v[76:79]
    ds_read_b128 a[36:39], v6 offset:18432
    ds_read_b128 a[4:7], v6 offset:1024
    v_mfma_f32_16x16x32_bf16 v[76:79], a[120:123], a[108:111], v[76:79]
    v_mov_b32 v21, 0
    v_mfma_f32_16x16x32_bf16 v[92:95], a[124:127], a[108:111], v[92:95]
    buffer_load_dwordx4 v11, s[8:11], s40 offen offset:0 sc1 lds
    v_mfma_f32_16x16x32_bf16 v[92:95], a[160:163], a[144:147], v[92:95]
    v_mfma_f32_16x16x32_bf16 v[88:91], a[160:163], a[140:143], v[88:91]
    ds_read_b128 a[40:43], v6 offset:19456
    ds_read_b128 a[8:11], v6 offset:2048
    v_mfma_f32_16x16x32_bf16 v[88:91], a[124:127], a[104:107], v[88:91]
    v_mfma_f32_16x16x32_bf16 v[84:87], a[124:127], a[100:103], v[84:87]
    v_mfma_f32_16x16x32_bf16 v[84:87], a[160:163], a[136:139], v[84:87]
    buffer_load_dwordx4 v11, s[8:11], s40 offen offset:1024 sc1 lds
    v_mfma_f32_16x16x32_bf16 v[80:83], a[160:163], a[132:135], v[80:83]
    ds_read_b128 a[44:47], v6 offset:20480
    v_lshl_add_u64 v[20:21], v[20:21], 0, s[0:1]
    v_mfma_f32_16x16x32_bf16 v[80:83], a[124:127], a[96:99], v[80:83]
    v_mfma_f32_16x16x32_bf16 v[96:99], a[128:131], a[96:99], v[96:99]
    ds_read_b128 a[12:15], v6 offset:3072
    ds_read_b128 a[48:51], v6 offset:21504
    v_mfma_f32_16x16x32_bf16 v[96:99], a[164:167], a[132:135], v[96:99]
    buffer_load_dwordx4 v11, s[8:11], s40 offen offset:2048 sc1 lds
    v_mfma_f32_16x16x32_bf16 v[100:103], a[164:167], a[136:139], v[100:103]
    global_load_dword v20, v[20:21], off
    v_mfma_f32_16x16x32_bf16 v[100:103], a[128:131], a[100:103], v[100:103]
    ds_read_b128 a[16:19], v9 offset:0
    ds_read_b128 a[52:55], v9 offset:18432
    v_mfma_f32_16x16x32_bf16 v[104:107], a[128:131], a[104:107], v[104:107]
    ds_read_b128 a[20:23], v9 offset:1024
    ds_read_b128 a[56:59], v9 offset:19456
    v_mfma_f32_16x16x32_bf16 v[104:107], a[164:167], a[140:143], v[104:107]
    v_mfma_f32_16x16x32_bf16 v[108:111], a[164:167], a[144:147], v[108:111]
    buffer_load_dwordx4 v11, s[8:11], s40 offen offset:3072 sc1 lds
    v_mfma_f32_16x16x32_bf16 v[108:111], a[128:131], a[108:111], v[108:111]
    s_waitcnt lgkmcnt(2)
    v_mfma_f32_16x16x32_bf16 v[32:35], a[16:19], a[0:3], v[32:35]
    s_lshl_b32 s0, s77, 1
    s_lshr_b32 s1, s76, 1
    v_mfma_f32_16x16x32_bf16 v[32:35], a[52:55], a[36:39], v[32:35]
    ds_read_b128 a[24:27], v9 offset:2048
    ds_read_b128 a[60:63], v9 offset:20480
    v_mfma_f32_16x16x32_bf16 v[36:39], a[52:55], a[40:43], v[36:39]
    s_xor_b32 s40, s19, 20
    s_mul_i32 s41, s40, 40960
    s_add_u32 s41, s41, s17
    v_mfma_f32_16x16x32_bf16 v[36:39], a[16:19], a[4:7], v[36:39]
    s_add_u32 m0, s20, 77824
    v_mfma_f32_16x16x32_bf16 v[40:43], a[16:19], a[8:11], v[40:43]
    buffer_load_dwordx4 v11, s[12:15], s41 offen offset:0 sc1 lds
    v_mfma_f32_16x16x32_bf16 v[40:43], a[52:55], a[44:47], v[40:43]
    v_mfma_f32_16x16x32_bf16 v[44:47], a[52:55], a[48:51], v[44:47]
    s_add_u32 s0, s0, s1
    s_lshl_b32 s60, s0, 12
    v_mfma_f32_16x16x32_bf16 v[44:47], a[16:19], a[12:15], v[44:47]
    ds_read_b128 a[28:31], v9 offset:3072
    s_waitcnt lgkmcnt(3)
    v_mfma_f32_16x16x32_bf16 v[60:63], a[20:23], a[12:15], v[60:63]
    buffer_load_dwordx4 v11, s[12:15], s41 offen offset:1024 sc1 lds
    v_mfma_f32_16x16x32_bf16 v[60:63], a[56:59], a[48:51], v[60:63]
    ds_read_b128 a[64:67], v9 offset:21504
    ds_read_b128 a[32:35], v9 offset:4096
    v_mfma_f32_16x16x32_bf16 v[56:59], a[56:59], a[44:47], v[56:59]
    s_lshl_b32 s0, s78, 1
    v_mfma_f32_16x16x32_bf16 v[56:59], a[20:23], a[8:11], v[56:59]
    ds_read_b128 a[68:71], v9 offset:22528
    v_mfma_f32_16x16x32_bf16 v[52:55], a[20:23], a[4:7], v[52:55]
    v_mfma_f32_16x16x32_bf16 v[52:55], a[56:59], a[40:43], v[52:55]
    buffer_load_dwordx4 v11, s[12:15], s41 offen offset:2048 sc1 lds
    v_mfma_f32_16x16x32_bf16 v[48:51], a[56:59], a[36:39], v[48:51]
    s_and_b32 s1, s76, 1
    v_mfma_f32_16x16x32_bf16 v[48:51], a[20:23], a[0:3], v[48:51]
    s_waitcnt vmcnt(13) lgkmcnt(0)
    s_barrier
    v_mfma_f32_16x16x32_bf16 v[64:67], a[24:27], a[0:3], v[64:67]
    s_add_u32 s0, s0, s1
    v_add_u32 v6, 0, v2
    v_add_u32 v9, 0, v3
    v_mfma_f32_16x16x32_bf16 v[64:67], a[60:63], a[36:39], v[64:67]
    buffer_load_dwordx4 v11, s[12:15], s41 offen offset:3072 sc1 lds
    v_mfma_f32_16x16x32_bf16 v[68:71], a[60:63], a[40:43], v[68:71]
    s_add_u32 m0, s20, 81920
    v_mfma_f32_16x16x32_bf16 v[68:71], a[24:27], a[4:7], v[68:71]
    s_mul_i32 s62, s0, 5120
    v_mfma_f32_16x16x32_bf16 v[72:75], a[24:27], a[8:11], v[72:75]
    s_add_u32 s41, s41, 4096
    s_lshl_b32 s0, s36, 10
    v_mfma_f32_16x16x32_bf16 v[72:75], a[60:63], a[44:47], v[72:75]
    buffer_load_dwordx4 v11, s[12:15], s41 offen sc1 lds
    v_mfma_f32_16x16x32_bf16 v[76:79], a[60:63], a[48:51], v[76:79]
    s_lshl_b32 s40, s40, 17
    s_add_u32 s40, s40, s16
    v_mfma_f32_16x16x32_bf16 v[76:79], a[24:27], a[12:15], v[76:79]
    s_add_u32 m0, s20, 73728
    v_mfma_f32_16x16x32_bf16 v[92:95], a[28:31], a[12:15], v[92:95]
    buffer_load_dwordx4 v11, s[8:11], s40 offen offset:0 sc1 lds
    v_mfma_f32_16x16x32_bf16 v[92:95], a[64:67], a[48:51], v[92:95]
    ds_read_b128 a[96:99], v6 offset:0
    v_mfma_f32_16x16x32_bf16 v[88:91], a[64:67], a[44:47], v[88:91]
    ds_read_b128 a[132:135], v6 offset:18432
    v_mfma_f32_16x16x32_bf16 v[88:91], a[28:31], a[8:11], v[88:91]
    ds_read_b128 a[100:103], v6 offset:1024
    ds_read_b128 a[136:139], v6 offset:19456
    v_mfma_f32_16x16x32_bf16 v[84:87], a[28:31], a[4:7], v[84:87]
    buffer_load_dwordx4 v11, s[8:11], s40 offen offset:1024 sc1 lds
    v_mfma_f32_16x16x32_bf16 v[84:87], a[64:67], a[40:43], v[84:87]
    ds_read_b128 a[104:107], v6 offset:2048
    v_mfma_f32_16x16x32_bf16 v[80:83], a[64:67], a[36:39], v[80:83]
    ds_read_b128 a[140:143], v6 offset:20480
    v_add_u32 v212, 0, v11
    v_mfma_f32_16x16x32_bf16 v[80:83], a[28:31], a[0:3], v[80:83]
    ds_read_b128 a[108:111], v6 offset:3072
    v_mfma_f32_16x16x32_bf16 v[96:99], a[32:35], a[0:3], v[96:99]
    buffer_load_dwordx4 v11, s[8:11], s40 offen offset:2048 sc1 lds
    v_mfma_f32_16x16x32_bf16 v[96:99], a[68:71], a[36:39], v[96:99]
    ds_read_b128 a[144:147], v6 offset:21504
    ds_read_b128 a[112:115], v9 offset:0
    v_mfma_f32_16x16x32_bf16 v[100:103], a[68:71], a[40:43], v[100:103]
    v_add_u32 v213, s0, v212
    v_mfma_f32_16x16x32_bf16 v[100:103], a[32:35], a[4:7], v[100:103]
    ds_read_b128 a[148:151], v9 offset:18432
    v_mfma_f32_16x16x32_bf16 v[104:107], a[32:35], a[8:11], v[104:107]
    ds_read_b128 a[116:119], v9 offset:1024
    ds_read_b128 a[152:155], v9 offset:19456
    v_mfma_f32_16x16x32_bf16 v[104:107], a[68:71], a[44:47], v[104:107]
    v_add_u32 v214, 36864, v11
    v_add_u32 v215, s0, v214
    v_mfma_f32_16x16x32_bf16 v[108:111], a[68:71], a[48:51], v[108:111]
    buffer_load_dwordx4 v11, s[8:11], s40 offen offset:3072 sc1 lds
    v_mfma_f32_16x16x32_bf16 v[108:111], a[32:35], a[12:15], v[108:111]
    s_waitcnt lgkmcnt(2)
    v_mfma_f32_16x16x32_bf16 v[32:35], a[112:115], a[96:99], v[32:35]
    ds_read_b128 a[120:123], v9 offset:2048
    ds_read_b128 a[156:159], v9 offset:20480
    v_mfma_f32_16x16x32_bf16 v[32:35], a[148:151], a[132:135], v[32:35]
    s_xor_b32 s40, s19, 22
    ds_read_b128 a[124:127], v9 offset:3072
    v_mfma_f32_16x16x32_bf16 v[36:39], a[148:151], a[136:139], v[36:39]
    v_mfma_f32_16x16x32_bf16 v[36:39], a[112:115], a[100:103], v[36:39]
    s_mul_i32 s41, s40, 40960
    s_add_u32 s41, s41, s17
    s_add_u32 m0, s20, 114688
    v_mfma_f32_16x16x32_bf16 v[40:43], a[112:115], a[104:107], v[40:43]
    buffer_load_dwordx4 v11, s[12:15], s41 offen offset:0 sc1 lds
    v_mfma_f32_16x16x32_bf16 v[40:43], a[148:151], a[140:143], v[40:43]
    v_mfma_f32_16x16x32_bf16 v[44:47], a[148:151], a[144:147], v[44:47]
    v_mfma_f32_16x16x32_bf16 v[44:47], a[112:115], a[108:111], v[44:47]
    s_waitcnt lgkmcnt(3)
    v_mfma_f32_16x16x32_bf16 v[60:63], a[116:119], a[108:111], v[60:63]
    buffer_load_dwordx4 v11, s[12:15], s41 offen offset:1024 sc1 lds
    v_mfma_f32_16x16x32_bf16 v[60:63], a[152:155], a[144:147], v[60:63]
    ds_read_b128 a[160:163], v9 offset:21504
    v_mfma_f32_16x16x32_bf16 v[56:59], a[152:155], a[140:143], v[56:59]
    ds_read_b128 a[128:131], v9 offset:4096
    v_mfma_f32_16x16x32_bf16 v[56:59], a[116:119], a[104:107], v[56:59]
    ds_read_b128 a[164:167], v9 offset:22528
    v_mfma_f32_16x16x32_bf16 v[52:55], a[116:119], a[100:103], v[52:55]
    v_mfma_f32_16x16x32_bf16 v[52:55], a[152:155], a[136:139], v[52:55]
    buffer_load_dwordx4 v11, s[12:15], s41 offen offset:2048 sc1 lds
    v_mfma_f32_16x16x32_bf16 v[48:51], a[152:155], a[132:135], v[48:51]
    v_mfma_f32_16x16x32_bf16 v[48:51], a[116:119], a[96:99], v[48:51]
    s_waitcnt vmcnt(12) lgkmcnt(0)
    s_barrier
    v_mfma_f32_16x16x32_bf16 v[64:67], a[120:123], a[96:99], v[64:67]
    v_add_u32 v6, 36864, v2
    v_add_u32 v9, 36864, v3
    v_mfma_f32_16x16x32_bf16 v[64:67], a[156:159], a[132:135], v[64:67]
    buffer_load_dwordx4 v11, s[12:15], s41 offen offset:3072 sc1 lds
    v_mfma_f32_16x16x32_bf16 v[68:71], a[156:159], a[136:139], v[68:71]
    v_mfma_f32_16x16x32_bf16 v[68:71], a[120:123], a[100:103], v[68:71]
    s_add_u32 m0, s20, 118784
    ds_read_b128 a[0:3], v6 offset:0
    v_mfma_f32_16x16x32_bf16 v[72:75], a[120:123], a[104:107], v[72:75]
    s_add_u32 s41, s41, 4096
    v_mfma_f32_16x16x32_bf16 v[72:75], a[156:159], a[140:143], v[72:75]
    v_mfma_f32_16x16x32_bf16 v[76:79], a[156:159], a[144:147], v[76:79]
    buffer_load_dwordx4 v11, s[12:15], s41 offen sc1 lds
    v_mfma_f32_16x16x32_bf16 v[76:79], a[120:123], a[108:111], v[76:79]
    s_lshl_b32 s40, s40, 17
    s_add_u32 s40, s40, s16
    v_mfma_f32_16x16x32_bf16 v[92:95], a[124:127], a[108:111], v[92:95]
    ds_read_b128 a[36:39], v6 offset:18432
    ds_read_b128 a[4:7], v6 offset:1024
    v_mfma_f32_16x16x32_bf16 v[92:95], a[160:163], a[144:147], v[92:95]
    s_add_u32 m0, s20, 110592
    v_mfma_f32_16x16x32_bf16 v[88:91], a[160:163], a[140:143], v[88:91]
    buffer_load_dwordx4 v11, s[8:11], s40 offen offset:0 sc1 lds
    v_mfma_f32_16x16x32_bf16 v[88:91], a[124:127], a[104:107], v[88:91]
    ds_read_b128 a[40:43], v6 offset:19456
    ds_read_b128 a[8:11], v6 offset:2048
    v_mfma_f32_16x16x32_bf16 v[84:87], a[124:127], a[100:103], v[84:87]
    ds_read_b128 a[44:47], v6 offset:20480
    ds_read_b128 a[12:15], v6 offset:3072
    v_mfma_f32_16x16x32_bf16 v[84:87], a[160:163], a[136:139], v[84:87]
    v_mfma_f32_16x16x32_bf16 v[80:83], a[160:163], a[132:135], v[80:83]
    buffer_load_dwordx4 v11, s[8:11], s40 offen offset:1024 sc1 lds
    v_mfma_f32_16x16x32_bf16 v[80:83], a[124:127], a[96:99], v[80:83]
    v_mfma_f32_16x16x32_bf16 v[96:99], a[128:131], a[96:99], v[96:99]
    ds_read_b128 a[48:51], v6 offset:21504
    ds_read_b128 a[16:19], v9 offset:0
    v_mfma_f32_16x16x32_bf16 v[96:99], a[164:167], a[132:135], v[96:99]
    ds_read_b128 a[52:55], v9 offset:18432
    ds_read_b128 a[20:23], v9 offset:1024
    v_mfma_f32_16x16x32_bf16 v[100:103], a[164:167], a[136:139], v[100:103]
    buffer_load_dwordx4 v11, s[8:11], s40 offen offset:2048 sc1 lds
    v_mfma_f32_16x16x32_bf16 v[100:103], a[128:131], a[100:103], v[100:103]
    v_mfma_f32_16x16x32_bf16 v[104:107], a[128:131], a[104:107], v[104:107]
    v_mfma_f32_16x16x32_bf16 v[104:107], a[164:167], a[140:143], v[104:107]
    v_mfma_f32_16x16x32_bf16 v[108:111], a[164:167], a[144:147], v[108:111]
    buffer_load_dwordx4 v11, s[8:11], s40 offen offset:3072 sc1 lds
    v_mfma_f32_16x16x32_bf16 v[108:111], a[128:131], a[108:111], v[108:111]
    ds_read_b128 a[56:59], v9 offset:19456
    s_waitcnt lgkmcnt(2)
    v_mfma_f32_16x16x32_bf16 v[32:35], a[16:19], a[0:3], v[32:35]
    ds_read_b128 a[24:27], v9 offset:2048
    ds_read_b128 a[60:63], v9 offset:20480
    v_mfma_f32_16x16x32_bf16 v[32:35], a[52:55], a[36:39], v[32:35]
    s_xor_b32 s40, s19, 24
    ds_read_b128 a[28:31], v9 offset:3072
    v_mfma_f32_16x16x32_bf16 v[36:39], a[52:55], a[40:43], v[36:39]
    v_mfma_f32_16x16x32_bf16 v[36:39], a[16:19], a[4:7], v[36:39]
    s_mul_i32 s41, s40, 40960
    s_add_u32 s41, s41, s17
    s_add_u32 m0, s20, 4096
    v_mfma_f32_16x16x32_bf16 v[40:43], a[16:19], a[8:11], v[40:43]
    buffer_load_dwordx4 v11, s[12:15], s41 offen offset:0 sc1 lds
    v_mfma_f32_16x16x32_bf16 v[40:43], a[52:55], a[44:47], v[40:43]
    v_mfma_f32_16x16x32_bf16 v[44:47], a[52:55], a[48:51], v[44:47]
    v_mfma_f32_16x16x32_bf16 v[44:47], a[16:19], a[12:15], v[44:47]
    s_waitcnt lgkmcnt(3)
    v_mfma_f32_16x16x32_bf16 v[60:63], a[20:23], a[12:15], v[60:63]
    buffer_load_dwordx4 v11, s[12:15], s41 offen offset:1024 sc1 lds
    v_mfma_f32_16x16x32_bf16 v[60:63], a[56:59], a[48:51], v[60:63]
    ds_read_b128 a[64:67], v9 offset:21504
    v_mfma_f32_16x16x32_bf16 v[56:59], a[56:59], a[44:47], v[56:59]
    ds_read_b128 a[32:35], v9 offset:4096
    v_mfma_f32_16x16x32_bf16 v[56:59], a[20:23], a[8:11], v[56:59]
    ds_read_b128 a[68:71], v9 offset:22528
    v_mfma_f32_16x16x32_bf16 v[52:55], a[20:23], a[4:7], v[52:55]
    v_mfma_f32_16x16x32_bf16 v[52:55], a[56:59], a[40:43], v[52:55]
    buffer_load_dwordx4 v11, s[12:15], s41 offen offset:2048 sc1 lds
    v_mfma_f32_16x16x32_bf16 v[48:51], a[56:59], a[36:39], v[48:51]
    v_mfma_f32_16x16x32_bf16 v[48:51], a[20:23], a[0:3], v[48:51]
    s_waitcnt vmcnt(12) lgkmcnt(0)
    s_barrier
    v_mfma_f32_16x16x32_bf16 v[64:67], a[24:27], a[0:3], v[64:67]
    v_add_u32 v6, 73728, v2
    v_add_u32 v9, 73728, v3
    v_mfma_f32_16x16x32_bf16 v[64:67], a[60:63], a[36:39], v[64:67]
    buffer_load_dwordx4 v11, s[12:15], s41 offen offset:3072 sc1 lds
    v_mfma_f32_16x16x32_bf16 v[68:71], a[60:63], a[40:43], v[68:71]
    v_mfma_f32_16x16x32_bf16 v[68:71], a[24:27], a[4:7], v[68:71]
    s_add_u32 m0, s20, 8192
    ds_read_b128 a[96:99], v6 offset:0
    v_mfma_f32_16x16x32_bf16 v[72:75], a[24:27], a[8:11], v[72:75]
    s_add_u32 s41, s41, 4096
    v_mfma_f32_16x16x32_bf16 v[72:75], a[60:63], a[44:47], v[72:75]
    v_mfma_f32_16x16x32_bf16 v[76:79], a[60:63], a[48:51], v[76:79]
    buffer_load_dwordx4 v11, s[12:15], s41 offen sc1 lds
    v_mfma_f32_16x16x32_bf16 v[76:79], a[24:27], a[12:15], v[76:79]
    s_lshl_b32 s40, s40, 17
    s_add_u32 s40, s40, s16
    v_mfma_f32_16x16x32_bf16 v[92:95], a[28:31], a[12:15], v[92:95]
    ds_read_b128 a[132:135], v6 offset:18432
    ds_read_b128 a[100:103], v6 offset:1024
    v_mfma_f32_16x16x32_bf16 v[92:95], a[64:67], a[48:51], v[92:95]
    s_add_u32 m0, s20, 0
    v_mfma_f32_16x16x32_bf16 v[88:91], a[64:67], a[44:47], v[88:91]
    buffer_load_dwordx4 v11, s[8:11], s40 offen offset:0 sc1 lds
    v_mfma_f32_16x16x32_bf16 v[88:91], a[28:31], a[8:11], v[88:91]
    ds_read_b128 a[136:139], v6 offset:19456
    ds_read_b128 a[104:107], v6 offset:2048
    v_mfma_f32_16x16x32_bf16 v[84:87], a[28:31], a[4:7], v[84:87]
    ds_read_b128 a[140:143], v6 offset:20480
    ds_read_b128 a[108:111], v6 offset:3072
    v_mfma_f32_16x16x32_bf16 v[84:87], a[64:67], a[40:43], v[84:87]
    v_mfma_f32_16x16x32_bf16 v[80:83], a[64:67], a[36:39], v[80:83]
    buffer_load_dwordx4 v11, s[8:11], s40 offen offset:1024 sc1 lds
    v_mfma_f32_16x16x32_bf16 v[80:83], a[28:31], a[0:3], v[80:83]
    v_mfma_f32_16x16x32_bf16 v[96:99], a[32:35], a[0:3], v[96:99]
    ds_read_b128 a[144:147], v6 offset:21504
    ds_read_b128 a[112:115], v9 offset:0
    v_mfma_f32_16x16x32_bf16 v[96:99], a[68:71], a[36:39], v[96:99]
    ds_read_b128 a[148:151], v9 offset:18432
    ds_read_b128 a[116:119], v9 offset:1024
    v_mfma_f32_16x16x32_bf16 v[100:103], a[68:71], a[40:43], v[100:103]
    buffer_load_dwordx4 v11, s[8:11], s40 offen offset:2048 sc1 lds
    v_mfma_f32_16x16x32_bf16 v[100:103], a[32:35], a[4:7], v[100:103]
    v_mfma_f32_16x16x32_bf16 v[104:107], a[32:35], a[8:11], v[104:107]
    v_mfma_f32_16x16x32_bf16 v[104:107], a[68:71], a[44:47], v[104:107]
    v_mfma_f32_16x16x32_bf16 v[108:111], a[68:71], a[48:51], v[108:111]
    buffer_load_dwordx4 v11, s[8:11], s40 offen offset:3072 sc1 lds
    v_mfma_f32_16x16x32_bf16 v[108:111], a[32:35], a[12:15], v[108:111]
    ds_read_b128 a[152:155], v9 offset:19456
    s_waitcnt lgkmcnt(2)
    v_mfma_f32_16x16x32_bf16 v[32:35], a[112:115], a[96:99], v[32:35]
    ds_read_b128 a[120:123], v9 offset:2048
    ds_read_b128 a[156:159], v9 offset:20480
    v_mfma_f32_16x16x32_bf16 v[32:35], a[148:151], a[132:135], v[32:35]
    s_xor_b32 s40, s19, 26
    ds_read_b128 a[124:127], v9 offset:3072
    v_mfma_f32_16x16x32_bf16 v[36:39], a[148:151], a[136:139], v[36:39]
    v_mfma_f32_16x16x32_bf16 v[36:39], a[112:115], a[100:103], v[36:39]
    s_mul_i32 s41, s40, 40960
    s_add_u32 s41, s41, s17
    s_add_u32 m0, s20, 40960
    v_mfma_f32_16x16x32_bf16 v[40:43], a[112:115], a[104:107], v[40:43]
    buffer_load_dwordx4 v11, s[12:15], s41 offen offset:0 sc1 lds
    v_mfma_f32_16x16x32_bf16 v[40:43], a[148:151], a[140:143], v[40:43]
    v_mfma_f32_16x16x32_bf16 v[44:47], a[148:151], a[144:147], v[44:47]
    v_mfma_f32_16x16x32_bf16 v[44:47], a[112:115], a[108:111], v[44:47]
    s_waitcnt lgkmcnt(3)
    v_mfma_f32_16x16x32_bf16 v[60:63], a[116:119], a[108:111], v[60:63]
    buffer_load_dwordx4 v11, s[12:15], s41 offen offset:1024 sc1 lds
    v_mfma_f32_16x16x32_bf16 v[60:63], a[152:155], a[144:147], v[60:63]
    ds_read_b128 a[160:163], v9 offset:21504
    v_mfma_f32_16x16x32_bf16 v[56:59], a[152:155], a[140:143], v[56:59]
    ds_read_b128 a[128:131], v9 offset:4096
    v_mfma_f32_16x16x32_bf16 v[56:59], a[116:119], a[104:107], v[56:59]
    ds_read_b128 a[164:167], v9 offset:22528
    v_mfma_f32_16x16x32_bf16 v[52:55], a[116:119], a[100:103], v[52:55]
    v_mfma_f32_16x16x32_bf16 v[52:55], a[152:155], a[136:139], v[52:55]
    buffer_load_dwordx4 v11, s[12:15], s41 offen offset:2048 sc1 lds
    v_mfma_f32_16x16x32_bf16 v[48:51], a[152:155], a[132:135], v[48:51]
    v_mfma_f32_16x16x32_bf16 v[48:51], a[116:119], a[96:99], v[48:51]
    s_waitcnt vmcnt(12) lgkmcnt(0)
    s_barrier
    v_mfma_f32_16x16x32_bf16 v[64:67], a[120:123], a[96:99], v[64:67]
    v_add_u32 v6, 110592, v2
    v_add_u32 v9, 110592, v3
    v_mfma_f32_16x16x32_bf16 v[64:67], a[156:159], a[132:135], v[64:67]
    buffer_load_dwordx4 v11, s[12:15], s41 offen offset:3072 sc1 lds
    v_mfma_f32_16x16x32_bf16 v[68:71], a[156:159], a[136:139], v[68:71]
    v_mfma_f32_16x16x32_bf16 v[68:71], a[120:123], a[100:103], v[68:71]
    s_add_u32 m0, s20, 45056
    ds_read_b128 a[0:3], v6 offset:0
    v_mfma_f32_16x16x32_bf16 v[72:75], a[120:123], a[104:107], v[72:75]
    s_add_u32 s41, s41, 4096
    v_mfma_f32_16x16x32_bf16 v[72:75], a[156:159], a[140:143], v[72:75]
    v_mfma_f32_16x16x32_bf16 v[76:79], a[156:159], a[144:147], v[76:79]
    buffer_load_dwordx4 v11, s[12:15], s41 offen sc1 lds
    v_mfma_f32_16x16x32_bf16 v[76:79], a[120:123], a[108:111], v[76:79]
    s_lshl_b32 s40, s40, 17
    s_add_u32 s40, s40, s16
    v_mfma_f32_16x16x32_bf16 v[92:95], a[124:127], a[108:111], v[92:95]
    ds_read_b128 a[36:39], v6 offset:18432
    ds_read_b128 a[4:7], v6 offset:1024
    v_mfma_f32_16x16x32_bf16 v[92:95], a[160:163], a[144:147], v[92:95]
    s_add_u32 m0, s20, 36864
    v_mfma_f32_16x16x32_bf16 v[88:91], a[160:163], a[140:143], v[88:91]
    buffer_load_dwordx4 v11, s[8:11], s40 offen offset:0 sc1 lds
    v_mfma_f32_16x16x32_bf16 v[88:91], a[124:127], a[104:107], v[88:91]
    ds_read_b128 a[40:43], v6 offset:19456
    ds_read_b128 a[8:11], v6 offset:2048
    v_mfma_f32_16x16x32_bf16 v[84:87], a[124:127], a[100:103], v[84:87]
    ds_read_b128 a[44:47], v6 offset:20480
    ds_read_b128 a[12:15], v6 offset:3072
    v_mfma_f32_16x16x32_bf16 v[84:87], a[160:163], a[136:139], v[84:87]
    v_mfma_f32_16x16x32_bf16 v[80:83], a[160:163], a[132:135], v[80:83]
    buffer_load_dwordx4 v11, s[8:11], s40 offen offset:1024 sc1 lds
    v_mfma_f32_16x16x32_bf16 v[80:83], a[124:127], a[96:99], v[80:83]
    v_mfma_f32_16x16x32_bf16 v[96:99], a[128:131], a[96:99], v[96:99]
    ds_read_b128 a[48:51], v6 offset:21504
    ds_read_b128 a[16:19], v9 offset:0
    v_mfma_f32_16x16x32_bf16 v[96:99], a[164:167], a[132:135], v[96:99]
    ds_read_b128 a[52:55], v9 offset:18432
    ds_read_b128 a[20:23], v9 offset:1024
    v_mfma_f32_16x16x32_bf16 v[100:103], a[164:167], a[136:139], v[100:103]
    buffer_load_dwordx4 v11, s[8:11], s40 offen offset:2048 sc1 lds
    v_mfma_f32_16x16x32_bf16 v[100:103], a[128:131], a[100:103], v[100:103]
    v_mfma_f32_16x16x32_bf16 v[104:107], a[128:131], a[104:107], v[104:107]
    v_mfma_f32_16x16x32_bf16 v[104:107], a[164:167], a[140:143], v[104:107]
    v_mfma_f32_16x16x32_bf16 v[108:111], a[164:167], a[144:147], v[108:111]
    buffer_load_dwordx4 v11, s[8:11], s40 offen offset:3072 sc1 lds
    v_mfma_f32_16x16x32_bf16 v[108:111], a[128:131], a[108:111], v[108:111]
    ds_read_b128 a[56:59], v9 offset:19456
    s_waitcnt lgkmcnt(2)
    v_mfma_f32_16x16x32_bf16 v[32:35], a[16:19], a[0:3], v[32:35]
    s_xor_b32 s40, s19, 28
    ds_read_b128 a[24:27], v9 offset:2048
    v_mfma_f32_16x16x32_bf16 v[32:35], a[52:55], a[36:39], v[32:35]
    s_mul_i32 s41, s40, 40960
    s_add_u32 s41, s41, s17
    s_add_u32 m0, s20, 77824
    v_mfma_f32_16x16x32_bf16 v[36:39], a[52:55], a[40:43], v[36:39]
    buffer_load_dwordx4 v11, s[12:15], s41 offen offset:0 sc1 lds
    v_mfma_f32_16x16x32_bf16 v[36:39], a[16:19], a[4:7], v[36:39]
    v_mfma_f32_16x16x32_bf16 v[40:43], a[16:19], a[8:11], v[40:43]
    v_mfma_f32_16x16x32_bf16 v[40:43], a[52:55], a[44:47], v[40:43]
    buffer_load_dwordx4 v11, s[12:15], s41 offen offset:1024 sc1 lds
    v_mfma_f32_16x16x32_bf16 v[44:47], a[52:55], a[48:51], v[44:47]
    ds_read_b128 a[60:63], v9 offset:20480
    v_mfma_f32_16x16x32_bf16 v[44:47], a[16:19], a[12:15], v[44:47]
    s_waitcnt lgkmcnt(2)
    v_mfma_f32_16x16x32_bf16 v[60:63], a[20:23], a[12:15], v[60:63]
    ds_read_b128 a[28:31], v9 offset:3072
    ds_read_b128 a[64:67], v9 offset:21504
    v_mfma_f32_16x16x32_bf16 v[60:63], a[56:59], a[48:51], v[60:63]
    buffer_load_dwordx4 v11, s[12:15], s41 offen offset:2048 sc1 lds
    v_mfma_f32_16x16x32_bf16 v[56:59], a[56:59], a[44:47], v[56:59]
    v_mfma_f32_16x16x32_bf16 v[56:59], a[20:23], a[8:11], v[56:59]
    ds_read_b128 a[32:35], v9 offset:4096
    ds_read_b128 a[68:71], v9 offset:22528
    v_mfma_f32_16x16x32_bf16 v[52:55], a[20:23], a[4:7], v[52:55]
    v_mfma_f32_16x16x32_bf16 v[52:55], a[56:59], a[40:43], v[52:55]
    buffer_load_dwordx4 v11, s[12:15], s41 offen offset:3072 sc1 lds
    v_mfma_f32_16x16x32_bf16 v[48:51], a[56:59], a[36:39], v[48:51]
    v_mfma_f32_16x16x32_bf16 v[48:51], a[20:23], a[0:3], v[48:51]
    s_waitcnt vmcnt(13) lgkmcnt(0)
    s_barrier
    v_mfma_f32_16x16x32_bf16 v[64:67], a[24:27], a[0:3], v[64:67]
    s_add_u32 m0, s20, 81920
    v_add_u32 v6, 0, v2
    v_mfma_f32_16x16x32_bf16 v[64:67], a[60:63], a[36:39], v[64:67]
    s_add_u32 s41, s41, 4096
    v_add_u32 v9, 0, v3
    v_mfma_f32_16x16x32_bf16 v[68:71], a[60:63], a[40:43], v[68:71]
    buffer_load_dword v4, v31, s[28:31], s50 offen sc0 sc1
    v_mfma_f32_16x16x32_bf16 v[68:71], a[24:27], a[4:7], v[68:71]
    v_mfma_f32_16x16x32_bf16 v[72:75], a[24:27], a[8:11], v[72:75]
    ds_read_b128 a[96:99], v6 offset:0
    ds_read_b128 a[132:135], v6 offset:18432
    v_mfma_f32_16x16x32_bf16 v[72:75], a[60:63], a[44:47], v[72:75]
    ds_read_b128 a[100:103], v6 offset:1024
    v_mfma_f32_16x16x32_bf16 v[76:79], a[60:63], a[48:51], v[76:79]
    buffer_load_dwordx4 v11, s[12:15], s41 offen sc1 lds
    v_mfma_f32_16x16x32_bf16 v[76:79], a[24:27], a[12:15], v[76:79]
    ds_read_b128 a[136:139], v6 offset:19456
    v_mfma_f32_16x16x32_bf16 v[92:95], a[28:31], a[12:15], v[92:95]
    ds_read_b128 a[104:107], v6 offset:2048
    v_mfma_f32_16x16x32_bf16 v[92:95], a[64:67], a[48:51], v[92:95]
    ds_read_b128 a[140:143], v6 offset:20480
    v_mfma_f32_16x16x32_bf16 v[88:91], a[64:67], a[44:47], v[88:91]
    s_lshl_b32 s40, s40, 17
    s_add_u32 s40, s40, s16
    s_add_u32 m0, s20, 73728
    v_mfma_f32_16x16x32_bf16 v[88:91], a[28:31], a[8:11], v[88:91]
    buffer_load_dwordx4 v11, s[8:11], s40 offen offset:0 sc1 lds
    v_mfma_f32_16x16x32_bf16 v[84:87], a[28:31], a[4:7], v[84:87]
    ds_read_b128 a[108:111], v6 offset:3072
    ds_read_b128 a[144:147], v6 offset:21504
    v_mfma_f32_16x16x32_bf16 v[84:87], a[64:67], a[40:43], v[84:87]
    buffer_load_dwordx4 v11, s[8:11], s40 offen offset:1024 sc1 lds
    v_mfma_f32_16x16x32_bf16 v[80:83], a[64:67], a[36:39], v[80:83]
    ds_read_b128 a[112:115], v9 offset:0
    ds_read_b128 a[148:151], v9 offset:18432
    v_mfma_f32_16x16x32_bf16 v[80:83], a[28:31], a[0:3], v[80:83]
    v_mfma_f32_16x16x32_bf16 v[96:99], a[32:35], a[0:3], v[96:99]
    v_mfma_f32_16x16x32_bf16 v[96:99], a[68:71], a[36:39], v[96:99]
    buffer_load_dwordx4 v11, s[8:11], s40 offen offset:2048 sc1 lds
    v_mfma_f32_16x16x32_bf16 v[100:103], a[68:71], a[40:43], v[100:103]
    v_mfma_f32_16x16x32_bf16 v[100:103], a[32:35], a[4:7], v[100:103]
    v_mfma_f32_16x16x32_bf16 v[104:107], a[32:35], a[8:11], v[104:107]
    v_mfma_f32_16x16x32_bf16 v[104:107], a[68:71], a[44:47], v[104:107]
    buffer_load_dwordx4 v11, s[8:11], s40 offen offset:3072 sc1 lds
    v_mfma_f32_16x16x32_bf16 v[108:111], a[68:71], a[48:51], v[108:111]
    ds_read_b128 a[116:119], v9 offset:1024
    ds_read_b128 a[152:155], v9 offset:19456
    v_mfma_f32_16x16x32_bf16 v[108:111], a[32:35], a[12:15], v[108:111]
    s_waitcnt lgkmcnt(2)
    v_mfma_f32_16x16x32_bf16 v[32:35], a[112:115], a[96:99], v[32:35]
    s_xor_b32 s40, s19, 30
    s_mul_i32 s41, s40, 40960
    s_add_u32 s41, s41, s17
    v_mfma_f32_16x16x32_bf16 v[32:35], a[148:151], a[132:135], v[32:35]
    s_add_u32 m0, s20, 114688
    v_mfma_f32_16x16x32_bf16 v[36:39], a[148:151], a[136:139], v[36:39]
    buffer_load_dwordx4 v11, s[12:15], s41 offen offset:0 sc1 lds
    v_mfma_f32_16x16x32_bf16 v[36:39], a[112:115], a[100:103], v[36:39]
    v_mfma_f32_16x16x32_bf16 v[40:43], a[112:115], a[104:107], v[40:43]
    v_mfma_f32_16x16x32_bf16 v[40:43], a[148:151], a[140:143], v[40:43]
    v_mfma_f32_16x16x32_bf16 v[44:47], a[148:151], a[144:147], v[44:47]
    buffer_load_dwordx4 v11, s[12:15], s41 offen offset:1024 sc1 lds
    v_mfma_f32_16x16x32_bf16 v[44:47], a[112:115], a[108:111], v[44:47]
    ds_read_b128 a[120:123], v9 offset:2048
    s_waitcnt lgkmcnt(1)
    v_mfma_f32_16x16x32_bf16 v[60:63], a[116:119], a[108:111], v[60:63]
    ds_read_b128 a[156:159], v9 offset:20480
    ds_read_b128 a[124:127], v9 offset:3072
    v_mfma_f32_16x16x32_bf16 v[60:63], a[152:155], a[144:147], v[60:63]
    buffer_load_dwordx4 v11, s[12:15], s41 offen offset:2048 sc1 lds
    v_mfma_f32_16x16x32_bf16 v[56:59], a[152:155], a[140:143], v[56:59]
    ds_read_b128 a[160:163], v9 offset:21504
    ds_read_b128 a[128:131], v9 offset:4096
    v_mfma_f32_16x16x32_bf16 v[56:59], a[116:119], a[104:107], v[56:59]
    ds_read_b128 a[164:167], v9 offset:22528
    v_mfma_f32_16x16x32_bf16 v[52:55], a[116:119], a[100:103], v[52:55]
    v_mfma_f32_16x16x32_bf16 v[52:55], a[152:155], a[136:139], v[52:55]
    buffer_load_dwordx4 v11, s[12:15], s41 offen offset:3072 sc1 lds
    v_mfma_f32_16x16x32_bf16 v[48:51], a[152:155], a[132:135], v[48:51]
    s_add_u32 m0, s20, 118784
    v_mfma_f32_16x16x32_bf16 v[48:51], a[116:119], a[96:99], v[48:51]
    s_waitcnt vmcnt(9) lgkmcnt(0)
    s_barrier
    v_mfma_f32_16x16x32_bf16 v[64:67], a[120:123], a[96:99], v[64:67]
    v_cmp_ne_u32 vcc, 1, v4
    s_nop 0
    s_cmp_eq_u64 vcc, 0
    s_cbranch_scc1 L_cwO16_ok
L_cwO16_no:
    s_mov_b32 s51, 0x40000
L_cwO16_spin:
    buffer_load_dword v4, v31, s[28:31], s50 offen sc0 sc1
    s_waitcnt vmcnt(0)
    v_cmp_ne_u32 vcc, 1, v4
    s_nop 0
    s_cmp_eq_u64 vcc, 0
    s_cbranch_scc1 L_cwO16_ok
L_cwO16_again:
    s_sleep 4
    s_sub_u32 s51, s51, 1
    s_cmp_lg_u32 s51, 0
    s_cbranch_scc1 L_cwO16_spin
L_cwO16_ok:
    v_mfma_f32_16x16x32_bf16 v[64:67], a[156:159], a[132:135], v[64:67]
    s_add_u32 s41, s41, 4096
    v_mfma_f32_16x16x32_bf16 v[68:71], a[156:159], a[136:139], v[68:71]
    buffer_load_dwordx4 v11, s[12:15], s41 offen sc1 lds
    v_mfma_f32_16x16x32_bf16 v[68:71], a[120:123], a[100:103], v[68:71]
    s_lshl_b32 s40, s40, 17
    s_add_u32 s40, s40, s16
    v_mfma_f32_16x16x32_bf16 v[72:75], a[120:123], a[104:107], v[72:75]
    v_add_u32 v6, 36864, v2
    v_add_u32 v9, 36864, v3
    v_mfma_f32_16x16x32_bf16 v[72:75], a[156:159], a[140:143], v[72:75]
    ds_read_b128 a[0:3], v6 offset:0
    v_mfma_f32_16x16x32_bf16 v[76:79], a[156:159], a[144:147], v[76:79]
    s_add_u32 m0, s20, 110592
    ds_read_b128 a[36:39], v6 offset:18432
    v_mfma_f32_16x16x32_bf16 v[76:79], a[120:123], a[108:111], v[76:79]
    ds_read_b128 a[4:7], v6 offset:1024
    v_mfma_f32_16x16x32_bf16 v[92:95], a[124:127], a[108:111], v[92:95]
    v_mfma_f32_16x16x32_bf16 v[92:95], a[160:163], a[144:147], v[92:95]
    buffer_load_dwordx4 v11, s[8:11], s40 offen offset:0 sc1 lds
    v_mfma_f32_16x16x32_bf16 v[88:91], a[160:163], a[140:143], v[88:91]
    ds_read_b128 a[40:43], v6 offset:19456
    v_mfma_f32_16x16x32_bf16 v[88:91], a[124:127], a[104:107], v[88:91]
    ds_read_b128 a[8:11], v6 offset:2048
    ds_read_b128 a[44:47], v6 offset:20480
    v_mfma_f32_16x16x32_bf16 v[84:87], a[124:127], a[100:103], v[84:87]
    v_mfma_f32_16x16x32_bf16 v[84:87], a[160:163], a[136:139], v[84:87]
    buffer_load_dwordx4 v11, s[8:11], s40 offen offset:1024 sc1 lds
    v_mfma_f32_16x16x32_bf16 v[80:83], a[160:163], a[132:135], v[80:83]
    ds_read_b128 a[12:15], v6 offset:3072
    ds_read_b128 a[48:51], v6 offset:21504
    v_mfma_f32_16x16x32_bf16 v[80:83], a[124:127], a[96:99], v[80:83]
    ds_read_b128 a[16:19], v9 offset:0
    v_mfma_f32_16x16x32_bf16 v[96:99], a[128:131], a[96:99], v[96:99]
    v_mfma_f32_16x16x32_bf16 v[96:99], a[164:167], a[132:135], v[96:99]
    buffer_load_dwordx4 v11, s[8:11], s40 offen offset:2048 sc1 lds
    v_mfma_f32_16x16x32_bf16 v[100:103], a[164:167], a[136:139], v[100:103]
    ds_read_b128 a[52:55], v9 offset:18432
    v_mfma_f32_16x16x32_bf16 v[100:103], a[128:131], a[100:103], v[100:103]
    ds_read_b128 a[20:23], v9 offset:1024
    ds_read_b128 a[56:59], v9 offset:19456
    v_mfma_f32_16x16x32_bf16 v[104:107], a[128:131], a[104:107], v[104:107]
    v_mfma_f32_16x16x32_bf16 v[104:107], a[164:167], a[140:143], v[104:107]
    v_mfma_f32_16x16x32_bf16 v[108:111], a[164:167], a[144:147], v[108:111]
    buffer_load_dwordx4 v11, s[8:11], s40 offen offset:3072 sc1 lds
    v_mfma_f32_16x16x32_bf16 v[108:111], a[128:131], a[108:111], v[108:111]
    s_waitcnt lgkmcnt(2)
    v_mfma_f32_16x16x32_bf16 v[32:35], a[16:19], a[0:3], v[32:35]
    ds_read_b128 a[24:27], v9 offset:2048
    ds_read_b128 a[60:63], v9 offset:20480
    v_mfma_f32_16x16x32_bf16 v[32:35], a[52:55], a[36:39], v[32:35]
    s_add_u32 s40, s36, 128
    ds_read_b128 a[28:31], v9 offset:3072
    v_mfma_f32_16x16x32_bf16 v[36:39], a[52:55], a[40:43], v[36:39]
    v_mfma_f32_16x16x32_bf16 v[36:39], a[16:19], a[4:7], v[36:39]
    s_mul_i32 s41, s40, 40960
    s_add_u32 s41, s41, s62
    s_add_u32 m0, s20, 4096
    v_mfma_f32_16x16x32_bf16 v[40:43], a[16:19], a[8:11], v[40:43]
    buffer_load_dwordx4 v11, s[12:15], s41 offen offset:0 sc1 lds
    v_mfma_f32_16x16x32_bf16 v[40:43], a[52:55], a[44:47], v[40:43]
    v_mfma_f32_16x16x32_bf16 v[44:47], a[52:55], a[48:51], v[44:47]
    v_mfma_f32_16x16x32_bf16 v[44:47], a[16:19], a[12:15], v[44:47]
    s_waitcnt lgkmcnt(3)
    v_mfma_f32_16x16x32_bf16 v[60:63], a[20:23], a[12:15], v[60:63]
    buffer_load_dwordx4 v11, s[12:15], s41 offen offset:1024 sc1 lds
    v_mfma_f32_16x16x32_bf16 v[60:63], a[56:59], a[48:51], v[60:63]
    ds_read_b128 a[64:67], v9 offset:21504
    v_mfma_f32_16x16x32_bf16 v[56:59], a[56:59], a[44:47], v[56:59]
    ds_read_b128 a[32:35], v9 offset:4096
    v_mfma_f32_16x16x32_bf16 v[56:59], a[20:23], a[8:11], v[56:59]
    ds_read_b128 a[68:71], v9 offset:22528
    v_mfma_f32_16x16x32_bf16 v[52:55], a[20:23], a[4:7], v[52:55]
    v_mfma_f32_16x16x32_bf16 v[52:55], a[56:59], a[40:43], v[52:55]
    buffer_load_dwordx4 v11, s[12:15], s41 offen offset:2048 sc1 lds
    v_mfma_f32_16x16x32_bf16 v[48:51], a[56:59], a[36:39], v[48:51]
    v_mfma_f32_16x16x32_bf16 v[48:51], a[20:23], a[0:3], v[48:51]
    s_waitcnt vmcnt(12) lgkmcnt(0)
    s_barrier
    v_mfma_f32_16x16x32_bf16 v[64:67], a[24:27], a[0:3], v[64:67]
    v_add_u32 v6, 73728, v2
    v_add_u32 v9, 73728, v3
    v_mfma_f32_16x16x32_bf16 v[64:67], a[60:63], a[36:39], v[64:67]
    buffer_load_dwordx4 v11, s[12:15], s41 offen offset:3072 sc1 lds
    v_mfma_f32_16x16x32_bf16 v[68:71], a[60:63], a[40:43], v[68:71]
    v_mfma_f32_16x16x32_bf16 v[68:71], a[24:27], a[4:7], v[68:71]
    s_add_u32 m0, s20, 8192
    ds_read_b128 a[96:99], v6 offset:0
    v_mfma_f32_16x16x32_bf16 v[72:75], a[24:27], a[8:11], v[72:75]
    s_add_u32 s41, s41, 4096
    v_mfma_f32_16x16x32_bf16 v[72:75], a[60:63], a[44:47], v[72:75]
    v_mfma_f32_16x16x32_bf16 v[76:79], a[60:63], a[48:51], v[76:79]
    buffer_load_dwordx4 v11, s[12:15], s41 offen sc1 lds
    v_mfma_f32_16x16x32_bf16 v[76:79], a[24:27], a[12:15], v[76:79]
    s_lshl_b32 s40, s40, 17
    s_add_u32 s40, s40, s60
    v_mfma_f32_16x16x32_bf16 v[92:95], a[28:31], a[12:15], v[92:95]
    ds_read_b128 a[132:135], v6 offset:18432
    ds_read_b128 a[100:103], v6 offset:1024
    v_mfma_f32_16x16x32_bf16 v[92:95], a[64:67], a[48:51], v[92:95]
    s_add_u32 m0, s20, 0
    v_mfma_f32_16x16x32_bf16 v[88:91], a[64:67], a[44:47], v[88:91]
    buffer_load_dwordx4 v11, s[8:11], s40 offen offset:0 sc1 lds
    v_mfma_f32_16x16x32_bf16 v[88:91], a[28:31], a[8:11], v[88:91]
    ds_read_b128 a[136:139], v6 offset:19456
    ds_read_b128 a[104:107], v6 offset:2048
    v_mfma_f32_16x16x32_bf16 v[84:87], a[28:31], a[4:7], v[84:87]
    ds_read_b128 a[140:143], v6 offset:20480
    ds_read_b128 a[108:111], v6 offset:3072
    v_mfma_f32_16x16x32_bf16 v[84:87], a[64:67], a[40:43], v[84:87]
    v_mfma_f32_16x16x32_bf16 v[80:83], a[64:67], a[36:39], v[80:83]
    buffer_load_dwordx4 v11, s[8:11], s40 offen offset:1024 sc1 lds
    v_mfma_f32_16x16x32_bf16 v[80:83], a[28:31], a[0:3], v[80:83]
    v_mfma_f32_16x16x32_bf16 v[96:99], a[32:35], a[0:3], v[96:99]
    ds_read_b128 a[144:147], v6 offset:21504
    ds_read_b128 a[112:115], v9 offset:0
    v_mfma_f32_16x16x32_bf16 v[96:99], a[68:71], a[36:39], v[96:99]
    ds_read_b128 a[148:151], v9 offset:18432
    ds_read_b128 a[116:119], v9 offset:1024
    v_mfma_f32_16x16x32_bf16 v[100:103], a[68:71], a[40:43], v[100:103]
    buffer_load_dwordx4 v11, s[8:11], s40 offen offset:2048 sc1 lds
    v_mfma_f32_16x16x32_bf16 v[100:103], a[32:35], a[4:7], v[100:103]
    v_mfma_f32_16x16x32_bf16 v[104:107], a[32:35], a[8:11], v[104:107]
    v_mfma_f32_16x16x32_bf16 v[104:107], a[68:71], a[44:47], v[104:107]
    v_mfma_f32_16x16x32_bf16 v[108:111], a[68:71], a[48:51], v[108:111]
    buffer_load_dwordx4 v11, s[8:11], s40 offen offset:3072 sc1 lds
    v_mfma_f32_16x16x32_bf16 v[108:111], a[32:35], a[12:15], v[108:111]
    ds_read_b128 a[152:155], v9 offset:19456
    s_waitcnt lgkmcnt(2)
    v_mfma_f32_16x16x32_bf16 v[32:35], a[112:115], a[96:99], v[32:35]
    ds_read_b128 a[120:123], v9 offset:2048
    ds_read_b128 a[156:159], v9 offset:20480
    v_mfma_f32_16x16x32_bf16 v[32:35], a[148:151], a[132:135], v[32:35]
    s_add_u32 s40, s36, 132
    ds_read_b128 a[124:127], v9 offset:3072
    v_mfma_f32_16x16x32_bf16 v[36:39], a[148:151], a[136:139], v[36:39]
    v_mfma_f32_16x16x32_bf16 v[36:39], a[112:115], a[100:103], v[36:39]
    s_mul_i32 s41, s40, 40960
    s_add_u32 s41, s41, s62
    s_add_u32 m0, s20, 40960
    v_mfma_f32_16x16x32_bf16 v[40:43], a[112:115], a[104:107], v[40:43]
    buffer_load_dwordx4 v11, s[12:15], s41 offen offset:0 sc1 lds
    v_mfma_f32_16x16x32_bf16 v[40:43], a[148:151], a[140:143], v[40:43]
    v_mfma_f32_16x16x32_bf16 v[44:47], a[148:151], a[144:147], v[44:47]
    v_mfma_f32_16x16x32_bf16 v[44:47], a[112:115], a[108:111], v[44:47]
    s_waitcnt lgkmcnt(3)
    v_mfma_f32_16x16x32_bf16 v[60:63], a[116:119], a[108:111], v[60:63]
    buffer_load_dwordx4 v11, s[12:15], s41 offen offset:1024 sc1 lds
    v_mfma_f32_16x16x32_bf16 v[60:63], a[152:155], a[144:147], v[60:63]
    ds_read_b128 a[160:163], v9 offset:21504
    v_mfma_f32_16x16x32_bf16 v[56:59], a[152:155], a[140:143], v[56:59]
    ds_read_b128 a[128:131], v9 offset:4096
    v_mfma_f32_16x16x32_bf16 v[56:59], a[116:119], a[104:107], v[56:59]
    ds_read_b128 a[164:167], v9 offset:22528
    v_mfma_f32_16x16x32_bf16 v[52:55], a[116:119], a[100:103], v[52:55]
    v_mfma_f32_16x16x32_bf16 v[52:55], a[152:155], a[136:139], v[52:55]
    buffer_load_dwordx4 v11, s[12:15], s41 offen offset:2048 sc1 lds
    v_mfma_f32_16x16x32_bf16 v[48:51], a[152:155], a[132:135], v[48:51]
    v_mfma_f32_16x16x32_bf16 v[48:51], a[116:119], a[96:99], v[48:51]
    s_waitcnt vmcnt(12) lgkmcnt(0)
    s_barrier
    v_mfma_f32_16x16x32_bf16 v[64:67], a[120:123], a[96:99], v[64:67]
    v_add_u32 v6, 110592, v2
    v_add_u32 v9, 110592, v3
    v_mfma_f32_16x16x32_bf16 v[64:67], a[156:159], a[132:135], v[64:67]
    buffer_load_dwordx4 v11, s[12:15], s41 offen offset:3072 sc1 lds
    v_mfma_f32_16x16x32_bf16 v[68:71], a[156:159], a[136:139], v[68:71]
    v_mfma_f32_16x16x32_bf16 v[68:71], a[120:123], a[100:103], v[68:71]
    s_add_u32 m0, s20, 45056
    ds_read_b128 a[0:3], v6 offset:0
    v_mfma_f32_16x16x32_bf16 v[72:75], a[120:123], a[104:107], v[72:75]
    s_add_u32 s41, s41, 4096
    v_mfma_f32_16x16x32_bf16 v[72:75], a[156:159], a[140:143], v[72:75]
    v_mfma_f32_16x16x32_bf16 v[76:79], a[156:159], a[144:147], v[76:79]
    buffer_load_dwordx4 v11, s[12:15], s41 offen sc1 lds
    v_mfma_f32_16x16x32_bf16 v[76:79], a[120:123], a[108:111], v[76:79]
    s_lshl_b32 s40, s40, 17
    s_add_u32 s40, s40, s60
    v_mfma_f32_16x16x32_bf16 v[92:95], a[124:127], a[108:111], v[92:95]
    ds_read_b128 a[36:39], v6 offset:18432
    ds_read_b128 a[4:7], v6 offset:1024
    v_mfma_f32_16x16x32_bf16 v[92:95], a[160:163], a[144:147], v[92:95]
    s_add_u32 m0, s20, 36864
    v_mfma_f32_16x16x32_bf16 v[88:91], a[160:163], a[140:143], v[88:91]
    buffer_load_dwordx4 v11, s[8:11], s40 offen offset:0 sc1 lds
    v_mfma_f32_16x16x32_bf16 v[88:91], a[124:127], a[104:107], v[88:91]
    ds_read_b128 a[40:43], v6 offset:19456
    ds_read_b128 a[8:11], v6 offset:2048
    v_mfma_f32_16x16x32_bf16 v[84:87], a[124:127], a[100:103], v[84:87]
    ds_read_b128 a[44:47], v6 offset:20480
    ds_read_b128 a[12:15], v6 offset:3072
    v_mfma_f32_16x16x32_bf16 v[84:87], a[160:163], a[136:139], v[84:87]
    v_mfma_f32_16x16x32_bf16 v[80:83], a[160:163], a[132:135], v[80:83]
    buffer_load_dwordx4 v11, s[8:11], s40 offen offset:1024 sc1 lds
    v_mfma_f32_16x16x32_bf16 v[80:83], a[124:127], a[96:99], v[80:83]
    v_mfma_f32_16x16x32_bf16 v[96:99], a[128:131], a[96:99], v[96:99]
    ds_read_b128 a[48:51], v6 offset:21504
    ds_read_b128 a[16:19], v9 offset:0
    v_mfma_f32_16x16x32_bf16 v[96:99], a[164:167], a[132:135], v[96:99]
    ds_read_b128 a[52:55], v9 offset:18432
    ds_read_b128 a[20:23], v9 offset:1024
    v_mfma_f32_16x16x32_bf16 v[100:103], a[164:167], a[136:139], v[100:103]
    buffer_load_dwordx4 v11, s[8:11], s40 offen offset:2048 sc1 lds
    v_mfma_f32_16x16x32_bf16 v[100:103], a[128:131], a[100:103], v[100:103]
    v_mfma_f32_16x16x32_bf16 v[104:107], a[128:131], a[104:107], v[104:107]
    v_mfma_f32_16x16x32_bf16 v[104:107], a[164:167], a[140:143], v[104:107]
    v_mfma_f32_16x16x32_bf16 v[108:111], a[164:167], a[144:147], v[108:111]
    buffer_load_dwordx4 v11, s[8:11], s40 offen offset:3072 sc1 lds
    v_mfma_f32_16x16x32_bf16 v[108:111], a[128:131], a[108:111], v[108:111]
    ds_read_b128 a[56:59], v9 offset:19456
    s_cmp_eq_u32 s36, s76
    s_cbranch_scc1 L_ownO
    s_waitcnt lgkmcnt(2)
    v_mfma_f32_16x16x32_bf16 v[32:35], a[16:19], a[0:3], v[32:35]
    v_mfma_f32_16x16x32_bf16 v[32:35], a[52:55], a[36:39], v[32:35]
    s_mov_b32 s23, 7
    v_mfma_f32_16x16x32_bf16 v[36:39], a[52:55], a[40:43], v[36:39]
    v_mfma_f32_16x16x32_bf16 v[36:39], a[16:19], a[4:7], v[36:39]
    v_mfma_f32_16x16x32_bf16 v[40:43], a[16:19], a[8:11], v[40:43]
    v_mfma_f32_16x16x32_bf16 v[40:43], a[52:55], a[44:47], v[40:43]
    ds_read_b128 a[24:27], v9 offset:2048
    ds_read_b128 a[60:63], v9 offset:20480
    v_mfma_f32_16x16x32_bf16 v[44:47], a[52:55], a[48:51], v[44:47]
    ds_read_b128 a[28:31], v9 offset:3072
    v_mfma_f32_16x16x32_bf16 v[44:47], a[16:19], a[12:15], v[44:47]
    s_waitcnt lgkmcnt(3)
    v_mfma_f32_16x16x32_bf16 v[48:51], a[20:23], a[0:3], v[48:51]
    ds_read_b128 a[64:67], v9 offset:21504
    ds_read_b128 a[32:35], v9 offset:4096
    v_mfma_f32_16x16x32_bf16 v[48:51], a[56:59], a[36:39], v[48:51]
    ds_read_b128 a[68:71], v9 offset:22528
    v_mfma_f32_16x16x32_bf16 v[52:55], a[56:59], a[40:43], v[52:55]
    v_mfma_f32_16x16x32_bf16 v[52:55], a[20:23], a[4:7], v[52:55]
    v_mfma_f32_16x16x32_bf16 v[56:59], a[20:23], a[8:11], v[56:59]
    v_mfma_f32_16x16x32_bf16 v[56:59], a[56:59], a[44:47], v[56:59]
    v_mfma_f32_16x16x32_bf16 v[60:63], a[56:59], a[48:51], v[60:63]
    buffer_load_dword v8, v18, s[28:31], s22 offen sc0 sc1
    v_mfma_f32_16x16x32_bf16 v[60:63], a[20:23], a[12:15], v[60:63]
    s_waitcnt lgkmcnt(4)
    v_mfma_f32_16x16x32_bf16 v[64:67], a[24:27], a[0:3], v[64:67]
    v_mfma_f32_16x16x32_bf16 v[64:67], a[60:63], a[36:39], v[64:67]
    v_cvt_pk_bf16_f32 v32, v32, v33
    v_cvt_pk_bf16_f32 v33, v34, v35
    v_mfma_f32_16x16x32_bf16 v[68:71], a[60:63], a[40:43], v[68:71]
    v_cvt_pk_bf16_f32 v34, v48, v49
    v_cvt_pk_bf16_f32 v35, v50, v51
    v_mfma_f32_16x16x32_bf16 v[68:71], a[24:27], a[4:7], v[68:71]
    s_add_u32 s3, s79, 0
    buffer_store_dwordx4 v[32:35], v11, s[28:31], s3 offen sc1
    v_mfma_f32_16x16x32_bf16 v[72:75], a[24:27], a[8:11], v[72:75]
    v_cvt_pk_bf16_f32 v36, v36, v37
    v_mfma_f32_16x16x32_bf16 v[72:75], a[60:63], a[44:47], v[72:75]
    v_cvt_pk_bf16_f32 v37, v38, v39
    v_cvt_pk_bf16_f32 v38, v52, v53
    v_mfma_f32_16x16x32_bf16 v[76:79], a[60:63], a[48:51], v[76:79]
    v_cvt_pk_bf16_f32 v39, v54, v55
    v_mfma_f32_16x16x32_bf16 v[76:79], a[24:27], a[12:15], v[76:79]
    s_add_u32 s3, s79, 2048
    s_waitcnt lgkmcnt(2)
    v_mfma_f32_16x16x32_bf16 v[80:83], a[28:31], a[0:3], v[80:83]
    buffer_store_dwordx4 v[36:39], v11, s[28:31], s3 offen sc1
    v_mfma_f32_16x16x32_bf16 v[80:83], a[64:67], a[36:39], v[80:83]
    v_cvt_pk_bf16_f32 v40, v40, v41
    v_cvt_pk_bf16_f32 v41, v42, v43
    v_mfma_f32_16x16x32_bf16 v[84:87], a[64:67], a[40:43], v[84:87]
    v_cvt_pk_bf16_f32 v42, v56, v57
    v_cvt_pk_bf16_f32 v43, v58, v59
    v_mfma_f32_16x16x32_bf16 v[84:87], a[28:31], a[4:7], v[84:87]
    s_add_u32 s3, s79, 4096
    v_mfma_f32_16x16x32_bf16 v[88:91], a[28:31], a[8:11], v[88:91]
    buffer_store_dwordx4 v[40:43], v11, s[28:31], s3 offen sc1
    v_mfma_f32_16x16x32_bf16 v[88:91], a[64:67], a[44:47], v[88:91]
    v_cvt_pk_bf16_f32 v44, v44, v45
    v_cvt_pk_bf16_f32 v45, v46, v47
    v_mfma_f32_16x16x32_bf16 v[92:95], a[64:67], a[48:51], v[92:95]
    v_cvt_pk_bf16_f32 v46, v60, v61
    v_cvt_pk_bf16_f32 v47, v62, v63
    v_mfma_f32_16x16x32_bf16 v[92:95], a[28:31], a[12:15], v[92:95]
    s_add_u32 s3, s79, 6144
    s_waitcnt lgkmcnt(0)
    v_mfma_f32_16x16x32_bf16 v[96:99], a[32:35], a[0:3], v[96:99]
    buffer_store_dwordx4 v[44:47], v11, s[28:31], s3 offen sc1
    v_mfma_f32_16x16x32_bf16 v[96:99], a[68:71], a[36:39], v[96:99]
    v_cvt_pk_bf16_f32 v64, v64, v65
    v_cvt_pk_bf16_f32 v65, v66, v67
    v_mfma_f32_16x16x32_bf16 v[100:103], a[68:71], a[40:43], v[100:103]
    v_cvt_pk_bf16_f32 v66, v80, v81
    v_cvt_pk_bf16_f32 v67, v82, v83
    v_mfma_f32_16x16x32_bf16 v[100:103], a[32:35], a[4:7], v[100:103]
    s_add_u32 s3, s79, 1024
    buffer_store_dwordx4 v[64:67], v11, s[28:31], s3 offen sc1
    v_cvt_pk_bf16_f32 v68, v68, v69
    v_cvt_pk_bf16_f32 v69, v70, v71
    v_mfma_f32_16x16x32_bf16 v[104:107], a[32:35], a[8:11], v[104:107]
    v_cvt_pk_bf16_f32 v70, v84, v85
    v_cvt_pk_bf16_f32 v71, v86, v87
    v_mfma_f32_16x16x32_bf16 v[104:107], a[68:71], a[44:47], v[104:107]
    s_add_u32 s3, s79, 3072
    buffer_store_dwordx4 v[68:71], v11, s[28:31], s3 offen sc1
    v_cvt_pk_bf16_f32 v72, v72, v73
    v_cvt_pk_bf16_f32 v73, v74, v75
    v_cvt_pk_bf16_f32 v74, v88, v89
    v_cvt_pk_bf16_f32 v75, v90, v91
    v_mfma_f32_16x16x32_bf16 v[108:111], a[68:71], a[48:51], v[108:111]
    s_add_u32 s3, s79, 5120
    v_mfma_f32_16x16x32_bf16 v[108:111], a[32:35], a[12:15], v[108:111]
    buffer_store_dwordx4 v[72:75], v11, s[28:31], s3 offen sc1
    s_nop 1
    v_cvt_pk_bf16_f32 v76, v76, v77
    v_cvt_pk_bf16_f32 v77, v78, v79
    v_cvt_pk_bf16_f32 v78, v92, v93
    v_cvt_pk_bf16_f32 v79, v94, v95
    s_add_u32 s3, s79, 7168
    buffer_store_dwordx4 v[76:79], v11, s[28:31], s3 offen sc1
    v_cvt_pk_bf16_f32 v96, v96, v97
    v_cvt_pk_bf16_f32 v97, v98, v99
    v_cvt_pk_bf16_f32 v98, v100, v101
    v_cvt_pk_bf16_f32 v99, v102, v103
    s_add_u32 s3, s79, 8192
    buffer_store_dwordx4 v[96:99], v11, s[28:31], s3 offen sc1
    v_cvt_pk_bf16_f32 v104, v104, v105
    v_cvt_pk_bf16_f32 v105, v106, v107
    v_cvt_pk_bf16_f32 v106, v108, v109
    v_cvt_pk_bf16_f32 v107, v110, v111
    s_add_u32 s3, s79, 9216
    buffer_store_dwordx4 v[104:107], v11, s[28:31], s3 offen sc1
    s_waitcnt vmcnt(10) lgkmcnt(0)
    s_branch L_joined
L_ownO:
    s_waitcnt lgkmcnt(2)
    v_mfma_f32_16x16x32_bf16 v[32:35], a[16:19], a[0:3], v[32:35]
    v_mfma_f32_16x16x32_bf16 v[32:35], a[52:55], a[36:39], v[32:35]
    s_mov_b32 s23, 7
    v_mfma_f32_16x16x32_bf16 v[36:39], a[52:55], a[40:43], v[36:39]
    v_mfma_f32_16x16x32_bf16 v[36:39], a[16:19], a[4:7], v[36:39]
    v_mfma_f32_16x16x32_bf16 v[40:43], a[16:19], a[8:11], v[40:43]
    v_mfma_f32_16x16x32_bf16 v[40:43], a[52:55], a[44:47], v[40:43]
    ds_read_b128 a[24:27], v9 offset:2048
    ds_read_b128 a[60:63], v9 offset:20480
    v_mfma_f32_16x16x32_bf16 v[44:47], a[52:55], a[48:51], v[44:47]
    ds_read_b128 a[28:31], v9 offset:3072
    v_mfma_f32_16x16x32_bf16 v[44:47], a[16:19], a[12:15], v[44:47]
    s_waitcnt lgkmcnt(3)
    v_mfma_f32_16x16x32_bf16 v[48:51], a[20:23], a[0:3], v[48:51]
    ds_read_b128 a[64:67], v9 offset:21504
    ds_read_b128 a[32:35], v9 offset:4096
    v_mfma_f32_16x16x32_bf16 v[48:51], a[56:59], a[36:39], v[48:51]
    ds_read_b128 a[68:71], v9 offset:22528
    v_mfma_f32_16x16x32_bf16 v[52:55], a[56:59], a[40:43], v[52:55]
    v_mfma_f32_16x16x32_bf16 v[52:55], a[20:23], a[4:7], v[52:55]
    v_mfma_f32_16x16x32_bf16 v[56:59], a[20:23], a[8:11], v[56:59]
    v_mfma_f32_16x16x32_bf16 v[56:59], a[56:59], a[44:47], v[56:59]
    v_mfma_f32_16x16x32_bf16 v[60:63], a[56:59], a[48:51], v[60:63]
    buffer_load_dword v8, v18, s[28:31], s22 offen sc0 sc1
    v_mfma_f32_16x16x32_bf16 v[60:63], a[20:23], a[12:15], v[60:63]
    s_waitcnt lgkmcnt(4)
    v_mfma_f32_16x16x32_bf16 v[64:67], a[24:27], a[0:3], v[64:67]
    v_mfma_f32_16x16x32_bf16 v[64:67], a[60:63], a[36:39], v[64:67]
    v_cvt_pk_bf16_f32 v32, v32, v33
    v_cvt_pk_bf16_f32 v33, v34, v35
    v_mfma_f32_16x16x32_bf16 v[68:71], a[60:63], a[40:43], v[68:71]
    v_cvt_pk_bf16_f32 v34, v48, v49
    v_cvt_pk_bf16_f32 v35, v50, v51
    v_mfma_f32_16x16x32_bf16 v[68:71], a[24:27], a[4:7], v[68:71]
    s_add_u32 s3, s79, 0
    ds_write_b128 v19, v[32:35] offset:0
    v_mfma_f32_16x16x32_bf16 v[72:75], a[24:27], a[8:11], v[72:75]
    v_cvt_pk_bf16_f32 v36, v36, v37
    v_mfma_f32_16x16x32_bf16 v[72:75], a[60:63], a[44:47], v[72:75]
    v_cvt_pk_bf16_f32 v37, v38, v39
    v_cvt_pk_bf16_f32 v38, v52, v53
    v_mfma_f32_16x16x32_bf16 v[76:79], a[60:63], a[48:51], v[76:79]
    v_cvt_pk_bf16_f32 v39, v54, v55
    v_mfma_f32_16x16x32_bf16 v[76:79], a[24:27], a[12:15], v[76:79]
    s_add_u32 s3, s79, 2048
    s_waitcnt lgkmcnt(3)
    v_mfma_f32_16x16x32_bf16 v[80:83], a[28:31], a[0:3], v[80:83]
    ds_write_b128 v19, v[36:39] offset:2048
    v_mfma_f32_16x16x32_bf16 v[80:83], a[64:67], a[36:39], v[80:83]
    v_cvt_pk_bf16_f32 v40, v40, v41
    v_cvt_pk_bf16_f32 v41, v42, v43
    v_mfma_f32_16x16x32_bf16 v[84:87], a[64:67], a[40:43], v[84:87]
    v_cvt_pk_bf16_f32 v42, v56, v57
    v_cvt_pk_bf16_f32 v43, v58, v59
    v_mfma_f32_16x16x32_bf16 v[84:87], a[28:31], a[4:7], v[84:87]
    s_add_u32 s3, s79, 4096
    v_mfma_f32_16x16x32_bf16 v[88:91], a[28:31], a[8:11], v[88:91]
    ds_write_b128 v19, v[40:43] offset:4096
    v_mfma_f32_16x16x32_bf16 v[88:91], a[64:67], a[44:47], v[88:91]
    v_cvt_pk_bf16_f32 v44, v44, v45
    v_cvt_pk_bf16_f32 v45, v46, v47
    v_mfma_f32_16x16x32_bf16 v[92:95], a[64:67], a[48:51], v[92:95]
    v_cvt_pk_bf16_f32 v46, v60, v61
    v_cvt_pk_bf16_f32 v47, v62, v63
    v_mfma_f32_16x16x32_bf16 v[92:95], a[28:31], a[12:15], v[92:95]
    s_add_u32 s3, s79, 6144
    s_waitcnt lgkmcnt(3)
    v_mfma_f32_16x16x32_bf16 v[96:99], a[32:35], a[0:3], v[96:99]
    ds_write_b128 v19, v[44:47] offset:6144
    v_mfma_f32_16x16x32_bf16 v[96:99], a[68:71], a[36:39], v[96:99]
    v_cvt_pk_bf16_f32 v64, v64, v65
    v_cvt_pk_bf16_f32 v65, v66, v67
    v_mfma_f32_16x16x32_bf16 v[100:103], a[68:71], a[40:43], v[100:103]
    v_cvt_pk_bf16_f32 v66, v80, v81
    v_cvt_pk_bf16_f32 v67, v82, v83
    v_mfma_f32_16x16x32_bf16 v[100:103], a[32:35], a[4:7], v[100:103]
    s_add_u32 s3, s79, 1024
    ds_write_b128 v19, v[64:67] offset:1024
    v_cvt_pk_bf16_f32 v68, v68, v69
    v_cvt_pk_bf16_f32 v69, v70, v71
    v_mfma_f32_16x16x32_bf16 v[104:107], a[32:35], a[8:11], v[104:107]
    v_cvt_pk_bf16_f32 v70, v84, v85
    v_cvt_pk_bf16_f32 v71, v86, v87
    v_mfma_f32_16x16x32_bf16 v[104:107], a[68:71], a[44:47], v[104:107]
    s_add_u32 s3, s79, 3072
    ds_write_b128 v19, v[68:71] offset:3072
    v_cvt_pk_bf16_f32 v72, v72, v73
    v_cvt_pk_bf16_f32 v73, v74, v75
    v_cvt_pk_bf16_f32 v74, v88, v89
    v_cvt_pk_bf16_f32 v75, v90, v91
    v_mfma_f32_16x16x32_bf16 v[108:111], a[68:71], a[48:51], v[108:111]
    s_add_u32 s3, s79, 5120
    v_mfma_f32_16x16x32_bf16 v[108:111], a[32:35], a[12:15], v[108:111]
    ds_write_b128 v19, v[72:75] offset:5120
    s_nop 1
    v_cvt_pk_bf16_f32 v76, v76, v77
    v_cvt_pk_bf16_f32 v77, v78, v79
    v_cvt_pk_bf16_f32 v78, v92, v93
    v_cvt_pk_bf16_f32 v79, v94, v95
    ds_write_b128 v19, v[76:79] offset:7168
    v_cvt_pk_bf16_f32 v96, v96, v97
    v_cvt_pk_bf16_f32 v97, v98, v99
    v_cvt_pk_bf16_f32 v98, v100, v101
    v_cvt_pk_bf16_f32 v99, v102, v103
    ds_write_b128 v19, v[96:99] offset:8192
    v_cvt_pk_bf16_f32 v104, v104, v105
    v_cvt_pk_bf16_f32 v105, v106, v107
    v_cvt_pk_bf16_f32 v106, v108, v109
    v_cvt_pk_bf16_f32 v107, v110, v111
    ds_write_b128 v19, v[104:107] offset:9216
    s_waitcnt vmcnt(0) lgkmcnt(0)
L_joined:
    s_mov_b32 s39, 0x40000
L_joined2:
    v_cmp_ne_u32 vcc, -1, v8
    s_nop 0
    s_and_b32 s25, vcc_lo, s23
    s_andn2_b32 s23, s23, s25
    s_bitcmp1_b32 s25, 0
    s_cbranch_scc0 L_nxa0
    buffer_load_dwordx4 v[152:155], v11, s[28:31], s44 offen sc1
    buffer_load_dwordx4 v[156:159], v11, s[28:31], s44 offen offset:1024 sc1
    buffer_load_dwordx4 v[160:163], v11, s[28:31], s47 offen sc1
L_nxa0:
    s_bitcmp1_b32 s25, 1
    s_cbranch_scc0 L_nxa1
    buffer_load_dwordx4 v[164:167], v11, s[28:31], s45 offen sc1
    buffer_load_dwordx4 v[168:171], v11, s[28:31], s45 offen offset:1024 sc1
    buffer_load_dwordx4 v[172:175], v11, s[28:31], s48 offen sc1
L_nxa1:
    s_bitcmp1_b32 s25, 2
    s_cbranch_scc0 L_nxa2
    buffer_load_dwordx4 v[176:179], v11, s[28:31], s46 offen sc1
    buffer_load_dwordx4 v[180:183], v11, s[28:31], s46 offen offset:1024 sc1
    buffer_load_dwordx4 v[184:187], v11, s[28:31], s49 offen sc1
L_nxa2:
    buffer_load_dword v8, v18, s[28:31], s22 offen sc0 sc1
    s_barrier
    ds_read_b128 v[188:191], v22
    ds_read_b128 v[192:195], v22 offset:1024
    ds_read_b128 v[196:199], v23
    ds_read_b128 a[0:3], v213 offset:0
    ds_read_b128 a[24:27], v213 offset:9216
    ds_read_b128 a[48:51], v213 offset:18432
    ds_read_b128 a[72:75], v213 offset:27648
    ds_read_b128 a[4:7], v212 offset:4096
    ds_read_b128 a[28:31], v212 offset:13312
    ds_read_b128 a[52:55], v212 offset:22528
    ds_read_b128 a[76:79], v212 offset:31744
    ds_read_b128 a[8:11], v212 offset:5120
    ds_read_b128 a[32:35], v212 offset:14336
    ds_read_b128 a[56:59], v212 offset:23552
    ds_read_b128 a[80:83], v212 offset:32768
    s_waitcnt lgkmcnt(4)
    v_mfma_f32_16x16x32_bf16 v[220:223], a[4:7], a[0:3], 0
    ds_read_b128 a[12:15], v212 offset:6144
    ds_read_b128 a[36:39], v212 offset:15360
    v_mfma_f32_16x16x32_bf16 v[220:223], a[28:31], a[24:27], v[220:223]
    ds_read_b128 a[60:63], v212 offset:24576
    ds_read_b128 a[84:87], v212 offset:33792
    v_mfma_f32_16x16x32_bf16 v[220:223], a[52:55], a[48:51], v[220:223]
    v_mfma_f32_16x16x32_bf16 v[220:223], a[76:79], a[72:75], v[220:223]
    s_waitcnt lgkmcnt(4)
    v_mfma_f32_16x16x32_bf16 v[224:227], a[8:11], a[0:3], 0
    ds_read_b128 a[16:19], v212 offset:7168
    ds_read_b128 a[40:43], v212 offset:16384
    v_mfma_f32_16x16x32_bf16 v[224:227], a[32:35], a[24:27], v[224:227]
    ds_read_b128 a[64:67], v212 offset:25600
    ds_read_b128 a[88:91], v212 offset:34816
    v_mfma_f32_16x16x32_bf16 v[224:227], a[56:59], a[48:51], v[224:227]
    v_mfma_f32_16x16x32_bf16 v[224:227], a[80:83], a[72:75], v[224:227]
    s_waitcnt lgkmcnt(4)
    v_mfma_f32_16x16x32_bf16 v[228:231], a[12:15], a[0:3], 0
    ds_read_b128 a[20:23], v212 offset:8192
    ds_read_b128 a[44:47], v212 offset:17408
    v_mfma_f32_16x16x32_bf16 v[228:231], a[36:39], a[24:27], v[228:231]
    ds_read_b128 a[68:71], v212 offset:26624
    ds_read_b128 a[92:95], v212 offset:35840
    v_mfma_f32_16x16x32_bf16 v[228:231], a[60:63], a[48:51], v[228:231]
    v_mfma_f32_16x16x32_bf16 v[228:231], a[84:87], a[72:75], v[228:231]
    s_waitcnt lgkmcnt(4)
    v_mfma_f32_16x16x32_bf16 v[232:235], a[16:19], a[0:3], 0
    ds_read_b128 a[96:99], v215 offset:0
    ds_read_b128 a[120:123], v215 offset:9216
    v_mfma_f32_16x16x32_bf16 v[232:235], a[40:43], a[24:27], v[232:235]
    ds_read_b128 a[144:147], v215 offset:18432
    ds_read_b128 a[168:171], v215 offset:27648
    v_mfma_f32_16x16x32_bf16 v[232:235], a[64:67], a[48:51], v[232:235]
    ds_read_b128 a[100:103], v214 offset:4096
    ds_read_b128 a[124:127], v214 offset:13312
    v_mfma_f32_16x16x32_bf16 v[232:235], a[88:91], a[72:75], v[232:235]
    ds_read_b128 a[148:151], v214 offset:22528
    ds_read_b128 a[172:175], v214 offset:31744
    s_waitcnt lgkmcnt(8)
    v_mfma_f32_16x16x32_bf16 v[236:239], a[20:23], a[0:3], 0
    ds_read_b128 a[104:107], v214 offset:5120
    ds_read_b128 a[128:131], v214 offset:14336
    v_mfma_f32_16x16x32_bf16 v[236:239], a[44:47], a[24:27], v[236:239]
    ds_read_b128 a[152:155], v214 offset:23552
    ds_read_b128 a[176:179], v214 offset:32768
    v_mfma_f32_16x16x32_bf16 v[236:239], a[68:71], a[48:51], v[236:239]
    v_mfma_f32_16x16x32_bf16 v[236:239], a[92:95], a[72:75], v[236:239]
    s_waitcnt lgkmcnt(4)
    v_mfma_f32_16x16x32_bf16 v[220:223], a[100:103], a[96:99], v[220:223]
    ds_read_b128 a[108:111], v214 offset:6144
    ds_read_b128 a[132:135], v214 offset:15360
    v_mfma_f32_16x16x32_bf16 v[220:223], a[124:127], a[120:123], v[220:223]
    ds_read_b128 a[156:159], v214 offset:24576
    ds_read_b128 a[180:183], v214 offset:33792
    v_mfma_f32_16x16x32_bf16 v[220:223], a[148:151], a[144:147], v[220:223]
    v_mfma_f32_16x16x32_bf16 v[220:223], a[172:175], a[168:171], v[220:223]
    s_waitcnt lgkmcnt(4)
    v_mfma_f32_16x16x32_bf16 v[224:227], a[104:107], a[96:99], v[224:227]
    ds_read_b128 a[112:115], v214 offset:7168
    ds_read_b128 a[136:139], v214 offset:16384
    v_mfma_f32_16x16x32_bf16 v[224:227], a[128:131], a[120:123], v[224:227]
    ds_read_b128 a[160:163], v214 offset:25600
    ds_read_b128 a[184:187], v214 offset:34816
    v_mfma_f32_16x16x32_bf16 v[224:227], a[152:155], a[144:147], v[224:227]
    v_mfma_f32_16x16x32_bf16 v[224:227], a[176:179], a[168:171], v[224:227]
    s_waitcnt lgkmcnt(4)
    v_mfma_f32_16x16x32_bf16 v[228:231], a[108:111], a[96:99], v[228:231]
    ds_read_b128 a[116:119], v214 offset:8192
    ds_read_b128 a[140:143], v214 offset:17408
    v_mfma_f32_16x16x32_bf16 v[228:231], a[132:135], a[120:123], v[228:231]
    ds_read_b128 a[164:167], v214 offset:26624
    ds_read_b128 a[188:191], v214 offset:35840
    v_mfma_f32_16x16x32_bf16 v[228:231], a[156:159], a[144:147], v[228:231]
    v_mfma_f32_16x16x32_bf16 v[228:231], a[180:183], a[168:171], v[228:231]
    s_waitcnt lgkmcnt(4)
    v_mfma_f32_16x16x32_bf16 v[232:235], a[112:115], a[96:99], v[232:235]
    v_mfma_f32_16x16x32_bf16 v[232:235], a[136:139], a[120:123], v[232:235]
    v_mfma_f32_16x16x32_bf16 v[232:235], a[160:163], a[144:147], v[232:235]
    v_mfma_f32_16x16x32_bf16 v[232:235], a[184:187], a[168:171], v[232:235]
    s_waitcnt lgkmcnt(0)
    v_mfma_f32_16x16x32_bf16 v[236:239], a[116:119], a[96:99], v[236:239]
    v_mfma_f32_16x16x32_bf16 v[236:239], a[140:143], a[120:123], v[236:239]
    v_mfma_f32_16x16x32_bf16 v[236:239], a[164:167], a[144:147], v[236:239]
    v_mfma_f32_16x16x32_bf16 v[236:239], a[188:191], a[168:171], v[236:239]
    s_waitcnt lgkmcnt(0)
    v_mfma_f32_16x16x32_bf16 v[220:223], v[202:205], v[188:191], v[220:223]
    v_mfma_f32_16x16x32_bf16 v[224:227], v[200:203], v[188:191], v[224:227]
    v_mfma_f32_16x16x32_bf16 v[228:231], v[202:205], v[192:195], v[228:231]
    v_mfma_f32_16x16x32_bf16 v[232:235], v[200:203], v[192:195], v[232:235]
    v_mfma_f32_16x16x32_bf16 v[236:239], v[206:209], v[196:199], v[236:239]
L_xwait:
    s_waitcnt vmcnt(0)
    v_cmp_ne_u32 vcc, -1, v8
    s_nop 0
    s_and_b32 s25, vcc_lo, s23
    s_andn2_b32 s23, s23, s25
    s_bitcmp1_b32 s25, 0
    s_cbranch_scc0 L_nxb0
    buffer_load_dwordx4 v[152:155], v11, s[28:31], s44 offen sc1
    buffer_load_dwordx4 v[156:159], v11, s[28:31], s44 offen offset:1024 sc1
    buffer_load_dwordx4 v[160:163], v11, s[28:31], s47 offen sc1
L_nxb0:
    s_bitcmp1_b32 s25, 1
    s_cbranch_scc0 L_nxb1
    buffer_load_dwordx4 v[164:167], v11, s[28:31], s45 offen sc1
    buffer_load_dwordx4 v[168:171], v11, s[28:31], s45 offen offset:1024 sc1
    buffer_load_dwordx4 v[172:175], v11, s[28:31], s48 offen sc1
L_nxb1:
    s_bitcmp1_b32 s25, 2
    s_cbranch_scc0 L_nxb2
    buffer_load_dwordx4 v[176:179], v11, s[28:31], s46 offen sc1
    buffer_load_dwordx4 v[180:183], v11, s[28:31], s46 offen offset:1024 sc1
    buffer_load_dwordx4 v[184:187], v11, s[28:31], s49 offen sc1
L_nxb2:
    s_cmp_eq_u32 s23, 0
    s_cbranch_scc1 L_xland
    buffer_load_dword v8, v18, s[28:31], s22 offen sc0 sc1
    s_sub_u32 s39, s39, 1
    s_cbranch_scc0 L_xwait
    s_branch L_xland
L_xagain:
    v_cmp_eq_u32 vcc, -1, v112
    s_nop 1
    s_cbranch_vccz L_nxc0
    buffer_load_dwordx4 v[152:155], v11, s[28:31], s44 offen sc1
    buffer_load_dwordx4 v[156:159], v11, s[28:31], s44 offen offset:1024 sc1
    buffer_load_dwordx4 v[160:163], v11, s[28:31], s47 offen sc1
L_nxc0:
    v_cmp_eq_u32 vcc, -1, v113
    s_nop 1
    s_cbranch_vccz L_nxc1
    buffer_load_dwordx4 v[164:167], v11, s[28:31], s45 offen sc1
    buffer_load_dwordx4 v[168:171], v11, s[28:31], s45 offen offset:1024 sc1
    buffer_load_dwordx4 v[172:175], v11, s[28:31], s48 offen sc1
L_nxc1:
    v_cmp_eq_u32 vcc, -1, v114
    s_nop 1
    s_cbranch_vccz L_nxc2
    buffer_load_dwordx4 v[176:179], v11, s[28:31], s46 offen sc1
    buffer_load_dwordx4 v[180:183], v11, s[28:31], s46 offen offset:1024 sc1
    buffer_load_dwordx4 v[184:187], v11, s[28:31], s49 offen sc1
L_nxc2:
    s_sub_u32 s39, s39, 1
L_xland:
    s_cmp_gt_i32 s39, 0
    s_cselect_b64 s[0:1], -1, 0
    s_waitcnt vmcnt(0)
    v_mfma_f32_16x16x32_bf16 v[132:135], v[202:205], v[152:155], v[220:223]
    v_max3_u32 v112, v152, v153, v154
    v_max3_u32 v112, v112, v155, v156
    v_mfma_f32_16x16x32_bf16 v[132:135], v[202:205], v[164:167], v[132:135]
    v_max3_u32 v112, v112, v157, v158
    v_max3_u32 v112, v112, v159, v160
    v_mfma_f32_16x16x32_bf16 v[132:135], v[202:205], v[176:179], v[132:135]
    v_max3_u32 v112, v112, v161, v162
    v_max_u32 v112, v112, v163
    v_mfma_f32_16x16x32_bf16 v[136:139], v[200:203], v[152:155], v[224:227]
    v_max3_u32 v113, v164, v165, v166
    v_max3_u32 v113, v113, v167, v168
    v_mfma_f32_16x16x32_bf16 v[136:139], v[200:203], v[164:167], v[136:139]
    v_max3_u32 v113, v113, v169, v170
    v_max3_u32 v113, v113, v171, v172
    v_mfma_f32_16x16x32_bf16 v[136:139], v[200:203], v[176:179], v[136:139]
    v_max3_u32 v113, v113, v173, v174
    v_max_u32 v113, v113, v175
    v_mfma_f32_16x16x32_bf16 v[140:143], v[202:205], v[156:159], v[228:231]
    v_max3_u32 v114, v176, v177, v178
    v_max3_u32 v114, v114, v179, v180
    v_mfma_f32_16x16x32_bf16 v[140:143], v[202:205], v[168:171], v[140:143]
    v_max3_u32 v114, v114, v181, v182
    v_max3_u32 v114, v114, v183, v184
    v_mfma_f32_16x16x32_bf16 v[140:143], v[202:205], v[180:183], v[140:143]
    v_max3_u32 v114, v114, v185, v186
    v_max_u32 v114, v114, v187
    v_mfma_f32_16x16x32_bf16 v[144:147], v[200:203], v[156:159], v[232:235]
    v_max3_u32 v115, v112, v113, v114
    v_cmp_eq_u32 vcc, -1, v115
    v_mfma_f32_16x16x32_bf16 v[144:147], v[200:203], v[168:171], v[144:147]
    s_and_b64 vcc, vcc, s[0:1]
    s_cbranch_scc1 L_xagain
    v_mfma_f32_16x16x32_bf16 v[144:147], v[200:203], v[180:183], v[144:147]
    v_mfma_f32_16x16x32_bf16 v[148:151], v[206:209], v[160:163], v[236:239]
    v_cvt_pk_bf16_f32 v132, v132, v133
    v_cvt_pk_bf16_f32 v133, v134, v135
    v_mfma_f32_16x16x32_bf16 v[148:151], v[206:209], v[172:175], v[148:151]
    v_cvt_pk_bf16_f32 v134, v136, v137
    v_cvt_pk_bf16_f32 v135, v138, v139
    v_mfma_f32_16x16x32_bf16 v[148:151], v[206:209], v[184:187], v[148:151]
    s_nop 0
    v_permlane16_swap_b32 v132, v134
    v_permlane16_swap_b32 v133, v135
    ds_bpermute_b32 v132, v28, v132
    ds_bpermute_b32 v133, v28, v133
    ds_bpermute_b32 v134, v28, v134
    ds_bpermute_b32 v135, v28, v135
    v_cvt_pk_bf16_f32 v140, v140, v141
    v_cvt_pk_bf16_f32 v141, v142, v143
    v_cvt_pk_bf16_f32 v142, v144, v145
    v_cvt_pk_bf16_f32 v143, v146, v147
    s_nop 1
    v_permlane16_swap_b32 v140, v142
    v_permlane16_swap_b32 v141, v143
    ds_bpermute_b32 v140, v28, v140
    ds_bpermute_b32 v141, v28, v141
    ds_bpermute_b32 v142, v28, v142
    ds_bpermute_b32 v143, v28, v143
    v_cvt_pk_bf16_f32 v148, v148, v149
    v_cvt_pk_bf16_f32 v149, v150, v151
    ds_bpermute_b32 v148, v29, v148
    ds_bpermute_b32 v149, v29, v149
    s_waitcnt lgkmcnt(6)
    buffer_store_dwordx4 v[132:135], v24, s[32:35], s24 offen offset:0
    s_waitcnt lgkmcnt(2)
    buffer_store_dwordx4 v[140:143], v24, s[32:35], s24 offen offset:64
    s_waitcnt lgkmcnt(0)
    buffer_store_dwordx2 v[148:149], v25, s[32:35], s24 offen offset:128
    s_endpgm
L_more:
    v_accvgpr_read_b32 v13, a85
    s_mov_b32 s85, 0
    v_xor_b32 v14, 32, v13
    s_lshl_b32 s0, s38, 2
    s_add_u32 s0, s0, s36
    s_sub_u32 s0, s0, 15
    s_add_u32 s65, s0, 895
    s_lshl_b32 s65, s65, 13
    s_add_u32 s62, s65, 4096
    s_mul_i32 s1, s0, 52
    s_lshr_b32 s1, s1, 8
    s_mul_i32 s1, s1, 39680
    s_lshl_b32 s0, s0, 8
    s_add_u32 s0, s0, s1
    s_add_u32 s64, s0, 2088960
    s_mov_b64 s[72:73], s[82:83]
    s_mov_b32 s74, 2211840
    s_sub_u32 s60, s39, 3
    s_add_u32 m0, s61, 0
    s_add_u32 s40, s64, 0
    buffer_load_dwordx4 v13, s[72:75], s40 offen offset:0 nt lds
    s_add_u32 s40, s64, 4096
    buffer_load_dwordx4 v14, s[72:75], s40 offen offset:1024 nt lds
    s_add_u32 s40, s64, 8192
    buffer_load_dwordx4 v13, s[72:75], s40 offen offset:2048 nt lds
    s_add_u32 s40, s64, 12288
    buffer_load_dwordx4 v14, s[72:75], s40 offen offset:3072 nt lds
    s_add_u32 m0, s61, 4096
    s_add_u32 s40, s64, 20480
    buffer_load_dwordx4 v13, s[72:75], s40 offen offset:0 nt lds
    s_add_u32 s40, s64, 24576
    buffer_load_dwordx4 v14, s[72:75], s40 offen offset:1024 nt lds
    s_add_u32 s40, s64, 28672
    buffer_load_dwordx4 v13, s[72:75], s40 offen offset:2048 nt lds
    s_add_u32 s40, s64, 32768
    buffer_load_dwordx4 v14, s[72:75], s40 offen offset:3072 nt lds
    s_branch L_loopA
L_slow:
    s_waitcnt vmcnt(0)
    s_mul_i32 s40, s37, 1081344
    s_add_u32 s4, s90, s40
    s_addc_u32 s5, s91, 0
    s_mov_b32 s6, 1081344
    v_mov_b64 v[128:129], 0
    v_mov_b64 v[130:131], 0
    v_mov_b64 v[132:133], 0
    v_mov_b64 v[134:135], 0
    v_mov_b64 v[136:137], 0
    v_mov_b64 v[138:139], 0
    v_mov_b64 v[140:141], 0
    v_mov_b64 v[142:143], 0
    v_mov_b64 v[144:145], 0
    v_mov_b64 v[146:147], 0
    v_mov_b64 v[148:149], 0
    v_mov_b64 v[150:151], 0
    v_mov_b64 v[152:153], 0
    v_mov_b64 v[154:155], 0
    v_mov_b64 v[156:157], 0
    v_mov_b64 v[158:159], 0
    v_mov_b64 v[160:161], 0
    v_mov_b64 v[162:163], 0
    v_mov_b64 v[164:165], 0
    v_mov_b64 v[166:167], 0
    v_mov_b64 v[168:169], 0
    v_mov_b64 v[170:171], 0
    v_mov_b64 v[172:173], 0
    v_mov_b64 v[174:175], 0
    v_mov_b64 v[176:177], 0
    v_mov_b64 v[178:179], 0
    v_mov_b64 v[180:181], 0
    v_mov_b64 v[182:183], 0
    v_mov_b64 v[184:185], 0
    v_mov_b64 v[186:187], 0
    v_mov_b64 v[188:189], 0
    v_mov_b64 v[190:191], 0
    v_mov_b64 v[192:193], 0
    v_mov_b64 v[194:195], 0
    v_mov_b64 v[196:197], 0
    v_mov_b64 v[198:199], 0
    v_mov_b64 v[200:201], 0
    v_mov_b64 v[202:203], 0
    v_mov_b64 v[204:205], 0
    v_mov_b64 v[206:207], 0
    v_mov_b64 v[208:209], 0
    v_mov_b64 v[210:211], 0
    v_mov_b64 v[212:213], 0
    v_mov_b64 v[214:215], 0
    v_mov_b64 v[216:217], 0
    v_mov_b64 v[218:219], 0
    v_mov_b64 v[220:221], 0
    v_mov_b64 v[222:223], 0
    v_mov_b64 v[224:225], 0
    v_mov_b64 v[226:227], 0
    v_mov_b64 v[228:229], 0
    v_mov_b64 v[230:231], 0
    v_mov_b64 v[232:233], 0
    v_mov_b64 v[234:235], 0
    v_mov_b64 v[236:237], 0
    v_mov_b64 v[238:239], 0
    v_mov_b64 v[240:241], 0
    v_mov_b64 v[242:243], 0
    v_mov_b64 v[244:245], 0
    v_mov_b64 v[246:247], 0
    v_mov_b64 v[248:249], 0
    v_mov_b64 v[250:251], 0
    v_mov_b64 v[252:253], 0
    v_mov_b64 v[254:255], 0
    v_accvgpr_write_b32 a64, 0
    v_accvgpr_write_b32 a65, 0
    v_accvgpr_write_b32 a66, 0
    v_accvgpr_write_b32 a67, 0
    v_accvgpr_write_b32 a68, 0
    v_accvgpr_write_b32 a69, 0
    v_accvgpr_write_b32 a70, 0
    v_accvgpr_write_b32 a71, 0
    v_mov_b32 v96, 0
    v_mov_b32 v97, 0
    v_mov_b32 v98, 0
    v_mov_b32 v99, 0
    v_mov_b32 v100, 0
    v_mov_b32 v101, 0
    v_mov_b32 v102, 0
    v_mov_b32 v103, 0
    v_mov_b32 v104, 0
    v_mov_b32 v105, 0
    v_mov_b32 v106, 0
    v_mov_b32 v107, 0
    v_mov_b32 v108, 0
    v_mov_b32 v109, 0
    v_mov_b32 v110, 0
    v_mov_b32 v111, 0
    v_mov_b32 v112, v5
    v_mov_b32 v113, v5
    v_mov_b32 v114, v5
    v_mov_b32 v115, v5
    v_subrev_u32 v14, s36, v3
    s_mul_i32 s40, s36, 15
    v_subrev_u32 v14, s40, v14
    s_mov_b32 s56, 0
    s_lshl_b32 s59, s38, 2
    s_sub_u32 s59, 64, s59
L_slow_pass:
    s_mov_b32 s57, 0
L_slow_step:
    s_lshl_b32 s58, s57, 14
    s_add_u32 s58, s58, 8192
    buffer_load_dwordx4 a[0:3], v11, s[4:7], s58 offen offset:0 sc1
    buffer_load_dwordx4 a[4:7], v11, s[4:7], s58 offen offset:1024 sc1
    buffer_load_dwordx4 a[8:11], v11, s[4:7], s58 offen offset:2048 sc1
    buffer_load_dwordx4 a[12:15], v11, s[4:7], s58 offen offset:3072 sc1
    s_add_u32 s58, s58, 4096
    buffer_load_dwordx4 a[16:19], v11, s[4:7], s58 offen offset:0 sc1
    buffer_load_dwordx4 a[20:23], v11, s[4:7], s58 offen offset:1024 sc1
    buffer_load_dwordx4 a[24:27], v11, s[4:7], s58 offen offset:2048 sc1
    buffer_load_dwordx4 a[28:31], v11, s[4:7], s58 offen offset:3072 sc1
    s_add_u32 s58, s58, 20480
    buffer_load_dwordx4 a[32:35], v11, s[4:7], s58 offen offset:0 sc1
    buffer_load_dwordx4 a[36:39], v11, s[4:7], s58 offen offset:1024 sc1
    buffer_load_dwordx4 a[40:43], v11, s[4:7], s58 offen offset:2048 sc1
    buffer_load_dwordx4 a[44:47], v11, s[4:7], s58 offen offset:3072 sc1
    s_add_u32 s58, s58, 4096
    buffer_load_dwordx4 a[48:51], v11, s[4:7], s58 offen offset:0 sc1
    buffer_load_dwordx4 a[52:55], v11, s[4:7], s58 offen offset:1024 sc1
    buffer_load_dwordx4 a[56:59], v11, s[4:7], s58 offen offset:2048 sc1
    buffer_load_dwordx4 a[60:63], v11, s[4:7], s58 offen offset:3072 sc1
    s_lshl_b32 s41, s57, 5
    s_lshl_b32 s40, s52, 4
    s_sub_u32 s40, s40, s41
    v_add_u32 v15, s40, v14
    v_cmp_gt_i32 s[44:45], 0, v15
    v_cmp_gt_i32 s[46:47], 1, v15
    v_cmp_gt_i32 s[48:49], 2, v15
    v_cmp_gt_i32 s[50:51], 3, v15
    v_cndmask_b32 v32, v96, v5, s[44:45]
    v_cndmask_b32 v33, v96, v5, s[46:47]
    v_cndmask_b32 v34, v96, v5, s[48:49]
    v_cndmask_b32 v35, v96, v5, s[50:51]
    v_cmp_gt_i32 s[44:45], 16, v15
    v_cmp_gt_i32 s[46:47], 17, v15
    v_cmp_gt_i32 s[48:49], 18, v15
    v_cmp_gt_i32 s[50:51], 19, v15
    v_cndmask_b32 v48, v96, v5, s[44:45]
    v_cndmask_b32 v49, v96, v5, s[46:47]
    v_cndmask_b32 v50, v96, v5, s[48:49]
    v_cndmask_b32 v51, v96, v5, s[50:51]
    s_lshl_b32 s40, s53, 4
    s_sub_u32 s40, s40, s41
    v_add_u32 v15, s40, v14
    v_cmp_gt_i32 s[44:45], 0, v15
    v_cmp_gt_i32 s[46:47], 1, v15
    v_cmp_gt_i32 s[48:49], 2, v15
    v_cmp_gt_i32 s[50:51], 3, v15
    v_cndmask_b32 v36, v100, v5, s[44:45]
    v_cndmask_b32 v37, v100, v5, s[46:47]
    v_cndmask_b32 v38, v100, v5, s[48:49]
    v_cndmask_b32 v39, v100, v5, s[50:51]
    v_cmp_gt_i32 s[44:45], 16, v15
    v_cmp_gt_i32 s[46:47], 17, v15
    v_cmp_gt_i32 s[48:49], 18, v15
    v_cmp_gt_i32 s[50:51], 19, v15
    v_cndmask_b32 v52, v100, v5, s[44:45]
    v_cndmask_b32 v53, v100, v5, s[46:47]
    v_cndmask_b32 v54, v100, v5, s[48:49]
    v_cndmask_b32 v55, v100, v5, s[50:51]
    s_lshl_b32 s40, s54, 4
    s_sub_u32 s40, s40, s41
    v_add_u32 v15, s40, v14
    v_cmp_gt_i32 s[44:45], 0, v15
    v_cmp_gt_i32 s[46:47], 1, v15
    v_cmp_gt_i32 s[48:49], 2, v15
    v_cmp_gt_i32 s[50:51], 3, v15
    v_cndmask_b32 v40, v104, v5, s[44:45]
    v_cndmask_b32 v41, v104, v5, s[46:47]
    v_cndmask_b32 v42, v104, v5, s[48:49]
    v_cndmask_b32 v43, v104, v5, s[50:51]
    v_cmp_gt_i32 s[44:45], 16, v15
    v_cmp_gt_i32 s[46:47], 17, v15
    v_cmp_gt_i32 s[48:49], 18, v15
    v_cmp_gt_i32 s[50:51], 19, v15
    v_cndmask_b32 v56, v104, v5, s[44:45]
    v_cndmask_b32 v57, v104, v5, s[46:47]
    v_cndmask_b32 v58, v104, v5, s[48:49]
    v_cndmask_b32 v59, v104, v5, s[50:51]
    s_lshl_b32 s40, s55, 4
    s_sub_u32 s40, s40, s41
    v_add_u32 v15, s40, v14
    v_cmp_gt_i32 s[44:45], 0, v15
    v_cmp_gt_i32 s[46:47], 1, v15
    v_cmp_gt_i32 s[48:49], 2, v15
    v_cmp_gt_i32 s[50:51], 3, v15
    v_cndmask_b32 v44, v108, v5, s[44:45]
    v_cndmask_b32 v45, v108, v5, s[46:47]
    v_cndmask_b32 v46, v108, v5, s[48:49]
    v_cndmask_b32 v47, v108, v5, s[50:51]
    v_cmp_gt_i32 s[44:45], 16, v15
    v_cmp_gt_i32 s[46:47], 17, v15
    v_cmp_gt_i32 s[48:49], 18, v15
    v_cmp_gt_i32 s[50:51], 19, v15
    v_cndmask_b32 v60, v108, v5, s[44:45]
    v_cndmask_b32 v61, v108, v5, s[46:47]
    v_cndmask_b32 v62, v108, v5, s[48:49]
    v_cndmask_b32 v63, v108, v5, s[50:51]
    s_waitcnt vmcnt(0)
    v_mfma_f32_16x16x32_bf16 v[32:35], a[0:3], a[128:131], v[32:35]
    v_mfma_f32_16x16x32_bf16 v[32:35], a[4:7], a[132:135], v[32:35]
    v_mfma_f32_16x16x32_bf16 v[32:35], a[8:11], a[136:139], v[32:35]
    v_mfma_f32_16x16x32_bf16 v[32:35], a[12:15], a[140:143], v[32:35]
    v_mfma_f32_16x16x32_bf16 v[36:39], a[0:3], a[144:147], v[36:39]
    v_mfma_f32_16x16x32_bf16 v[36:39], a[4:7], a[148:151], v[36:39]
    v_mfma_f32_16x16x32_bf16 v[36:39], a[8:11], a[152:155], v[36:39]
    v_mfma_f32_16x16x32_bf16 v[36:39], a[12:15], a[156:159], v[36:39]
    v_mfma_f32_16x16x32_bf16 v[40:43], a[0:3], a[160:163], v[40:43]
    v_mfma_f32_16x16x32_bf16 v[40:43], a[4:7], a[164:167], v[40:43]
    v_mfma_f32_16x16x32_bf16 v[40:43], a[8:11], a[168:171], v[40:43]
    v_mfma_f32_16x16x32_bf16 v[40:43], a[12:15], a[172:175], v[40:43]
    v_mfma_f32_16x16x32_bf16 v[44:47], a[0:3], a[176:179], v[44:47]
    v_mfma_f32_16x16x32_bf16 v[44:47], a[4:7], a[180:183], v[44:47]
    v_mfma_f32_16x16x32_bf16 v[44:47], a[8:11], a[184:187], v[44:47]
    v_mfma_f32_16x16x32_bf16 v[44:47], a[12:15], a[188:191], v[44:47]
    v_mfma_f32_16x16x32_bf16 v[48:51], a[16:19], a[128:131], v[48:51]
    v_mfma_f32_16x16x32_bf16 v[48:51], a[20:23], a[132:135], v[48:51]
    v_mfma_f32_16x16x32_bf16 v[48:51], a[24:27], a[136:139], v[48:51]
    v_mfma_f32_16x16x32_bf16 v[48:51], a[28:31], a[140:143], v[48:51]
    v_mfma_f32_16x16x32_bf16 v[52:55], a[16:19], a[144:147], v[52:55]
    v_mfma_f32_16x16x32_bf16 v[52:55], a[20:23], a[148:151], v[52:55]
    v_mfma_f32_16x16x32_bf16 v[52:55], a[24:27], a[152:155], v[52:55]
    v_mfma_f32_16x16x32_bf16 v[52:55], a[28:31], a[156:159], v[52:55]
    v_mfma_f32_16x16x32_bf16 v[56:59], a[16:19], a[160:163], v[56:59]
    v_mfma_f32_16x16x32_bf16 v[56:59], a[20:23], a[164:167], v[56:59]
    v_mfma_f32_16x16x32_bf16 v[56:59], a[24:27], a[168:171], v[56:59]
    v_mfma_f32_16x16x32_bf16 v[56:59], a[28:31], a[172:175], v[56:59]
    v_mfma_f32_16x16x32_bf16 v[60:63], a[16:19], a[176:179], v[60:63]
    v_mfma_f32_16x16x32_bf16 v[60:63], a[20:23], a[180:183], v[60:63]
    v_mfma_f32_16x16x32_bf16 v[60:63], a[24:27], a[184:187], v[60:63]
    v_mfma_f32_16x16x32_bf16 v[60:63], a[28:31], a[188:191], v[60:63]
    s_nop 7
    s_cmp_eq_u32 s56, 0
    s_cbranch_scc0 L_slow_pv
    v_max3_f32 v112, v112, v32, v33
    v_max3_f32 v112, v112, v34, v35
    v_max3_f32 v112, v112, v48, v49
    v_max3_f32 v112, v112, v50, v51
    v_max3_f32 v113, v113, v36, v37
    v_max3_f32 v113, v113, v38, v39
    v_max3_f32 v113, v113, v52, v53
    v_max3_f32 v113, v113, v54, v55
    v_max3_f32 v114, v114, v40, v41
    v_max3_f32 v114, v114, v42, v43
    v_max3_f32 v114, v114, v56, v57
    v_max3_f32 v114, v114, v58, v59
    v_max3_f32 v115, v115, v44, v45
    v_max3_f32 v115, v115, v46, v47
    v_max3_f32 v115, v115, v60, v61
    v_max3_f32 v115, v115, v62, v63
    s_branch L_slow_next
L_slow_pv:
    v_exp_f32 v32, v32
    v_exp_f32 v33, v33
    v_exp_f32 v34, v34
    v_exp_f32 v35, v35
    v_exp_f32 v36, v36
    v_exp_f32 v37, v37
    v_exp_f32 v38, v38
    v_exp_f32 v39, v39
    v_exp_f32 v40, v40
    v_exp_f32 v41, v41
    v_exp_f32 v42, v42
    v_exp_f32 v43, v43
    v_exp_f32 v44, v44
    v_exp_f32 v45, v45
    v_exp_f32 v46, v46
    v_exp_f32 v47, v47
    v_exp_f32 v48, v48
    v_exp_f32 v49, v49
    v_exp_f32 v50, v50
    v_exp_f32 v51, v51
    v_exp_f32 v52, v52
    v_exp_f32 v53, v53
    v_exp_f32 v54, v54
    v_exp_f32 v55, v55
    v_exp_f32 v56, v56
    v_exp_f32 v57, v57
    v_exp_f32 v58, v58
    v_exp_f32 v59, v59
    v_exp_f32 v60, v60
    v_exp_f32 v61, v61
    v_exp_f32 v62, v62
    v_exp_f32 v63, v63
    v_cvt_pk_bf16_f32 v64, v32, v33
    v_cvt_pk_bf16_f32 v65, v34, v35
    v_cvt_pk_bf16_f32 v68, v36, v37
    v_cvt_pk_bf16_f32 v69, v38, v39
    v_cvt_pk_bf16_f32 v72, v40, v41
    v_cvt_pk_bf16_f32 v73, v42, v43
    v_cvt_pk_bf16_f32 v76, v44, v45
    v_cvt_pk_bf16_f32 v77, v46, v47
    v_cvt_pk_bf16_f32 v66, v48, v49
    v_cvt_pk_bf16_f32 v67, v50, v51
    v_cvt_pk_bf16_f32 v70, v52, v53
    v_cvt_pk_bf16_f32 v71, v54, v55
    v_cvt_pk_bf16_f32 v74, v56, v57
    v_cvt_pk_bf16_f32 v75, v58, v59
    v_cvt_pk_bf16_f32 v78, v60, v61
    v_cvt_pk_bf16_f32 v79, v62, v63
    s_nop 1
    v_mfma_f32_16x16x32_bf16 v[128:131], a[32:35], v[64:67], v[128:131]
    v_mfma_f32_16x16x32_bf16 v[160:163], a[32:35], v[68:71], v[160:163]
    v_mfma_f32_16x16x32_bf16 v[192:195], a[32:35], v[72:75], v[192:195]
    v_mfma_f32_16x16x32_bf16 v[224:227], a[32:35], v[76:79], v[224:227]
    v_mfma_f32_16x16x32_bf16 v[228:231], a[36:39], v[76:79], v[228:231]
    v_mfma_f32_16x16x32_bf16 v[196:199], a[36:39], v[72:75], v[196:199]
    v_mfma_f32_16x16x32_bf16 v[164:167], a[36:39], v[68:71], v[164:167]
    v_mfma_f32_16x16x32_bf16 v[132:135], a[36:39], v[64:67], v[132:135]
    v_mfma_f32_16x16x32_bf16 v[136:139], a[40:43], v[64:67], v[136:139]
    v_mfma_f32_16x16x32_bf16 v[168:171], a[40:43], v[68:71], v[168:171]
    v_mfma_f32_16x16x32_bf16 v[200:203], a[40:43], v[72:75], v[200:203]
    v_mfma_f32_16x16x32_bf16 v[232:235], a[40:43], v[76:79], v[232:235]
    v_smfmac_f32_16x16x64_bf16 a[68:71], a[80:83], v[72:79], v6
    v_mfma_f32_16x16x32_bf16 v[236:239], a[44:47], v[76:79], v[236:239]
    v_mfma_f32_16x16x32_bf16 v[204:207], a[44:47], v[72:75], v[204:207]
    v_mfma_f32_16x16x32_bf16 v[172:175], a[44:47], v[68:71], v[172:175]
    v_mfma_f32_16x16x32_bf16 v[140:143], a[44:47], v[64:67], v[140:143]
    v_mfma_f32_16x16x32_bf16 v[144:147], a[48:51], v[64:67], v[144:147]
    v_mfma_f32_16x16x32_bf16 v[176:179], a[48:51], v[68:71], v[176:179]
    v_mfma_f32_16x16x32_bf16 v[208:211], a[48:51], v[72:75], v[208:211]
    v_mfma_f32_16x16x32_bf16 v[240:243], a[48:51], v[76:79], v[240:243]
    v_mfma_f32_16x16x32_bf16 v[244:247], a[52:55], v[76:79], v[244:247]
    v_mfma_f32_16x16x32_bf16 v[212:215], a[52:55], v[72:75], v[212:215]
    v_mfma_f32_16x16x32_bf16 v[180:183], a[52:55], v[68:71], v[180:183]
    v_mfma_f32_16x16x32_bf16 v[148:151], a[52:55], v[64:67], v[148:151]
    v_smfmac_f32_16x16x64_bf16 a[64:67], a[80:83], v[64:71], v6
    v_mfma_f32_16x16x32_bf16 v[152:155], a[56:59], v[64:67], v[152:155]
    v_mfma_f32_16x16x32_bf16 v[184:187], a[56:59], v[68:71], v[184:187]
    v_mfma_f32_16x16x32_bf16 v[216:219], a[56:59], v[72:75], v[216:219]
    v_mfma_f32_16x16x32_bf16 v[248:251], a[56:59], v[76:79], v[248:251]
    v_mfma_f32_16x16x32_bf16 v[252:255], a[60:63], v[76:79], v[252:255]
    v_mfma_f32_16x16x32_bf16 v[220:223], a[60:63], v[72:75], v[220:223]
    v_mfma_f32_16x16x32_bf16 v[188:191], a[60:63], v[68:71], v[188:191]
    v_mfma_f32_16x16x32_bf16 v[156:159], a[60:63], v[64:67], v[156:159]
    s_nop 7
L_slow_next:
    s_add_u32 s57, s57, 1
    s_cmp_lt_u32 s57, s59
    s_cbranch_scc1 L_slow_step
    s_cmp_eq_u32 s56, 0
    s_cbranch_scc0 L_slow_end
    v_mov_b32 v116, v112
    s_nop 1
    v_permlane16_swap_b32 v112, v116
    v_max_f32 v112, v112, v116
    v_mov_b32 v116, v112
    s_nop 1
    v_permlane32_swap_b32 v112, v116
    v_max_f32 v112, v112, v116
    v_sub_f32 v96, 0, v112
    v_mov_b32 v116, v113
    s_nop 1
    v_permlane16_swap_b32 v113, v116
    v_max_f32 v113, v113, v116
    v_mov_b32 v116, v113
    s_nop 1
    v_permlane32_swap_b32 v113, v116
    v_max_f32 v113, v113, v116
    v_sub_f32 v100, 0, v113
    v_mov_b32 v116, v114
    s_nop 1
    v_permlane16_swap_b32 v114, v116
    v_max_f32 v114, v114, v116
    v_mov_b32 v116, v114
    s_nop 1
    v_permlane32_swap_b32 v114, v116
    v_max_f32 v114, v114, v116
    v_sub_f32 v104, 0, v114
    v_mov_b32 v116, v115
    s_nop 1
    v_permlane16_swap_b32 v115, v116
    v_max_f32 v115, v115, v116
    v_mov_b32 v116, v115
    s_nop 1
    v_permlane32_swap_b32 v115, v116
    v_max_f32 v115, v115, v116
    v_sub_f32 v108, 0, v115
    s_mov_b32 s56, 1
    s_branch L_slow_pass
L_slow_end:
    s_lshl_b32 s42, s37, 19
    s_add_u32 s42, s42, 36700160
    v_accvgpr_read_b32 v100, a64
    v_accvgpr_read_b32 v101, a65
    v_accvgpr_read_b32 v102, a66
    v_accvgpr_read_b32 v103, a67
    v_add_f32 v100, v100, v101
    v_add_f32 v102, v102, v103
    v_rcp_f32 v100, v100
    v_rcp_f32 v102, v102
    s_nop 0
    v_mul_f32 v100, v100, v8
    v_mul_f32 v102, v102, v9
    s_lshl_b32 s43, s52, 10
    s_add_u32 s43, s43, s42
    v_pk_mul_f32 v[128:129], v[128:129], v[100:101] op_sel_hi:[1,0]
    v_pk_mul_f32 v[130:131], v[130:131], v[100:101] op_sel_hi:[1,0]
    v_pk_mul_f32 v[132:133], v[132:133], v[100:101] op_sel_hi:[1,0]
    v_pk_mul_f32 v[134:135], v[134:135], v[100:101] op_sel_hi:[1,0]
    v_cvt_pk_bf16_f32 v128, v128, v129
    v_cvt_pk_bf16_f32 v129, v130, v131
    v_cvt_pk_bf16_f32 v130, v132, v133
    v_cvt_pk_bf16_f32 v131, v134, v135
    buffer_store_dwordx4 v[128:131], v11, s[28:31], s43 offen sc1
    s_add_u32 s43, s43, 131072
    v_pk_mul_f32 v[136:137], v[136:137], v[100:101] op_sel_hi:[1,0]
    v_pk_mul_f32 v[138:139], v[138:139], v[100:101] op_sel_hi:[1,0]
    v_pk_mul_f32 v[140:141], v[140:141], v[100:101] op_sel_hi:[1,0]
    v_pk_mul_f32 v[142:143], v[142:143], v[100:101] op_sel_hi:[1,0]
    v_cvt_pk_bf16_f32 v136, v136, v137
    v_cvt_pk_bf16_f32 v137, v138, v139
    v_cvt_pk_bf16_f32 v138, v140, v141
    v_cvt_pk_bf16_f32 v139, v142, v143
    buffer_store_dwordx4 v[136:139], v11, s[28:31], s43 offen sc1
    s_add_u32 s43, s43, 131072
    v_pk_mul_f32 v[144:145], v[144:145], v[100:101] op_sel_hi:[1,0]
    v_pk_mul_f32 v[146:147], v[146:147], v[100:101] op_sel_hi:[1,0]
    v_pk_mul_f32 v[148:149], v[148:149], v[100:101] op_sel_hi:[1,0]
    v_pk_mul_f32 v[150:151], v[150:151], v[100:101] op_sel_hi:[1,0]
    v_cvt_pk_bf16_f32 v144, v144, v145
    v_cvt_pk_bf16_f32 v145, v146, v147
    v_cvt_pk_bf16_f32 v146, v148, v149
    v_cvt_pk_bf16_f32 v147, v150, v151
    buffer_store_dwordx4 v[144:147], v11, s[28:31], s43 offen sc1
    s_add_u32 s43, s43, 131072
    v_pk_mul_f32 v[152:153], v[152:153], v[100:101] op_sel_hi:[1,0]
    v_pk_mul_f32 v[154:155], v[154:155], v[100:101] op_sel_hi:[1,0]
    v_pk_mul_f32 v[156:157], v[156:157], v[100:101] op_sel_hi:[1,0]
    v_pk_mul_f32 v[158:159], v[158:159], v[100:101] op_sel_hi:[1,0]
    v_cvt_pk_bf16_f32 v152, v152, v153
    v_cvt_pk_bf16_f32 v153, v154, v155
    v_cvt_pk_bf16_f32 v154, v156, v157
    v_cvt_pk_bf16_f32 v155, v158, v159
    buffer_store_dwordx4 v[152:155], v11, s[28:31], s43 offen sc1
    s_lshl_b32 s43, s53, 10
    s_add_u32 s43, s43, s42
    v_pk_mul_f32 v[160:161], v[160:161], v[102:103] op_sel_hi:[1,0]
    v_pk_mul_f32 v[162:163], v[162:163], v[102:103] op_sel_hi:[1,0]
    v_pk_mul_f32 v[164:165], v[164:165], v[102:103] op_sel_hi:[1,0]
    v_pk_mul_f32 v[166:167], v[166:167], v[102:103] op_sel_hi:[1,0]
    v_cvt_pk_bf16_f32 v160, v160, v161
    v_cvt_pk_bf16_f32 v161, v162, v163
    v_cvt_pk_bf16_f32 v162, v164, v165
    v_cvt_pk_bf16_f32 v163, v166, v167
    buffer_store_dwordx4 v[160:163], v11, s[28:31], s43 offen sc1
    s_add_u32 s43, s43, 131072
    v_pk_mul_f32 v[168:169], v[168:169], v[102:103] op_sel_hi:[1,0]
    v_pk_mul_f32 v[170:171], v[170:171], v[102:103] op_sel_hi:[1,0]
    v_pk_mul_f32 v[172:173], v[172:173], v[102:103] op_sel_hi:[1,0]
    v_pk_mul_f32 v[174:175], v[174:175], v[102:103] op_sel_hi:[1,0]
    v_cvt_pk_bf16_f32 v168, v168, v169
    v_cvt_pk_bf16_f32 v169, v170, v171
    v_cvt_pk_bf16_f32 v170, v172, v173
    v_cvt_pk_bf16_f32 v171, v174, v175
    buffer_store_dwordx4 v[168:171], v11, s[28:31], s43 offen sc1
    s_add_u32 s43, s43, 131072
    v_pk_mul_f32 v[176:177], v[176:177], v[102:103] op_sel_hi:[1,0]
    v_pk_mul_f32 v[178:179], v[178:179], v[102:103] op_sel_hi:[1,0]
    v_pk_mul_f32 v[180:181], v[180:181], v[102:103] op_sel_hi:[1,0]
    v_pk_mul_f32 v[182:183], v[182:183], v[102:103] op_sel_hi:[1,0]
    v_cvt_pk_bf16_f32 v176, v176, v177
    v_cvt_pk_bf16_f32 v177, v178, v179
    v_cvt_pk_bf16_f32 v178, v180, v181
    v_cvt_pk_bf16_f32 v179, v182, v183
    buffer_store_dwordx4 v[176:179], v11, s[28:31], s43 offen sc1
    s_add_u32 s43, s43, 131072
    v_pk_mul_f32 v[184:185], v[184:185], v[102:103] op_sel_hi:[1,0]
    v_pk_mul_f32 v[186:187], v[186:187], v[102:103] op_sel_hi:[1,0]
    v_pk_mul_f32 v[188:189], v[188:189], v[102:103] op_sel_hi:[1,0]
    v_pk_mul_f32 v[190:191], v[190:191], v[102:103] op_sel_hi:[1,0]
    v_cvt_pk_bf16_f32 v184, v184, v185
    v_cvt_pk_bf16_f32 v185, v186, v187
    v_cvt_pk_bf16_f32 v186, v188, v189
    v_cvt_pk_bf16_f32 v187, v190, v191
    buffer_store_dwordx4 v[184:187], v11, s[28:31], s43 offen sc1
    s_waitcnt vmcnt(0)
    s_branch L_attn_fin
L_code_end:
.p2align 12
.section .rodata,"a"
.p2align 6
.amdhsa_kernel gated_mix__compressed_kv_cla__dense_activation_mish__prompt_kernel
  .amdhsa_next_free_vgpr 512
  .amdhsa_next_free_sgpr 102
  .amdhsa_accum_offset 256
  .amdhsa_group_segment_fixed_size 0
  .amdhsa_kernarg_size 112
  .amdhsa_user_sgpr_count 2
  .amdhsa_user_sgpr_kernarg_segment_ptr 1
  .amdhsa_system_sgpr_workgroup_id_x 1
.end_amdhsa_kernel
```
